```python
import torch

def _softmax(x, axis=-1):
    return torch.softmax(x, dim=axis)
def _gelu(x):
    return torch.nn.functional.gelu(x, approximate="tanh")
def _silu(x):
    return torch.nn.functional.silu(x)
def _sigmoid(x):
    return torch.sigmoid(x)
def _layernorm(x, axis=-1, eps=1e-5):
    m = x.mean(dim=axis, keepdim=True)
    v = x.var(dim=axis, keepdim=True, unbiased=False)
    return (x - m) / torch.sqrt(v + eps)
def _scatter_add(tgt, idx, src, axis=0):
    return tgt.clone().index_add_(axis, idx, src)
def _segment_sum(src, seg, n):
    out = torch.zeros((n,) + src.shape[1:], dtype=src.dtype)
    return out.index_add_(0, seg, src)
def _pad(x, pw):
    flat = tuple(v for pair in reversed(pw) for v in pair)
    return torch.nn.functional.pad(x, flat)

kernel_name = 'concat_heads__mha_block_cached__mha_block_cached__near_ridge'

def setup_inputs():

    _w = (lambda a: (lambda t: t.to(torch.bfloat16) if t.is_floating_point() else t)(torch.as_tensor(a)))
    def _A_setup():
        B, Sq, D = 16, 192, 640
        H, Sk, Dh = 32, 512, 128
        return {
            "x": _w((lambda *s: torch.randn(*s, dtype=torch.bfloat16) * 0.8)(B, Sq, D)),
            "k_cache": _w((lambda *s: torch.randn(*s, dtype=torch.bfloat16) * 0.8)(B, H, Sk, Dh)),
            "v_cache": _w((lambda *s: torch.randn(*s, dtype=torch.bfloat16) * 0.05)(B, H, Sk, Dh)),
            "wq": _w((lambda *s: torch.randn(*s, dtype=torch.bfloat16) * 0.8)(D, H * Dh) * (D ** -0.5)),
            "wo": _w((lambda *s: torch.randn(*s, dtype=torch.bfloat16) * 0.05)(H * Dh, D) * ((H * Dh) ** -0.5)),
        }
    _A_in = _A_setup()

    def _B_setup():
        B, Sq, D = 16, 192, 640
        H, Sk, Dh = 32, 512, 128
        return {
            "x": _w((lambda *s: torch.randn(*s, dtype=torch.bfloat16) * 0.8)(B, Sq, D)),
            "k_cache": _w((lambda *s: torch.randn(*s, dtype=torch.bfloat16) * 0.8)(B, H, Sk, Dh)),
            "v_cache": _w((lambda *s: torch.randn(*s, dtype=torch.bfloat16) * 0.05)(B, H, Sk, Dh)),
            "wq": _w((lambda *s: torch.randn(*s, dtype=torch.bfloat16) * 0.8)(D, H * Dh) * (D ** -0.5)),
            "wo": _w((lambda *s: torch.randn(*s, dtype=torch.bfloat16) * 0.05)(H * Dh, D) * ((H * Dh) ** -0.5)),
        }
    _B_in = _B_setup()

    return {
        "A_x": _A_in["x"],
        "A_k_cache": _A_in["k_cache"],
        "A_v_cache": _A_in["v_cache"],
        "A_wq": _A_in["wq"],
        "A_wo": _A_in["wo"],
        "B_x": _B_in["x"],
        "B_k_cache": _B_in["k_cache"],
        "B_v_cache": _B_in["v_cache"],
        "B_wq": _B_in["wq"],
        "B_wo": _B_in["wo"],
    }

def reference(A_x, A_k_cache, A_v_cache, A_wq, A_wo, B_x, B_k_cache, B_v_cache, B_wq, B_wo):
    def _A_ref(x, k_cache, v_cache, wq, wo):
        B, Sq, D = x.shape
        H, Dh = 32, 128
        q = (lambda x, *d: x.permute(*d))((x @ wq).reshape(B, Sq, H, Dh), 0, 2, 1, 3)
        scores = torch.einsum("bhqd,bhkd->bhqk", q, k_cache) * (Dh ** -0.5)
        p = _softmax(scores, axis=-1)
        o = torch.einsum("bhqk,bhkd->bhqd", p, v_cache)
        return (lambda x, *d: x.permute(*d))(o, 0, 2, 1, 3).reshape(B, Sq, H * Dh) @ wo

    def _B_ref(x, k_cache, v_cache, wq, wo):
        B, Sq, D = x.shape
        H, Dh = 32, 128
        q = (lambda x, *d: x.permute(*d))((x @ wq).reshape(B, Sq, H, Dh), 0, 2, 1, 3)
        scores = torch.einsum("bhqd,bhkd->bhqk", q, k_cache) * (Dh ** -0.5)
        p = _softmax(scores, axis=-1)
        o = torch.einsum("bhqk,bhkd->bhqd", p, v_cache)
        return (lambda x, *d: x.permute(*d))(o, 0, 2, 1, 3).reshape(B, Sq, H * Dh) @ wo

    a = _A_ref(A_x, A_k_cache, A_v_cache, A_wq, A_wo)
    b = _B_ref(B_x, B_k_cache, B_v_cache, B_wq, B_wo)
    return torch.concatenate([a, b], axis=-1)
```

```asm
; @launch grid=(256,1,1) block=(256,1,1) lds=163840
.amdgcn_target "amdgcn-amd-amdhsa--gfx950"
.text
.globl concat_heads__mha_block_cached__mha_block_cached__near_ridge_kernel
.p2align 8
.type concat_heads__mha_block_cached__mha_block_cached__near_ridge_kernel,@function
concat_heads__mha_block_cached__mha_block_cached__near_ridge_kernel:
    s_cmp_ge_u32 s2, 256
    s_cbranch_scc1 L_end
    v_lshrrev_b32 v2, 6, v0
    v_and_b32 v1, 63, v0
    s_and_b32 s52, s2, 7
    v_readfirstlane_b32 s4, v2
    s_lshr_b32 s53, s2, 3
    s_lshr_b32 s54, s53, 3
    s_lshl_b32 s36, s52, 2
    s_add_u32 s36, s36, s54
    s_and_b32 s37, s53, 7
    s_lshr_b32 s55, s36, 4
    s_and_b32 s56, s36, 15
    s_and_b32 s87, s36, 0
    s_min_u32 s87, s87, 1
    s_lshr_b32 s5, s4, 1
    s_and_b32 s6, s4, 1
    s_mul_i32 s57, s55, 40
    s_add_u32 s58, s0, s57
    s_addc_u32 s59, s1, 0
    s_load_dwordx2 s[8:9], s[58:59], 0
    s_load_dwordx4 s[72:75], s[58:59], 8
    s_load_dwordx2 s[12:13], s[58:59], 24
    s_load_dwordx2 s[60:61], s[58:59], 32
    s_load_dwordx2 s[28:29], s[0:1], 80
    s_load_dwordx2 s[32:33], s[0:1], 88
    s_load_dwordx2 s[20:21], s[0:1], 96
    s_getpc_b64 s[64:65]
L_pc:
    s_sub_u32 s64, s64, L_pc-concat_heads__mha_block_cached__mha_block_cached__near_ridge_kernel
    s_subb_u32 s65, s65, 0
    s_mov_b32 s66, L_codeend-concat_heads__mha_block_cached__mha_block_cached__near_ridge_kernel
    s_mov_b32 s67, 0x20000
    s_lshr_b32 s53, s2, 3
    s_lshl_b32 s53, s53, 2
    s_add_u32 s53, s53, s4
    s_mul_i32 s86, s53, 640
    v_lshlrev_b32 v58, 7, v1
    v_bfrev_b32 v59, 1
    v_cmp_gt_u32 vcc, 5, v1
    s_nop 1
    v_cndmask_b32 v58, v59, v58, vcc
    buffer_load_dword v0, v58, s[64:67], s86 offen
    v_lshrrev_b32 v40, 4, v1
    v_and_b32 v41, 15, v1
    v_lshrrev_b32 v42, 2, v1
    v_and_b32 v43, 3, v1
    v_bfe_u32 v44, v1, 2, 2
    v_lshrrev_b32 v46, 3, v1
    v_and_b32 v45, 6, v46
    v_and_b32 v47, 7, v1
    v_xor_b32 v45, v45, v47
    v_lshlrev_b32 v45, 4, v45
    v_mul_u32_u24 v46, 1280, v46
    s_mul_i32 s52, s4, 61440
    v_add3_u32 v2, v45, v46, s52
    v_add_u32 v3, 9216, v2
    v_add_u32 v4, 18432, v2
    v_lshlrev_b32 v45, 2, v40
    v_xor_b32 v45, v45, v41
    v_lshlrev_b32 v45, 4, v45
    v_lshl_add_u32 v45, v40, 13, v45
    s_lshl_b32 s52, s6, 17
    v_add_u32 v5, s52, v45
    v_add_u32 v6, 31744, v5
    v_add_u32 v7, 63488, v5
    v_add_u32 v38, 95232, v5
    s_lshl_b32 s41, s5, 15
    s_mul_i32 s42, s6, 6144
    s_add_u32 s41, s41, s42
    s_add_u32 s41, s41, 16384
    s_lshl_b32 s42, s4, 12
    s_lshr_b32 s84, s36, 2
    s_and_b32 s84, s84, 3
    s_mul_i32 s84, s84, 5
    s_lshr_b32 s84, s84, 1
    s_lshr_b32 s85, s37, 1
    s_mul_i32 s85, s85, 5
    s_lshr_b32 s85, s85, 1
    s_add_u32 s84, s84, s85
    s_sub_u32 s85, s84, 10
    s_cmp_ge_u32 s84, 10
    s_cselect_b32 s84, s85, s84
    s_add_u32 s92, s84, 1
    s_cmp_eq_u32 s92, 10
    s_cselect_b32 s92, 0, s92
    s_lshl_b32 s85, s84, 7
    s_lshl_b32 s71, s92, 19
    s_lshl_b32 s92, s92, 7
    s_lshl_b32 s84, s84, 19
    s_add_u32 s70, s84, 262144
    s_add_u32 s101, s71, 262144
    s_lshl_b32 s43, s4, 13
    s_mov_b32 s7, 0
    s_waitcnt lgkmcnt(0)
    s_mul_i32 s52, s56, 245760
    s_add_u32 s8, s8, s52
    s_addc_u32 s9, s9, 0
    s_mov_b32 s10, 245760
    s_mov_b32 s11, 0x20000
    s_lshl_b32 s52, s37, 1
    s_add_u32 s52, s52, s5
    s_lshl_b32 s53, s52, 8
    s_lshl_b32 s54, s87, 12
    s_add_u32 s53, s53, s54
    s_add_u32 s12, s12, s53
    s_addc_u32 s13, s13, 0
    s_sub_u32 s14, 5242880, s53
    s_mov_b32 s15, 0x20000
    s_mov_b32 s39, s84
    s_add_u32 m0, s42, 0
    s_nop 0
    buffer_load_dwordx4 v5, s[12:15], s39 offen offset:0 lds
    buffer_load_dwordx4 v6, s[12:15], s39 offen offset:1024 lds
    buffer_load_dwordx4 v7, s[12:15], s39 offen offset:2048 lds
    buffer_load_dwordx4 v38, s[12:15], s39 offen offset:3072 lds
    s_add_u32 s38, s85, 0
    s_add_u32 m0, s41, 0
    s_nop 0
    buffer_load_dwordx4 v2, s[8:11], s38 offen offset:0 lds
    buffer_load_dwordx4 v3, s[8:11], s38 offen offset:1024 lds
    buffer_load_dwordx4 v4, s[8:11], s38 offen offset:2048 lds
    s_add_u32 s38, s85, 30720
    s_add_u32 m0, s41, 3072
    s_nop 0
    buffer_load_dwordx4 v2, s[8:11], s38 offen offset:0 lds
    buffer_load_dwordx4 v3, s[8:11], s38 offen offset:1024 lds
    buffer_load_dwordx4 v4, s[8:11], s38 offen offset:2048 lds
    s_mov_b32 s39, s70
    s_add_u32 m0, s42, 32768
    s_nop 0
    buffer_load_dwordx4 v5, s[12:15], s39 offen offset:0 lds
    buffer_load_dwordx4 v6, s[12:15], s39 offen offset:1024 lds
    buffer_load_dwordx4 v7, s[12:15], s39 offen offset:2048 lds
    buffer_load_dwordx4 v38, s[12:15], s39 offen offset:3072 lds
    s_lshl_b32 s57, s56, 3
    s_add_u32 s57, s57, s37
    s_mul_i32 s54, s57, 40960
    s_mul_i32 s53, s4, 320
    s_add_u32 s54, s54, s53
    s_add_u32 s60, s60, s54
    s_addc_u32 s61, s61, 0
    s_mov_b32 s62, 40000
    s_mov_b32 s63, 0x20000
    s_lshl_b32 s53, s56, 5
    s_add_u32 s53, s53, s52
    s_lshl_b32 s53, s53, 17
    s_add_u32 s72, s72, s53
    s_addc_u32 s73, s73, 0
    s_add_u32 s74, s74, s53
    s_addc_u32 s75, s75, 0
    s_cmp_eq_u32 s6, 0
    s_cselect_b32 s16, s72, s74
    s_cselect_b32 s17, s73, s75
    s_mov_b32 s18, 131072
    s_mov_b32 s19, 0x20000
    s_mul_i32 s53, s55, 5242880
    s_add_u32 s53, s53, 0x3000000
    s_add_u32 s24, s20, s53
    s_addc_u32 s25, s21, 0
    s_mov_b32 s26, 5242880
    s_mov_b32 s27, 0x20000
    s_mul_i32 s51, s4, 10240
    s_add_u32 s51, s51, 98304
    s_mul_i32 s49, s4, 1310720
    s_mul_i32 s53, s57, 10240
    s_add_u32 s49, s49, s53
    s_mov_b32 s90, s20
    s_mov_b32 s91, s21
    s_mul_i32 s53, s36, 1572864
    s_add_u32 s20, s20, s53
    s_addc_u32 s21, s21, 0
    s_mov_b32 s22, 1572864
    s_mov_b32 s23, 0x20000
    s_lshl_b32 s53, s6, 5
    s_add_u32 s53, s53, s52
    s_mul_i32 s48, s53, 24576
    s_lshr_b32 s53, s37, 1
    s_mul_i32 s53, s53, 320
    s_and_b32 s54, s37, 0
    s_mul_i32 s54, s54, 96
    s_mul_i32 s57, s56, 192
    s_add_u32 s54, s54, s57
    s_mul_i32 s54, s54, 2560
    s_mul_i32 s57, s55, 1280
    s_add_u32 s54, s54, s57
    s_add_u32 s54, s54, s53
    s_add_u32 s28, s28, s54
    s_addc_u32 s29, s29, 0
    s_mov_b32 s30, 489280
    s_mov_b32 s31, 0x20000
    s_mov_b32 s34, 256
    s_mov_b32 s35, 0x20000
    s_mov_b32 s46, 0x3e0293ee
    s_mov_b32 s47, 0x3e0293ee
    v_lshlrev_b32 v45, 1, v40
    v_xor_b32 v45, v45, v41
    v_lshlrev_b32 v45, 4, v45
    v_lshl_add_u32 v8, v40, 8, v45
    v_xor_b32 v9, 0x80, v8
    v_and_b32 v45, 7, v41
    v_lshlrev_b32 v45, 1, v45
    v_xor_b32 v45, v45, v40
    v_lshlrev_b32 v45, 4, v45
    v_lshl_add_u32 v45, v41, 8, v45
    s_lshl_b32 s52, s5, 14
    v_add_u32 v10, s52, v45
    v_xor_b32 v11, 64, v10
    v_xor_b32 v12, 128, v10
    v_xor_b32 v13, 192, v10
    v_add_u32 v14, 0x10000, v10
    v_add_u32 v15, 0x10000, v11
    v_add_u32 v16, 0x10000, v12
    v_add_u32 v17, 0x10000, v13
    v_lshl_add_u32 v45, v40, 2, v44
    v_and_b32 v46, 7, v45
    v_lshlrev_b32 v46, 1, v46
    v_lshrrev_b32 v47, 1, v43
    v_xor_b32 v46, v46, v47
    v_lshlrev_b32 v46, 4, v46
    v_lshl_add_u32 v46, v45, 8, v46
    v_and_b32 v47, 1, v43
    v_lshl_add_u32 v46, v47, 3, v46
    s_add_u32 s52, s52, 8192
    v_add_u32 v18, s52, v46
    v_xor_b32 v19, 32, v18
    v_xor_b32 v20, 64, v18
    v_xor_b32 v21, 96, v18
    v_xor_b32 v22, 128, v18
    v_xor_b32 v23, 160, v18
    v_xor_b32 v24, 192, v18
    v_xor_b32 v25, 224, v18
    v_add_u32 v26, 0x10000, v18
    v_add_u32 v27, 0x10000, v19
    v_add_u32 v28, 0x10000, v20
    v_add_u32 v29, 0x10000, v21
    v_add_u32 v30, 0x10000, v22
    v_add_u32 v31, 0x10000, v23
    v_add_u32 v32, 0x10000, v24
    v_add_u32 v33, 0x10000, v25
    v_lshlrev_b32 v57, 4, v1
    v_lshrrev_b32 v47, 4, v1
    v_and_b32 v48, 6, v1
    v_xor_b32 v48, v48, v47
    v_lshlrev_b32 v48, 4, v48
    v_and_b32 v49, 15, v1
    v_lshl_add_u32 v48, v49, 7, v48
    s_lshl_b32 s52, s6, 15
    s_add_u32 s52, s52, 16384
    v_add_u32 v40, s52, v48
    v_bfe_u32 v48, v1, 2, 2
    v_and_b32 v49, 3, v1
    v_lshl_add_u32 v49, v48, 2, v49
    v_lshlrev_b32 v49, 4, v49
    v_lshl_add_u32 v48, v47, 3, v48
    v_lshl_add_u32 v49, v48, 8, v49
    s_lshl_b32 s52, s5, 13
    v_add_u32 v41, s52, v49
    v_xor_b32 v42, 64, v41
    v_xor_b32 v43, 128, v41
    v_xor_b32 v44, 192, v41
    s_add_u32 s88, s90, 0x3a00000
    s_addc_u32 s89, s91, 0
    s_mov_b32 s90, 8421376
    s_mov_b32 s91, 0x20000
    s_lshl_b32 s53, s2, 7
    s_lshl_b32 s54, s4, 2
    s_add_u32 s53, s53, s54
    s_add_u32 s93, s53, 8388608
    v_mov_b32 v58, 0
    s_mov_b64 exec, 1
    buffer_store_dword v58, off, s[88:91], s93 sc1
    buffer_store_dword v58, off, s[88:91], s93 offset:16 sc1
    s_mov_b64 exec, -1
    s_add_u32 s94, s43, 131072
    s_movk_i32 s55, 960
    v_lshlrev_b32 v57, 4, v1
    v_mul_u32_u24 v58, 3277, v1
    v_add_u32 v59, 0, v58
    v_lshrrev_b32 v59, 16, v59
    v_mad_u32_u24 v48, v59, s55, v57
    v_lshlrev_b32 v59, 3, v59
    v_and_b32 v59, 32, v59
    v_xor_b32 v48, v48, v59
    v_add_u32 v59, 209728, v58
    v_lshrrev_b32 v59, 16, v59
    v_mad_u32_u24 v49, v59, s55, v57
    v_lshlrev_b32 v59, 3, v59
    v_and_b32 v59, 32, v59
    v_xor_b32 v49, v49, v59
    v_add_u32 v59, 419456, v58
    v_lshrrev_b32 v59, 16, v59
    v_mad_u32_u24 v50, v59, s55, v57
    v_lshlrev_b32 v59, 3, v59
    v_and_b32 v59, 32, v59
    v_xor_b32 v50, v50, v59
    v_add_u32 v59, 629184, v58
    v_lshrrev_b32 v59, 16, v59
    v_mad_u32_u24 v51, v59, s55, v57
    v_lshlrev_b32 v59, 3, v59
    v_and_b32 v59, 32, v59
    v_xor_b32 v51, v51, v59
    v_add_u32 v59, 838912, v58
    v_lshrrev_b32 v59, 16, v59
    v_mad_u32_u24 v52, v59, s55, v57
    v_lshlrev_b32 v59, 3, v59
    v_and_b32 v59, 32, v59
    v_xor_b32 v52, v52, v59
    v_add_u32 v52, 4096, v52
    v_lshrrev_b32 v58, 4, v1
    v_bfe_u32 v59, v1, 2, 2
    v_lshl_add_u32 v59, v58, 2, v59
    v_mul_u32_u24 v59, 320, v59
    v_bfe_u32 v60, v1, 1, 1
    v_lshl_add_u32 v59, v60, 4, v59
    v_and_b32 v60, 1, v1
    v_lshl_add_u32 v59, v60, 3, v59
    v_add_u32 v59, s94, v59
    v_and_b32 v58, 1, v58
    v_lshl_add_u32 v53, v58, 5, v59
    v_xor_b32 v58, 1, v58
    v_lshl_add_u32 v54, v58, 5, v59
    s_add_u32 s38, s92, 0
    s_add_u32 m0, s41, 65536
    s_nop 0
    buffer_load_dwordx4 v2, s[8:11], s38 offen offset:0 lds
    buffer_load_dwordx4 v3, s[8:11], s38 offen offset:1024 lds
    buffer_load_dwordx4 v4, s[8:11], s38 offen offset:2048 lds
    s_mov_b32 s39, s71
    s_add_u32 m0, s42, 65536
    s_nop 0
    buffer_load_dwordx4 v5, s[12:15], s39 offen offset:0 lds
    buffer_load_dwordx4 v6, s[12:15], s39 offen offset:1024 lds
    buffer_load_dwordx4 v7, s[12:15], s39 offen offset:2048 lds
    buffer_load_dwordx4 v38, s[12:15], s39 offen offset:3072 lds
    s_mov_b32 s40, 0
    s_waitcnt vmcnt(13)
    s_barrier
    ds_read_b64_tr_b16 a[240:241], v41 offset:0
    ds_read_b64_tr_b16 a[242:243], v41 offset:1024
    ds_read_b64_tr_b16 a[244:245], v41 offset:8
    ds_read_b64_tr_b16 a[246:247], v41 offset:1032
    ds_read_b64_tr_b16 a[248:249], v42 offset:0
    ds_read_b64_tr_b16 a[250:251], v42 offset:1024
    ds_read_b128 a[192:195], v40 offset:0
    ds_read_b128 a[196:199], v40 offset:2048
    ds_read_b128 a[200:203], v40 offset:4096
    ds_read_b128 a[204:207], v40 offset:6144
    ds_read_b128 a[208:211], v40 offset:8192
    ds_read_b128 a[212:215], v40 offset:10240
    s_mov_b32 s39, s101
    s_waitcnt lgkmcnt(4)
L_qfirst0:
    v_mfma_f32_16x16x32_bf16 v[64:67], a[240:243], a[192:195], 0
    s_waitcnt lgkmcnt(2)
    s_add_u32 s54, s38, 30720
    v_mfma_f32_16x16x32_bf16 v[96:99], a[240:243], a[196:199], 0
    ds_read_b64_tr_b16 a[252:253], v42 offset:8
    v_mfma_f32_16x16x32_bf16 v[128:131], a[240:243], a[200:203], 0
    ds_read_b64_tr_b16 a[254:255], v42 offset:1032
    s_add_u32 m0, s41, 68608
    v_mfma_f32_16x16x32_bf16 v[160:163], a[240:243], a[204:207], 0
    s_waitcnt lgkmcnt(2)
    buffer_load_dwordx4 v2, s[8:11], s54 offen offset:0 lds
    v_mfma_f32_16x16x32_bf16 v[192:195], a[240:243], a[208:211], 0
    v_mfma_f32_16x16x32_bf16 v[224:227], a[240:243], a[212:215], 0
    v_mfma_f32_16x16x32_bf16 v[68:71], a[244:247], a[192:195], 0
    v_mfma_f32_16x16x32_bf16 v[100:103], a[244:247], a[196:199], 0
    ds_read_b64_tr_b16 a[240:241], v43 offset:0
    v_mfma_f32_16x16x32_bf16 v[132:135], a[244:247], a[200:203], 0
    ds_read_b64_tr_b16 a[242:243], v43 offset:1024
    s_add_u32 m0, s41, 68608
    v_mfma_f32_16x16x32_bf16 v[164:167], a[244:247], a[204:207], 0
    buffer_load_dwordx4 v3, s[8:11], s54 offen offset:1024 lds
    v_mfma_f32_16x16x32_bf16 v[196:199], a[244:247], a[208:211], 0
    v_mfma_f32_16x16x32_bf16 v[228:231], a[244:247], a[212:215], 0
    v_mfma_f32_16x16x32_bf16 v[72:75], a[248:251], a[192:195], 0
    v_mfma_f32_16x16x32_bf16 v[104:107], a[248:251], a[196:199], 0
    ds_read_b64_tr_b16 a[244:245], v43 offset:8
    v_mfma_f32_16x16x32_bf16 v[136:139], a[248:251], a[200:203], 0
    ds_read_b64_tr_b16 a[246:247], v43 offset:1032
    s_add_u32 m0, s41, 68608
    v_mfma_f32_16x16x32_bf16 v[168:171], a[248:251], a[204:207], 0
    buffer_load_dwordx4 v4, s[8:11], s54 offen offset:2048 lds
    v_mfma_f32_16x16x32_bf16 v[200:203], a[248:251], a[208:211], 0
    s_add_u32 s38, s38, 128
    v_mfma_f32_16x16x32_bf16 v[232:235], a[248:251], a[212:215], 0
    s_waitcnt lgkmcnt(4)
    s_cmp_eq_u32 s38, 1280
    s_cselect_b32 s38, 0, s38
    v_mfma_f32_16x16x32_bf16 v[76:79], a[252:255], a[192:195], 0
    v_mfma_f32_16x16x32_bf16 v[108:111], a[252:255], a[196:199], 0
    ds_read_b64_tr_b16 a[248:249], v44 offset:0
    v_mfma_f32_16x16x32_bf16 v[140:143], a[252:255], a[200:203], 0
    ds_read_b64_tr_b16 a[250:251], v44 offset:1024
    s_add_u32 m0, s42, 98304
    v_mfma_f32_16x16x32_bf16 v[172:175], a[252:255], a[204:207], 0
    buffer_load_dwordx4 v5, s[12:15], s39 offen offset:0 lds
    v_mfma_f32_16x16x32_bf16 v[204:207], a[252:255], a[208:211], 0
    v_mfma_f32_16x16x32_bf16 v[236:239], a[252:255], a[212:215], 0
    s_waitcnt lgkmcnt(4)
    v_mfma_f32_16x16x32_bf16 v[80:83], a[240:243], a[192:195], 0
    v_mfma_f32_16x16x32_bf16 v[112:115], a[240:243], a[196:199], 0
    ds_read_b64_tr_b16 a[252:253], v44 offset:8
    v_mfma_f32_16x16x32_bf16 v[144:147], a[240:243], a[200:203], 0
    ds_read_b64_tr_b16 a[254:255], v44 offset:1032
    v_xor_b32 v40, 0x40, v40
    v_mfma_f32_16x16x32_bf16 v[176:179], a[240:243], a[204:207], 0
    v_add_u32 v41, 0x8000, v41
    v_add_u32 v42, 0x8000, v42
    v_mfma_f32_16x16x32_bf16 v[208:211], a[240:243], a[208:211], 0
    v_add_u32 v43, 0x8000, v43
    v_mfma_f32_16x16x32_bf16 v[240:243], a[240:243], a[212:215], 0
    s_waitcnt vmcnt(13)
    s_waitcnt lgkmcnt(4)
    v_add_u32 v44, 0x8000, v44
    v_mfma_f32_16x16x32_bf16 v[84:87], a[244:247], a[192:195], 0
    v_mfma_f32_16x16x32_bf16 v[116:119], a[244:247], a[196:199], 0
    s_waitcnt lgkmcnt(0)
    s_barrier
    v_mfma_f32_16x16x32_bf16 v[148:151], a[244:247], a[200:203], 0
    ds_read_b64_tr_b16 a[240:241], v41 offset:0
    v_mfma_f32_16x16x32_bf16 v[180:183], a[244:247], a[204:207], 0
    ds_read_b64_tr_b16 a[242:243], v41 offset:1024
    v_mfma_f32_16x16x32_bf16 v[212:215], a[244:247], a[208:211], 0
    ds_read_b128 a[216:219], v40 offset:0
    s_add_u32 m0, s42, 98304
    v_mfma_f32_16x16x32_bf16 v[244:247], a[244:247], a[212:215], 0
    buffer_load_dwordx4 v6, s[12:15], s39 offen offset:1024 lds
    v_mfma_f32_16x16x32_bf16 v[88:91], a[248:251], a[192:195], 0
    ds_read_b64_tr_b16 a[244:245], v41 offset:8
    v_mfma_f32_16x16x32_bf16 v[120:123], a[248:251], a[196:199], 0
    ds_read_b64_tr_b16 a[246:247], v41 offset:1032
    v_mfma_f32_16x16x32_bf16 v[152:155], a[248:251], a[200:203], 0
    ds_read_b128 a[220:223], v40 offset:2048
    v_mfma_f32_16x16x32_bf16 v[184:187], a[248:251], a[204:207], 0
    ds_read_b128 a[224:227], v40 offset:4096
    v_mfma_f32_16x16x32_bf16 v[216:219], a[248:251], a[208:211], 0
    ds_read_b128 a[228:231], v40 offset:6144
    s_add_u32 m0, s42, 98304
    v_mfma_f32_16x16x32_bf16 v[248:251], a[248:251], a[212:215], 0
    buffer_load_dwordx4 v7, s[12:15], s39 offen offset:2048 lds
    v_mfma_f32_16x16x32_bf16 v[92:95], a[252:255], a[192:195], 0
    ds_read_b64_tr_b16 a[248:249], v42 offset:0
    v_mfma_f32_16x16x32_bf16 v[124:127], a[252:255], a[196:199], 0
    ds_read_b64_tr_b16 a[250:251], v42 offset:1024
    v_mfma_f32_16x16x32_bf16 v[156:159], a[252:255], a[200:203], 0
    ds_read_b128 a[232:235], v40 offset:8192
    v_mfma_f32_16x16x32_bf16 v[188:191], a[252:255], a[204:207], 0
    ds_read_b128 a[236:239], v40 offset:10240
    v_mfma_f32_16x16x32_bf16 v[220:223], a[252:255], a[208:211], 0
    s_add_u32 m0, s42, 98304
    s_waitcnt lgkmcnt(6)
    v_mfma_f32_16x16x32_bf16 v[252:255], a[252:255], a[212:215], 0
    buffer_load_dwordx4 v38, s[12:15], s39 offen offset:3072 lds
    v_mfma_f32_16x16x32_bf16 v[64:67], a[240:243], a[216:219], v[64:67]
    s_waitcnt lgkmcnt(4)
    s_add_u32 s39, s39, 262144
    v_mfma_f32_16x16x32_bf16 v[96:99], a[240:243], a[220:223], v[96:99]
    ds_read_b64_tr_b16 a[252:253], v42 offset:8
    s_cmp_eq_u32 s39, 5242880
    s_cselect_b32 s39, 0, s39
    v_mfma_f32_16x16x32_bf16 v[128:131], a[240:243], a[224:227], v[128:131]
    ds_read_b64_tr_b16 a[254:255], v42 offset:1032
    s_add_u32 m0, s42, 0
    v_mfma_f32_16x16x32_bf16 v[160:163], a[240:243], a[228:231], v[160:163]
    s_waitcnt lgkmcnt(2)
    buffer_load_dwordx4 v5, s[12:15], s39 offen offset:0 lds
    v_mfma_f32_16x16x32_bf16 v[192:195], a[240:243], a[232:235], v[192:195]
    s_mov_b32 s56, 0
    v_mfma_f32_16x16x32_bf16 v[224:227], a[240:243], a[236:239], v[224:227]
    s_add_u32 m0, s94, 0
    v_mfma_f32_16x16x32_bf16 v[68:71], a[244:247], a[216:219], v[68:71]
    buffer_load_dwordx4 v48, s[60:63], s56 offen offset:0 nt lds
    v_mfma_f32_16x16x32_bf16 v[100:103], a[244:247], a[220:223], v[100:103]
    ds_read_b64_tr_b16 a[240:241], v43 offset:0
    v_mfma_f32_16x16x32_bf16 v[132:135], a[244:247], a[224:227], v[132:135]
    ds_read_b64_tr_b16 a[242:243], v43 offset:1024
    s_add_u32 m0, s42, 0
    v_mfma_f32_16x16x32_bf16 v[164:167], a[244:247], a[228:231], v[164:167]
    buffer_load_dwordx4 v6, s[12:15], s39 offen offset:1024 lds
    v_mfma_f32_16x16x32_bf16 v[196:199], a[244:247], a[232:235], v[196:199]
    v_mfma_f32_16x16x32_bf16 v[228:231], a[244:247], a[236:239], v[228:231]
    s_add_u32 m0, s94, 0
    v_mfma_f32_16x16x32_bf16 v[72:75], a[248:251], a[216:219], v[72:75]
    buffer_load_dwordx4 v49, s[60:63], s56 offen offset:1024 nt lds
    v_mfma_f32_16x16x32_bf16 v[104:107], a[248:251], a[220:223], v[104:107]
    ds_read_b64_tr_b16 a[244:245], v43 offset:8
    v_mfma_f32_16x16x32_bf16 v[136:139], a[248:251], a[224:227], v[136:139]
    ds_read_b64_tr_b16 a[246:247], v43 offset:1032
    s_add_u32 m0, s42, 0
    v_mfma_f32_16x16x32_bf16 v[168:171], a[248:251], a[228:231], v[168:171]
    buffer_load_dwordx4 v7, s[12:15], s39 offen offset:2048 lds
    v_mfma_f32_16x16x32_bf16 v[200:203], a[248:251], a[232:235], v[200:203]
    v_mfma_f32_16x16x32_bf16 v[232:235], a[248:251], a[236:239], v[232:235]
    s_waitcnt lgkmcnt(4)
    s_add_u32 m0, s94, 0
    v_mfma_f32_16x16x32_bf16 v[76:79], a[252:255], a[216:219], v[76:79]
    buffer_load_dwordx4 v50, s[60:63], s56 offen offset:2048 nt lds
    v_mfma_f32_16x16x32_bf16 v[108:111], a[252:255], a[220:223], v[108:111]
    ds_read_b64_tr_b16 a[248:249], v44 offset:0
    v_mfma_f32_16x16x32_bf16 v[140:143], a[252:255], a[224:227], v[140:143]
    ds_read_b64_tr_b16 a[250:251], v44 offset:1024
    s_add_u32 m0, s42, 0
    v_mfma_f32_16x16x32_bf16 v[172:175], a[252:255], a[228:231], v[172:175]
    buffer_load_dwordx4 v38, s[12:15], s39 offen offset:3072 lds
    v_mfma_f32_16x16x32_bf16 v[204:207], a[252:255], a[232:235], v[204:207]
    s_add_u32 s39, s39, 262144
    v_mfma_f32_16x16x32_bf16 v[236:239], a[252:255], a[236:239], v[236:239]
    s_waitcnt lgkmcnt(4)
    s_cmp_eq_u32 s39, 5242880
    s_cselect_b32 s39, 0, s39
    s_add_u32 m0, s94, 0
    v_mfma_f32_16x16x32_bf16 v[80:83], a[240:243], a[216:219], v[80:83]
    buffer_load_dwordx4 v51, s[60:63], s56 offen offset:3072 nt lds
    v_mfma_f32_16x16x32_bf16 v[112:115], a[240:243], a[220:223], v[112:115]
    ds_read_b64_tr_b16 a[252:253], v44 offset:8
    v_mfma_f32_16x16x32_bf16 v[144:147], a[240:243], a[224:227], v[144:147]
    ds_read_b64_tr_b16 a[254:255], v44 offset:1032
    v_xor_b32 v40, 0x10040, v40
    v_mfma_f32_16x16x32_bf16 v[176:179], a[240:243], a[228:231], v[176:179]
    v_add_u32 v41, 0x8000, v41
    v_add_u32 v42, 0x8000, v42
    v_mfma_f32_16x16x32_bf16 v[208:211], a[240:243], a[232:235], v[208:211]
    v_add_u32 v43, 0x8000, v43
    v_mfma_f32_16x16x32_bf16 v[240:243], a[240:243], a[236:239], v[240:243]
    s_waitcnt vmcnt(12)
    s_waitcnt lgkmcnt(4)
    v_add_u32 v44, 0x8000, v44
    s_add_u32 m0, s94, 4096
    v_mfma_f32_16x16x32_bf16 v[84:87], a[244:247], a[216:219], v[84:87]
    buffer_load_dwordx4 v52, s[60:63], s56 offen offset:0 nt lds
    v_mfma_f32_16x16x32_bf16 v[116:119], a[244:247], a[220:223], v[116:119]
    s_waitcnt lgkmcnt(0)
    s_barrier
    v_mfma_f32_16x16x32_bf16 v[148:151], a[244:247], a[224:227], v[148:151]
    ds_read_b64_tr_b16 a[240:241], v41 offset:0
    v_mfma_f32_16x16x32_bf16 v[180:183], a[244:247], a[228:231], v[180:183]
    ds_read_b64_tr_b16 a[242:243], v41 offset:1024
    v_mfma_f32_16x16x32_bf16 v[212:215], a[244:247], a[232:235], v[212:215]
    ds_read_b128 a[192:195], v40 offset:0
    s_add_u32 m0, s41, 0
    v_mfma_f32_16x16x32_bf16 v[244:247], a[244:247], a[236:239], v[244:247]
    buffer_load_dwordx4 v2, s[8:11], s38 offen offset:0 lds
    v_mfma_f32_16x16x32_bf16 v[88:91], a[248:251], a[216:219], v[88:91]
    ds_read_b64_tr_b16 a[244:245], v41 offset:8
    v_mfma_f32_16x16x32_bf16 v[120:123], a[248:251], a[220:223], v[120:123]
    ds_read_b64_tr_b16 a[246:247], v41 offset:1032
    v_mfma_f32_16x16x32_bf16 v[152:155], a[248:251], a[224:227], v[152:155]
    ds_read_b128 a[196:199], v40 offset:2048
    v_mfma_f32_16x16x32_bf16 v[184:187], a[248:251], a[228:231], v[184:187]
    ds_read_b128 a[200:203], v40 offset:4096
    v_mfma_f32_16x16x32_bf16 v[216:219], a[248:251], a[232:235], v[216:219]
    ds_read_b128 a[204:207], v40 offset:6144
    s_add_u32 m0, s41, 0
    v_mfma_f32_16x16x32_bf16 v[248:251], a[248:251], a[236:239], v[248:251]
    buffer_load_dwordx4 v3, s[8:11], s38 offen offset:1024 lds
    v_mfma_f32_16x16x32_bf16 v[92:95], a[252:255], a[216:219], v[92:95]
    ds_read_b64_tr_b16 a[248:249], v42 offset:0
    v_mfma_f32_16x16x32_bf16 v[124:127], a[252:255], a[220:223], v[124:127]
    ds_read_b64_tr_b16 a[250:251], v42 offset:1024
    v_mfma_f32_16x16x32_bf16 v[156:159], a[252:255], a[224:227], v[156:159]
    ds_read_b128 a[208:211], v40 offset:8192
    v_mfma_f32_16x16x32_bf16 v[188:191], a[252:255], a[228:231], v[188:191]
    ds_read_b128 a[212:215], v40 offset:10240
    v_mfma_f32_16x16x32_bf16 v[220:223], a[252:255], a[232:235], v[220:223]
    s_add_u32 m0, s41, 0
    s_waitcnt lgkmcnt(6)
    v_mfma_f32_16x16x32_bf16 v[252:255], a[252:255], a[236:239], v[252:255]
    buffer_load_dwordx4 v4, s[8:11], s38 offen offset:2048 lds
    v_mfma_f32_16x16x32_bf16 v[64:67], a[240:243], a[192:195], v[64:67]
    s_waitcnt lgkmcnt(4)
    s_add_u32 s54, s38, 30720
    v_mfma_f32_16x16x32_bf16 v[96:99], a[240:243], a[196:199], v[96:99]
    ds_read_b64_tr_b16 a[252:253], v42 offset:8
    v_mfma_f32_16x16x32_bf16 v[128:131], a[240:243], a[200:203], v[128:131]
    ds_read_b64_tr_b16 a[254:255], v42 offset:1032
    s_add_u32 m0, s41, 3072
    v_mfma_f32_16x16x32_bf16 v[160:163], a[240:243], a[204:207], v[160:163]
    s_waitcnt lgkmcnt(2)
    buffer_load_dwordx4 v2, s[8:11], s54 offen offset:0 lds
    v_mfma_f32_16x16x32_bf16 v[192:195], a[240:243], a[208:211], v[192:195]
    v_mfma_f32_16x16x32_bf16 v[224:227], a[240:243], a[212:215], v[224:227]
    v_mfma_f32_16x16x32_bf16 v[68:71], a[244:247], a[192:195], v[68:71]
    v_mfma_f32_16x16x32_bf16 v[100:103], a[244:247], a[196:199], v[100:103]
    ds_read_b64_tr_b16 a[240:241], v43 offset:0
    v_mfma_f32_16x16x32_bf16 v[132:135], a[244:247], a[200:203], v[132:135]
    ds_read_b64_tr_b16 a[242:243], v43 offset:1024
    s_add_u32 m0, s41, 3072
    v_mfma_f32_16x16x32_bf16 v[164:167], a[244:247], a[204:207], v[164:167]
    buffer_load_dwordx4 v3, s[8:11], s54 offen offset:1024 lds
    v_mfma_f32_16x16x32_bf16 v[196:199], a[244:247], a[208:211], v[196:199]
    v_mfma_f32_16x16x32_bf16 v[228:231], a[244:247], a[212:215], v[228:231]
    v_mfma_f32_16x16x32_bf16 v[72:75], a[248:251], a[192:195], v[72:75]
    v_mfma_f32_16x16x32_bf16 v[104:107], a[248:251], a[196:199], v[104:107]
    ds_read_b64_tr_b16 a[244:245], v43 offset:8
    v_mfma_f32_16x16x32_bf16 v[136:139], a[248:251], a[200:203], v[136:139]
    ds_read_b64_tr_b16 a[246:247], v43 offset:1032
    s_add_u32 m0, s41, 3072
    v_mfma_f32_16x16x32_bf16 v[168:171], a[248:251], a[204:207], v[168:171]
    buffer_load_dwordx4 v4, s[8:11], s54 offen offset:2048 lds
    v_mfma_f32_16x16x32_bf16 v[200:203], a[248:251], a[208:211], v[200:203]
    s_add_u32 s38, s38, 128
    v_mfma_f32_16x16x32_bf16 v[232:235], a[248:251], a[212:215], v[232:235]
    s_waitcnt lgkmcnt(4)
    s_cmp_eq_u32 s38, 1280
    s_cselect_b32 s38, 0, s38
    v_mfma_f32_16x16x32_bf16 v[76:79], a[252:255], a[192:195], v[76:79]
    v_mfma_f32_16x16x32_bf16 v[108:111], a[252:255], a[196:199], v[108:111]
    ds_read_b64_tr_b16 a[248:249], v44 offset:0
    v_mfma_f32_16x16x32_bf16 v[140:143], a[252:255], a[200:203], v[140:143]
    ds_read_b64_tr_b16 a[250:251], v44 offset:1024
    s_add_u32 m0, s42, 32768
    v_mfma_f32_16x16x32_bf16 v[172:175], a[252:255], a[204:207], v[172:175]
    buffer_load_dwordx4 v5, s[12:15], s39 offen offset:0 lds
    v_mfma_f32_16x16x32_bf16 v[204:207], a[252:255], a[208:211], v[204:207]
    v_mfma_f32_16x16x32_bf16 v[236:239], a[252:255], a[212:215], v[236:239]
    s_waitcnt lgkmcnt(4)
    v_mfma_f32_16x16x32_bf16 v[80:83], a[240:243], a[192:195], v[80:83]
    v_mfma_f32_16x16x32_bf16 v[112:115], a[240:243], a[196:199], v[112:115]
    ds_read_b64_tr_b16 a[252:253], v44 offset:8
    v_mfma_f32_16x16x32_bf16 v[144:147], a[240:243], a[200:203], v[144:147]
    ds_read_b64_tr_b16 a[254:255], v44 offset:1032
    v_xor_b32 v40, 0x40, v40
    v_mfma_f32_16x16x32_bf16 v[176:179], a[240:243], a[204:207], v[176:179]
    v_add_u32 v41, 0x8000, v41
    v_add_u32 v42, 0x8000, v42
    v_mfma_f32_16x16x32_bf16 v[208:211], a[240:243], a[208:211], v[208:211]
    v_add_u32 v43, 0x8000, v43
    v_mfma_f32_16x16x32_bf16 v[240:243], a[240:243], a[212:215], v[240:243]
    s_waitcnt vmcnt(16)
    s_waitcnt lgkmcnt(4)
    v_add_u32 v44, 0x8000, v44
    v_mfma_f32_16x16x32_bf16 v[84:87], a[244:247], a[192:195], v[84:87]
    v_mfma_f32_16x16x32_bf16 v[116:119], a[244:247], a[196:199], v[116:119]
    s_waitcnt lgkmcnt(0)
    s_barrier
    v_mfma_f32_16x16x32_bf16 v[148:151], a[244:247], a[200:203], v[148:151]
    ds_read_b64_tr_b16 a[240:241], v41 offset:0
    v_mfma_f32_16x16x32_bf16 v[180:183], a[244:247], a[204:207], v[180:183]
    ds_read_b64_tr_b16 a[242:243], v41 offset:1024
    v_mfma_f32_16x16x32_bf16 v[212:215], a[244:247], a[208:211], v[212:215]
    ds_read_b128 a[216:219], v40 offset:0
    s_add_u32 m0, s42, 32768
    v_mfma_f32_16x16x32_bf16 v[244:247], a[244:247], a[212:215], v[244:247]
    buffer_load_dwordx4 v6, s[12:15], s39 offen offset:1024 lds
    v_mfma_f32_16x16x32_bf16 v[88:91], a[248:251], a[192:195], v[88:91]
    ds_read_b64_tr_b16 a[244:245], v41 offset:8
    v_mfma_f32_16x16x32_bf16 v[120:123], a[248:251], a[196:199], v[120:123]
    ds_read_b64_tr_b16 a[246:247], v41 offset:1032
    v_mfma_f32_16x16x32_bf16 v[152:155], a[248:251], a[200:203], v[152:155]
    ds_read_b128 a[220:223], v40 offset:2048
    v_mfma_f32_16x16x32_bf16 v[184:187], a[248:251], a[204:207], v[184:187]
    ds_read_b128 a[224:227], v40 offset:4096
    v_mfma_f32_16x16x32_bf16 v[216:219], a[248:251], a[208:211], v[216:219]
    ds_read_b128 a[228:231], v40 offset:6144
    s_add_u32 m0, s42, 32768
    v_mfma_f32_16x16x32_bf16 v[248:251], a[248:251], a[212:215], v[248:251]
    buffer_load_dwordx4 v7, s[12:15], s39 offen offset:2048 lds
    v_mfma_f32_16x16x32_bf16 v[92:95], a[252:255], a[192:195], v[92:95]
    ds_read_b64_tr_b16 a[248:249], v42 offset:0
    v_mfma_f32_16x16x32_bf16 v[124:127], a[252:255], a[196:199], v[124:127]
    ds_read_b64_tr_b16 a[250:251], v42 offset:1024
    v_mfma_f32_16x16x32_bf16 v[156:159], a[252:255], a[200:203], v[156:159]
    ds_read_b128 a[232:235], v40 offset:8192
    v_mfma_f32_16x16x32_bf16 v[188:191], a[252:255], a[204:207], v[188:191]
    ds_read_b128 a[236:239], v40 offset:10240
    v_mfma_f32_16x16x32_bf16 v[220:223], a[252:255], a[208:211], v[220:223]
    s_add_u32 m0, s42, 32768
    s_waitcnt lgkmcnt(6)
    v_mfma_f32_16x16x32_bf16 v[252:255], a[252:255], a[212:215], v[252:255]
    buffer_load_dwordx4 v38, s[12:15], s39 offen offset:3072 lds
    v_mfma_f32_16x16x32_bf16 v[64:67], a[240:243], a[216:219], v[64:67]
    s_waitcnt lgkmcnt(4)
    s_add_u32 s39, s39, 262144
    v_mfma_f32_16x16x32_bf16 v[96:99], a[240:243], a[220:223], v[96:99]
    ds_read_b64_tr_b16 a[252:253], v42 offset:8
    s_cmp_eq_u32 s39, 5242880
    s_cselect_b32 s39, 0, s39
    v_mfma_f32_16x16x32_bf16 v[128:131], a[240:243], a[224:227], v[128:131]
    ds_read_b64_tr_b16 a[254:255], v42 offset:1032
    s_add_u32 m0, s42, 65536
    v_mfma_f32_16x16x32_bf16 v[160:163], a[240:243], a[228:231], v[160:163]
    s_waitcnt lgkmcnt(2)
    buffer_load_dwordx4 v5, s[12:15], s39 offen offset:0 lds
    v_mfma_f32_16x16x32_bf16 v[192:195], a[240:243], a[232:235], v[192:195]
    s_waitcnt vmcnt(11)
    v_mfma_f32_16x16x32_bf16 v[224:227], a[240:243], a[236:239], v[224:227]
    ds_read_b64_tr_b16 a[96:97], v53 offset:0
    v_mfma_f32_16x16x32_bf16 v[68:71], a[244:247], a[216:219], v[68:71]
    ds_read_b64_tr_b16 a[100:101], v54 offset:0
    v_mfma_f32_16x16x32_bf16 v[100:103], a[244:247], a[220:223], v[100:103]
    ds_read_b64_tr_b16 a[240:241], v43 offset:0
    v_mfma_f32_16x16x32_bf16 v[132:135], a[244:247], a[224:227], v[132:135]
    ds_read_b64_tr_b16 a[242:243], v43 offset:1024
    s_add_u32 m0, s42, 65536
    v_mfma_f32_16x16x32_bf16 v[164:167], a[244:247], a[228:231], v[164:167]
    buffer_load_dwordx4 v6, s[12:15], s39 offen offset:1024 lds
    v_mfma_f32_16x16x32_bf16 v[196:199], a[244:247], a[232:235], v[196:199]
    ds_read_b64_tr_b16 a[104:105], v53 offset:64
    v_mfma_f32_16x16x32_bf16 v[228:231], a[244:247], a[236:239], v[228:231]
    ds_read_b64_tr_b16 a[108:109], v54 offset:64
    v_mfma_f32_16x16x32_bf16 v[72:75], a[248:251], a[216:219], v[72:75]
    ds_read_b64_tr_b16 a[112:113], v53 offset:128
    v_mfma_f32_16x16x32_bf16 v[104:107], a[248:251], a[220:223], v[104:107]
    ds_read_b64_tr_b16 a[244:245], v43 offset:8
    v_mfma_f32_16x16x32_bf16 v[136:139], a[248:251], a[224:227], v[136:139]
    ds_read_b64_tr_b16 a[246:247], v43 offset:1032
    s_add_u32 m0, s42, 65536
    v_mfma_f32_16x16x32_bf16 v[168:171], a[248:251], a[228:231], v[168:171]
    buffer_load_dwordx4 v7, s[12:15], s39 offen offset:2048 lds
    v_mfma_f32_16x16x32_bf16 v[200:203], a[248:251], a[232:235], v[200:203]
    ds_read_b64_tr_b16 a[116:117], v54 offset:128
    v_mfma_f32_16x16x32_bf16 v[232:235], a[248:251], a[236:239], v[232:235]
    ds_read_b64_tr_b16 a[120:121], v53 offset:192
    s_waitcnt lgkmcnt(11)
    v_mfma_f32_16x16x32_bf16 v[76:79], a[252:255], a[216:219], v[76:79]
    ds_read_b64_tr_b16 a[124:125], v54 offset:192
    v_mfma_f32_16x16x32_bf16 v[108:111], a[252:255], a[220:223], v[108:111]
    ds_read_b64_tr_b16 a[248:249], v44 offset:0
    v_mfma_f32_16x16x32_bf16 v[140:143], a[252:255], a[224:227], v[140:143]
    ds_read_b64_tr_b16 a[250:251], v44 offset:1024
    s_add_u32 m0, s42, 65536
    v_mfma_f32_16x16x32_bf16 v[172:175], a[252:255], a[228:231], v[172:175]
    buffer_load_dwordx4 v38, s[12:15], s39 offen offset:3072 lds
    v_mfma_f32_16x16x32_bf16 v[204:207], a[252:255], a[232:235], v[204:207]
    ds_read_b64_tr_b16 a[128:129], v53 offset:256
    s_add_u32 s39, s39, 262144
    v_mfma_f32_16x16x32_bf16 v[236:239], a[252:255], a[236:239], v[236:239]
    s_waitcnt lgkmcnt(11)
    s_cmp_eq_u32 s39, 5242880
    s_cselect_b32 s39, 0, s39
    v_mfma_f32_16x16x32_bf16 v[80:83], a[240:243], a[216:219], v[80:83]
    ds_read_b64_tr_b16 a[132:133], v54 offset:256
    v_mfma_f32_16x16x32_bf16 v[112:115], a[240:243], a[220:223], v[112:115]
    ds_read_b64_tr_b16 a[252:253], v44 offset:8
    v_mfma_f32_16x16x32_bf16 v[144:147], a[240:243], a[224:227], v[144:147]
    ds_read_b64_tr_b16 a[254:255], v44 offset:1032
    v_xor_b32 v40, 0x10040, v40
    v_mfma_f32_16x16x32_bf16 v[176:179], a[240:243], a[228:231], v[176:179]
    v_subrev_u32 v41, 0x18000, v41
    v_subrev_u32 v42, 0x18000, v42
    v_mfma_f32_16x16x32_bf16 v[208:211], a[240:243], a[232:235], v[208:211]
    v_subrev_u32 v43, 0x18000, v43
    v_mfma_f32_16x16x32_bf16 v[240:243], a[240:243], a[236:239], v[240:243]
    s_waitcnt vmcnt(8)
    s_waitcnt lgkmcnt(9)
    v_subrev_u32 v44, 0x18000, v44
    v_mfma_f32_16x16x32_bf16 v[84:87], a[244:247], a[216:219], v[84:87]
    v_mfma_f32_16x16x32_bf16 v[116:119], a[244:247], a[220:223], v[116:119]
    s_waitcnt lgkmcnt(0)
    s_barrier
    v_mfma_f32_16x16x32_bf16 v[148:151], a[244:247], a[224:227], v[148:151]
    ds_read_b64_tr_b16 a[240:241], v41 offset:0
    v_mfma_f32_16x16x32_bf16 v[180:183], a[244:247], a[228:231], v[180:183]
    ds_read_b64_tr_b16 a[242:243], v41 offset:1024
    v_mfma_f32_16x16x32_bf16 v[212:215], a[244:247], a[232:235], v[212:215]
    ds_read_b128 a[192:195], v40 offset:0
    s_add_u32 m0, s41, 65536
    v_mfma_f32_16x16x32_bf16 v[244:247], a[244:247], a[236:239], v[244:247]
    buffer_load_dwordx4 v2, s[8:11], s38 offen offset:0 lds
    v_mfma_f32_16x16x32_bf16 v[88:91], a[248:251], a[216:219], v[88:91]
    ds_read_b64_tr_b16 a[244:245], v41 offset:8
    v_mfma_f32_16x16x32_bf16 v[120:123], a[248:251], a[220:223], v[120:123]
    ds_read_b64_tr_b16 a[246:247], v41 offset:1032
    v_mfma_f32_16x16x32_bf16 v[152:155], a[248:251], a[224:227], v[152:155]
    ds_read_b128 a[196:199], v40 offset:2048
    v_mfma_f32_16x16x32_bf16 v[184:187], a[248:251], a[228:231], v[184:187]
    ds_read_b128 a[200:203], v40 offset:4096
    v_mfma_f32_16x16x32_bf16 v[216:219], a[248:251], a[232:235], v[216:219]
    ds_read_b128 a[204:207], v40 offset:6144
    s_add_u32 m0, s41, 65536
    v_mfma_f32_16x16x32_bf16 v[248:251], a[248:251], a[236:239], v[248:251]
    buffer_load_dwordx4 v3, s[8:11], s38 offen offset:1024 lds
    v_mfma_f32_16x16x32_bf16 v[92:95], a[252:255], a[216:219], v[92:95]
    ds_read_b64_tr_b16 a[248:249], v42 offset:0
    v_mfma_f32_16x16x32_bf16 v[124:127], a[252:255], a[220:223], v[124:127]
    ds_read_b64_tr_b16 a[250:251], v42 offset:1024
    v_mfma_f32_16x16x32_bf16 v[156:159], a[252:255], a[224:227], v[156:159]
    ds_read_b128 a[208:211], v40 offset:8192
    v_mfma_f32_16x16x32_bf16 v[188:191], a[252:255], a[228:231], v[188:191]
    ds_read_b128 a[212:215], v40 offset:10240
    v_mfma_f32_16x16x32_bf16 v[220:223], a[252:255], a[232:235], v[220:223]
    s_add_u32 m0, s41, 65536
    s_waitcnt lgkmcnt(6)
    v_mfma_f32_16x16x32_bf16 v[252:255], a[252:255], a[236:239], v[252:255]
    buffer_load_dwordx4 v4, s[8:11], s38 offen offset:2048 lds
    v_mfma_f32_16x16x32_bf16 v[64:67], a[240:243], a[192:195], v[64:67]
    s_waitcnt lgkmcnt(4)
    s_add_u32 s54, s38, 30720
    v_mfma_f32_16x16x32_bf16 v[96:99], a[240:243], a[196:199], v[96:99]
    ds_read_b64_tr_b16 a[252:253], v42 offset:8
    v_mfma_f32_16x16x32_bf16 v[128:131], a[240:243], a[200:203], v[128:131]
    ds_read_b64_tr_b16 a[254:255], v42 offset:1032
    s_add_u32 m0, s41, 68608
    v_mfma_f32_16x16x32_bf16 v[160:163], a[240:243], a[204:207], v[160:163]
    s_waitcnt lgkmcnt(2)
    buffer_load_dwordx4 v2, s[8:11], s54 offen offset:0 lds
    v_mfma_f32_16x16x32_bf16 v[192:195], a[240:243], a[208:211], v[192:195]
    s_mov_b32 s56, 20480
    v_mfma_f32_16x16x32_bf16 v[224:227], a[240:243], a[212:215], v[224:227]
    s_add_u32 m0, s94, 0
    v_mfma_f32_16x16x32_bf16 v[68:71], a[244:247], a[192:195], v[68:71]
    buffer_load_dwordx4 v48, s[60:63], s56 offen offset:0 nt lds
    v_mfma_f32_16x16x32_bf16 v[100:103], a[244:247], a[196:199], v[100:103]
    ds_read_b64_tr_b16 a[240:241], v43 offset:0
    v_mfma_f32_16x16x32_bf16 v[132:135], a[244:247], a[200:203], v[132:135]
    ds_read_b64_tr_b16 a[242:243], v43 offset:1024
    s_add_u32 m0, s41, 68608
    v_mfma_f32_16x16x32_bf16 v[164:167], a[244:247], a[204:207], v[164:167]
    buffer_load_dwordx4 v3, s[8:11], s54 offen offset:1024 lds
    v_mfma_f32_16x16x32_bf16 v[196:199], a[244:247], a[208:211], v[196:199]
    v_mfma_f32_16x16x32_bf16 v[228:231], a[244:247], a[212:215], v[228:231]
    s_add_u32 m0, s94, 0
    v_mfma_f32_16x16x32_bf16 v[72:75], a[248:251], a[192:195], v[72:75]
    buffer_load_dwordx4 v49, s[60:63], s56 offen offset:1024 nt lds
    v_mfma_f32_16x16x32_bf16 v[104:107], a[248:251], a[196:199], v[104:107]
    ds_read_b64_tr_b16 a[244:245], v43 offset:8
    v_mfma_f32_16x16x32_bf16 v[136:139], a[248:251], a[200:203], v[136:139]
    ds_read_b64_tr_b16 a[246:247], v43 offset:1032
    s_add_u32 m0, s41, 68608
    v_mfma_f32_16x16x32_bf16 v[168:171], a[248:251], a[204:207], v[168:171]
    buffer_load_dwordx4 v4, s[8:11], s54 offen offset:2048 lds
    v_mfma_f32_16x16x32_bf16 v[200:203], a[248:251], a[208:211], v[200:203]
    s_add_u32 s38, s38, 128
    v_mfma_f32_16x16x32_bf16 v[232:235], a[248:251], a[212:215], v[232:235]
    s_waitcnt lgkmcnt(4)
    s_cmp_eq_u32 s38, 1280
    s_cselect_b32 s38, 0, s38
    s_add_u32 m0, s94, 0
    v_mfma_f32_16x16x32_bf16 v[76:79], a[252:255], a[192:195], v[76:79]
    buffer_load_dwordx4 v50, s[60:63], s56 offen offset:2048 nt lds
    v_mfma_f32_16x16x32_bf16 v[108:111], a[252:255], a[196:199], v[108:111]
    ds_read_b64_tr_b16 a[248:249], v44 offset:0
    v_mfma_f32_16x16x32_bf16 v[140:143], a[252:255], a[200:203], v[140:143]
    ds_read_b64_tr_b16 a[250:251], v44 offset:1024
    s_add_u32 m0, s42, 98304
    v_mfma_f32_16x16x32_bf16 v[172:175], a[252:255], a[204:207], v[172:175]
    buffer_load_dwordx4 v5, s[12:15], s39 offen offset:0 lds
    v_mfma_f32_16x16x32_bf16 v[204:207], a[252:255], a[208:211], v[204:207]
    v_mfma_f32_16x16x32_bf16 v[236:239], a[252:255], a[212:215], v[236:239]
    s_waitcnt lgkmcnt(4)
    s_add_u32 m0, s94, 0
    v_mfma_f32_16x16x32_bf16 v[80:83], a[240:243], a[192:195], v[80:83]
    buffer_load_dwordx4 v51, s[60:63], s56 offen offset:3072 nt lds
    v_mfma_f32_16x16x32_bf16 v[112:115], a[240:243], a[196:199], v[112:115]
    ds_read_b64_tr_b16 a[252:253], v44 offset:8
    v_mfma_f32_16x16x32_bf16 v[144:147], a[240:243], a[200:203], v[144:147]
    ds_read_b64_tr_b16 a[254:255], v44 offset:1032
    v_xor_b32 v40, 0x40, v40
    v_mfma_f32_16x16x32_bf16 v[176:179], a[240:243], a[204:207], v[176:179]
    v_add_u32 v41, 0x8000, v41
    v_add_u32 v42, 0x8000, v42
    v_mfma_f32_16x16x32_bf16 v[208:211], a[240:243], a[208:211], v[208:211]
    v_add_u32 v43, 0x8000, v43
    v_mfma_f32_16x16x32_bf16 v[240:243], a[240:243], a[212:215], v[240:243]
    s_waitcnt vmcnt(15)
    s_waitcnt lgkmcnt(4)
    v_add_u32 v44, 0x8000, v44
    s_add_u32 m0, s94, 4096
    v_mfma_f32_16x16x32_bf16 v[84:87], a[244:247], a[192:195], v[84:87]
    buffer_load_dwordx4 v52, s[60:63], s56 offen offset:0 nt lds
    v_mfma_f32_16x16x32_bf16 v[116:119], a[244:247], a[196:199], v[116:119]
    s_waitcnt lgkmcnt(0)
    s_barrier
    v_mfma_f32_16x16x32_bf16 v[148:151], a[244:247], a[200:203], v[148:151]
    ds_read_b64_tr_b16 a[240:241], v41 offset:0
    v_mfma_f32_16x16x32_bf16 v[180:183], a[244:247], a[204:207], v[180:183]
    ds_read_b64_tr_b16 a[242:243], v41 offset:1024
    v_mfma_f32_16x16x32_bf16 v[212:215], a[244:247], a[208:211], v[212:215]
    ds_read_b128 a[216:219], v40 offset:0
    s_add_u32 m0, s42, 98304
    v_mfma_f32_16x16x32_bf16 v[244:247], a[244:247], a[212:215], v[244:247]
    buffer_load_dwordx4 v6, s[12:15], s39 offen offset:1024 lds
    v_mfma_f32_16x16x32_bf16 v[88:91], a[248:251], a[192:195], v[88:91]
    ds_read_b64_tr_b16 a[244:245], v41 offset:8
    v_mfma_f32_16x16x32_bf16 v[120:123], a[248:251], a[196:199], v[120:123]
    ds_read_b64_tr_b16 a[246:247], v41 offset:1032
    v_mfma_f32_16x16x32_bf16 v[152:155], a[248:251], a[200:203], v[152:155]
    ds_read_b128 a[220:223], v40 offset:2048
    v_mfma_f32_16x16x32_bf16 v[184:187], a[248:251], a[204:207], v[184:187]
    ds_read_b128 a[224:227], v40 offset:4096
    v_mfma_f32_16x16x32_bf16 v[216:219], a[248:251], a[208:211], v[216:219]
    ds_read_b128 a[228:231], v40 offset:6144
    s_add_u32 m0, s42, 98304
    v_mfma_f32_16x16x32_bf16 v[248:251], a[248:251], a[212:215], v[248:251]
    buffer_load_dwordx4 v7, s[12:15], s39 offen offset:2048 lds
    v_mfma_f32_16x16x32_bf16 v[92:95], a[252:255], a[192:195], v[92:95]
    ds_read_b64_tr_b16 a[248:249], v42 offset:0
    v_mfma_f32_16x16x32_bf16 v[124:127], a[252:255], a[196:199], v[124:127]
    ds_read_b64_tr_b16 a[250:251], v42 offset:1024
    v_mfma_f32_16x16x32_bf16 v[156:159], a[252:255], a[200:203], v[156:159]
    ds_read_b128 a[232:235], v40 offset:8192
    v_mfma_f32_16x16x32_bf16 v[188:191], a[252:255], a[204:207], v[188:191]
    ds_read_b128 a[236:239], v40 offset:10240
    v_mfma_f32_16x16x32_bf16 v[220:223], a[252:255], a[208:211], v[220:223]
    s_add_u32 m0, s42, 98304
    s_waitcnt lgkmcnt(6)
    v_mfma_f32_16x16x32_bf16 v[252:255], a[252:255], a[212:215], v[252:255]
    buffer_load_dwordx4 v38, s[12:15], s39 offen offset:3072 lds
    v_mfma_f32_16x16x32_bf16 v[64:67], a[240:243], a[216:219], v[64:67]
    s_waitcnt lgkmcnt(4)
    s_add_u32 s39, s39, 262144
    v_mfma_f32_16x16x32_bf16 v[96:99], a[240:243], a[220:223], v[96:99]
    ds_read_b64_tr_b16 a[252:253], v42 offset:8
    s_cmp_eq_u32 s39, 5242880
    s_cselect_b32 s39, 0, s39
    v_mfma_f32_16x16x32_bf16 v[128:131], a[240:243], a[224:227], v[128:131]
    ds_read_b64_tr_b16 a[254:255], v42 offset:1032
    s_add_u32 m0, s42, 0
    v_mfma_f32_16x16x32_bf16 v[160:163], a[240:243], a[228:231], v[160:163]
    s_waitcnt lgkmcnt(2)
    buffer_load_dwordx4 v5, s[12:15], s39 offen offset:0 lds
    v_mfma_f32_16x16x32_bf16 v[192:195], a[240:243], a[232:235], v[192:195]
    v_mfma_f32_16x16x32_bf16 v[224:227], a[240:243], a[236:239], v[224:227]
    v_mfma_f32_16x16x32_bf16 v[68:71], a[244:247], a[216:219], v[68:71]
    v_mfma_f32_16x16x32_bf16 v[100:103], a[244:247], a[220:223], v[100:103]
    ds_read_b64_tr_b16 a[240:241], v43 offset:0
    v_mfma_f32_16x16x32_bf16 v[132:135], a[244:247], a[224:227], v[132:135]
    ds_read_b64_tr_b16 a[242:243], v43 offset:1024
    s_add_u32 m0, s42, 0
    v_mfma_f32_16x16x32_bf16 v[164:167], a[244:247], a[228:231], v[164:167]
    buffer_load_dwordx4 v6, s[12:15], s39 offen offset:1024 lds
    v_mfma_f32_16x16x32_bf16 v[196:199], a[244:247], a[232:235], v[196:199]
    v_mfma_f32_16x16x32_bf16 v[228:231], a[244:247], a[236:239], v[228:231]
    v_mfma_f32_16x16x32_bf16 v[72:75], a[248:251], a[216:219], v[72:75]
    v_mfma_f32_16x16x32_bf16 v[104:107], a[248:251], a[220:223], v[104:107]
    ds_read_b64_tr_b16 a[244:245], v43 offset:8
    v_mfma_f32_16x16x32_bf16 v[136:139], a[248:251], a[224:227], v[136:139]
    ds_read_b64_tr_b16 a[246:247], v43 offset:1032
    s_add_u32 m0, s42, 0
    v_mfma_f32_16x16x32_bf16 v[168:171], a[248:251], a[228:231], v[168:171]
    buffer_load_dwordx4 v7, s[12:15], s39 offen offset:2048 lds
    v_mfma_f32_16x16x32_bf16 v[200:203], a[248:251], a[232:235], v[200:203]
    v_mfma_f32_16x16x32_bf16 v[232:235], a[248:251], a[236:239], v[232:235]
    s_waitcnt lgkmcnt(4)
    v_mfma_f32_16x16x32_bf16 v[76:79], a[252:255], a[216:219], v[76:79]
    v_mfma_f32_16x16x32_bf16 v[108:111], a[252:255], a[220:223], v[108:111]
    ds_read_b64_tr_b16 a[248:249], v44 offset:0
    v_mfma_f32_16x16x32_bf16 v[140:143], a[252:255], a[224:227], v[140:143]
    ds_read_b64_tr_b16 a[250:251], v44 offset:1024
    s_add_u32 m0, s42, 0
    v_mfma_f32_16x16x32_bf16 v[172:175], a[252:255], a[228:231], v[172:175]
    buffer_load_dwordx4 v38, s[12:15], s39 offen offset:3072 lds
    v_mfma_f32_16x16x32_bf16 v[204:207], a[252:255], a[232:235], v[204:207]
    s_add_u32 s39, s39, 262144
    v_mfma_f32_16x16x32_bf16 v[236:239], a[252:255], a[236:239], v[236:239]
    s_waitcnt lgkmcnt(4)
    s_cmp_eq_u32 s39, 5242880
    s_cselect_b32 s39, 0, s39
    v_mfma_f32_16x16x32_bf16 v[80:83], a[240:243], a[216:219], v[80:83]
    v_mfma_f32_16x16x32_bf16 v[112:115], a[240:243], a[220:223], v[112:115]
    ds_read_b64_tr_b16 a[252:253], v44 offset:8
    v_mfma_f32_16x16x32_bf16 v[144:147], a[240:243], a[224:227], v[144:147]
    ds_read_b64_tr_b16 a[254:255], v44 offset:1032
    v_xor_b32 v40, 0x10040, v40
    v_mfma_f32_16x16x32_bf16 v[176:179], a[240:243], a[228:231], v[176:179]
    v_add_u32 v41, 0x8000, v41
    v_add_u32 v42, 0x8000, v42
    v_mfma_f32_16x16x32_bf16 v[208:211], a[240:243], a[232:235], v[208:211]
    v_add_u32 v43, 0x8000, v43
    v_mfma_f32_16x16x32_bf16 v[240:243], a[240:243], a[236:239], v[240:243]
    s_waitcnt vmcnt(11)
    s_waitcnt lgkmcnt(4)
    v_add_u32 v44, 0x8000, v44
    v_mfma_f32_16x16x32_bf16 v[84:87], a[244:247], a[216:219], v[84:87]
    v_mfma_f32_16x16x32_bf16 v[116:119], a[244:247], a[220:223], v[116:119]
    s_waitcnt lgkmcnt(0)
    s_barrier
    v_mfma_f32_16x16x32_bf16 v[148:151], a[244:247], a[224:227], v[148:151]
    ds_read_b64_tr_b16 a[240:241], v41 offset:0
    v_mfma_f32_16x16x32_bf16 v[180:183], a[244:247], a[228:231], v[180:183]
    ds_read_b64_tr_b16 a[242:243], v41 offset:1024
    v_mfma_f32_16x16x32_bf16 v[212:215], a[244:247], a[232:235], v[212:215]
    ds_read_b128 a[192:195], v40 offset:0
    s_add_u32 m0, s41, 0
    v_mfma_f32_16x16x32_bf16 v[244:247], a[244:247], a[236:239], v[244:247]
    buffer_load_dwordx4 v2, s[8:11], s38 offen offset:0 lds
    v_mfma_f32_16x16x32_bf16 v[88:91], a[248:251], a[216:219], v[88:91]
    ds_read_b64_tr_b16 a[244:245], v41 offset:8
    v_mfma_f32_16x16x32_bf16 v[120:123], a[248:251], a[220:223], v[120:123]
    ds_read_b64_tr_b16 a[246:247], v41 offset:1032
    v_mfma_f32_16x16x32_bf16 v[152:155], a[248:251], a[224:227], v[152:155]
    ds_read_b128 a[196:199], v40 offset:2048
    v_mfma_f32_16x16x32_bf16 v[184:187], a[248:251], a[228:231], v[184:187]
    ds_read_b128 a[200:203], v40 offset:4096
    v_mfma_f32_16x16x32_bf16 v[216:219], a[248:251], a[232:235], v[216:219]
    ds_read_b128 a[204:207], v40 offset:6144
    s_add_u32 m0, s41, 0
    v_mfma_f32_16x16x32_bf16 v[248:251], a[248:251], a[236:239], v[248:251]
    buffer_load_dwordx4 v3, s[8:11], s38 offen offset:1024 lds
    v_mfma_f32_16x16x32_bf16 v[92:95], a[252:255], a[216:219], v[92:95]
    ds_read_b64_tr_b16 a[248:249], v42 offset:0
    v_mfma_f32_16x16x32_bf16 v[124:127], a[252:255], a[220:223], v[124:127]
    ds_read_b64_tr_b16 a[250:251], v42 offset:1024
    v_mfma_f32_16x16x32_bf16 v[156:159], a[252:255], a[224:227], v[156:159]
    ds_read_b128 a[208:211], v40 offset:8192
    v_mfma_f32_16x16x32_bf16 v[188:191], a[252:255], a[228:231], v[188:191]
    ds_read_b128 a[212:215], v40 offset:10240
    v_mfma_f32_16x16x32_bf16 v[220:223], a[252:255], a[232:235], v[220:223]
    s_add_u32 m0, s41, 0
    s_waitcnt lgkmcnt(6)
    v_mfma_f32_16x16x32_bf16 v[252:255], a[252:255], a[236:239], v[252:255]
    buffer_load_dwordx4 v4, s[8:11], s38 offen offset:2048 lds
    v_mfma_f32_16x16x32_bf16 v[64:67], a[240:243], a[192:195], v[64:67]
    s_waitcnt lgkmcnt(4)
    s_add_u32 s54, s38, 30720
    v_mfma_f32_16x16x32_bf16 v[96:99], a[240:243], a[196:199], v[96:99]
    ds_read_b64_tr_b16 a[252:253], v42 offset:8
    v_mfma_f32_16x16x32_bf16 v[128:131], a[240:243], a[200:203], v[128:131]
    ds_read_b64_tr_b16 a[254:255], v42 offset:1032
    s_add_u32 m0, s41, 3072
    v_mfma_f32_16x16x32_bf16 v[160:163], a[240:243], a[204:207], v[160:163]
    s_waitcnt lgkmcnt(2)
    buffer_load_dwordx4 v2, s[8:11], s54 offen offset:0 lds
    v_mfma_f32_16x16x32_bf16 v[192:195], a[240:243], a[208:211], v[192:195]
    s_waitcnt vmcnt(11)
    v_mfma_f32_16x16x32_bf16 v[224:227], a[240:243], a[212:215], v[224:227]
    ds_read_b64_tr_b16 a[98:99], v53 offset:0
    v_mfma_f32_16x16x32_bf16 v[68:71], a[244:247], a[192:195], v[68:71]
    ds_read_b64_tr_b16 a[102:103], v54 offset:0
    v_mfma_f32_16x16x32_bf16 v[100:103], a[244:247], a[196:199], v[100:103]
    ds_read_b64_tr_b16 a[240:241], v43 offset:0
    v_mfma_f32_16x16x32_bf16 v[132:135], a[244:247], a[200:203], v[132:135]
    ds_read_b64_tr_b16 a[242:243], v43 offset:1024
    s_add_u32 m0, s41, 3072
    v_mfma_f32_16x16x32_bf16 v[164:167], a[244:247], a[204:207], v[164:167]
    buffer_load_dwordx4 v3, s[8:11], s54 offen offset:1024 lds
    v_mfma_f32_16x16x32_bf16 v[196:199], a[244:247], a[208:211], v[196:199]
    ds_read_b64_tr_b16 a[106:107], v53 offset:64
    v_mfma_f32_16x16x32_bf16 v[228:231], a[244:247], a[212:215], v[228:231]
    ds_read_b64_tr_b16 a[110:111], v54 offset:64
    v_mfma_f32_16x16x32_bf16 v[72:75], a[248:251], a[192:195], v[72:75]
    ds_read_b64_tr_b16 a[114:115], v53 offset:128
    v_mfma_f32_16x16x32_bf16 v[104:107], a[248:251], a[196:199], v[104:107]
    ds_read_b64_tr_b16 a[244:245], v43 offset:8
    v_mfma_f32_16x16x32_bf16 v[136:139], a[248:251], a[200:203], v[136:139]
    ds_read_b64_tr_b16 a[246:247], v43 offset:1032
    s_add_u32 m0, s41, 3072
    v_mfma_f32_16x16x32_bf16 v[168:171], a[248:251], a[204:207], v[168:171]
    buffer_load_dwordx4 v4, s[8:11], s54 offen offset:2048 lds
    v_mfma_f32_16x16x32_bf16 v[200:203], a[248:251], a[208:211], v[200:203]
    ds_read_b64_tr_b16 a[118:119], v54 offset:128
    s_add_u32 s38, s38, 128
    v_mfma_f32_16x16x32_bf16 v[232:235], a[248:251], a[212:215], v[232:235]
    s_waitcnt lgkmcnt(10)
    s_cmp_eq_u32 s38, 1280
    s_cselect_b32 s38, 0, s38
    v_mfma_f32_16x16x32_bf16 v[76:79], a[252:255], a[192:195], v[76:79]
    ds_read_b64_tr_b16 a[122:123], v53 offset:192
    v_mfma_f32_16x16x32_bf16 v[108:111], a[252:255], a[196:199], v[108:111]
    ds_read_b64_tr_b16 a[248:249], v44 offset:0
    v_mfma_f32_16x16x32_bf16 v[140:143], a[252:255], a[200:203], v[140:143]
    ds_read_b64_tr_b16 a[250:251], v44 offset:1024
    s_add_u32 m0, s42, 32768
    v_mfma_f32_16x16x32_bf16 v[172:175], a[252:255], a[204:207], v[172:175]
    buffer_load_dwordx4 v5, s[12:15], s39 offen offset:0 lds
    v_mfma_f32_16x16x32_bf16 v[204:207], a[252:255], a[208:211], v[204:207]
    ds_read_b64_tr_b16 a[126:127], v54 offset:192
    v_mfma_f32_16x16x32_bf16 v[236:239], a[252:255], a[212:215], v[236:239]
    ds_read_b64_tr_b16 a[130:131], v53 offset:256
    s_waitcnt lgkmcnt(11)
    v_mfma_f32_16x16x32_bf16 v[80:83], a[240:243], a[192:195], v[80:83]
    ds_read_b64_tr_b16 a[134:135], v54 offset:256
    v_mfma_f32_16x16x32_bf16 v[112:115], a[240:243], a[196:199], v[112:115]
    ds_read_b64_tr_b16 a[252:253], v44 offset:8
    v_mfma_f32_16x16x32_bf16 v[144:147], a[240:243], a[200:203], v[144:147]
    ds_read_b64_tr_b16 a[254:255], v44 offset:1032
    v_xor_b32 v40, 0x40, v40
    v_mfma_f32_16x16x32_bf16 v[176:179], a[240:243], a[204:207], v[176:179]
    v_add_u32 v41, 0x8000, v41
    v_add_u32 v42, 0x8000, v42
    v_mfma_f32_16x16x32_bf16 v[208:211], a[240:243], a[208:211], v[208:211]
    v_add_u32 v43, 0x8000, v43
    v_mfma_f32_16x16x32_bf16 v[240:243], a[240:243], a[212:215], v[240:243]
    s_waitcnt vmcnt(11)
    s_waitcnt lgkmcnt(9)
    v_add_u32 v44, 0x8000, v44
    v_mfma_f32_16x16x32_bf16 v[84:87], a[244:247], a[192:195], v[84:87]
    v_mfma_f32_16x16x32_bf16 v[116:119], a[244:247], a[196:199], v[116:119]
    s_waitcnt lgkmcnt(0)
    s_barrier
    v_mfma_f32_16x16x32_bf16 v[148:151], a[244:247], a[200:203], v[148:151]
    ds_read_b64_tr_b16 a[240:241], v41 offset:0
    v_mfma_f32_16x16x32_bf16 v[180:183], a[244:247], a[204:207], v[180:183]
    ds_read_b64_tr_b16 a[242:243], v41 offset:1024
    v_mfma_f32_16x16x32_bf16 v[212:215], a[244:247], a[208:211], v[212:215]
    ds_read_b128 a[216:219], v40 offset:0
    s_add_u32 m0, s42, 32768
    v_mfma_f32_16x16x32_bf16 v[244:247], a[244:247], a[212:215], v[244:247]
    buffer_load_dwordx4 v6, s[12:15], s39 offen offset:1024 lds
    v_mfma_f32_16x16x32_bf16 v[88:91], a[248:251], a[192:195], v[88:91]
    ds_read_b64_tr_b16 a[244:245], v41 offset:8
    v_mfma_f32_16x16x32_bf16 v[120:123], a[248:251], a[196:199], v[120:123]
    ds_read_b64_tr_b16 a[246:247], v41 offset:1032
    v_mfma_f32_16x16x32_bf16 v[152:155], a[248:251], a[200:203], v[152:155]
    ds_read_b128 a[220:223], v40 offset:2048
    v_mfma_f32_16x16x32_bf16 v[184:187], a[248:251], a[204:207], v[184:187]
    ds_read_b128 a[224:227], v40 offset:4096
    v_mfma_f32_16x16x32_bf16 v[216:219], a[248:251], a[208:211], v[216:219]
    ds_read_b128 a[228:231], v40 offset:6144
    s_add_u32 m0, s42, 32768
    v_mfma_f32_16x16x32_bf16 v[248:251], a[248:251], a[212:215], v[248:251]
    buffer_load_dwordx4 v7, s[12:15], s39 offen offset:2048 lds
    v_mfma_f32_16x16x32_bf16 v[92:95], a[252:255], a[192:195], v[92:95]
    ds_read_b64_tr_b16 a[248:249], v42 offset:0
    v_mfma_f32_16x16x32_bf16 v[124:127], a[252:255], a[196:199], v[124:127]
    ds_read_b64_tr_b16 a[250:251], v42 offset:1024
    v_mfma_f32_16x16x32_bf16 v[156:159], a[252:255], a[200:203], v[156:159]
    ds_read_b128 a[232:235], v40 offset:8192
    v_mfma_f32_16x16x32_bf16 v[188:191], a[252:255], a[204:207], v[188:191]
    ds_read_b128 a[236:239], v40 offset:10240
    v_mfma_f32_16x16x32_bf16 v[220:223], a[252:255], a[208:211], v[220:223]
    s_add_u32 m0, s42, 32768
    s_waitcnt lgkmcnt(6)
    v_mfma_f32_16x16x32_bf16 v[252:255], a[252:255], a[212:215], v[252:255]
    buffer_load_dwordx4 v38, s[12:15], s39 offen offset:3072 lds
    v_mfma_f32_16x16x32_bf16 v[64:67], a[240:243], a[216:219], v[64:67]
    s_waitcnt lgkmcnt(4)
    s_add_u32 s39, s39, 262144
    v_mfma_f32_16x16x32_bf16 v[96:99], a[240:243], a[220:223], v[96:99]
    ds_read_b64_tr_b16 a[252:253], v42 offset:8
    s_cmp_eq_u32 s39, 5242880
    s_cselect_b32 s39, 0, s39
    v_mfma_f32_16x16x32_bf16 v[128:131], a[240:243], a[224:227], v[128:131]
    ds_read_b64_tr_b16 a[254:255], v42 offset:1032
    s_add_u32 m0, s42, 65536
    v_mfma_f32_16x16x32_bf16 v[160:163], a[240:243], a[228:231], v[160:163]
    s_waitcnt lgkmcnt(2)
    buffer_load_dwordx4 v5, s[12:15], s39 offen offset:0 lds
    v_mfma_f32_16x16x32_bf16 v[192:195], a[240:243], a[232:235], v[192:195]
    v_mfma_f32_16x16x32_bf16 v[224:227], a[240:243], a[236:239], v[224:227]
    s_add_u32 s57, s49, 0
    v_mfma_f32_16x16x32_bf16 v[68:71], a[244:247], a[216:219], v[68:71]
    buffer_store_dwordx4 a[96:99], v57, s[24:27], s57 offen offset:0 sc1
    v_mfma_f32_16x16x32_bf16 v[100:103], a[244:247], a[220:223], v[100:103]
    ds_read_b64_tr_b16 a[240:241], v43 offset:0
    v_mfma_f32_16x16x32_bf16 v[132:135], a[244:247], a[224:227], v[132:135]
    ds_read_b64_tr_b16 a[242:243], v43 offset:1024
    s_add_u32 m0, s42, 65536
    v_mfma_f32_16x16x32_bf16 v[164:167], a[244:247], a[228:231], v[164:167]
    buffer_load_dwordx4 v6, s[12:15], s39 offen offset:1024 lds
    v_mfma_f32_16x16x32_bf16 v[196:199], a[244:247], a[232:235], v[196:199]
    v_mfma_f32_16x16x32_bf16 v[228:231], a[244:247], a[236:239], v[228:231]
    v_mfma_f32_16x16x32_bf16 v[72:75], a[248:251], a[216:219], v[72:75]
    v_mfma_f32_16x16x32_bf16 v[104:107], a[248:251], a[220:223], v[104:107]
    ds_read_b64_tr_b16 a[244:245], v43 offset:8
    v_mfma_f32_16x16x32_bf16 v[136:139], a[248:251], a[224:227], v[136:139]
    ds_read_b64_tr_b16 a[246:247], v43 offset:1032
    s_add_u32 m0, s42, 65536
    v_mfma_f32_16x16x32_bf16 v[168:171], a[248:251], a[228:231], v[168:171]
    buffer_load_dwordx4 v7, s[12:15], s39 offen offset:2048 lds
    v_mfma_f32_16x16x32_bf16 v[200:203], a[248:251], a[232:235], v[200:203]
    buffer_store_dwordx4 a[100:103], v57, s[24:27], s57 offen offset:1024 sc1
    v_mfma_f32_16x16x32_bf16 v[232:235], a[248:251], a[236:239], v[232:235]
    s_waitcnt lgkmcnt(4)
    v_mfma_f32_16x16x32_bf16 v[76:79], a[252:255], a[216:219], v[76:79]
    v_mfma_f32_16x16x32_bf16 v[108:111], a[252:255], a[220:223], v[108:111]
    ds_read_b64_tr_b16 a[248:249], v44 offset:0
    v_mfma_f32_16x16x32_bf16 v[140:143], a[252:255], a[224:227], v[140:143]
    ds_read_b64_tr_b16 a[250:251], v44 offset:1024
    s_add_u32 m0, s42, 65536
    v_mfma_f32_16x16x32_bf16 v[172:175], a[252:255], a[228:231], v[172:175]
    buffer_load_dwordx4 v38, s[12:15], s39 offen offset:3072 lds
    v_mfma_f32_16x16x32_bf16 v[204:207], a[252:255], a[232:235], v[204:207]
    s_add_u32 s39, s39, 262144
    v_mfma_f32_16x16x32_bf16 v[236:239], a[252:255], a[236:239], v[236:239]
    s_waitcnt lgkmcnt(4)
    s_cmp_eq_u32 s39, 5242880
    s_cselect_b32 s39, 0, s39
    v_mfma_f32_16x16x32_bf16 v[80:83], a[240:243], a[216:219], v[80:83]
    buffer_store_dwordx4 a[104:107], v57, s[24:27], s57 offen offset:2048 sc1
    v_mfma_f32_16x16x32_bf16 v[112:115], a[240:243], a[220:223], v[112:115]
    ds_read_b64_tr_b16 a[252:253], v44 offset:8
    v_mfma_f32_16x16x32_bf16 v[144:147], a[240:243], a[224:227], v[144:147]
    ds_read_b64_tr_b16 a[254:255], v44 offset:1032
    v_xor_b32 v40, 0x10040, v40
    v_mfma_f32_16x16x32_bf16 v[176:179], a[240:243], a[228:231], v[176:179]
    v_subrev_u32 v41, 0x18000, v41
    v_subrev_u32 v42, 0x18000, v42
    v_mfma_f32_16x16x32_bf16 v[208:211], a[240:243], a[232:235], v[208:211]
    v_subrev_u32 v43, 0x18000, v43
    v_mfma_f32_16x16x32_bf16 v[240:243], a[240:243], a[236:239], v[240:243]
    s_waitcnt vmcnt(11)
    s_waitcnt lgkmcnt(4)
    v_subrev_u32 v44, 0x18000, v44
    v_mfma_f32_16x16x32_bf16 v[84:87], a[244:247], a[216:219], v[84:87]
    v_mfma_f32_16x16x32_bf16 v[116:119], a[244:247], a[220:223], v[116:119]
    s_waitcnt lgkmcnt(0)
    s_barrier
    v_mfma_f32_16x16x32_bf16 v[148:151], a[244:247], a[224:227], v[148:151]
    ds_read_b64_tr_b16 a[240:241], v41 offset:0
    v_mfma_f32_16x16x32_bf16 v[180:183], a[244:247], a[228:231], v[180:183]
    ds_read_b64_tr_b16 a[242:243], v41 offset:1024
    v_mfma_f32_16x16x32_bf16 v[212:215], a[244:247], a[232:235], v[212:215]
    ds_read_b128 a[192:195], v40 offset:0
    s_add_u32 m0, s41, 65536
    v_mfma_f32_16x16x32_bf16 v[244:247], a[244:247], a[236:239], v[244:247]
    buffer_load_dwordx4 v2, s[8:11], s38 offen offset:0 lds
    v_mfma_f32_16x16x32_bf16 v[88:91], a[248:251], a[216:219], v[88:91]
    ds_read_b64_tr_b16 a[244:245], v41 offset:8
    v_mfma_f32_16x16x32_bf16 v[120:123], a[248:251], a[220:223], v[120:123]
    ds_read_b64_tr_b16 a[246:247], v41 offset:1032
    v_mfma_f32_16x16x32_bf16 v[152:155], a[248:251], a[224:227], v[152:155]
    ds_read_b128 a[196:199], v40 offset:2048
    v_mfma_f32_16x16x32_bf16 v[184:187], a[248:251], a[228:231], v[184:187]
    ds_read_b128 a[200:203], v40 offset:4096
    v_mfma_f32_16x16x32_bf16 v[216:219], a[248:251], a[232:235], v[216:219]
    ds_read_b128 a[204:207], v40 offset:6144
    s_add_u32 m0, s41, 65536
    v_mfma_f32_16x16x32_bf16 v[248:251], a[248:251], a[236:239], v[248:251]
    buffer_load_dwordx4 v3, s[8:11], s38 offen offset:1024 lds
    v_mfma_f32_16x16x32_bf16 v[92:95], a[252:255], a[216:219], v[92:95]
    ds_read_b64_tr_b16 a[248:249], v42 offset:0
    v_mfma_f32_16x16x32_bf16 v[124:127], a[252:255], a[220:223], v[124:127]
    ds_read_b64_tr_b16 a[250:251], v42 offset:1024
    v_mfma_f32_16x16x32_bf16 v[156:159], a[252:255], a[224:227], v[156:159]
    ds_read_b128 a[208:211], v40 offset:8192
    v_mfma_f32_16x16x32_bf16 v[188:191], a[252:255], a[228:231], v[188:191]
    ds_read_b128 a[212:215], v40 offset:10240
    v_mfma_f32_16x16x32_bf16 v[220:223], a[252:255], a[232:235], v[220:223]
    s_add_u32 m0, s41, 65536
    s_waitcnt lgkmcnt(6)
    v_mfma_f32_16x16x32_bf16 v[252:255], a[252:255], a[236:239], v[252:255]
    buffer_load_dwordx4 v4, s[8:11], s38 offen offset:2048 lds
    v_mfma_f32_16x16x32_bf16 v[64:67], a[240:243], a[192:195], v[64:67]
    s_waitcnt lgkmcnt(4)
    s_add_u32 s54, s38, 30720
    v_mfma_f32_16x16x32_bf16 v[96:99], a[240:243], a[196:199], v[96:99]
    ds_read_b64_tr_b16 a[252:253], v42 offset:8
    v_mfma_f32_16x16x32_bf16 v[128:131], a[240:243], a[200:203], v[128:131]
    ds_read_b64_tr_b16 a[254:255], v42 offset:1032
    s_add_u32 m0, s41, 68608
    v_mfma_f32_16x16x32_bf16 v[160:163], a[240:243], a[204:207], v[160:163]
    s_waitcnt lgkmcnt(2)
    buffer_load_dwordx4 v2, s[8:11], s54 offen offset:0 lds
    v_mfma_f32_16x16x32_bf16 v[192:195], a[240:243], a[208:211], v[192:195]
    buffer_store_dwordx4 a[108:111], v57, s[24:27], s57 offen offset:3072 sc1
    v_mfma_f32_16x16x32_bf16 v[224:227], a[240:243], a[212:215], v[224:227]
    s_add_u32 s57, s49, 4096
    v_mfma_f32_16x16x32_bf16 v[68:71], a[244:247], a[192:195], v[68:71]
    v_mfma_f32_16x16x32_bf16 v[100:103], a[244:247], a[196:199], v[100:103]
    ds_read_b64_tr_b16 a[240:241], v43 offset:0
    v_mfma_f32_16x16x32_bf16 v[132:135], a[244:247], a[200:203], v[132:135]
    ds_read_b64_tr_b16 a[242:243], v43 offset:1024
    s_add_u32 m0, s41, 68608
    v_mfma_f32_16x16x32_bf16 v[164:167], a[244:247], a[204:207], v[164:167]
    buffer_load_dwordx4 v3, s[8:11], s54 offen offset:1024 lds
    v_mfma_f32_16x16x32_bf16 v[196:199], a[244:247], a[208:211], v[196:199]
    v_mfma_f32_16x16x32_bf16 v[228:231], a[244:247], a[212:215], v[228:231]
    v_mfma_f32_16x16x32_bf16 v[72:75], a[248:251], a[192:195], v[72:75]
    buffer_store_dwordx4 a[112:115], v57, s[24:27], s57 offen offset:0 sc1
    v_mfma_f32_16x16x32_bf16 v[104:107], a[248:251], a[196:199], v[104:107]
    ds_read_b64_tr_b16 a[244:245], v43 offset:8
    v_mfma_f32_16x16x32_bf16 v[136:139], a[248:251], a[200:203], v[136:139]
    ds_read_b64_tr_b16 a[246:247], v43 offset:1032
    s_add_u32 m0, s41, 68608
    v_mfma_f32_16x16x32_bf16 v[168:171], a[248:251], a[204:207], v[168:171]
    buffer_load_dwordx4 v4, s[8:11], s54 offen offset:2048 lds
    v_mfma_f32_16x16x32_bf16 v[200:203], a[248:251], a[208:211], v[200:203]
    s_add_u32 s38, s38, 128
    v_mfma_f32_16x16x32_bf16 v[232:235], a[248:251], a[212:215], v[232:235]
    s_waitcnt lgkmcnt(4)
    s_cmp_eq_u32 s38, 1280
    s_cselect_b32 s38, 0, s38
    v_mfma_f32_16x16x32_bf16 v[76:79], a[252:255], a[192:195], v[76:79]
    v_mfma_f32_16x16x32_bf16 v[108:111], a[252:255], a[196:199], v[108:111]
    ds_read_b64_tr_b16 a[248:249], v44 offset:0
    v_mfma_f32_16x16x32_bf16 v[140:143], a[252:255], a[200:203], v[140:143]
    ds_read_b64_tr_b16 a[250:251], v44 offset:1024
    s_add_u32 m0, s42, 98304
    v_mfma_f32_16x16x32_bf16 v[172:175], a[252:255], a[204:207], v[172:175]
    buffer_load_dwordx4 v5, s[12:15], s39 offen offset:0 lds
    v_mfma_f32_16x16x32_bf16 v[204:207], a[252:255], a[208:211], v[204:207]
    buffer_store_dwordx4 a[116:119], v57, s[24:27], s57 offen offset:1024 sc1
    v_mfma_f32_16x16x32_bf16 v[236:239], a[252:255], a[212:215], v[236:239]
    s_waitcnt lgkmcnt(4)
    v_mfma_f32_16x16x32_bf16 v[80:83], a[240:243], a[192:195], v[80:83]
    v_mfma_f32_16x16x32_bf16 v[112:115], a[240:243], a[196:199], v[112:115]
    ds_read_b64_tr_b16 a[252:253], v44 offset:8
    v_mfma_f32_16x16x32_bf16 v[144:147], a[240:243], a[200:203], v[144:147]
    ds_read_b64_tr_b16 a[254:255], v44 offset:1032
    v_xor_b32 v40, 0x40, v40
    v_mfma_f32_16x16x32_bf16 v[176:179], a[240:243], a[204:207], v[176:179]
    v_add_u32 v41, 0x8000, v41
    v_add_u32 v42, 0x8000, v42
    v_mfma_f32_16x16x32_bf16 v[208:211], a[240:243], a[208:211], v[208:211]
    v_add_u32 v43, 0x8000, v43
    v_mfma_f32_16x16x32_bf16 v[240:243], a[240:243], a[212:215], v[240:243]
    s_waitcnt vmcnt(17)
    s_waitcnt lgkmcnt(4)
    v_add_u32 v44, 0x8000, v44
    v_mfma_f32_16x16x32_bf16 v[84:87], a[244:247], a[192:195], v[84:87]
    buffer_store_dwordx4 a[120:123], v57, s[24:27], s57 offen offset:2048 sc1
    v_mfma_f32_16x16x32_bf16 v[116:119], a[244:247], a[196:199], v[116:119]
    s_waitcnt lgkmcnt(0)
    s_barrier
    v_mfma_f32_16x16x32_bf16 v[148:151], a[244:247], a[200:203], v[148:151]
    ds_read_b64_tr_b16 a[240:241], v41 offset:0
    v_mfma_f32_16x16x32_bf16 v[180:183], a[244:247], a[204:207], v[180:183]
    ds_read_b64_tr_b16 a[242:243], v41 offset:1024
    v_mfma_f32_16x16x32_bf16 v[212:215], a[244:247], a[208:211], v[212:215]
    ds_read_b128 a[216:219], v40 offset:0
    s_add_u32 m0, s42, 98304
    v_mfma_f32_16x16x32_bf16 v[244:247], a[244:247], a[212:215], v[244:247]
    buffer_load_dwordx4 v6, s[12:15], s39 offen offset:1024 lds
    v_mfma_f32_16x16x32_bf16 v[88:91], a[248:251], a[192:195], v[88:91]
    ds_read_b64_tr_b16 a[244:245], v41 offset:8
    v_mfma_f32_16x16x32_bf16 v[120:123], a[248:251], a[196:199], v[120:123]
    ds_read_b64_tr_b16 a[246:247], v41 offset:1032
    v_mfma_f32_16x16x32_bf16 v[152:155], a[248:251], a[200:203], v[152:155]
    ds_read_b128 a[220:223], v40 offset:2048
    v_mfma_f32_16x16x32_bf16 v[184:187], a[248:251], a[204:207], v[184:187]
    ds_read_b128 a[224:227], v40 offset:4096
    v_mfma_f32_16x16x32_bf16 v[216:219], a[248:251], a[208:211], v[216:219]
    ds_read_b128 a[228:231], v40 offset:6144
    s_add_u32 m0, s42, 98304
    v_mfma_f32_16x16x32_bf16 v[248:251], a[248:251], a[212:215], v[248:251]
    buffer_load_dwordx4 v7, s[12:15], s39 offen offset:2048 lds
    v_mfma_f32_16x16x32_bf16 v[92:95], a[252:255], a[192:195], v[92:95]
    ds_read_b64_tr_b16 a[248:249], v42 offset:0
    v_mfma_f32_16x16x32_bf16 v[124:127], a[252:255], a[196:199], v[124:127]
    ds_read_b64_tr_b16 a[250:251], v42 offset:1024
    v_mfma_f32_16x16x32_bf16 v[156:159], a[252:255], a[200:203], v[156:159]
    ds_read_b128 a[232:235], v40 offset:8192
    v_mfma_f32_16x16x32_bf16 v[188:191], a[252:255], a[204:207], v[188:191]
    ds_read_b128 a[236:239], v40 offset:10240
    v_mfma_f32_16x16x32_bf16 v[220:223], a[252:255], a[208:211], v[220:223]
    s_add_u32 m0, s42, 98304
    s_waitcnt lgkmcnt(6)
    v_mfma_f32_16x16x32_bf16 v[252:255], a[252:255], a[212:215], v[252:255]
    buffer_load_dwordx4 v38, s[12:15], s39 offen offset:3072 lds
    v_mfma_f32_16x16x32_bf16 v[64:67], a[240:243], a[216:219], v[64:67]
    s_waitcnt lgkmcnt(4)
    s_add_u32 s39, s39, 262144
    v_mfma_f32_16x16x32_bf16 v[96:99], a[240:243], a[220:223], v[96:99]
    ds_read_b64_tr_b16 a[252:253], v42 offset:8
    s_cmp_eq_u32 s39, 5242880
    s_cselect_b32 s39, 0, s39
    v_mfma_f32_16x16x32_bf16 v[128:131], a[240:243], a[224:227], v[128:131]
    ds_read_b64_tr_b16 a[254:255], v42 offset:1032
    s_add_u32 m0, s42, 0
    v_mfma_f32_16x16x32_bf16 v[160:163], a[240:243], a[228:231], v[160:163]
    s_waitcnt lgkmcnt(2)
    buffer_load_dwordx4 v5, s[12:15], s39 offen offset:0 lds
    v_mfma_f32_16x16x32_bf16 v[192:195], a[240:243], a[232:235], v[192:195]
    buffer_store_dwordx4 a[124:127], v57, s[24:27], s57 offen offset:3072 sc1
    v_mfma_f32_16x16x32_bf16 v[224:227], a[240:243], a[236:239], v[224:227]
    s_add_u32 s57, s49, 8192
    v_mfma_f32_16x16x32_bf16 v[68:71], a[244:247], a[216:219], v[68:71]
    v_mfma_f32_16x16x32_bf16 v[100:103], a[244:247], a[220:223], v[100:103]
    ds_read_b64_tr_b16 a[240:241], v43 offset:0
    v_mfma_f32_16x16x32_bf16 v[132:135], a[244:247], a[224:227], v[132:135]
    ds_read_b64_tr_b16 a[242:243], v43 offset:1024
    s_add_u32 m0, s42, 0
    v_mfma_f32_16x16x32_bf16 v[164:167], a[244:247], a[228:231], v[164:167]
    buffer_load_dwordx4 v6, s[12:15], s39 offen offset:1024 lds
    v_mfma_f32_16x16x32_bf16 v[196:199], a[244:247], a[232:235], v[196:199]
    v_mfma_f32_16x16x32_bf16 v[228:231], a[244:247], a[236:239], v[228:231]
    v_mfma_f32_16x16x32_bf16 v[72:75], a[248:251], a[216:219], v[72:75]
    buffer_store_dwordx4 a[128:131], v57, s[24:27], s57 offen offset:0 sc1
    v_mfma_f32_16x16x32_bf16 v[104:107], a[248:251], a[220:223], v[104:107]
    ds_read_b64_tr_b16 a[244:245], v43 offset:8
    v_mfma_f32_16x16x32_bf16 v[136:139], a[248:251], a[224:227], v[136:139]
    ds_read_b64_tr_b16 a[246:247], v43 offset:1032
    s_add_u32 m0, s42, 0
    v_mfma_f32_16x16x32_bf16 v[168:171], a[248:251], a[228:231], v[168:171]
    buffer_load_dwordx4 v7, s[12:15], s39 offen offset:2048 lds
    v_mfma_f32_16x16x32_bf16 v[200:203], a[248:251], a[232:235], v[200:203]
    v_mfma_f32_16x16x32_bf16 v[232:235], a[248:251], a[236:239], v[232:235]
    s_waitcnt lgkmcnt(4)
    v_mfma_f32_16x16x32_bf16 v[76:79], a[252:255], a[216:219], v[76:79]
    v_mfma_f32_16x16x32_bf16 v[108:111], a[252:255], a[220:223], v[108:111]
    ds_read_b64_tr_b16 a[248:249], v44 offset:0
    v_mfma_f32_16x16x32_bf16 v[140:143], a[252:255], a[224:227], v[140:143]
    ds_read_b64_tr_b16 a[250:251], v44 offset:1024
    s_add_u32 m0, s42, 0
    v_mfma_f32_16x16x32_bf16 v[172:175], a[252:255], a[228:231], v[172:175]
    buffer_load_dwordx4 v38, s[12:15], s39 offen offset:3072 lds
    v_mfma_f32_16x16x32_bf16 v[204:207], a[252:255], a[232:235], v[204:207]
    s_add_u32 s39, s39, 262144
    buffer_store_dwordx4 a[132:135], v57, s[24:27], s57 offen offset:1024 sc1
    v_mfma_f32_16x16x32_bf16 v[236:239], a[252:255], a[236:239], v[236:239]
    s_waitcnt lgkmcnt(4)
    s_cmp_eq_u32 s39, 5242880
    s_cselect_b32 s39, 0, s39
    v_mfma_f32_16x16x32_bf16 v[80:83], a[240:243], a[216:219], v[80:83]
    v_mfma_f32_16x16x32_bf16 v[112:115], a[240:243], a[220:223], v[112:115]
    ds_read_b64_tr_b16 a[252:253], v44 offset:8
    v_mfma_f32_16x16x32_bf16 v[144:147], a[240:243], a[224:227], v[144:147]
    ds_read_b64_tr_b16 a[254:255], v44 offset:1032
    v_xor_b32 v40, 0x10040, v40
    v_mfma_f32_16x16x32_bf16 v[176:179], a[240:243], a[228:231], v[176:179]
    v_add_u32 v41, 0x8000, v41
    v_add_u32 v42, 0x8000, v42
    v_mfma_f32_16x16x32_bf16 v[208:211], a[240:243], a[232:235], v[208:211]
    v_add_u32 v43, 0x8000, v43
    v_mfma_f32_16x16x32_bf16 v[240:243], a[240:243], a[236:239], v[240:243]
    s_waitcnt vmcnt(13)
    s_waitcnt lgkmcnt(4)
    v_add_u32 v44, 0x8000, v44
    v_mfma_f32_16x16x32_bf16 v[84:87], a[244:247], a[216:219], v[84:87]
    v_mfma_f32_16x16x32_bf16 v[116:119], a[244:247], a[220:223], v[116:119]
    s_waitcnt lgkmcnt(0)
    s_barrier
    v_mfma_f32_16x16x32_bf16 v[148:151], a[244:247], a[224:227], v[148:151]
    ds_read_b64_tr_b16 a[240:241], v41 offset:0
    v_mfma_f32_16x16x32_bf16 v[180:183], a[244:247], a[228:231], v[180:183]
    ds_read_b64_tr_b16 a[242:243], v41 offset:1024
    v_mfma_f32_16x16x32_bf16 v[212:215], a[244:247], a[232:235], v[212:215]
    ds_read_b128 a[192:195], v40 offset:0
    s_add_u32 m0, s41, 0
    v_mfma_f32_16x16x32_bf16 v[244:247], a[244:247], a[236:239], v[244:247]
    buffer_load_dwordx4 v2, s[8:11], s38 offen offset:0 lds
    v_mfma_f32_16x16x32_bf16 v[88:91], a[248:251], a[216:219], v[88:91]
    ds_read_b64_tr_b16 a[244:245], v41 offset:8
    v_mfma_f32_16x16x32_bf16 v[120:123], a[248:251], a[220:223], v[120:123]
    ds_read_b64_tr_b16 a[246:247], v41 offset:1032
    v_mfma_f32_16x16x32_bf16 v[152:155], a[248:251], a[224:227], v[152:155]
    ds_read_b128 a[196:199], v40 offset:2048
    v_mfma_f32_16x16x32_bf16 v[184:187], a[248:251], a[228:231], v[184:187]
    ds_read_b128 a[200:203], v40 offset:4096
    v_mfma_f32_16x16x32_bf16 v[216:219], a[248:251], a[232:235], v[216:219]
    ds_read_b128 a[204:207], v40 offset:6144
    s_add_u32 m0, s41, 0
    v_mfma_f32_16x16x32_bf16 v[248:251], a[248:251], a[236:239], v[248:251]
    buffer_load_dwordx4 v3, s[8:11], s38 offen offset:1024 lds
    v_mfma_f32_16x16x32_bf16 v[92:95], a[252:255], a[216:219], v[92:95]
    ds_read_b64_tr_b16 a[248:249], v42 offset:0
    v_mfma_f32_16x16x32_bf16 v[124:127], a[252:255], a[220:223], v[124:127]
    ds_read_b64_tr_b16 a[250:251], v42 offset:1024
    v_mfma_f32_16x16x32_bf16 v[156:159], a[252:255], a[224:227], v[156:159]
    ds_read_b128 a[208:211], v40 offset:8192
    v_mfma_f32_16x16x32_bf16 v[188:191], a[252:255], a[228:231], v[188:191]
    ds_read_b128 a[212:215], v40 offset:10240
    v_mfma_f32_16x16x32_bf16 v[220:223], a[252:255], a[232:235], v[220:223]
    s_add_u32 m0, s41, 0
    s_waitcnt lgkmcnt(6)
    v_mfma_f32_16x16x32_bf16 v[252:255], a[252:255], a[236:239], v[252:255]
    buffer_load_dwordx4 v4, s[8:11], s38 offen offset:2048 lds
    v_mfma_f32_16x16x32_bf16 v[64:67], a[240:243], a[192:195], v[64:67]
    s_waitcnt lgkmcnt(4)
    s_add_u32 s54, s38, 30720
    v_mfma_f32_16x16x32_bf16 v[96:99], a[240:243], a[196:199], v[96:99]
    ds_read_b64_tr_b16 a[252:253], v42 offset:8
    v_mfma_f32_16x16x32_bf16 v[128:131], a[240:243], a[200:203], v[128:131]
    ds_read_b64_tr_b16 a[254:255], v42 offset:1032
    s_add_u32 m0, s41, 3072
    v_mfma_f32_16x16x32_bf16 v[160:163], a[240:243], a[204:207], v[160:163]
    s_waitcnt lgkmcnt(2)
    buffer_load_dwordx4 v2, s[8:11], s54 offen offset:0 lds
    v_mfma_f32_16x16x32_bf16 v[192:195], a[240:243], a[208:211], v[192:195]
    v_mfma_f32_16x16x32_bf16 v[224:227], a[240:243], a[212:215], v[224:227]
    v_mfma_f32_16x16x32_bf16 v[68:71], a[244:247], a[192:195], v[68:71]
    v_mfma_f32_16x16x32_bf16 v[100:103], a[244:247], a[196:199], v[100:103]
    ds_read_b64_tr_b16 a[240:241], v43 offset:0
    v_mfma_f32_16x16x32_bf16 v[132:135], a[244:247], a[200:203], v[132:135]
    ds_read_b64_tr_b16 a[242:243], v43 offset:1024
    s_add_u32 m0, s41, 3072
    v_mfma_f32_16x16x32_bf16 v[164:167], a[244:247], a[204:207], v[164:167]
    buffer_load_dwordx4 v3, s[8:11], s54 offen offset:1024 lds
    v_mfma_f32_16x16x32_bf16 v[196:199], a[244:247], a[208:211], v[196:199]
    v_mfma_f32_16x16x32_bf16 v[228:231], a[244:247], a[212:215], v[228:231]
    v_mfma_f32_16x16x32_bf16 v[72:75], a[248:251], a[192:195], v[72:75]
    v_mfma_f32_16x16x32_bf16 v[104:107], a[248:251], a[196:199], v[104:107]
    ds_read_b64_tr_b16 a[244:245], v43 offset:8
    v_mfma_f32_16x16x32_bf16 v[136:139], a[248:251], a[200:203], v[136:139]
    ds_read_b64_tr_b16 a[246:247], v43 offset:1032
    s_add_u32 m0, s41, 3072
    v_mfma_f32_16x16x32_bf16 v[168:171], a[248:251], a[204:207], v[168:171]
    buffer_load_dwordx4 v4, s[8:11], s54 offen offset:2048 lds
    v_mfma_f32_16x16x32_bf16 v[200:203], a[248:251], a[208:211], v[200:203]
    s_add_u32 s38, s38, 128
    v_mfma_f32_16x16x32_bf16 v[232:235], a[248:251], a[212:215], v[232:235]
    s_waitcnt lgkmcnt(4)
    s_cmp_eq_u32 s38, 1280
    s_cselect_b32 s38, 0, s38
    v_mfma_f32_16x16x32_bf16 v[76:79], a[252:255], a[192:195], v[76:79]
    v_mfma_f32_16x16x32_bf16 v[108:111], a[252:255], a[196:199], v[108:111]
    ds_read_b64_tr_b16 a[248:249], v44 offset:0
    v_mfma_f32_16x16x32_bf16 v[140:143], a[252:255], a[200:203], v[140:143]
    ds_read_b64_tr_b16 a[250:251], v44 offset:1024
    s_add_u32 m0, s42, 32768
    v_mfma_f32_16x16x32_bf16 v[172:175], a[252:255], a[204:207], v[172:175]
    buffer_load_dwordx4 v5, s[12:15], s39 offen offset:0 lds
    v_mfma_f32_16x16x32_bf16 v[204:207], a[252:255], a[208:211], v[204:207]
    v_mfma_f32_16x16x32_bf16 v[236:239], a[252:255], a[212:215], v[236:239]
    s_waitcnt lgkmcnt(4)
    v_mfma_f32_16x16x32_bf16 v[80:83], a[240:243], a[192:195], v[80:83]
    v_mfma_f32_16x16x32_bf16 v[112:115], a[240:243], a[196:199], v[112:115]
    ds_read_b64_tr_b16 a[252:253], v44 offset:8
    v_mfma_f32_16x16x32_bf16 v[144:147], a[240:243], a[200:203], v[144:147]
    ds_read_b64_tr_b16 a[254:255], v44 offset:1032
    v_xor_b32 v40, 0x40, v40
    v_mfma_f32_16x16x32_bf16 v[176:179], a[240:243], a[204:207], v[176:179]
    v_add_u32 v41, 0x8000, v41
    v_add_u32 v42, 0x8000, v42
    v_mfma_f32_16x16x32_bf16 v[208:211], a[240:243], a[208:211], v[208:211]
    v_add_u32 v43, 0x8000, v43
    v_mfma_f32_16x16x32_bf16 v[240:243], a[240:243], a[212:215], v[240:243]
    s_waitcnt vmcnt(14)
    s_waitcnt lgkmcnt(4)
    v_add_u32 v44, 0x8000, v44
    v_mfma_f32_16x16x32_bf16 v[84:87], a[244:247], a[192:195], v[84:87]
    v_mfma_f32_16x16x32_bf16 v[116:119], a[244:247], a[196:199], v[116:119]
    s_waitcnt lgkmcnt(0)
    s_barrier
    v_mfma_f32_16x16x32_bf16 v[148:151], a[244:247], a[200:203], v[148:151]
    ds_read_b64_tr_b16 a[240:241], v41 offset:0
    v_mfma_f32_16x16x32_bf16 v[180:183], a[244:247], a[204:207], v[180:183]
    ds_read_b64_tr_b16 a[242:243], v41 offset:1024
    v_mfma_f32_16x16x32_bf16 v[212:215], a[244:247], a[208:211], v[212:215]
    ds_read_b128 a[216:219], v40 offset:0
    s_add_u32 m0, s42, 32768
    v_mfma_f32_16x16x32_bf16 v[244:247], a[244:247], a[212:215], v[244:247]
    buffer_load_dwordx4 v6, s[12:15], s39 offen offset:1024 lds
    v_mfma_f32_16x16x32_bf16 v[88:91], a[248:251], a[192:195], v[88:91]
    ds_read_b64_tr_b16 a[244:245], v41 offset:8
    v_mfma_f32_16x16x32_bf16 v[120:123], a[248:251], a[196:199], v[120:123]
    ds_read_b64_tr_b16 a[246:247], v41 offset:1032
    v_mfma_f32_16x16x32_bf16 v[152:155], a[248:251], a[200:203], v[152:155]
    ds_read_b128 a[220:223], v40 offset:2048
    v_mfma_f32_16x16x32_bf16 v[184:187], a[248:251], a[204:207], v[184:187]
    ds_read_b128 a[224:227], v40 offset:4096
    v_mfma_f32_16x16x32_bf16 v[216:219], a[248:251], a[208:211], v[216:219]
    ds_read_b128 a[228:231], v40 offset:6144
    s_add_u32 m0, s42, 32768
    v_mfma_f32_16x16x32_bf16 v[248:251], a[248:251], a[212:215], v[248:251]
    buffer_load_dwordx4 v7, s[12:15], s39 offen offset:2048 lds
    v_mfma_f32_16x16x32_bf16 v[92:95], a[252:255], a[192:195], v[92:95]
    ds_read_b64_tr_b16 a[248:249], v42 offset:0
    v_mfma_f32_16x16x32_bf16 v[124:127], a[252:255], a[196:199], v[124:127]
    ds_read_b64_tr_b16 a[250:251], v42 offset:1024
    v_mfma_f32_16x16x32_bf16 v[156:159], a[252:255], a[200:203], v[156:159]
    ds_read_b128 a[232:235], v40 offset:8192
    v_mfma_f32_16x16x32_bf16 v[188:191], a[252:255], a[204:207], v[188:191]
    ds_read_b128 a[236:239], v40 offset:10240
    v_mfma_f32_16x16x32_bf16 v[220:223], a[252:255], a[208:211], v[220:223]
    s_add_u32 m0, s42, 32768
    s_waitcnt lgkmcnt(6)
    v_mfma_f32_16x16x32_bf16 v[252:255], a[252:255], a[212:215], v[252:255]
    buffer_load_dwordx4 v38, s[12:15], s39 offen offset:3072 lds
    v_mfma_f32_16x16x32_bf16 v[64:67], a[240:243], a[216:219], v[64:67]
    s_waitcnt lgkmcnt(4)
    s_add_u32 s39, s39, 262144
    v_mfma_f32_16x16x32_bf16 v[96:99], a[240:243], a[220:223], v[96:99]
    ds_read_b64_tr_b16 a[252:253], v42 offset:8
    s_cmp_eq_u32 s39, 5242880
    s_cselect_b32 s39, 0, s39
    v_mfma_f32_16x16x32_bf16 v[128:131], a[240:243], a[224:227], v[128:131]
    ds_read_b64_tr_b16 a[254:255], v42 offset:1032
    s_add_u32 m0, s42, 65536
    v_mfma_f32_16x16x32_bf16 v[160:163], a[240:243], a[228:231], v[160:163]
    s_waitcnt lgkmcnt(2)
    buffer_load_dwordx4 v5, s[12:15], s39 offen offset:0 lds
    v_mfma_f32_16x16x32_bf16 v[192:195], a[240:243], a[232:235], v[192:195]
    v_mfma_f32_16x16x32_bf16 v[224:227], a[240:243], a[236:239], v[224:227]
    v_mfma_f32_16x16x32_bf16 v[68:71], a[244:247], a[216:219], v[68:71]
    v_mfma_f32_16x16x32_bf16 v[100:103], a[244:247], a[220:223], v[100:103]
    ds_read_b64_tr_b16 a[240:241], v43 offset:0
    v_mfma_f32_16x16x32_bf16 v[132:135], a[244:247], a[224:227], v[132:135]
    ds_read_b64_tr_b16 a[242:243], v43 offset:1024
    s_add_u32 m0, s42, 65536
    v_mfma_f32_16x16x32_bf16 v[164:167], a[244:247], a[228:231], v[164:167]
    buffer_load_dwordx4 v6, s[12:15], s39 offen offset:1024 lds
    v_mfma_f32_16x16x32_bf16 v[196:199], a[244:247], a[232:235], v[196:199]
    v_mfma_f32_16x16x32_bf16 v[228:231], a[244:247], a[236:239], v[228:231]
    v_mfma_f32_16x16x32_bf16 v[72:75], a[248:251], a[216:219], v[72:75]
    v_mfma_f32_16x16x32_bf16 v[104:107], a[248:251], a[220:223], v[104:107]
    ds_read_b64_tr_b16 a[244:245], v43 offset:8
    v_mfma_f32_16x16x32_bf16 v[136:139], a[248:251], a[224:227], v[136:139]
    ds_read_b64_tr_b16 a[246:247], v43 offset:1032
    s_add_u32 m0, s42, 65536
    v_mfma_f32_16x16x32_bf16 v[168:171], a[248:251], a[228:231], v[168:171]
    buffer_load_dwordx4 v7, s[12:15], s39 offen offset:2048 lds
    v_mfma_f32_16x16x32_bf16 v[200:203], a[248:251], a[232:235], v[200:203]
    v_mfma_f32_16x16x32_bf16 v[232:235], a[248:251], a[236:239], v[232:235]
    s_waitcnt lgkmcnt(4)
    v_mfma_f32_16x16x32_bf16 v[76:79], a[252:255], a[216:219], v[76:79]
    v_mfma_f32_16x16x32_bf16 v[108:111], a[252:255], a[220:223], v[108:111]
    ds_read_b64_tr_b16 a[248:249], v44 offset:0
    v_mfma_f32_16x16x32_bf16 v[140:143], a[252:255], a[224:227], v[140:143]
    ds_read_b64_tr_b16 a[250:251], v44 offset:1024
    s_add_u32 m0, s42, 65536
    v_mfma_f32_16x16x32_bf16 v[172:175], a[252:255], a[228:231], v[172:175]
    buffer_load_dwordx4 v38, s[12:15], s39 offen offset:3072 lds
    v_mfma_f32_16x16x32_bf16 v[204:207], a[252:255], a[232:235], v[204:207]
    s_add_u32 s39, s39, 262144
    v_mfma_f32_16x16x32_bf16 v[236:239], a[252:255], a[236:239], v[236:239]
    s_waitcnt lgkmcnt(4)
    s_cmp_eq_u32 s39, 5242880
    s_cselect_b32 s39, 0, s39
    s_add_u32 m0, s43, 131072
    v_mfma_f32_16x16x32_bf16 v[80:83], a[240:243], a[216:219], v[80:83]
    buffer_load_dwordx4 v8, s[16:19], s40 offen offset:0 nt lds
    v_mfma_f32_16x16x32_bf16 v[112:115], a[240:243], a[220:223], v[112:115]
    ds_read_b64_tr_b16 a[252:253], v44 offset:8
    v_mfma_f32_16x16x32_bf16 v[144:147], a[240:243], a[224:227], v[144:147]
    ds_read_b64_tr_b16 a[254:255], v44 offset:1032
    v_xor_b32 v40, 0x10040, v40
    v_mfma_f32_16x16x32_bf16 v[176:179], a[240:243], a[228:231], v[176:179]
    v_subrev_u32 v41, 0x18000, v41
    v_subrev_u32 v42, 0x18000, v42
    v_mfma_f32_16x16x32_bf16 v[208:211], a[240:243], a[232:235], v[208:211]
    v_subrev_u32 v43, 0x18000, v43
    v_mfma_f32_16x16x32_bf16 v[240:243], a[240:243], a[236:239], v[240:243]
    s_waitcnt vmcnt(9)
    s_waitcnt lgkmcnt(4)
    s_add_u32 m0, s43, 131072
    v_subrev_u32 v44, 0x18000, v44
    v_mfma_f32_16x16x32_bf16 v[84:87], a[244:247], a[216:219], v[84:87]
    buffer_load_dwordx4 v9, s[16:19], s40 offen offset:1024 nt lds
    v_mfma_f32_16x16x32_bf16 v[116:119], a[244:247], a[220:223], v[116:119]
    s_waitcnt lgkmcnt(0)
    s_barrier
    v_mfma_f32_16x16x32_bf16 v[148:151], a[244:247], a[224:227], v[148:151]
    ds_read_b64_tr_b16 a[240:241], v41 offset:0
    v_mfma_f32_16x16x32_bf16 v[180:183], a[244:247], a[228:231], v[180:183]
    ds_read_b64_tr_b16 a[242:243], v41 offset:1024
    v_mfma_f32_16x16x32_bf16 v[212:215], a[244:247], a[232:235], v[212:215]
    ds_read_b128 a[192:195], v40 offset:0
    s_add_u32 m0, s41, 65536
    v_mfma_f32_16x16x32_bf16 v[244:247], a[244:247], a[236:239], v[244:247]
    buffer_load_dwordx4 v2, s[8:11], s38 offen offset:0 lds
    v_mfma_f32_16x16x32_bf16 v[88:91], a[248:251], a[216:219], v[88:91]
    ds_read_b64_tr_b16 a[244:245], v41 offset:8
    v_mfma_f32_16x16x32_bf16 v[120:123], a[248:251], a[220:223], v[120:123]
    ds_read_b64_tr_b16 a[246:247], v41 offset:1032
    v_mfma_f32_16x16x32_bf16 v[152:155], a[248:251], a[224:227], v[152:155]
    ds_read_b128 a[196:199], v40 offset:2048
    v_mfma_f32_16x16x32_bf16 v[184:187], a[248:251], a[228:231], v[184:187]
    ds_read_b128 a[200:203], v40 offset:4096
    v_mfma_f32_16x16x32_bf16 v[216:219], a[248:251], a[232:235], v[216:219]
    ds_read_b128 a[204:207], v40 offset:6144
    s_add_u32 m0, s41, 65536
    v_mfma_f32_16x16x32_bf16 v[248:251], a[248:251], a[236:239], v[248:251]
    buffer_load_dwordx4 v3, s[8:11], s38 offen offset:1024 lds
    v_mfma_f32_16x16x32_bf16 v[92:95], a[252:255], a[216:219], v[92:95]
    ds_read_b64_tr_b16 a[248:249], v42 offset:0
    v_mfma_f32_16x16x32_bf16 v[124:127], a[252:255], a[220:223], v[124:127]
    ds_read_b64_tr_b16 a[250:251], v42 offset:1024
    v_mfma_f32_16x16x32_bf16 v[156:159], a[252:255], a[224:227], v[156:159]
    ds_read_b128 a[208:211], v40 offset:8192
    v_mfma_f32_16x16x32_bf16 v[188:191], a[252:255], a[228:231], v[188:191]
    ds_read_b128 a[212:215], v40 offset:10240
    v_mfma_f32_16x16x32_bf16 v[220:223], a[252:255], a[232:235], v[220:223]
    s_add_u32 m0, s41, 65536
    s_waitcnt lgkmcnt(6)
    v_mfma_f32_16x16x32_bf16 v[252:255], a[252:255], a[236:239], v[252:255]
    buffer_load_dwordx4 v4, s[8:11], s38 offen offset:2048 lds
    v_mfma_f32_16x16x32_bf16 v[64:67], a[240:243], a[192:195], v[64:67]
    s_waitcnt lgkmcnt(4)
    s_add_u32 s54, s38, 30720
    v_mfma_f32_16x16x32_bf16 v[96:99], a[240:243], a[196:199], v[96:99]
    ds_read_b64_tr_b16 a[252:253], v42 offset:8
    v_mfma_f32_16x16x32_bf16 v[128:131], a[240:243], a[200:203], v[128:131]
    ds_read_b64_tr_b16 a[254:255], v42 offset:1032
    s_add_u32 m0, s41, 68608
    v_mfma_f32_16x16x32_bf16 v[160:163], a[240:243], a[204:207], v[160:163]
    s_waitcnt lgkmcnt(2)
    buffer_load_dwordx4 v2, s[8:11], s54 offen offset:0 lds
    v_mfma_f32_16x16x32_bf16 v[192:195], a[240:243], a[208:211], v[192:195]
    v_mfma_f32_16x16x32_bf16 v[224:227], a[240:243], a[212:215], v[224:227]
    v_mfma_f32_16x16x32_bf16 v[68:71], a[244:247], a[192:195], v[68:71]
    v_mfma_f32_16x16x32_bf16 v[100:103], a[244:247], a[196:199], v[100:103]
    ds_read_b64_tr_b16 a[240:241], v43 offset:0
    v_mfma_f32_16x16x32_bf16 v[132:135], a[244:247], a[200:203], v[132:135]
    ds_read_b64_tr_b16 a[242:243], v43 offset:1024
    s_add_u32 m0, s41, 68608
    v_mfma_f32_16x16x32_bf16 v[164:167], a[244:247], a[204:207], v[164:167]
    buffer_load_dwordx4 v3, s[8:11], s54 offen offset:1024 lds
    v_mfma_f32_16x16x32_bf16 v[196:199], a[244:247], a[208:211], v[196:199]
    v_mfma_f32_16x16x32_bf16 v[228:231], a[244:247], a[212:215], v[228:231]
    v_mfma_f32_16x16x32_bf16 v[72:75], a[248:251], a[192:195], v[72:75]
    v_mfma_f32_16x16x32_bf16 v[104:107], a[248:251], a[196:199], v[104:107]
    ds_read_b64_tr_b16 a[244:245], v43 offset:8
    v_mfma_f32_16x16x32_bf16 v[136:139], a[248:251], a[200:203], v[136:139]
    ds_read_b64_tr_b16 a[246:247], v43 offset:1032
    s_add_u32 m0, s41, 68608
    v_mfma_f32_16x16x32_bf16 v[168:171], a[248:251], a[204:207], v[168:171]
    buffer_load_dwordx4 v4, s[8:11], s54 offen offset:2048 lds
    v_mfma_f32_16x16x32_bf16 v[200:203], a[248:251], a[208:211], v[200:203]
    s_add_u32 s38, s38, 128
    v_mfma_f32_16x16x32_bf16 v[232:235], a[248:251], a[212:215], v[232:235]
    s_waitcnt lgkmcnt(4)
    s_cmp_eq_u32 s38, 1280
    s_cselect_b32 s38, 0, s38
    v_mfma_f32_16x16x32_bf16 v[76:79], a[252:255], a[192:195], v[76:79]
    v_mfma_f32_16x16x32_bf16 v[108:111], a[252:255], a[196:199], v[108:111]
    ds_read_b64_tr_b16 a[248:249], v44 offset:0
    v_mfma_f32_16x16x32_bf16 v[140:143], a[252:255], a[200:203], v[140:143]
    ds_read_b64_tr_b16 a[250:251], v44 offset:1024
    s_add_u32 m0, s42, 98304
    v_mfma_f32_16x16x32_bf16 v[172:175], a[252:255], a[204:207], v[172:175]
    buffer_load_dwordx4 v5, s[12:15], s39 offen offset:0 lds
    v_mfma_f32_16x16x32_bf16 v[204:207], a[252:255], a[208:211], v[204:207]
    v_mfma_f32_16x16x32_bf16 v[236:239], a[252:255], a[212:215], v[236:239]
    s_waitcnt lgkmcnt(4)
    s_add_u32 m0, s43, 131072
    v_mfma_f32_16x16x32_bf16 v[80:83], a[240:243], a[192:195], v[80:83]
    buffer_load_dwordx4 v8, s[16:19], s40 offen offset:2048 nt lds
    v_mfma_f32_16x16x32_bf16 v[112:115], a[240:243], a[196:199], v[112:115]
    ds_read_b64_tr_b16 a[252:253], v44 offset:8
    v_mfma_f32_16x16x32_bf16 v[144:147], a[240:243], a[200:203], v[144:147]
    ds_read_b64_tr_b16 a[254:255], v44 offset:1032
    v_xor_b32 v40, 0x40, v40
    v_mfma_f32_16x16x32_bf16 v[176:179], a[240:243], a[204:207], v[176:179]
    v_add_u32 v41, 0x8000, v41
    v_add_u32 v42, 0x8000, v42
    v_mfma_f32_16x16x32_bf16 v[208:211], a[240:243], a[208:211], v[208:211]
    v_add_u32 v43, 0x8000, v43
    v_mfma_f32_16x16x32_bf16 v[240:243], a[240:243], a[212:215], v[240:243]
    s_waitcnt vmcnt(14)
    s_waitcnt lgkmcnt(4)
    s_add_u32 m0, s43, 131072
    v_add_u32 v44, 0x8000, v44
    v_mfma_f32_16x16x32_bf16 v[84:87], a[244:247], a[192:195], v[84:87]
    buffer_load_dwordx4 v9, s[16:19], s40 offen offset:3072 nt lds
    s_add_u32 s40, s40, 4096
    v_mfma_f32_16x16x32_bf16 v[116:119], a[244:247], a[196:199], v[116:119]
    s_waitcnt lgkmcnt(0)
    s_barrier
    v_mfma_f32_16x16x32_bf16 v[148:151], a[244:247], a[200:203], v[148:151]
    ds_read_b64_tr_b16 a[240:241], v41 offset:0
    v_mfma_f32_16x16x32_bf16 v[180:183], a[244:247], a[204:207], v[180:183]
    ds_read_b64_tr_b16 a[242:243], v41 offset:1024
    v_mfma_f32_16x16x32_bf16 v[212:215], a[244:247], a[208:211], v[212:215]
    ds_read_b128 a[216:219], v40 offset:0
    s_add_u32 m0, s42, 98304
    v_mfma_f32_16x16x32_bf16 v[244:247], a[244:247], a[212:215], v[244:247]
    buffer_load_dwordx4 v6, s[12:15], s39 offen offset:1024 lds
    v_mfma_f32_16x16x32_bf16 v[88:91], a[248:251], a[192:195], v[88:91]
    ds_read_b64_tr_b16 a[244:245], v41 offset:8
    v_mfma_f32_16x16x32_bf16 v[120:123], a[248:251], a[196:199], v[120:123]
    ds_read_b64_tr_b16 a[246:247], v41 offset:1032
    v_mfma_f32_16x16x32_bf16 v[152:155], a[248:251], a[200:203], v[152:155]
    ds_read_b128 a[220:223], v40 offset:2048
    v_mfma_f32_16x16x32_bf16 v[184:187], a[248:251], a[204:207], v[184:187]
    ds_read_b128 a[224:227], v40 offset:4096
    v_mfma_f32_16x16x32_bf16 v[216:219], a[248:251], a[208:211], v[216:219]
    ds_read_b128 a[228:231], v40 offset:6144
    s_add_u32 m0, s42, 98304
    v_mfma_f32_16x16x32_bf16 v[248:251], a[248:251], a[212:215], v[248:251]
    buffer_load_dwordx4 v7, s[12:15], s39 offen offset:2048 lds
    v_mfma_f32_16x16x32_bf16 v[92:95], a[252:255], a[192:195], v[92:95]
    ds_read_b64_tr_b16 a[248:249], v42 offset:0
    v_mfma_f32_16x16x32_bf16 v[124:127], a[252:255], a[196:199], v[124:127]
    ds_read_b64_tr_b16 a[250:251], v42 offset:1024
    v_mfma_f32_16x16x32_bf16 v[156:159], a[252:255], a[200:203], v[156:159]
    ds_read_b128 a[232:235], v40 offset:8192
    v_mfma_f32_16x16x32_bf16 v[188:191], a[252:255], a[204:207], v[188:191]
    ds_read_b128 a[236:239], v40 offset:10240
    v_mfma_f32_16x16x32_bf16 v[220:223], a[252:255], a[208:211], v[220:223]
    s_add_u32 m0, s42, 98304
    s_waitcnt lgkmcnt(6)
    v_mfma_f32_16x16x32_bf16 v[252:255], a[252:255], a[212:215], v[252:255]
    buffer_load_dwordx4 v38, s[12:15], s39 offen offset:3072 lds
    v_mfma_f32_16x16x32_bf16 v[64:67], a[240:243], a[216:219], v[64:67]
    s_waitcnt lgkmcnt(4)
    s_add_u32 s39, s39, 262144
    v_mfma_f32_16x16x32_bf16 v[96:99], a[240:243], a[220:223], v[96:99]
    ds_read_b64_tr_b16 a[252:253], v42 offset:8
    s_cmp_eq_u32 s39, 5242880
    s_cselect_b32 s39, 0, s39
    v_mfma_f32_16x16x32_bf16 v[128:131], a[240:243], a[224:227], v[128:131]
    ds_read_b64_tr_b16 a[254:255], v42 offset:1032
    s_add_u32 m0, s42, 0
    v_mfma_f32_16x16x32_bf16 v[160:163], a[240:243], a[228:231], v[160:163]
    s_waitcnt lgkmcnt(2)
    buffer_load_dwordx4 v5, s[12:15], s39 offen offset:0 lds
    v_mfma_f32_16x16x32_bf16 v[192:195], a[240:243], a[232:235], v[192:195]
    v_mfma_f32_16x16x32_bf16 v[224:227], a[240:243], a[236:239], v[224:227]
    v_mfma_f32_16x16x32_bf16 v[68:71], a[244:247], a[216:219], v[68:71]
    v_mfma_f32_16x16x32_bf16 v[100:103], a[244:247], a[220:223], v[100:103]
    ds_read_b64_tr_b16 a[240:241], v43 offset:0
    v_mfma_f32_16x16x32_bf16 v[132:135], a[244:247], a[224:227], v[132:135]
    ds_read_b64_tr_b16 a[242:243], v43 offset:1024
    s_add_u32 m0, s42, 0
    v_mfma_f32_16x16x32_bf16 v[164:167], a[244:247], a[228:231], v[164:167]
    buffer_load_dwordx4 v6, s[12:15], s39 offen offset:1024 lds
    v_mfma_f32_16x16x32_bf16 v[196:199], a[244:247], a[232:235], v[196:199]
    v_mfma_f32_16x16x32_bf16 v[228:231], a[244:247], a[236:239], v[228:231]
    v_mfma_f32_16x16x32_bf16 v[72:75], a[248:251], a[216:219], v[72:75]
    v_mfma_f32_16x16x32_bf16 v[104:107], a[248:251], a[220:223], v[104:107]
    ds_read_b64_tr_b16 a[244:245], v43 offset:8
    v_mfma_f32_16x16x32_bf16 v[136:139], a[248:251], a[224:227], v[136:139]
    ds_read_b64_tr_b16 a[246:247], v43 offset:1032
    s_add_u32 m0, s42, 0
    v_mfma_f32_16x16x32_bf16 v[168:171], a[248:251], a[228:231], v[168:171]
    buffer_load_dwordx4 v7, s[12:15], s39 offen offset:2048 lds
    v_mfma_f32_16x16x32_bf16 v[200:203], a[248:251], a[232:235], v[200:203]
    v_mfma_f32_16x16x32_bf16 v[232:235], a[248:251], a[236:239], v[232:235]
    s_waitcnt lgkmcnt(4)
    v_mfma_f32_16x16x32_bf16 v[76:79], a[252:255], a[216:219], v[76:79]
    v_mfma_f32_16x16x32_bf16 v[108:111], a[252:255], a[220:223], v[108:111]
    ds_read_b64_tr_b16 a[248:249], v44 offset:0
    v_mfma_f32_16x16x32_bf16 v[140:143], a[252:255], a[224:227], v[140:143]
    ds_read_b64_tr_b16 a[250:251], v44 offset:1024
    s_add_u32 m0, s42, 0
    v_mfma_f32_16x16x32_bf16 v[172:175], a[252:255], a[228:231], v[172:175]
    buffer_load_dwordx4 v38, s[12:15], s39 offen offset:3072 lds
    v_mfma_f32_16x16x32_bf16 v[204:207], a[252:255], a[232:235], v[204:207]
    s_add_u32 s39, s39, 262144
    v_mfma_f32_16x16x32_bf16 v[236:239], a[252:255], a[236:239], v[236:239]
    s_waitcnt lgkmcnt(4)
    s_cmp_eq_u32 s39, 5242880
    s_cselect_b32 s39, 0, s39
    s_add_u32 m0, s43, 135168
    v_mfma_f32_16x16x32_bf16 v[80:83], a[240:243], a[216:219], v[80:83]
    buffer_load_dwordx4 v8, s[16:19], s40 offen offset:0 nt lds
    v_mfma_f32_16x16x32_bf16 v[112:115], a[240:243], a[220:223], v[112:115]
    ds_read_b64_tr_b16 a[252:253], v44 offset:8
    v_mfma_f32_16x16x32_bf16 v[144:147], a[240:243], a[224:227], v[144:147]
    ds_read_b64_tr_b16 a[254:255], v44 offset:1032
    v_xor_b32 v40, 0x10040, v40
    v_mfma_f32_16x16x32_bf16 v[176:179], a[240:243], a[228:231], v[176:179]
    v_add_u32 v41, 0x8000, v41
    v_add_u32 v42, 0x8000, v42
    v_mfma_f32_16x16x32_bf16 v[208:211], a[240:243], a[232:235], v[208:211]
    v_add_u32 v43, 0x8000, v43
    v_mfma_f32_16x16x32_bf16 v[240:243], a[240:243], a[236:239], v[240:243]
    s_waitcnt vmcnt(11)
    s_waitcnt lgkmcnt(4)
    s_add_u32 m0, s43, 135168
    v_add_u32 v44, 0x8000, v44
    v_mfma_f32_16x16x32_bf16 v[84:87], a[244:247], a[216:219], v[84:87]
    buffer_load_dwordx4 v9, s[16:19], s40 offen offset:1024 nt lds
    v_mfma_f32_16x16x32_bf16 v[116:119], a[244:247], a[220:223], v[116:119]
    s_waitcnt lgkmcnt(0)
    s_barrier
    v_mfma_f32_16x16x32_bf16 v[148:151], a[244:247], a[224:227], v[148:151]
    ds_read_b64_tr_b16 a[240:241], v41 offset:0
    v_mfma_f32_16x16x32_bf16 v[180:183], a[244:247], a[228:231], v[180:183]
    ds_read_b64_tr_b16 a[242:243], v41 offset:1024
    v_mfma_f32_16x16x32_bf16 v[212:215], a[244:247], a[232:235], v[212:215]
    ds_read_b128 a[192:195], v40 offset:0
    s_add_u32 m0, s41, 0
    v_mfma_f32_16x16x32_bf16 v[244:247], a[244:247], a[236:239], v[244:247]
    buffer_load_dwordx4 v2, s[8:11], s38 offen offset:0 lds
    v_mfma_f32_16x16x32_bf16 v[88:91], a[248:251], a[216:219], v[88:91]
    ds_read_b64_tr_b16 a[244:245], v41 offset:8
    v_mfma_f32_16x16x32_bf16 v[120:123], a[248:251], a[220:223], v[120:123]
    ds_read_b64_tr_b16 a[246:247], v41 offset:1032
    v_mfma_f32_16x16x32_bf16 v[152:155], a[248:251], a[224:227], v[152:155]
    ds_read_b128 a[196:199], v40 offset:2048
    v_mfma_f32_16x16x32_bf16 v[184:187], a[248:251], a[228:231], v[184:187]
    ds_read_b128 a[200:203], v40 offset:4096
    v_mfma_f32_16x16x32_bf16 v[216:219], a[248:251], a[232:235], v[216:219]
    ds_read_b128 a[204:207], v40 offset:6144
    s_add_u32 m0, s41, 0
    v_mfma_f32_16x16x32_bf16 v[248:251], a[248:251], a[236:239], v[248:251]
    buffer_load_dwordx4 v3, s[8:11], s38 offen offset:1024 lds
    v_mfma_f32_16x16x32_bf16 v[92:95], a[252:255], a[216:219], v[92:95]
    ds_read_b64_tr_b16 a[248:249], v42 offset:0
    v_mfma_f32_16x16x32_bf16 v[124:127], a[252:255], a[220:223], v[124:127]
    ds_read_b64_tr_b16 a[250:251], v42 offset:1024
    v_mfma_f32_16x16x32_bf16 v[156:159], a[252:255], a[224:227], v[156:159]
    ds_read_b128 a[208:211], v40 offset:8192
    v_mfma_f32_16x16x32_bf16 v[188:191], a[252:255], a[228:231], v[188:191]
    ds_read_b128 a[212:215], v40 offset:10240
    v_mfma_f32_16x16x32_bf16 v[220:223], a[252:255], a[232:235], v[220:223]
    s_add_u32 m0, s41, 0
    s_waitcnt lgkmcnt(6)
    v_mfma_f32_16x16x32_bf16 v[252:255], a[252:255], a[236:239], v[252:255]
    buffer_load_dwordx4 v4, s[8:11], s38 offen offset:2048 lds
    v_mfma_f32_16x16x32_bf16 v[64:67], a[240:243], a[192:195], v[64:67]
    s_waitcnt lgkmcnt(4)
    s_add_u32 s54, s38, 30720
    v_mfma_f32_16x16x32_bf16 v[96:99], a[240:243], a[196:199], v[96:99]
    ds_read_b64_tr_b16 a[252:253], v42 offset:8
    v_mfma_f32_16x16x32_bf16 v[128:131], a[240:243], a[200:203], v[128:131]
    ds_read_b64_tr_b16 a[254:255], v42 offset:1032
    s_add_u32 m0, s41, 3072
    v_mfma_f32_16x16x32_bf16 v[160:163], a[240:243], a[204:207], v[160:163]
    s_waitcnt lgkmcnt(2)
    buffer_load_dwordx4 v2, s[8:11], s54 offen offset:0 lds
    v_mfma_f32_16x16x32_bf16 v[192:195], a[240:243], a[208:211], v[192:195]
    v_mfma_f32_16x16x32_bf16 v[224:227], a[240:243], a[212:215], v[224:227]
    v_mfma_f32_16x16x32_bf16 v[68:71], a[244:247], a[192:195], v[68:71]
    v_mfma_f32_16x16x32_bf16 v[100:103], a[244:247], a[196:199], v[100:103]
    ds_read_b64_tr_b16 a[240:241], v43 offset:0
    v_mfma_f32_16x16x32_bf16 v[132:135], a[244:247], a[200:203], v[132:135]
    ds_read_b64_tr_b16 a[242:243], v43 offset:1024
    s_add_u32 m0, s41, 3072
    v_mfma_f32_16x16x32_bf16 v[164:167], a[244:247], a[204:207], v[164:167]
    buffer_load_dwordx4 v3, s[8:11], s54 offen offset:1024 lds
    v_mfma_f32_16x16x32_bf16 v[196:199], a[244:247], a[208:211], v[196:199]
    v_mfma_f32_16x16x32_bf16 v[228:231], a[244:247], a[212:215], v[228:231]
    v_mfma_f32_16x16x32_bf16 v[72:75], a[248:251], a[192:195], v[72:75]
    v_mfma_f32_16x16x32_bf16 v[104:107], a[248:251], a[196:199], v[104:107]
    ds_read_b64_tr_b16 a[244:245], v43 offset:8
    v_mfma_f32_16x16x32_bf16 v[136:139], a[248:251], a[200:203], v[136:139]
    ds_read_b64_tr_b16 a[246:247], v43 offset:1032
    s_add_u32 m0, s41, 3072
    v_mfma_f32_16x16x32_bf16 v[168:171], a[248:251], a[204:207], v[168:171]
    buffer_load_dwordx4 v4, s[8:11], s54 offen offset:2048 lds
    v_mfma_f32_16x16x32_bf16 v[200:203], a[248:251], a[208:211], v[200:203]
    s_add_u32 s38, s38, 128
    v_mfma_f32_16x16x32_bf16 v[232:235], a[248:251], a[212:215], v[232:235]
    s_waitcnt lgkmcnt(4)
    s_cmp_eq_u32 s38, 1280
    s_cselect_b32 s38, 0, s38
    v_mfma_f32_16x16x32_bf16 v[76:79], a[252:255], a[192:195], v[76:79]
    v_mfma_f32_16x16x32_bf16 v[108:111], a[252:255], a[196:199], v[108:111]
    ds_read_b64_tr_b16 a[248:249], v44 offset:0
    v_mfma_f32_16x16x32_bf16 v[140:143], a[252:255], a[200:203], v[140:143]
    ds_read_b64_tr_b16 a[250:251], v44 offset:1024
    s_add_u32 m0, s42, 32768
    v_mfma_f32_16x16x32_bf16 v[172:175], a[252:255], a[204:207], v[172:175]
    buffer_load_dwordx4 v5, s[12:15], s39 offen offset:0 lds
    v_mfma_f32_16x16x32_bf16 v[204:207], a[252:255], a[208:211], v[204:207]
    v_mfma_f32_16x16x32_bf16 v[236:239], a[252:255], a[212:215], v[236:239]
    s_waitcnt lgkmcnt(4)
    s_add_u32 m0, s43, 135168
    v_mfma_f32_16x16x32_bf16 v[80:83], a[240:243], a[192:195], v[80:83]
    buffer_load_dwordx4 v8, s[16:19], s40 offen offset:2048 nt lds
    v_mfma_f32_16x16x32_bf16 v[112:115], a[240:243], a[196:199], v[112:115]
    ds_read_b64_tr_b16 a[252:253], v44 offset:8
    v_mfma_f32_16x16x32_bf16 v[144:147], a[240:243], a[200:203], v[144:147]
    ds_read_b64_tr_b16 a[254:255], v44 offset:1032
    v_xor_b32 v40, 0x40, v40
    v_mfma_f32_16x16x32_bf16 v[176:179], a[240:243], a[204:207], v[176:179]
    v_add_u32 v41, 0x8000, v41
    v_add_u32 v42, 0x8000, v42
    v_mfma_f32_16x16x32_bf16 v[208:211], a[240:243], a[208:211], v[208:211]
    v_add_u32 v43, 0x8000, v43
    v_mfma_f32_16x16x32_bf16 v[240:243], a[240:243], a[212:215], v[240:243]
    s_waitcnt vmcnt(14)
    s_waitcnt lgkmcnt(4)
    s_add_u32 m0, s43, 135168
    v_add_u32 v44, 0x8000, v44
    v_mfma_f32_16x16x32_bf16 v[84:87], a[244:247], a[192:195], v[84:87]
    buffer_load_dwordx4 v9, s[16:19], s40 offen offset:3072 nt lds
    s_add_u32 s40, s40, 4096
    v_mfma_f32_16x16x32_bf16 v[116:119], a[244:247], a[196:199], v[116:119]
    s_waitcnt lgkmcnt(0)
    s_barrier
    v_mfma_f32_16x16x32_bf16 v[148:151], a[244:247], a[200:203], v[148:151]
    ds_read_b64_tr_b16 a[240:241], v41 offset:0
    v_mfma_f32_16x16x32_bf16 v[180:183], a[244:247], a[204:207], v[180:183]
    ds_read_b64_tr_b16 a[242:243], v41 offset:1024
    v_mfma_f32_16x16x32_bf16 v[212:215], a[244:247], a[208:211], v[212:215]
    ds_read_b128 a[216:219], v40 offset:0
    s_add_u32 m0, s42, 32768
    v_mfma_f32_16x16x32_bf16 v[244:247], a[244:247], a[212:215], v[244:247]
    buffer_load_dwordx4 v6, s[12:15], s39 offen offset:1024 lds
    v_mfma_f32_16x16x32_bf16 v[88:91], a[248:251], a[192:195], v[88:91]
    ds_read_b64_tr_b16 a[244:245], v41 offset:8
    v_mfma_f32_16x16x32_bf16 v[120:123], a[248:251], a[196:199], v[120:123]
    ds_read_b64_tr_b16 a[246:247], v41 offset:1032
    v_mfma_f32_16x16x32_bf16 v[152:155], a[248:251], a[200:203], v[152:155]
    ds_read_b128 a[220:223], v40 offset:2048
    v_mfma_f32_16x16x32_bf16 v[184:187], a[248:251], a[204:207], v[184:187]
    ds_read_b128 a[224:227], v40 offset:4096
    v_mfma_f32_16x16x32_bf16 v[216:219], a[248:251], a[208:211], v[216:219]
    ds_read_b128 a[228:231], v40 offset:6144
    s_add_u32 m0, s42, 32768
    v_mfma_f32_16x16x32_bf16 v[248:251], a[248:251], a[212:215], v[248:251]
    buffer_load_dwordx4 v7, s[12:15], s39 offen offset:2048 lds
    v_mfma_f32_16x16x32_bf16 v[92:95], a[252:255], a[192:195], v[92:95]
    ds_read_b64_tr_b16 a[248:249], v42 offset:0
    v_mfma_f32_16x16x32_bf16 v[124:127], a[252:255], a[196:199], v[124:127]
    ds_read_b64_tr_b16 a[250:251], v42 offset:1024
    v_mfma_f32_16x16x32_bf16 v[156:159], a[252:255], a[200:203], v[156:159]
    ds_read_b128 a[232:235], v40 offset:8192
    v_mfma_f32_16x16x32_bf16 v[188:191], a[252:255], a[204:207], v[188:191]
    ds_read_b128 a[236:239], v40 offset:10240
    v_mfma_f32_16x16x32_bf16 v[220:223], a[252:255], a[208:211], v[220:223]
    s_add_u32 m0, s42, 32768
    s_waitcnt lgkmcnt(6)
    v_mfma_f32_16x16x32_bf16 v[252:255], a[252:255], a[212:215], v[252:255]
    buffer_load_dwordx4 v38, s[12:15], s39 offen offset:3072 lds
    v_mfma_f32_16x16x32_bf16 v[64:67], a[240:243], a[216:219], v[64:67]
    s_waitcnt lgkmcnt(4)
    s_add_u32 s39, s39, 262144
    v_mfma_f32_16x16x32_bf16 v[96:99], a[240:243], a[220:223], v[96:99]
    ds_read_b64_tr_b16 a[252:253], v42 offset:8
    s_cmp_eq_u32 s39, 5242880
    s_cselect_b32 s39, 0, s39
    v_mfma_f32_16x16x32_bf16 v[128:131], a[240:243], a[224:227], v[128:131]
    ds_read_b64_tr_b16 a[254:255], v42 offset:1032
    s_add_u32 m0, s42, 65536
    v_mfma_f32_16x16x32_bf16 v[160:163], a[240:243], a[228:231], v[160:163]
    s_waitcnt lgkmcnt(2)
    buffer_load_dwordx4 v5, s[12:15], s39 offen offset:0 lds
    v_mfma_f32_16x16x32_bf16 v[192:195], a[240:243], a[232:235], v[192:195]
    v_mfma_f32_16x16x32_bf16 v[224:227], a[240:243], a[236:239], v[224:227]
    v_mfma_f32_16x16x32_bf16 v[68:71], a[244:247], a[216:219], v[68:71]
    v_mfma_f32_16x16x32_bf16 v[100:103], a[244:247], a[220:223], v[100:103]
    ds_read_b64_tr_b16 a[240:241], v43 offset:0
    v_mfma_f32_16x16x32_bf16 v[132:135], a[244:247], a[224:227], v[132:135]
    ds_read_b64_tr_b16 a[242:243], v43 offset:1024
    s_add_u32 m0, s42, 65536
    v_mfma_f32_16x16x32_bf16 v[164:167], a[244:247], a[228:231], v[164:167]
    buffer_load_dwordx4 v6, s[12:15], s39 offen offset:1024 lds
    v_mfma_f32_16x16x32_bf16 v[196:199], a[244:247], a[232:235], v[196:199]
    v_mfma_f32_16x16x32_bf16 v[228:231], a[244:247], a[236:239], v[228:231]
    v_mfma_f32_16x16x32_bf16 v[72:75], a[248:251], a[216:219], v[72:75]
    v_mfma_f32_16x16x32_bf16 v[104:107], a[248:251], a[220:223], v[104:107]
    ds_read_b64_tr_b16 a[244:245], v43 offset:8
    v_mfma_f32_16x16x32_bf16 v[136:139], a[248:251], a[224:227], v[136:139]
    ds_read_b64_tr_b16 a[246:247], v43 offset:1032
    s_add_u32 m0, s42, 65536
    v_mfma_f32_16x16x32_bf16 v[168:171], a[248:251], a[228:231], v[168:171]
    buffer_load_dwordx4 v7, s[12:15], s39 offen offset:2048 lds
    v_mfma_f32_16x16x32_bf16 v[200:203], a[248:251], a[232:235], v[200:203]
    v_mfma_f32_16x16x32_bf16 v[232:235], a[248:251], a[236:239], v[232:235]
    s_waitcnt lgkmcnt(4)
    v_mfma_f32_16x16x32_bf16 v[76:79], a[252:255], a[216:219], v[76:79]
    v_mfma_f32_16x16x32_bf16 v[108:111], a[252:255], a[220:223], v[108:111]
    ds_read_b64_tr_b16 a[248:249], v44 offset:0
    v_mfma_f32_16x16x32_bf16 v[140:143], a[252:255], a[224:227], v[140:143]
    ds_read_b64_tr_b16 a[250:251], v44 offset:1024
    s_add_u32 m0, s42, 65536
    v_mfma_f32_16x16x32_bf16 v[172:175], a[252:255], a[228:231], v[172:175]
    buffer_load_dwordx4 v38, s[12:15], s39 offen offset:3072 lds
    v_mfma_f32_16x16x32_bf16 v[204:207], a[252:255], a[232:235], v[204:207]
    s_add_u32 s39, s39, 262144
    v_mfma_f32_16x16x32_bf16 v[236:239], a[252:255], a[236:239], v[236:239]
    s_waitcnt lgkmcnt(4)
    s_cmp_eq_u32 s39, 5242880
    s_cselect_b32 s39, 0, s39
    v_mfma_f32_16x16x32_bf16 v[80:83], a[240:243], a[216:219], v[80:83]
    v_mfma_f32_16x16x32_bf16 v[112:115], a[240:243], a[220:223], v[112:115]
    ds_read_b64_tr_b16 a[252:253], v44 offset:8
    v_mfma_f32_16x16x32_bf16 v[144:147], a[240:243], a[224:227], v[144:147]
    ds_read_b64_tr_b16 a[254:255], v44 offset:1032
    v_xor_b32 v40, 0x10040, v40
    v_mfma_f32_16x16x32_bf16 v[176:179], a[240:243], a[228:231], v[176:179]
    v_subrev_u32 v41, 0x18000, v41
    v_subrev_u32 v42, 0x18000, v42
    v_mfma_f32_16x16x32_bf16 v[208:211], a[240:243], a[232:235], v[208:211]
    v_subrev_u32 v43, 0x18000, v43
    v_mfma_f32_16x16x32_bf16 v[240:243], a[240:243], a[236:239], v[240:243]
    s_waitcnt vmcnt(10)
    s_waitcnt lgkmcnt(4)
    v_subrev_u32 v44, 0x18000, v44
    v_mfma_f32_16x16x32_bf16 v[84:87], a[244:247], a[216:219], v[84:87]
    v_mfma_f32_16x16x32_bf16 v[116:119], a[244:247], a[220:223], v[116:119]
    s_waitcnt lgkmcnt(0)
    s_barrier
    v_mfma_f32_16x16x32_bf16 v[148:151], a[244:247], a[224:227], v[148:151]
    ds_read_b64_tr_b16 a[240:241], v41 offset:0
    v_mfma_f32_16x16x32_bf16 v[180:183], a[244:247], a[228:231], v[180:183]
    ds_read_b64_tr_b16 a[242:243], v41 offset:1024
    v_mfma_f32_16x16x32_bf16 v[212:215], a[244:247], a[232:235], v[212:215]
    ds_read_b128 a[192:195], v40 offset:0
    s_add_u32 m0, s41, 65536
    v_mfma_f32_16x16x32_bf16 v[244:247], a[244:247], a[236:239], v[244:247]
    buffer_load_dwordx4 v2, s[8:11], s38 offen offset:0 lds
    v_mfma_f32_16x16x32_bf16 v[88:91], a[248:251], a[216:219], v[88:91]
    ds_read_b64_tr_b16 a[244:245], v41 offset:8
    v_mfma_f32_16x16x32_bf16 v[120:123], a[248:251], a[220:223], v[120:123]
    ds_read_b64_tr_b16 a[246:247], v41 offset:1032
    v_mfma_f32_16x16x32_bf16 v[152:155], a[248:251], a[224:227], v[152:155]
    ds_read_b128 a[196:199], v40 offset:2048
    v_mfma_f32_16x16x32_bf16 v[184:187], a[248:251], a[228:231], v[184:187]
    ds_read_b128 a[200:203], v40 offset:4096
    v_mfma_f32_16x16x32_bf16 v[216:219], a[248:251], a[232:235], v[216:219]
    ds_read_b128 a[204:207], v40 offset:6144
    s_add_u32 m0, s41, 65536
    v_mfma_f32_16x16x32_bf16 v[248:251], a[248:251], a[236:239], v[248:251]
    buffer_load_dwordx4 v3, s[8:11], s38 offen offset:1024 lds
    v_mfma_f32_16x16x32_bf16 v[92:95], a[252:255], a[216:219], v[92:95]
    ds_read_b64_tr_b16 a[248:249], v42 offset:0
    v_mfma_f32_16x16x32_bf16 v[124:127], a[252:255], a[220:223], v[124:127]
    ds_read_b64_tr_b16 a[250:251], v42 offset:1024
    v_mfma_f32_16x16x32_bf16 v[156:159], a[252:255], a[224:227], v[156:159]
    ds_read_b128 a[208:211], v40 offset:8192
    v_mfma_f32_16x16x32_bf16 v[188:191], a[252:255], a[228:231], v[188:191]
    ds_read_b128 a[212:215], v40 offset:10240
    v_mfma_f32_16x16x32_bf16 v[220:223], a[252:255], a[232:235], v[220:223]
    s_add_u32 m0, s41, 65536
    s_waitcnt lgkmcnt(6)
    v_mfma_f32_16x16x32_bf16 v[252:255], a[252:255], a[236:239], v[252:255]
    buffer_load_dwordx4 v4, s[8:11], s38 offen offset:2048 lds
L_qtail:
    v_mfma_f32_16x16x32_bf16 v[64:67], a[240:243], a[192:195], v[64:67]
    s_waitcnt lgkmcnt(4)
    s_add_u32 s54, s38, 30720
    v_mfma_f32_16x16x32_bf16 v[96:99], a[240:243], a[196:199], v[96:99]
    ds_read_b64_tr_b16 a[252:253], v42 offset:8
    v_mfma_f32_16x16x32_bf16 v[128:131], a[240:243], a[200:203], v[128:131]
    ds_read_b64_tr_b16 a[254:255], v42 offset:1032
    s_add_u32 m0, s41, 68608
    v_mfma_f32_16x16x32_bf16 v[160:163], a[240:243], a[204:207], v[160:163]
    s_waitcnt lgkmcnt(2)
    buffer_load_dwordx4 v2, s[8:11], s54 offen offset:0 lds
    v_mfma_f32_16x16x32_bf16 v[192:195], a[240:243], a[208:211], v[192:195]
    v_mfma_f32_16x16x32_bf16 v[224:227], a[240:243], a[212:215], v[224:227]
    v_mfma_f32_16x16x32_bf16 v[68:71], a[244:247], a[192:195], v[68:71]
    v_mfma_f32_16x16x32_bf16 v[100:103], a[244:247], a[196:199], v[100:103]
    ds_read_b64_tr_b16 a[240:241], v43 offset:0
    v_mfma_f32_16x16x32_bf16 v[132:135], a[244:247], a[200:203], v[132:135]
    ds_read_b64_tr_b16 a[242:243], v43 offset:1024
    s_add_u32 m0, s41, 68608
    v_mfma_f32_16x16x32_bf16 v[164:167], a[244:247], a[204:207], v[164:167]
    buffer_load_dwordx4 v3, s[8:11], s54 offen offset:1024 lds
    v_mfma_f32_16x16x32_bf16 v[196:199], a[244:247], a[208:211], v[196:199]
    v_mfma_f32_16x16x32_bf16 v[228:231], a[244:247], a[212:215], v[228:231]
    v_mfma_f32_16x16x32_bf16 v[72:75], a[248:251], a[192:195], v[72:75]
    v_mfma_f32_16x16x32_bf16 v[104:107], a[248:251], a[196:199], v[104:107]
    ds_read_b64_tr_b16 a[244:245], v43 offset:8
    v_mfma_f32_16x16x32_bf16 v[136:139], a[248:251], a[200:203], v[136:139]
    ds_read_b64_tr_b16 a[246:247], v43 offset:1032
    s_add_u32 m0, s41, 68608
    v_mfma_f32_16x16x32_bf16 v[168:171], a[248:251], a[204:207], v[168:171]
    buffer_load_dwordx4 v4, s[8:11], s54 offen offset:2048 lds
    v_mfma_f32_16x16x32_bf16 v[200:203], a[248:251], a[208:211], v[200:203]
    s_add_u32 s38, s38, 128
    v_mfma_f32_16x16x32_bf16 v[232:235], a[248:251], a[212:215], v[232:235]
    s_waitcnt lgkmcnt(4)
    s_cmp_eq_u32 s38, 1280
    s_cselect_b32 s38, 0, s38
    v_mfma_f32_16x16x32_bf16 v[76:79], a[252:255], a[192:195], v[76:79]
    v_mfma_f32_16x16x32_bf16 v[108:111], a[252:255], a[196:199], v[108:111]
    ds_read_b64_tr_b16 a[248:249], v44 offset:0
    v_mfma_f32_16x16x32_bf16 v[140:143], a[252:255], a[200:203], v[140:143]
    ds_read_b64_tr_b16 a[250:251], v44 offset:1024
    s_add_u32 m0, s42, 98304
    v_mfma_f32_16x16x32_bf16 v[172:175], a[252:255], a[204:207], v[172:175]
    buffer_load_dwordx4 v5, s[12:15], s39 offen offset:0 lds
    v_mfma_f32_16x16x32_bf16 v[204:207], a[252:255], a[208:211], v[204:207]
    v_mfma_f32_16x16x32_bf16 v[236:239], a[252:255], a[212:215], v[236:239]
    s_waitcnt lgkmcnt(4)
    v_mfma_f32_16x16x32_bf16 v[80:83], a[240:243], a[192:195], v[80:83]
    v_mfma_f32_16x16x32_bf16 v[112:115], a[240:243], a[196:199], v[112:115]
    ds_read_b64_tr_b16 a[252:253], v44 offset:8
    v_mfma_f32_16x16x32_bf16 v[144:147], a[240:243], a[200:203], v[144:147]
    ds_read_b64_tr_b16 a[254:255], v44 offset:1032
    v_xor_b32 v40, 0x40, v40
    v_mfma_f32_16x16x32_bf16 v[176:179], a[240:243], a[204:207], v[176:179]
    v_add_u32 v41, 0x8000, v41
    v_add_u32 v42, 0x8000, v42
    v_mfma_f32_16x16x32_bf16 v[208:211], a[240:243], a[208:211], v[208:211]
    v_add_u32 v43, 0x8000, v43
    v_mfma_f32_16x16x32_bf16 v[240:243], a[240:243], a[212:215], v[240:243]
    s_waitcnt vmcnt(11)
    s_waitcnt lgkmcnt(4)
    v_add_u32 v44, 0x8000, v44
    v_mfma_f32_16x16x32_bf16 v[84:87], a[244:247], a[192:195], v[84:87]
    v_mfma_f32_16x16x32_bf16 v[116:119], a[244:247], a[196:199], v[116:119]
    s_waitcnt lgkmcnt(0)
    s_barrier
    v_mfma_f32_16x16x32_bf16 v[148:151], a[244:247], a[200:203], v[148:151]
    ds_read_b64_tr_b16 a[240:241], v41 offset:0
    v_mfma_f32_16x16x32_bf16 v[180:183], a[244:247], a[204:207], v[180:183]
    ds_read_b64_tr_b16 a[242:243], v41 offset:1024
    v_mfma_f32_16x16x32_bf16 v[212:215], a[244:247], a[208:211], v[212:215]
    ds_read_b128 a[216:219], v40 offset:0
    s_add_u32 m0, s42, 98304
    v_mfma_f32_16x16x32_bf16 v[244:247], a[244:247], a[212:215], v[244:247]
    buffer_load_dwordx4 v6, s[12:15], s39 offen offset:1024 lds
    v_mfma_f32_16x16x32_bf16 v[88:91], a[248:251], a[192:195], v[88:91]
    ds_read_b64_tr_b16 a[244:245], v41 offset:8
    v_mfma_f32_16x16x32_bf16 v[120:123], a[248:251], a[196:199], v[120:123]
    ds_read_b64_tr_b16 a[246:247], v41 offset:1032
    v_mfma_f32_16x16x32_bf16 v[152:155], a[248:251], a[200:203], v[152:155]
    ds_read_b128 a[220:223], v40 offset:2048
    v_mfma_f32_16x16x32_bf16 v[184:187], a[248:251], a[204:207], v[184:187]
    ds_read_b128 a[224:227], v40 offset:4096
    v_mfma_f32_16x16x32_bf16 v[216:219], a[248:251], a[208:211], v[216:219]
    ds_read_b128 a[228:231], v40 offset:6144
    s_add_u32 m0, s42, 98304
    v_mfma_f32_16x16x32_bf16 v[248:251], a[248:251], a[212:215], v[248:251]
    buffer_load_dwordx4 v7, s[12:15], s39 offen offset:2048 lds
    v_mfma_f32_16x16x32_bf16 v[92:95], a[252:255], a[192:195], v[92:95]
    ds_read_b64_tr_b16 a[248:249], v42 offset:0
    v_mfma_f32_16x16x32_bf16 v[124:127], a[252:255], a[196:199], v[124:127]
    ds_read_b64_tr_b16 a[250:251], v42 offset:1024
    v_mfma_f32_16x16x32_bf16 v[156:159], a[252:255], a[200:203], v[156:159]
    ds_read_b128 a[232:235], v40 offset:8192
    v_mfma_f32_16x16x32_bf16 v[188:191], a[252:255], a[204:207], v[188:191]
    ds_read_b128 a[236:239], v40 offset:10240
    v_mfma_f32_16x16x32_bf16 v[220:223], a[252:255], a[208:211], v[220:223]
    s_add_u32 m0, s42, 98304
    s_waitcnt lgkmcnt(6)
    v_mfma_f32_16x16x32_bf16 v[252:255], a[252:255], a[212:215], v[252:255]
    buffer_load_dwordx4 v38, s[12:15], s39 offen offset:3072 lds
    v_mfma_f32_16x16x32_bf16 v[64:67], a[240:243], a[216:219], v[64:67]
    s_waitcnt lgkmcnt(4)
    v_mfma_f32_16x16x32_bf16 v[96:99], a[240:243], a[220:223], v[96:99]
    ds_read_b64_tr_b16 a[252:253], v42 offset:8
    v_mfma_f32_16x16x32_bf16 v[128:131], a[240:243], a[224:227], v[128:131]
    ds_read_b64_tr_b16 a[254:255], v42 offset:1032
    v_mfma_f32_16x16x32_bf16 v[160:163], a[240:243], a[228:231], v[160:163]
    s_waitcnt lgkmcnt(2)
    v_mfma_f32_16x16x32_bf16 v[192:195], a[240:243], a[232:235], v[192:195]
    v_mfma_f32_16x16x32_bf16 v[224:227], a[240:243], a[236:239], v[224:227]
    v_mfma_f32_16x16x32_bf16 v[68:71], a[244:247], a[216:219], v[68:71]
    v_mfma_f32_16x16x32_bf16 v[100:103], a[244:247], a[220:223], v[100:103]
    ds_read_b64_tr_b16 a[240:241], v43 offset:0
    v_mfma_f32_16x16x32_bf16 v[132:135], a[244:247], a[224:227], v[132:135]
    ds_read_b64_tr_b16 a[242:243], v43 offset:1024
    v_mfma_f32_16x16x32_bf16 v[164:167], a[244:247], a[228:231], v[164:167]
    v_mfma_f32_16x16x32_bf16 v[196:199], a[244:247], a[232:235], v[196:199]
    v_mfma_f32_16x16x32_bf16 v[228:231], a[244:247], a[236:239], v[228:231]
    v_mfma_f32_16x16x32_bf16 v[72:75], a[248:251], a[216:219], v[72:75]
    v_mfma_f32_16x16x32_bf16 v[104:107], a[248:251], a[220:223], v[104:107]
    ds_read_b64_tr_b16 a[244:245], v43 offset:8
    v_mfma_f32_16x16x32_bf16 v[136:139], a[248:251], a[224:227], v[136:139]
    ds_read_b64_tr_b16 a[246:247], v43 offset:1032
    v_mfma_f32_16x16x32_bf16 v[168:171], a[248:251], a[228:231], v[168:171]
    v_mfma_f32_16x16x32_bf16 v[200:203], a[248:251], a[232:235], v[200:203]
    v_mfma_f32_16x16x32_bf16 v[232:235], a[248:251], a[236:239], v[232:235]
    s_waitcnt lgkmcnt(4)
    v_mfma_f32_16x16x32_bf16 v[76:79], a[252:255], a[216:219], v[76:79]
    v_mfma_f32_16x16x32_bf16 v[108:111], a[252:255], a[220:223], v[108:111]
    ds_read_b64_tr_b16 a[248:249], v44 offset:0
    v_mfma_f32_16x16x32_bf16 v[140:143], a[252:255], a[224:227], v[140:143]
    ds_read_b64_tr_b16 a[250:251], v44 offset:1024
    v_mfma_f32_16x16x32_bf16 v[172:175], a[252:255], a[228:231], v[172:175]
    v_mfma_f32_16x16x32_bf16 v[204:207], a[252:255], a[232:235], v[204:207]
    v_mfma_f32_16x16x32_bf16 v[236:239], a[252:255], a[236:239], v[236:239]
    s_waitcnt lgkmcnt(4)
    v_mfma_f32_16x16x32_bf16 v[80:83], a[240:243], a[216:219], v[80:83]
    v_mfma_f32_16x16x32_bf16 v[112:115], a[240:243], a[220:223], v[112:115]
    ds_read_b64_tr_b16 a[252:253], v44 offset:8
    v_mfma_f32_16x16x32_bf16 v[144:147], a[240:243], a[224:227], v[144:147]
    ds_read_b64_tr_b16 a[254:255], v44 offset:1032
    v_xor_b32 v40, 0x10040, v40
    v_mfma_f32_16x16x32_bf16 v[176:179], a[240:243], a[228:231], v[176:179]
    v_add_u32 v41, 0x8000, v41
    v_add_u32 v42, 0x8000, v42
    v_mfma_f32_16x16x32_bf16 v[208:211], a[240:243], a[232:235], v[208:211]
    v_add_u32 v43, 0x8000, v43
    v_mfma_f32_16x16x32_bf16 v[240:243], a[240:243], a[236:239], v[240:243]
    s_waitcnt vmcnt(4)
    s_waitcnt lgkmcnt(4)
    v_add_u32 v44, 0x8000, v44
    v_mfma_f32_16x16x32_bf16 v[84:87], a[244:247], a[216:219], v[84:87]
    v_mfma_f32_16x16x32_bf16 v[116:119], a[244:247], a[220:223], v[116:119]
    s_waitcnt lgkmcnt(0)
    s_barrier
    v_mfma_f32_16x16x32_bf16 v[148:151], a[244:247], a[224:227], v[148:151]
    ds_read_b64_tr_b16 a[240:241], v41 offset:0
    v_mfma_f32_16x16x32_bf16 v[180:183], a[244:247], a[228:231], v[180:183]
    ds_read_b64_tr_b16 a[242:243], v41 offset:1024
    v_mfma_f32_16x16x32_bf16 v[212:215], a[244:247], a[232:235], v[212:215]
    ds_read_b128 a[192:195], v40 offset:0
    s_add_u32 m0, s43, 0
    v_mfma_f32_16x16x32_bf16 v[244:247], a[244:247], a[236:239], v[244:247]
    buffer_load_dwordx4 v8, s[16:19], s40 offen offset:0 nt lds
    v_mfma_f32_16x16x32_bf16 v[88:91], a[248:251], a[216:219], v[88:91]
    ds_read_b64_tr_b16 a[244:245], v41 offset:8
    v_mfma_f32_16x16x32_bf16 v[120:123], a[248:251], a[220:223], v[120:123]
    ds_read_b64_tr_b16 a[246:247], v41 offset:1032
    v_mfma_f32_16x16x32_bf16 v[152:155], a[248:251], a[224:227], v[152:155]
    ds_read_b128 a[196:199], v40 offset:2048
    v_mfma_f32_16x16x32_bf16 v[184:187], a[248:251], a[228:231], v[184:187]
    ds_read_b128 a[200:203], v40 offset:4096
    v_mfma_f32_16x16x32_bf16 v[216:219], a[248:251], a[232:235], v[216:219]
    ds_read_b128 a[204:207], v40 offset:6144
    s_add_u32 m0, s43, 0
    v_mfma_f32_16x16x32_bf16 v[248:251], a[248:251], a[236:239], v[248:251]
    buffer_load_dwordx4 v9, s[16:19], s40 offen offset:1024 nt lds
    v_mfma_f32_16x16x32_bf16 v[92:95], a[252:255], a[216:219], v[92:95]
    ds_read_b64_tr_b16 a[248:249], v42 offset:0
    v_mfma_f32_16x16x32_bf16 v[124:127], a[252:255], a[220:223], v[124:127]
    ds_read_b64_tr_b16 a[250:251], v42 offset:1024
    v_mfma_f32_16x16x32_bf16 v[156:159], a[252:255], a[224:227], v[156:159]
    ds_read_b128 a[208:211], v40 offset:8192
    v_mfma_f32_16x16x32_bf16 v[188:191], a[252:255], a[228:231], v[188:191]
    ds_read_b128 a[212:215], v40 offset:10240
    v_mfma_f32_16x16x32_bf16 v[220:223], a[252:255], a[232:235], v[220:223]
    s_add_u32 m0, s43, 0
    s_waitcnt lgkmcnt(6)
    v_mfma_f32_16x16x32_bf16 v[252:255], a[252:255], a[236:239], v[252:255]
    buffer_load_dwordx4 v8, s[16:19], s40 offen offset:2048 nt lds
    v_mfma_f32_16x16x32_bf16 v[64:67], a[240:243], a[192:195], v[64:67]
    s_waitcnt lgkmcnt(4)
    v_mfma_f32_16x16x32_bf16 v[96:99], a[240:243], a[196:199], v[96:99]
    ds_read_b64_tr_b16 a[252:253], v42 offset:8
    v_mfma_f32_16x16x32_bf16 v[128:131], a[240:243], a[200:203], v[128:131]
    ds_read_b64_tr_b16 a[254:255], v42 offset:1032
    s_add_u32 m0, s43, 0
    v_mfma_f32_16x16x32_bf16 v[160:163], a[240:243], a[204:207], v[160:163]
    s_waitcnt lgkmcnt(2)
    buffer_load_dwordx4 v9, s[16:19], s40 offen offset:3072 nt lds
    s_add_u32 s40, s40, 4096
    v_mfma_f32_16x16x32_bf16 v[192:195], a[240:243], a[208:211], v[192:195]
    v_mfma_f32_16x16x32_bf16 v[224:227], a[240:243], a[212:215], v[224:227]
    v_mfma_f32_16x16x32_bf16 v[68:71], a[244:247], a[192:195], v[68:71]
    v_mfma_f32_16x16x32_bf16 v[100:103], a[244:247], a[196:199], v[100:103]
    ds_read_b64_tr_b16 a[240:241], v43 offset:0
    v_mfma_f32_16x16x32_bf16 v[132:135], a[244:247], a[200:203], v[132:135]
    ds_read_b64_tr_b16 a[242:243], v43 offset:1024
    v_mfma_f32_16x16x32_bf16 v[164:167], a[244:247], a[204:207], v[164:167]
    v_mfma_f32_16x16x32_bf16 v[196:199], a[244:247], a[208:211], v[196:199]
    v_mfma_f32_16x16x32_bf16 v[228:231], a[244:247], a[212:215], v[228:231]
    v_mfma_f32_16x16x32_bf16 v[72:75], a[248:251], a[192:195], v[72:75]
    v_mfma_f32_16x16x32_bf16 v[104:107], a[248:251], a[196:199], v[104:107]
    ds_read_b64_tr_b16 a[244:245], v43 offset:8
    v_mfma_f32_16x16x32_bf16 v[136:139], a[248:251], a[200:203], v[136:139]
    ds_read_b64_tr_b16 a[246:247], v43 offset:1032
    s_add_u32 m0, s43, 4096
    v_mfma_f32_16x16x32_bf16 v[168:171], a[248:251], a[204:207], v[168:171]
    buffer_load_dwordx4 v8, s[16:19], s40 offen offset:0 nt lds
    v_mfma_f32_16x16x32_bf16 v[200:203], a[248:251], a[208:211], v[200:203]
    v_mfma_f32_16x16x32_bf16 v[232:235], a[248:251], a[212:215], v[232:235]
    s_waitcnt lgkmcnt(4)
    v_mfma_f32_16x16x32_bf16 v[76:79], a[252:255], a[192:195], v[76:79]
    v_mfma_f32_16x16x32_bf16 v[108:111], a[252:255], a[196:199], v[108:111]
    ds_read_b64_tr_b16 a[248:249], v44 offset:0
    v_mfma_f32_16x16x32_bf16 v[140:143], a[252:255], a[200:203], v[140:143]
    ds_read_b64_tr_b16 a[250:251], v44 offset:1024
    v_mfma_f32_16x16x32_bf16 v[172:175], a[252:255], a[204:207], v[172:175]
    v_mfma_f32_16x16x32_bf16 v[204:207], a[252:255], a[208:211], v[204:207]
    v_mfma_f32_16x16x32_bf16 v[236:239], a[252:255], a[212:215], v[236:239]
    s_waitcnt lgkmcnt(4)
    v_mfma_f32_16x16x32_bf16 v[80:83], a[240:243], a[192:195], v[80:83]
    v_mfma_f32_16x16x32_bf16 v[112:115], a[240:243], a[196:199], v[112:115]
    ds_read_b64_tr_b16 a[252:253], v44 offset:8
    v_mfma_f32_16x16x32_bf16 v[144:147], a[240:243], a[200:203], v[144:147]
    ds_read_b64_tr_b16 a[254:255], v44 offset:1032
    s_add_u32 m0, s43, 4096
    v_xor_b32 v40, 0x40, v40
    v_mfma_f32_16x16x32_bf16 v[176:179], a[240:243], a[204:207], v[176:179]
    buffer_load_dwordx4 v9, s[16:19], s40 offen offset:1024 nt lds
    v_mfma_f32_16x16x32_bf16 v[208:211], a[240:243], a[208:211], v[208:211]
    v_add_u32 v41, 0x8000, v41
    v_add_u32 v42, 0x8000, v42
    v_mfma_f32_16x16x32_bf16 v[240:243], a[240:243], a[212:215], v[240:243]
    s_waitcnt vmcnt(6)
    s_waitcnt lgkmcnt(4)
    v_add_u32 v43, 0x8000, v43
    v_add_u32 v44, 0x8000, v44
    v_mfma_f32_16x16x32_bf16 v[84:87], a[244:247], a[192:195], v[84:87]
    v_mfma_f32_16x16x32_bf16 v[116:119], a[244:247], a[196:199], v[116:119]
    s_waitcnt lgkmcnt(0)
    s_barrier
    v_mfma_f32_16x16x32_bf16 v[148:151], a[244:247], a[200:203], v[148:151]
    ds_read_b64_tr_b16 a[240:241], v41 offset:0
    v_mfma_f32_16x16x32_bf16 v[180:183], a[244:247], a[204:207], v[180:183]
    ds_read_b64_tr_b16 a[242:243], v41 offset:1024
    v_mfma_f32_16x16x32_bf16 v[212:215], a[244:247], a[208:211], v[212:215]
    ds_read_b128 a[216:219], v40 offset:0
    v_mfma_f32_16x16x32_bf16 v[244:247], a[244:247], a[212:215], v[244:247]
    v_mfma_f32_16x16x32_bf16 v[88:91], a[248:251], a[192:195], v[88:91]
    ds_read_b64_tr_b16 a[244:245], v41 offset:8
    v_mfma_f32_16x16x32_bf16 v[120:123], a[248:251], a[196:199], v[120:123]
    ds_read_b64_tr_b16 a[246:247], v41 offset:1032
    v_mfma_f32_16x16x32_bf16 v[152:155], a[248:251], a[200:203], v[152:155]
    ds_read_b128 a[220:223], v40 offset:2048
    v_mfma_f32_16x16x32_bf16 v[184:187], a[248:251], a[204:207], v[184:187]
    ds_read_b128 a[224:227], v40 offset:4096
    v_mfma_f32_16x16x32_bf16 v[216:219], a[248:251], a[208:211], v[216:219]
    ds_read_b128 a[228:231], v40 offset:6144
    s_add_u32 m0, s43, 4096
    v_mfma_f32_16x16x32_bf16 v[248:251], a[248:251], a[212:215], v[248:251]
    buffer_load_dwordx4 v8, s[16:19], s40 offen offset:2048 nt lds
    v_mfma_f32_16x16x32_bf16 v[92:95], a[252:255], a[192:195], v[92:95]
    ds_read_b64_tr_b16 a[248:249], v42 offset:0
    v_mfma_f32_16x16x32_bf16 v[124:127], a[252:255], a[196:199], v[124:127]
    ds_read_b64_tr_b16 a[250:251], v42 offset:1024
    v_mfma_f32_16x16x32_bf16 v[156:159], a[252:255], a[200:203], v[156:159]
    ds_read_b128 a[232:235], v40 offset:8192
    v_mfma_f32_16x16x32_bf16 v[188:191], a[252:255], a[204:207], v[188:191]
    ds_read_b128 a[236:239], v40 offset:10240
    v_mfma_f32_16x16x32_bf16 v[220:223], a[252:255], a[208:211], v[220:223]
    s_waitcnt lgkmcnt(6)
    v_mfma_f32_16x16x32_bf16 v[252:255], a[252:255], a[212:215], v[252:255]
    v_mfma_f32_16x16x32_bf16 v[64:67], a[240:243], a[216:219], v[64:67]
    s_waitcnt lgkmcnt(4)
    v_mfma_f32_16x16x32_bf16 v[96:99], a[240:243], a[220:223], v[96:99]
    ds_read_b64_tr_b16 a[252:253], v42 offset:8
    v_mfma_f32_16x16x32_bf16 v[128:131], a[240:243], a[224:227], v[128:131]
    ds_read_b64_tr_b16 a[254:255], v42 offset:1032
    v_mfma_f32_16x16x32_bf16 v[160:163], a[240:243], a[228:231], v[160:163]
    s_waitcnt lgkmcnt(2)
    v_mfma_f32_16x16x32_bf16 v[192:195], a[240:243], a[232:235], v[192:195]
    v_mfma_f32_16x16x32_bf16 v[224:227], a[240:243], a[236:239], v[224:227]
    v_mfma_f32_16x16x32_bf16 v[68:71], a[244:247], a[216:219], v[68:71]
    v_mfma_f32_16x16x32_bf16 v[100:103], a[244:247], a[220:223], v[100:103]
    ds_read_b64_tr_b16 a[240:241], v43 offset:0
    v_mfma_f32_16x16x32_bf16 v[132:135], a[244:247], a[224:227], v[132:135]
    ds_read_b64_tr_b16 a[242:243], v43 offset:1024
    s_add_u32 m0, s43, 4096
    v_mfma_f32_16x16x32_bf16 v[164:167], a[244:247], a[228:231], v[164:167]
    buffer_load_dwordx4 v9, s[16:19], s40 offen offset:3072 nt lds
    s_add_u32 s40, s40, 4096
    v_mfma_f32_16x16x32_bf16 v[196:199], a[244:247], a[232:235], v[196:199]
    v_mfma_f32_16x16x32_bf16 v[228:231], a[244:247], a[236:239], v[228:231]
    v_mfma_f32_16x16x32_bf16 v[72:75], a[248:251], a[216:219], v[72:75]
    v_mfma_f32_16x16x32_bf16 v[104:107], a[248:251], a[220:223], v[104:107]
    ds_read_b64_tr_b16 a[244:245], v43 offset:8
    v_mfma_f32_16x16x32_bf16 v[136:139], a[248:251], a[224:227], v[136:139]
    ds_read_b64_tr_b16 a[246:247], v43 offset:1032
    v_mfma_f32_16x16x32_bf16 v[168:171], a[248:251], a[228:231], v[168:171]
    v_mfma_f32_16x16x32_bf16 v[200:203], a[248:251], a[232:235], v[200:203]
    v_mfma_f32_16x16x32_bf16 v[232:235], a[248:251], a[236:239], v[232:235]
    s_waitcnt lgkmcnt(4)
    v_mfma_f32_16x16x32_bf16 v[76:79], a[252:255], a[216:219], v[76:79]
    v_mfma_f32_16x16x32_bf16 v[108:111], a[252:255], a[220:223], v[108:111]
    ds_read_b64_tr_b16 a[248:249], v44 offset:0
    v_mfma_f32_16x16x32_bf16 v[140:143], a[252:255], a[224:227], v[140:143]
    ds_read_b64_tr_b16 a[250:251], v44 offset:1024
    v_mfma_f32_16x16x32_bf16 v[172:175], a[252:255], a[228:231], v[172:175]
    v_mfma_f32_16x16x32_bf16 v[204:207], a[252:255], a[232:235], v[204:207]
    v_mfma_f32_16x16x32_bf16 v[236:239], a[252:255], a[236:239], v[236:239]
    s_waitcnt lgkmcnt(4)
    v_mfma_f32_16x16x32_bf16 v[80:83], a[240:243], a[216:219], v[80:83]
    v_mfma_f32_16x16x32_bf16 v[112:115], a[240:243], a[220:223], v[112:115]
    ds_read_b64_tr_b16 a[252:253], v44 offset:8
    v_mfma_f32_16x16x32_bf16 v[144:147], a[240:243], a[224:227], v[144:147]
    ds_read_b64_tr_b16 a[254:255], v44 offset:1032
    s_add_u32 m0, s43, 32768
    v_mfma_f32_16x16x32_bf16 v[176:179], a[240:243], a[228:231], v[176:179]
    buffer_load_dwordx4 v8, s[16:19], s40 offen offset:0 nt lds
    v_mfma_f32_16x16x32_bf16 v[208:211], a[240:243], a[232:235], v[208:211]
    v_mfma_f32_16x16x32_bf16 v[240:243], a[240:243], a[236:239], v[240:243]
    s_waitcnt lgkmcnt(4)
    v_mfma_f32_16x16x32_bf16 v[84:87], a[244:247], a[216:219], v[84:87]
    v_mfma_f32_16x16x32_bf16 v[116:119], a[244:247], a[220:223], v[116:119]
    s_waitcnt lgkmcnt(0)
    s_barrier
    v_mfma_f32_16x16x32_bf16 v[148:151], a[244:247], a[224:227], v[148:151]
    v_mfma_f32_16x16x32_bf16 v[180:183], a[244:247], a[228:231], v[180:183]
    v_mfma_f32_16x16x32_bf16 v[212:215], a[244:247], a[232:235], v[212:215]
    v_mfma_f32_16x16x32_bf16 v[244:247], a[244:247], a[236:239], v[244:247]
    v_mfma_f32_16x16x32_bf16 v[88:91], a[248:251], a[216:219], v[88:91]
    v_mfma_f32_16x16x32_bf16 v[120:123], a[248:251], a[220:223], v[120:123]
    v_mfma_f32_16x16x32_bf16 v[152:155], a[248:251], a[224:227], v[152:155]
    v_mfma_f32_16x16x32_bf16 v[184:187], a[248:251], a[228:231], v[184:187]
    v_mfma_f32_16x16x32_bf16 v[216:219], a[248:251], a[232:235], v[216:219]
    s_add_u32 m0, s43, 32768
    v_mfma_f32_16x16x32_bf16 v[248:251], a[248:251], a[236:239], v[248:251]
    buffer_load_dwordx4 v9, s[16:19], s40 offen offset:1024 nt lds
    v_mfma_f32_16x16x32_bf16 v[92:95], a[252:255], a[216:219], v[92:95]
    v_mfma_f32_16x16x32_bf16 v[124:127], a[252:255], a[220:223], v[124:127]
    v_mfma_f32_16x16x32_bf16 v[156:159], a[252:255], a[224:227], v[156:159]
    v_mfma_f32_16x16x32_bf16 v[188:191], a[252:255], a[228:231], v[188:191]
    v_mfma_f32_16x16x32_bf16 v[220:223], a[252:255], a[232:235], v[220:223]
    v_mfma_f32_16x16x32_bf16 v[252:255], a[252:255], a[236:239], v[252:255]
    s_cmp_eq_u32 s4, 0
    s_cbranch_scc1 L_sig0
L_nosig0:
    s_add_u32 s12, s12, 4096
    s_addc_u32 s13, s13, 0
    s_sub_u32 s14, s14, 4096
    s_add_u32 s52, s7, s87
    s_cmp_eq_u32 s52, 0
    s_cselect_b32 s14, s14, 0
    s_cselect_b32 s10, s10, 0
    s_cselect_b32 s62, 40000, 0
    s_cselect_b32 s26, 5242880, 0
    v_add_u32 v52, 0x10000, v14
    v_add_u32 v53, 0x10000, v15
    v_add_u32 v54, 0x10000, v16
    v_add_u32 v55, 0x10000, v17
    v_add_u32 v56, 0x10000, v26
    v_add_u32 v57, 0x10000, v27
    v_add_u32 v58, 0x10000, v28
    v_add_u32 v59, 0x10000, v29
    v_add_u32 v60, 0x10000, v30
    v_add_u32 v61, 0x10000, v31
    v_add_u32 v62, 0x10000, v32
    v_add_u32 v63, 0x10000, v33
    s_add_u32 m0, s43, 32768
    s_waitcnt vmcnt(7)
    buffer_load_dwordx4 v8, s[16:19], s40 offen offset:2048 nt lds
    s_add_u32 m0, s43, 32768
    s_waitcnt vmcnt(7)
    buffer_load_dwordx4 v9, s[16:19], s40 offen offset:3072 nt lds
    s_add_u32 s40, s40, 4096
    v_pk_mul_f32 v[64:65], v[64:65], s[46:47]
    v_pk_mul_f32 v[66:67], v[66:67], s[46:47]
    v_pk_mul_f32 v[68:69], v[68:69], s[46:47]
    v_pk_mul_f32 v[70:71], v[70:71], s[46:47]
    v_pk_mul_f32 v[72:73], v[72:73], s[46:47]
    v_pk_mul_f32 v[74:75], v[74:75], s[46:47]
    v_pk_mul_f32 v[76:77], v[76:77], s[46:47]
    v_pk_mul_f32 v[78:79], v[78:79], s[46:47]
    v_pk_mul_f32 v[80:81], v[80:81], s[46:47]
    v_pk_mul_f32 v[82:83], v[82:83], s[46:47]
    v_pk_mul_f32 v[84:85], v[84:85], s[46:47]
    v_pk_mul_f32 v[86:87], v[86:87], s[46:47]
    v_pk_mul_f32 v[88:89], v[88:89], s[46:47]
    v_pk_mul_f32 v[90:91], v[90:91], s[46:47]
    v_pk_mul_f32 v[92:93], v[92:93], s[46:47]
    v_pk_mul_f32 v[94:95], v[94:95], s[46:47]
    v_cvt_pk_bf16_f32 v64, v64, v65
    v_cvt_pk_bf16_f32 v65, v66, v67
    v_cvt_pk_bf16_f32 v66, v68, v69
    v_cvt_pk_bf16_f32 v67, v70, v71
    v_cvt_pk_bf16_f32 v68, v72, v73
    v_cvt_pk_bf16_f32 v69, v74, v75
    v_cvt_pk_bf16_f32 v70, v76, v77
    v_cvt_pk_bf16_f32 v71, v78, v79
    v_cvt_pk_bf16_f32 v72, v80, v81
    v_cvt_pk_bf16_f32 v73, v82, v83
    v_cvt_pk_bf16_f32 v74, v84, v85
    v_cvt_pk_bf16_f32 v75, v86, v87
    v_cvt_pk_bf16_f32 v76, v88, v89
    v_cvt_pk_bf16_f32 v77, v90, v91
    v_cvt_pk_bf16_f32 v78, v92, v93
    v_cvt_pk_bf16_f32 v79, v94, v95
    v_accvgpr_write_b32 a192, v64
    v_accvgpr_write_b32 a193, v65
    v_accvgpr_write_b32 a194, v66
    v_accvgpr_write_b32 a195, v67
    v_accvgpr_write_b32 a196, v68
    v_accvgpr_write_b32 a197, v69
    v_accvgpr_write_b32 a198, v70
    v_accvgpr_write_b32 a199, v71
    v_accvgpr_write_b32 a200, v72
    v_accvgpr_write_b32 a201, v73
    v_accvgpr_write_b32 a202, v74
    v_accvgpr_write_b32 a203, v75
    v_accvgpr_write_b32 a204, v76
    v_accvgpr_write_b32 a205, v77
    v_accvgpr_write_b32 a206, v78
    v_accvgpr_write_b32 a207, v79
    ds_read_b128 v[64:67], v52 offset:0
    v_pk_mul_f32 v[96:97], v[96:97], s[46:47]
    v_pk_mul_f32 v[98:99], v[98:99], s[46:47]
    ds_read_b128 v[68:71], v53 offset:0
    v_pk_mul_f32 v[100:101], v[100:101], s[46:47]
    v_pk_mul_f32 v[102:103], v[102:103], s[46:47]
    ds_read_b128 v[72:75], v54 offset:0
    v_pk_mul_f32 v[104:105], v[104:105], s[46:47]
    v_pk_mul_f32 v[106:107], v[106:107], s[46:47]
    ds_read_b128 v[76:79], v55 offset:0
    v_pk_mul_f32 v[108:109], v[108:109], s[46:47]
    v_pk_mul_f32 v[110:111], v[110:111], s[46:47]
    ds_read_b128 v[80:83], v52 offset:4096
    v_pk_mul_f32 v[112:113], v[112:113], s[46:47]
    v_pk_mul_f32 v[114:115], v[114:115], s[46:47]
    ds_read_b128 v[84:87], v53 offset:4096
    v_pk_mul_f32 v[116:117], v[116:117], s[46:47]
    v_pk_mul_f32 v[118:119], v[118:119], s[46:47]
    ds_read_b128 v[88:91], v54 offset:4096
    v_pk_mul_f32 v[120:121], v[120:121], s[46:47]
    v_pk_mul_f32 v[122:123], v[122:123], s[46:47]
    ds_read_b128 v[92:95], v55 offset:4096
    v_pk_mul_f32 v[124:125], v[124:125], s[46:47]
    v_pk_mul_f32 v[126:127], v[126:127], s[46:47]
    s_add_u32 m0, s43, 36864
    s_waitcnt vmcnt(7)
    buffer_load_dwordx4 v8, s[16:19], s40 offen offset:0 nt lds
    s_add_u32 m0, s43, 36864
    s_waitcnt vmcnt(7)
    buffer_load_dwordx4 v9, s[16:19], s40 offen offset:1024 nt lds
    v_cvt_pk_bf16_f32 v96, v96, v97
    v_cvt_pk_bf16_f32 v97, v98, v99
    v_cvt_pk_bf16_f32 v98, v100, v101
    v_cvt_pk_bf16_f32 v99, v102, v103
    v_cvt_pk_bf16_f32 v100, v104, v105
    v_cvt_pk_bf16_f32 v101, v106, v107
    v_cvt_pk_bf16_f32 v102, v108, v109
    v_cvt_pk_bf16_f32 v103, v110, v111
    v_cvt_pk_bf16_f32 v104, v112, v113
    v_cvt_pk_bf16_f32 v105, v114, v115
    v_cvt_pk_bf16_f32 v106, v116, v117
    v_cvt_pk_bf16_f32 v107, v118, v119
    v_cvt_pk_bf16_f32 v108, v120, v121
    v_cvt_pk_bf16_f32 v109, v122, v123
    v_cvt_pk_bf16_f32 v110, v124, v125
    v_cvt_pk_bf16_f32 v111, v126, v127
    v_accvgpr_write_b32 a208, v96
    v_accvgpr_write_b32 a209, v97
    v_accvgpr_write_b32 a210, v98
    v_accvgpr_write_b32 a211, v99
    v_accvgpr_write_b32 a212, v100
    v_accvgpr_write_b32 a213, v101
    v_accvgpr_write_b32 a214, v102
    v_accvgpr_write_b32 a215, v103
    v_accvgpr_write_b32 a216, v104
    v_accvgpr_write_b32 a217, v105
    v_accvgpr_write_b32 a218, v106
    v_accvgpr_write_b32 a219, v107
    v_accvgpr_write_b32 a220, v108
    v_accvgpr_write_b32 a221, v109
    v_accvgpr_write_b32 a222, v110
    v_accvgpr_write_b32 a223, v111
    ds_read_b64_tr_b16 v[96:97], v56 offset:0
    v_pk_mul_f32 v[128:129], v[128:129], s[46:47]
    v_pk_mul_f32 v[130:131], v[130:131], s[46:47]
    v_pk_mul_f32 v[132:133], v[132:133], s[46:47]
    v_pk_mul_f32 v[134:135], v[134:135], s[46:47]
    ds_read_b64_tr_b16 v[98:99], v56 offset:4096
    v_pk_mul_f32 v[136:137], v[136:137], s[46:47]
    v_pk_mul_f32 v[138:139], v[138:139], s[46:47]
    v_pk_mul_f32 v[140:141], v[140:141], s[46:47]
    v_pk_mul_f32 v[142:143], v[142:143], s[46:47]
    ds_read_b64_tr_b16 v[100:101], v57 offset:0
    v_pk_mul_f32 v[144:145], v[144:145], s[46:47]
    v_pk_mul_f32 v[146:147], v[146:147], s[46:47]
    v_pk_mul_f32 v[148:149], v[148:149], s[46:47]
    v_pk_mul_f32 v[150:151], v[150:151], s[46:47]
    ds_read_b64_tr_b16 v[102:103], v57 offset:4096
    v_pk_mul_f32 v[152:153], v[152:153], s[46:47]
    v_pk_mul_f32 v[154:155], v[154:155], s[46:47]
    v_pk_mul_f32 v[156:157], v[156:157], s[46:47]
    v_pk_mul_f32 v[158:159], v[158:159], s[46:47]
    ds_read_b64_tr_b16 v[104:105], v58 offset:0
    v_pk_mul_f32 v[160:161], v[160:161], s[46:47]
    v_pk_mul_f32 v[162:163], v[162:163], s[46:47]
    v_pk_mul_f32 v[164:165], v[164:165], s[46:47]
    v_pk_mul_f32 v[166:167], v[166:167], s[46:47]
    ds_read_b64_tr_b16 v[106:107], v58 offset:4096
    v_pk_mul_f32 v[168:169], v[168:169], s[46:47]
    v_pk_mul_f32 v[170:171], v[170:171], s[46:47]
    v_pk_mul_f32 v[172:173], v[172:173], s[46:47]
    v_pk_mul_f32 v[174:175], v[174:175], s[46:47]
    ds_read_b64_tr_b16 v[108:109], v59 offset:0
    v_pk_mul_f32 v[176:177], v[176:177], s[46:47]
    v_pk_mul_f32 v[178:179], v[178:179], s[46:47]
    v_pk_mul_f32 v[180:181], v[180:181], s[46:47]
    v_pk_mul_f32 v[182:183], v[182:183], s[46:47]
    ds_read_b64_tr_b16 v[110:111], v59 offset:4096
    v_pk_mul_f32 v[184:185], v[184:185], s[46:47]
    v_pk_mul_f32 v[186:187], v[186:187], s[46:47]
    v_pk_mul_f32 v[188:189], v[188:189], s[46:47]
    v_pk_mul_f32 v[190:191], v[190:191], s[46:47]
    ds_read_b64_tr_b16 v[112:113], v60 offset:0
    v_pk_mul_f32 v[192:193], v[192:193], s[46:47]
    v_pk_mul_f32 v[194:195], v[194:195], s[46:47]
    v_pk_mul_f32 v[196:197], v[196:197], s[46:47]
    v_pk_mul_f32 v[198:199], v[198:199], s[46:47]
    ds_read_b64_tr_b16 v[114:115], v60 offset:4096
    v_pk_mul_f32 v[200:201], v[200:201], s[46:47]
    v_pk_mul_f32 v[202:203], v[202:203], s[46:47]
    v_pk_mul_f32 v[204:205], v[204:205], s[46:47]
    v_pk_mul_f32 v[206:207], v[206:207], s[46:47]
    ds_read_b64_tr_b16 v[116:117], v61 offset:0
    v_pk_mul_f32 v[208:209], v[208:209], s[46:47]
    v_pk_mul_f32 v[210:211], v[210:211], s[46:47]
    v_pk_mul_f32 v[212:213], v[212:213], s[46:47]
    v_pk_mul_f32 v[214:215], v[214:215], s[46:47]
    ds_read_b64_tr_b16 v[118:119], v61 offset:4096
    v_pk_mul_f32 v[216:217], v[216:217], s[46:47]
    v_pk_mul_f32 v[218:219], v[218:219], s[46:47]
    v_pk_mul_f32 v[220:221], v[220:221], s[46:47]
    v_pk_mul_f32 v[222:223], v[222:223], s[46:47]
    ds_read_b64_tr_b16 v[120:121], v62 offset:0
    v_pk_mul_f32 v[224:225], v[224:225], s[46:47]
    v_pk_mul_f32 v[226:227], v[226:227], s[46:47]
    v_pk_mul_f32 v[228:229], v[228:229], s[46:47]
    v_pk_mul_f32 v[230:231], v[230:231], s[46:47]
    ds_read_b64_tr_b16 v[122:123], v62 offset:4096
    v_pk_mul_f32 v[232:233], v[232:233], s[46:47]
    v_pk_mul_f32 v[234:235], v[234:235], s[46:47]
    v_pk_mul_f32 v[236:237], v[236:237], s[46:47]
    v_pk_mul_f32 v[238:239], v[238:239], s[46:47]
    ds_read_b64_tr_b16 v[124:125], v63 offset:0
    v_pk_mul_f32 v[240:241], v[240:241], s[46:47]
    v_pk_mul_f32 v[242:243], v[242:243], s[46:47]
    v_pk_mul_f32 v[244:245], v[244:245], s[46:47]
    v_pk_mul_f32 v[246:247], v[246:247], s[46:47]
    ds_read_b64_tr_b16 v[126:127], v63 offset:4096
    v_pk_mul_f32 v[248:249], v[248:249], s[46:47]
    v_pk_mul_f32 v[250:251], v[250:251], s[46:47]
    v_pk_mul_f32 v[252:253], v[252:253], s[46:47]
    v_pk_mul_f32 v[254:255], v[254:255], s[46:47]
    s_add_u32 m0, s43, 36864
    s_waitcnt vmcnt(7)
    buffer_load_dwordx4 v8, s[16:19], s40 offen offset:2048 nt lds
    s_add_u32 m0, s43, 36864
    s_waitcnt vmcnt(7)
    buffer_load_dwordx4 v9, s[16:19], s40 offen offset:3072 nt lds
    s_add_u32 s40, s40, 4096
    s_waitcnt lgkmcnt(15)
    v_mfma_f32_16x16x32_bf16 v[40:43], v[64:67], a[192:195], 0
    v_cvt_pk_bf16_f32 v128, v128, v129
    v_cvt_pk_bf16_f32 v129, v130, v131
    v_mfma_f32_16x16x32_bf16 v[40:43], v[68:71], a[196:199], v[40:43]
    v_cvt_pk_bf16_f32 v130, v132, v133
    v_cvt_pk_bf16_f32 v131, v134, v135
    v_mfma_f32_16x16x32_bf16 v[40:43], v[72:75], a[200:203], v[40:43]
    v_cvt_pk_bf16_f32 v132, v136, v137
    v_cvt_pk_bf16_f32 v133, v138, v139
    v_mfma_f32_16x16x32_bf16 v[40:43], v[76:79], a[204:207], v[40:43]
    v_cvt_pk_bf16_f32 v134, v140, v141
    v_cvt_pk_bf16_f32 v135, v142, v143
    v_mfma_f32_16x16x32_bf16 v[44:47], v[64:67], a[208:211], 0
    v_cvt_pk_bf16_f32 v136, v144, v145
    v_cvt_pk_bf16_f32 v137, v146, v147
    v_mfma_f32_16x16x32_bf16 v[44:47], v[68:71], a[212:215], v[44:47]
    v_cvt_pk_bf16_f32 v138, v148, v149
    v_cvt_pk_bf16_f32 v139, v150, v151
    v_mfma_f32_16x16x32_bf16 v[44:47], v[72:75], a[216:219], v[44:47]
    v_cvt_pk_bf16_f32 v140, v152, v153
    v_cvt_pk_bf16_f32 v141, v154, v155
    v_mfma_f32_16x16x32_bf16 v[44:47], v[76:79], a[220:223], v[44:47]
    v_cvt_pk_bf16_f32 v142, v156, v157
    v_cvt_pk_bf16_f32 v143, v158, v159
    v_accvgpr_write_b32 a224, v128
    v_accvgpr_write_b32 a225, v129
    v_accvgpr_write_b32 a226, v130
    v_accvgpr_write_b32 a227, v131
    v_accvgpr_write_b32 a228, v132
    v_accvgpr_write_b32 a229, v133
    v_accvgpr_write_b32 a230, v134
    v_accvgpr_write_b32 a231, v135
    v_accvgpr_write_b32 a232, v136
    v_accvgpr_write_b32 a233, v137
    v_accvgpr_write_b32 a234, v138
    v_accvgpr_write_b32 a235, v139
    v_accvgpr_write_b32 a236, v140
    v_accvgpr_write_b32 a237, v141
    v_accvgpr_write_b32 a238, v142
    v_accvgpr_write_b32 a239, v143
    s_add_u32 m0, s43, 65536
    s_waitcnt vmcnt(7)
    buffer_load_dwordx4 v8, s[16:19], s40 offen offset:0 nt lds
    v_mfma_f32_16x16x32_bf16 v[48:51], v[64:67], a[224:227], 0
    v_cvt_pk_bf16_f32 v160, v160, v161
    v_cvt_pk_bf16_f32 v161, v162, v163
    v_mfma_f32_16x16x32_bf16 v[48:51], v[68:71], a[228:231], v[48:51]
    v_cvt_pk_bf16_f32 v162, v164, v165
    v_cvt_pk_bf16_f32 v163, v166, v167
    v_mfma_f32_16x16x32_bf16 v[48:51], v[72:75], a[232:235], v[48:51]
    v_cvt_pk_bf16_f32 v164, v168, v169
    v_cvt_pk_bf16_f32 v165, v170, v171
    v_mfma_f32_16x16x32_bf16 v[48:51], v[76:79], a[236:239], v[48:51]
    v_cvt_pk_bf16_f32 v166, v172, v173
    v_cvt_pk_bf16_f32 v167, v174, v175
    v_cvt_pk_bf16_f32 v168, v176, v177
    v_cvt_pk_bf16_f32 v169, v178, v179
    v_cvt_pk_bf16_f32 v170, v180, v181
    v_cvt_pk_bf16_f32 v171, v182, v183
    v_cvt_pk_bf16_f32 v172, v184, v185
    v_cvt_pk_bf16_f32 v173, v186, v187
    v_cvt_pk_bf16_f32 v174, v188, v189
    v_cvt_pk_bf16_f32 v175, v190, v191
    v_accvgpr_write_b32 a240, v160
    v_accvgpr_write_b32 a241, v161
    v_accvgpr_write_b32 a242, v162
    v_accvgpr_write_b32 a243, v163
    v_accvgpr_write_b32 a244, v164
    v_accvgpr_write_b32 a245, v165
    v_accvgpr_write_b32 a246, v166
    v_accvgpr_write_b32 a247, v167
    v_accvgpr_write_b32 a248, v168
    v_accvgpr_write_b32 a249, v169
    v_accvgpr_write_b32 a250, v170
    v_accvgpr_write_b32 a251, v171
    v_accvgpr_write_b32 a252, v172
    v_accvgpr_write_b32 a253, v173
    v_accvgpr_write_b32 a254, v174
    v_accvgpr_write_b32 a255, v175
    s_add_u32 m0, s43, 65536
    s_waitcnt vmcnt(7)
    buffer_load_dwordx4 v9, s[16:19], s40 offen offset:1024 nt lds
    s_add_u32 m0, s43, 65536
    s_waitcnt vmcnt(7)
    buffer_load_dwordx4 v8, s[16:19], s40 offen offset:2048 nt lds
    v_mfma_f32_16x16x32_bf16 v[52:55], v[64:67], a[240:243], 0
    v_cvt_pk_bf16_f32 v192, v192, v193
    v_cvt_pk_bf16_f32 v193, v194, v195
    v_mfma_f32_16x16x32_bf16 v[52:55], v[68:71], a[244:247], v[52:55]
    v_cvt_pk_bf16_f32 v194, v196, v197
    v_cvt_pk_bf16_f32 v195, v198, v199
    v_mfma_f32_16x16x32_bf16 v[52:55], v[72:75], a[248:251], v[52:55]
    v_cvt_pk_bf16_f32 v196, v200, v201
    v_cvt_pk_bf16_f32 v197, v202, v203
    v_mfma_f32_16x16x32_bf16 v[52:55], v[76:79], a[252:255], v[52:55]
    v_cvt_pk_bf16_f32 v198, v204, v205
    v_cvt_pk_bf16_f32 v199, v206, v207
    v_cvt_pk_bf16_f32 v200, v208, v209
    v_cvt_pk_bf16_f32 v201, v210, v211
    v_cvt_pk_bf16_f32 v202, v212, v213
    v_cvt_pk_bf16_f32 v203, v214, v215
    v_cvt_pk_bf16_f32 v204, v216, v217
    v_cvt_pk_bf16_f32 v205, v218, v219
    v_cvt_pk_bf16_f32 v206, v220, v221
    v_cvt_pk_bf16_f32 v207, v222, v223
    v_max3_f32 v40, v40, v41, v42
    v_max3_f32 v44, v44, v45, v46
    v_max3_f32 v48, v48, v49, v50
    v_max_f32 v40, v40, v43
    v_max_f32 v44, v44, v47
    v_max_f32 v48, v48, v51
    v_mov_b32 v41, v40
    v_mov_b32 v45, v44
    v_mov_b32 v49, v48
    v_permlane32_swap_b32 v40, v41
    v_permlane32_swap_b32 v44, v45
    v_permlane32_swap_b32 v48, v49
    v_max_f32 v40, v40, v41
    v_max_f32 v44, v44, v45
    v_max_f32 v48, v48, v49
    v_mov_b32 v41, v40
    v_mov_b32 v45, v44
    v_mov_b32 v49, v48
    v_permlane16_swap_b32 v40, v41
    v_permlane16_swap_b32 v44, v45
    v_permlane16_swap_b32 v48, v49
    v_max_f32 v40, v40, v41
    v_max_f32 v44, v44, v45
    v_max_f32 v48, v48, v49
    v_mul_f32 v40, -1.0, v40
    v_mul_f32 v44, -1.0, v44
    v_mul_f32 v48, -1.0, v48
    v_mov_b32 v41, v40
    v_mov_b32 v45, v44
    v_mov_b32 v49, v48
    v_mov_b32 v42, v40
    v_mov_b32 v46, v44
    v_mov_b32 v50, v48
    v_mov_b32 v43, v40
    v_mov_b32 v47, v44
    v_mov_b32 v51, v48
    s_add_u32 m0, s43, 65536
    s_waitcnt vmcnt(7)
    buffer_load_dwordx4 v9, s[16:19], s40 offen offset:3072 nt lds
    s_add_u32 s40, s40, 4096
    s_add_u32 m0, s43, 69632
    s_waitcnt vmcnt(7)
    buffer_load_dwordx4 v8, s[16:19], s40 offen offset:0 nt lds
    v_mfma_f32_16x16x32_bf16 v[56:59], v[64:67], v[192:195], 0
    v_cvt_pk_bf16_f32 v224, v224, v225
    v_cvt_pk_bf16_f32 v225, v226, v227
    v_mfma_f32_16x16x32_bf16 v[56:59], v[68:71], v[196:199], v[56:59]
    v_cvt_pk_bf16_f32 v226, v228, v229
    v_cvt_pk_bf16_f32 v227, v230, v231
    v_mfma_f32_16x16x32_bf16 v[56:59], v[72:75], v[200:203], v[56:59]
    v_cvt_pk_bf16_f32 v228, v232, v233
    v_cvt_pk_bf16_f32 v229, v234, v235
    v_mfma_f32_16x16x32_bf16 v[56:59], v[76:79], v[204:207], v[56:59]
    v_cvt_pk_bf16_f32 v230, v236, v237
    v_cvt_pk_bf16_f32 v231, v238, v239
    v_cvt_pk_bf16_f32 v232, v240, v241
    v_cvt_pk_bf16_f32 v233, v242, v243
    v_cvt_pk_bf16_f32 v234, v244, v245
    v_cvt_pk_bf16_f32 v235, v246, v247
    v_cvt_pk_bf16_f32 v236, v248, v249
    v_cvt_pk_bf16_f32 v237, v250, v251
    v_cvt_pk_bf16_f32 v238, v252, v253
    v_cvt_pk_bf16_f32 v239, v254, v255
    s_add_u32 m0, s43, 69632
    s_waitcnt vmcnt(7)
    buffer_load_dwordx4 v9, s[16:19], s40 offen offset:1024 nt lds
    s_add_u32 m0, s43, 69632
    s_waitcnt vmcnt(7)
    buffer_load_dwordx4 v8, s[16:19], s40 offen offset:2048 nt lds
    v_mfma_f32_16x16x32_bf16 v[60:63], v[64:67], v[224:227], 0
    v_mov_b32 v34, 0x3f803f80
    v_mov_b32 v35, 0x3f803f80
    v_mfma_f32_16x16x32_bf16 v[60:63], v[68:71], v[228:231], v[60:63]
    v_mov_b32 v36, 0x3f803f80
    v_mov_b32 v37, 0x3f803f80
    v_mfma_f32_16x16x32_bf16 v[60:63], v[72:75], v[232:235], v[60:63]
    v_mov_b32 v244, 0
    v_mov_b32 v245, 0
    v_mfma_f32_16x16x32_bf16 v[60:63], v[76:79], v[236:239], v[60:63]
    v_mov_b32 v246, 0
    v_mov_b32 v247, 0
    s_add_u32 m0, s43, 69632
    s_waitcnt vmcnt(7)
    buffer_load_dwordx4 v9, s[16:19], s40 offen offset:3072 nt lds
    s_add_u32 s40, s40, 4096
    v_max3_f32 v52, v52, v53, v54
    v_max3_f32 v56, v56, v57, v58
    v_max_f32 v52, v52, v55
    v_max_f32 v56, v56, v59
    v_mov_b32 v53, v52
    v_mov_b32 v57, v56
    v_max3_f32 v60, v60, v61, v62
    v_permlane32_swap_b32 v52, v53
    v_permlane32_swap_b32 v56, v57
    v_max_f32 v60, v60, v63
    v_max_f32 v52, v52, v53
    v_max_f32 v56, v56, v57
    v_mov_b32 v61, v60
    v_mov_b32 v53, v52
    v_mov_b32 v57, v56
    v_permlane32_swap_b32 v60, v61
    v_permlane16_swap_b32 v52, v53
    v_permlane16_swap_b32 v56, v57
    v_max_f32 v60, v60, v61
    v_max_f32 v52, v52, v53
    v_max_f32 v56, v56, v57
    v_mov_b32 v61, v60
    v_mul_f32 v52, -1.0, v52
    v_mul_f32 v56, -1.0, v56
    v_permlane16_swap_b32 v60, v61
    v_mov_b32 v53, v52
    v_mov_b32 v57, v56
    v_max_f32 v60, v60, v61
    v_mov_b32 v54, v52
    v_mov_b32 v58, v56
    v_mul_f32 v60, -1.0, v60
    v_mov_b32 v55, v52
    v_mov_b32 v59, v56
    v_mov_b32 v61, v60
    v_mov_b32 v62, v60
    v_mov_b32 v63, v60
    s_waitcnt lgkmcnt(0)
    s_mov_b32 s44, 3
    s_mov_b32 s99, 0x1e000
    s_add_u32 m0, s43, 98304
L_a0:
    v_mfma_f32_16x16x32_bf16 v[160:163], v[64:67], a[192:195], v[40:43]
    v_mfma_f32_16x16x32_bf16 v[160:163], v[68:71], a[196:199], v[160:163]
    v_accvgpr_write_b32 a160, 0
    v_accvgpr_write_b32 a161, 0
    v_mfma_f32_16x16x32_bf16 v[160:163], v[72:75], a[200:203], v[160:163]
    v_accvgpr_write_b32 a162, 0
    v_accvgpr_write_b32 a163, 0
    v_mfma_f32_16x16x32_bf16 v[160:163], v[76:79], a[204:207], v[160:163]
    v_accvgpr_write_b32 a164, 0
    v_accvgpr_write_b32 a165, 0
    v_mfma_f32_16x16x32_bf16 v[164:167], v[80:83], a[192:195], v[40:43]
    v_accvgpr_write_b32 a166, 0
    v_accvgpr_write_b32 a167, 0
    v_mfma_f32_16x16x32_bf16 v[164:167], v[84:87], a[196:199], v[164:167]
    v_accvgpr_write_b32 a168, 0
    v_accvgpr_write_b32 a169, 0
    v_mfma_f32_16x16x32_bf16 v[164:167], v[88:91], a[200:203], v[164:167]
    v_accvgpr_write_b32 a170, 0
    v_accvgpr_write_b32 a171, 0
    v_mfma_f32_16x16x32_bf16 v[164:167], v[92:95], a[204:207], v[164:167]
    s_barrier
    s_nop 3
    v_exp_f32 v160, v160
    v_exp_f32 v161, v161
    v_exp_f32 v162, v162
    v_exp_f32 v163, v163
    v_cvt_pk_bf16_f32 v176, v160, v161
    v_cvt_pk_bf16_f32 v177, v162, v163
    v_mfma_f32_16x16x32_bf16 v[168:171], v[64:67], a[208:211], v[44:47]
    v_exp_f32 v164, v164
    v_mfma_f32_16x16x32_bf16 v[168:171], v[68:71], a[212:215], v[168:171]
    v_exp_f32 v165, v165
    v_mfma_f32_16x16x32_bf16 v[168:171], v[72:75], a[216:219], v[168:171]
    ds_read_b64_tr_b16 v[128:129], v18 offset:0
    v_cvt_pk_bf16_f32 v178, v164, v165
    v_mfma_f32_16x16x32_bf16 v[168:171], v[76:79], a[220:223], v[168:171]
    v_exp_f32 v166, v166
    v_mfma_f32_16x16x32_bf16 v[172:175], v[80:83], a[208:211], v[44:47]
    v_exp_f32 v167, v167
    v_mfma_f32_16x16x32_bf16 v[172:175], v[84:87], a[212:215], v[172:175]
    ds_read_b64_tr_b16 v[130:131], v18 offset:4096
    v_cvt_pk_bf16_f32 v179, v166, v167
    v_mfma_f32_16x16x32_bf16 v[172:175], v[88:91], a[216:219], v[172:175]
    v_accvgpr_write_b32 a172, 0
    v_accvgpr_write_b32 a173, 0
    v_mfma_f32_16x16x32_bf16 v[172:175], v[92:95], a[220:223], v[172:175]
    v_exp_f32 v168, v168
    v_mfma_f32_16x16x32_bf16 a[0:3], v[96:99], v[176:179], 0
    v_exp_f32 v169, v169
    v_mfma_f32_16x16x32_bf16 a[4:7], v[100:103], v[176:179], 0
    ds_read_b64_tr_b16 v[132:133], v19 offset:0
    v_cvt_pk_bf16_f32 v180, v168, v169
    v_mfma_f32_16x16x32_bf16 a[8:11], v[104:107], v[176:179], 0
    v_exp_f32 v170, v170
    v_mfma_f32_16x16x32_bf16 a[12:15], v[108:111], v[176:179], 0
    v_exp_f32 v171, v171
    v_mfma_f32_16x16x32_bf16 a[16:19], v[112:115], v[176:179], 0
    ds_read_b64_tr_b16 v[134:135], v19 offset:4096
    v_cvt_pk_bf16_f32 v181, v170, v171
    v_mfma_f32_16x16x32_bf16 a[20:23], v[116:119], v[176:179], 0
    v_accvgpr_write_b32 a174, 0
    v_accvgpr_write_b32 a175, 0
    v_mfma_f32_16x16x32_bf16 a[24:27], v[120:123], v[176:179], 0
    v_accvgpr_write_b32 a176, 0
    v_accvgpr_write_b32 a177, 0
    v_mfma_f32_16x16x32_bf16 a[28:31], v[124:127], v[176:179], 0
    s_waitcnt vmcnt(4)
    buffer_load_dwordx4 v8, s[16:19], s40 offen offset:0 nt lds
    v_mfma_f32_16x16x32_bf16 v[208:211], v[34:37], v[176:179], 0
    s_add_u32 s40, s40, 1024
    v_accvgpr_write_b32 a178, 0
    v_accvgpr_write_b32 a179, 0
    v_mfma_f32_16x16x32_bf16 v[160:163], v[64:67], a[224:227], v[48:51]
    s_add_u32 s99, s99, 1024
    v_exp_f32 v172, v172
    v_mfma_f32_16x16x32_bf16 v[160:163], v[68:71], a[228:231], v[160:163]
    s_and_b32 s100, s99, 0x19fff
    v_exp_f32 v173, v173
    v_mfma_f32_16x16x32_bf16 v[160:163], v[72:75], a[232:235], v[160:163]
    ds_read_b64_tr_b16 v[136:137], v20 offset:0
    v_cvt_pk_bf16_f32 v182, v172, v173
    v_mfma_f32_16x16x32_bf16 v[160:163], v[76:79], a[236:239], v[160:163]
    s_or_b32 m0, s100, s43
    v_exp_f32 v174, v174
    v_mfma_f32_16x16x32_bf16 v[164:167], v[80:83], a[224:227], v[48:51]
    s_or_b32 s99, s99, 0x6000
    v_exp_f32 v175, v175
    v_mfma_f32_16x16x32_bf16 v[164:167], v[84:87], a[228:231], v[164:167]
    ds_read_b64_tr_b16 v[138:139], v20 offset:4096
    v_cvt_pk_bf16_f32 v183, v174, v175
    v_mfma_f32_16x16x32_bf16 v[164:167], v[88:91], a[232:235], v[164:167]
    v_accvgpr_write_b32 a180, 0
    v_accvgpr_write_b32 a181, 0
    v_mfma_f32_16x16x32_bf16 v[164:167], v[92:95], a[236:239], v[164:167]
    v_exp_f32 v160, v160
    v_mfma_f32_16x16x32_bf16 a[32:35], v[96:99], v[180:183], 0
    v_exp_f32 v161, v161
    v_mfma_f32_16x16x32_bf16 a[36:39], v[100:103], v[180:183], 0
    ds_read_b64_tr_b16 v[140:141], v21 offset:0
    v_cvt_pk_bf16_f32 v176, v160, v161
    v_mfma_f32_16x16x32_bf16 a[40:43], v[104:107], v[180:183], 0
    v_exp_f32 v162, v162
    v_mfma_f32_16x16x32_bf16 a[44:47], v[108:111], v[180:183], 0
    v_exp_f32 v163, v163
    v_mfma_f32_16x16x32_bf16 a[48:51], v[112:115], v[180:183], 0
    ds_read_b64_tr_b16 v[142:143], v21 offset:4096
    v_cvt_pk_bf16_f32 v177, v162, v163
    v_mfma_f32_16x16x32_bf16 a[52:55], v[116:119], v[180:183], 0
    v_accvgpr_write_b32 a182, 0
    v_accvgpr_write_b32 a183, 0
    v_mfma_f32_16x16x32_bf16 a[56:59], v[120:123], v[180:183], 0
    v_accvgpr_write_b32 a184, 0
    v_accvgpr_write_b32 a185, 0
    v_mfma_f32_16x16x32_bf16 a[60:63], v[124:127], v[180:183], 0
    s_waitcnt vmcnt(4)
    buffer_load_dwordx4 v9, s[16:19], s40 offen offset:0 nt lds
    v_mfma_f32_16x16x32_bf16 v[212:215], v[34:37], v[180:183], 0
    s_add_u32 s40, s40, 1024
    v_accvgpr_write_b32 a186, 0
    v_accvgpr_write_b32 a187, 0
    v_mfma_f32_16x16x32_bf16 v[168:171], v[64:67], a[240:243], v[52:55]
    s_add_u32 s99, s99, 1024
    v_exp_f32 v164, v164
    v_mfma_f32_16x16x32_bf16 v[168:171], v[68:71], a[244:247], v[168:171]
    s_and_b32 s100, s99, 0x19fff
    v_exp_f32 v165, v165
    v_mfma_f32_16x16x32_bf16 v[168:171], v[72:75], a[248:251], v[168:171]
    ds_read_b64_tr_b16 v[144:145], v22 offset:0
    v_cvt_pk_bf16_f32 v178, v164, v165
    v_mfma_f32_16x16x32_bf16 v[168:171], v[76:79], a[252:255], v[168:171]
    s_or_b32 m0, s100, s43
    v_exp_f32 v166, v166
    v_mfma_f32_16x16x32_bf16 v[172:175], v[80:83], a[240:243], v[52:55]
    s_or_b32 s99, s99, 0x6000
    v_exp_f32 v167, v167
    v_mfma_f32_16x16x32_bf16 v[172:175], v[84:87], a[244:247], v[172:175]
    ds_read_b64_tr_b16 v[146:147], v22 offset:4096
    v_cvt_pk_bf16_f32 v179, v166, v167
    v_mfma_f32_16x16x32_bf16 v[172:175], v[88:91], a[248:251], v[172:175]
    v_accvgpr_write_b32 a188, 0
    v_accvgpr_write_b32 a189, 0
    v_mfma_f32_16x16x32_bf16 v[172:175], v[92:95], a[252:255], v[172:175]
    v_exp_f32 v168, v168
    v_mfma_f32_16x16x32_bf16 a[64:67], v[96:99], v[176:179], 0
    v_exp_f32 v169, v169
    v_mfma_f32_16x16x32_bf16 a[68:71], v[100:103], v[176:179], 0
    ds_read_b64_tr_b16 v[148:149], v23 offset:0
    v_cvt_pk_bf16_f32 v180, v168, v169
    v_mfma_f32_16x16x32_bf16 a[72:75], v[104:107], v[176:179], 0
    v_exp_f32 v170, v170
    v_mfma_f32_16x16x32_bf16 a[76:79], v[108:111], v[176:179], 0
    v_exp_f32 v171, v171
    v_mfma_f32_16x16x32_bf16 a[80:83], v[112:115], v[176:179], 0
    ds_read_b64_tr_b16 v[150:151], v23 offset:4096
    v_cvt_pk_bf16_f32 v181, v170, v171
    v_mfma_f32_16x16x32_bf16 a[84:87], v[116:119], v[176:179], 0
    v_accvgpr_write_b32 a190, 0
    v_accvgpr_write_b32 a191, 0
    v_mfma_f32_16x16x32_bf16 a[88:91], v[120:123], v[176:179], 0
    v_mfma_f32_16x16x32_bf16 a[92:95], v[124:127], v[176:179], 0
    s_waitcnt vmcnt(4)
    buffer_load_dwordx4 v8, s[16:19], s40 offen offset:0 nt lds
    v_mfma_f32_16x16x32_bf16 v[216:219], v[34:37], v[176:179], 0
    s_add_u32 s40, s40, 1024
    v_mfma_f32_16x16x32_bf16 v[160:163], v[64:67], v[192:195], v[56:59]
    s_add_u32 s99, s99, 1024
    v_exp_f32 v172, v172
    v_mfma_f32_16x16x32_bf16 v[160:163], v[68:71], v[196:199], v[160:163]
    s_and_b32 s100, s99, 0x19fff
    v_exp_f32 v173, v173
    v_mfma_f32_16x16x32_bf16 v[160:163], v[72:75], v[200:203], v[160:163]
    ds_read_b64_tr_b16 v[152:153], v24 offset:0
    v_cvt_pk_bf16_f32 v182, v172, v173
    v_mfma_f32_16x16x32_bf16 v[160:163], v[76:79], v[204:207], v[160:163]
    s_or_b32 m0, s100, s43
    v_exp_f32 v174, v174
    v_mfma_f32_16x16x32_bf16 v[164:167], v[80:83], v[192:195], v[56:59]
    s_or_b32 s99, s99, 0x6000
    v_exp_f32 v175, v175
    v_mfma_f32_16x16x32_bf16 v[164:167], v[84:87], v[196:199], v[164:167]
    ds_read_b64_tr_b16 v[154:155], v24 offset:4096
    v_cvt_pk_bf16_f32 v183, v174, v175
    v_mfma_f32_16x16x32_bf16 v[164:167], v[88:91], v[200:203], v[164:167]
    v_mfma_f32_16x16x32_bf16 v[164:167], v[92:95], v[204:207], v[164:167]
    v_exp_f32 v160, v160
    v_mfma_f32_16x16x32_bf16 a[96:99], v[96:99], v[180:183], 0
    v_exp_f32 v161, v161
    v_mfma_f32_16x16x32_bf16 a[100:103], v[100:103], v[180:183], 0
    ds_read_b64_tr_b16 v[156:157], v25 offset:0
    v_cvt_pk_bf16_f32 v176, v160, v161
    v_mfma_f32_16x16x32_bf16 a[104:107], v[104:107], v[180:183], 0
    v_exp_f32 v162, v162
    v_mfma_f32_16x16x32_bf16 a[108:111], v[108:111], v[180:183], 0
    v_exp_f32 v163, v163
    v_mfma_f32_16x16x32_bf16 a[112:115], v[112:115], v[180:183], 0
    ds_read_b64_tr_b16 v[158:159], v25 offset:4096
    v_cvt_pk_bf16_f32 v177, v162, v163
    v_mfma_f32_16x16x32_bf16 a[116:119], v[116:119], v[180:183], 0
    v_mfma_f32_16x16x32_bf16 a[120:123], v[120:123], v[180:183], 0
    v_mfma_f32_16x16x32_bf16 a[124:127], v[124:127], v[180:183], 0
    s_waitcnt vmcnt(4)
    buffer_load_dwordx4 v9, s[16:19], s40 offen offset:0 nt lds
    v_mfma_f32_16x16x32_bf16 v[220:223], v[34:37], v[180:183], 0
    s_add_u32 s40, s40, 1024
    v_mfma_f32_16x16x32_bf16 v[168:171], v[64:67], v[224:227], v[60:63]
    s_add_u32 s99, s99, 1024
    v_exp_f32 v164, v164
    v_mfma_f32_16x16x32_bf16 v[168:171], v[68:71], v[228:231], v[168:171]
    s_and_b32 s100, s99, 0x19fff
    v_exp_f32 v165, v165
    v_mfma_f32_16x16x32_bf16 v[168:171], v[72:75], v[232:235], v[168:171]
    ds_read_b128 v[64:67], v10 offset:0
    v_cvt_pk_bf16_f32 v178, v164, v165
    v_mfma_f32_16x16x32_bf16 v[168:171], v[76:79], v[236:239], v[168:171]
    s_or_b32 m0, s100, s43
    v_exp_f32 v166, v166
    v_mfma_f32_16x16x32_bf16 v[172:175], v[80:83], v[224:227], v[60:63]
    s_or_b32 s99, s99, 0x6000
    v_exp_f32 v167, v167
    v_mfma_f32_16x16x32_bf16 v[172:175], v[84:87], v[228:231], v[172:175]
    ds_read_b128 v[68:71], v11 offset:0
    v_cvt_pk_bf16_f32 v179, v166, v167
    v_mfma_f32_16x16x32_bf16 v[172:175], v[88:91], v[232:235], v[172:175]
    ds_read_b128 v[72:75], v12 offset:0
    v_mfma_f32_16x16x32_bf16 v[172:175], v[92:95], v[236:239], v[172:175]
    v_exp_f32 v168, v168
    v_mfma_f32_16x16x32_bf16 a[128:131], v[96:99], v[176:179], 0
    v_exp_f32 v169, v169
    v_mfma_f32_16x16x32_bf16 a[132:135], v[100:103], v[176:179], 0
    ds_read_b128 v[76:79], v13 offset:0
    v_cvt_pk_bf16_f32 v180, v168, v169
    v_mfma_f32_16x16x32_bf16 a[136:139], v[104:107], v[176:179], 0
    v_exp_f32 v170, v170
    v_mfma_f32_16x16x32_bf16 a[140:143], v[108:111], v[176:179], 0
    v_exp_f32 v171, v171
    v_mfma_f32_16x16x32_bf16 a[144:147], v[112:115], v[176:179], 0
    ds_read_b128 v[80:83], v10 offset:4096
    v_cvt_pk_bf16_f32 v181, v170, v171
    v_mfma_f32_16x16x32_bf16 a[148:151], v[116:119], v[176:179], 0
    ds_read_b128 v[84:87], v11 offset:4096
    v_mfma_f32_16x16x32_bf16 a[152:155], v[120:123], v[176:179], 0
    ds_read_b128 v[88:91], v12 offset:4096
    v_mfma_f32_16x16x32_bf16 a[156:159], v[124:127], v[176:179], 0
    ds_read_b128 v[92:95], v13 offset:4096
    v_mfma_f32_16x16x32_bf16 v[240:243], v[34:37], v[176:179], 0
    s_waitcnt lgkmcnt(6)
L_aloop:
    v_mfma_f32_16x16x32_bf16 v[160:163], v[64:67], a[192:195], v[40:43]
    v_exp_f32 v172, v172
    v_mfma_f32_16x16x32_bf16 v[160:163], v[68:71], a[196:199], v[160:163]
    s_waitcnt lgkmcnt(4)
    v_exp_f32 v173, v173
    v_mfma_f32_16x16x32_bf16 v[160:163], v[72:75], a[200:203], v[160:163]
    v_cvt_pk_bf16_f32 v182, v172, v173
    v_mfma_f32_16x16x32_bf16 v[160:163], v[76:79], a[204:207], v[160:163]
    s_waitcnt lgkmcnt(2)
    v_exp_f32 v174, v174
    v_mfma_f32_16x16x32_bf16 v[164:167], v[80:83], a[192:195], v[40:43]
    v_exp_f32 v175, v175
    v_mfma_f32_16x16x32_bf16 v[164:167], v[84:87], a[196:199], v[164:167]
    s_waitcnt lgkmcnt(0)
    v_cvt_pk_bf16_f32 v183, v174, v175
    v_mfma_f32_16x16x32_bf16 v[164:167], v[88:91], a[200:203], v[164:167]
    v_mfma_f32_16x16x32_bf16 v[164:167], v[92:95], a[204:207], v[164:167]
    v_exp_f32 v160, v160
    v_mfma_f32_16x16x32_bf16 a[160:163], v[96:99], v[180:183], a[160:163]
    v_exp_f32 v161, v161
    v_mfma_f32_16x16x32_bf16 a[164:167], v[100:103], v[180:183], a[164:167]
    v_cvt_pk_bf16_f32 v176, v160, v161
    v_mfma_f32_16x16x32_bf16 a[168:171], v[104:107], v[180:183], a[168:171]
    v_exp_f32 v162, v162
    v_mfma_f32_16x16x32_bf16 a[172:175], v[108:111], v[180:183], a[172:175]
    v_exp_f32 v163, v163
    v_mfma_f32_16x16x32_bf16 a[176:179], v[112:115], v[180:183], a[176:179]
    v_cvt_pk_bf16_f32 v177, v162, v163
    v_mfma_f32_16x16x32_bf16 a[180:183], v[116:119], v[180:183], a[180:183]
    s_barrier
    v_mfma_f32_16x16x32_bf16 a[184:187], v[120:123], v[180:183], a[184:187]
    v_mfma_f32_16x16x32_bf16 a[188:191], v[124:127], v[180:183], a[188:191]
    s_waitcnt vmcnt(4)
    buffer_load_dwordx4 v8, s[16:19], s40 offen offset:0 nt lds
    v_mfma_f32_16x16x32_bf16 v[244:247], v[34:37], v[180:183], v[244:247]
    s_add_u32 s40, s40, 1024
    v_mfma_f32_16x16x32_bf16 v[168:171], v[64:67], a[208:211], v[44:47]
    s_add_u32 s99, s99, 1024
    v_exp_f32 v164, v164
    v_mfma_f32_16x16x32_bf16 v[168:171], v[68:71], a[212:215], v[168:171]
    s_and_b32 s100, s99, 0x19fff
    v_exp_f32 v165, v165
    v_mfma_f32_16x16x32_bf16 v[168:171], v[72:75], a[216:219], v[168:171]
    ds_read_b64_tr_b16 v[96:97], v18 offset:32768
    v_cvt_pk_bf16_f32 v178, v164, v165
    v_mfma_f32_16x16x32_bf16 v[168:171], v[76:79], a[220:223], v[168:171]
    s_or_b32 m0, s100, s43
    v_exp_f32 v166, v166
    v_mfma_f32_16x16x32_bf16 v[172:175], v[80:83], a[208:211], v[44:47]
    s_or_b32 s99, s99, 0x6000
    v_exp_f32 v167, v167
    v_mfma_f32_16x16x32_bf16 v[172:175], v[84:87], a[212:215], v[172:175]
    ds_read_b64_tr_b16 v[98:99], v18 offset:36864
    v_cvt_pk_bf16_f32 v179, v166, v167
    v_mfma_f32_16x16x32_bf16 v[172:175], v[88:91], a[216:219], v[172:175]
    s_waitcnt vmcnt(4)
    buffer_load_dwordx4 v9, s[16:19], s40 offen offset:0 nt lds
    v_mfma_f32_16x16x32_bf16 v[172:175], v[92:95], a[220:223], v[172:175]
    s_add_u32 s40, s40, 1024
    v_exp_f32 v168, v168
    v_mfma_f32_16x16x32_bf16 a[0:3], v[128:131], v[176:179], a[0:3]
    s_add_u32 s99, s99, 1024
    v_exp_f32 v169, v169
    v_mfma_f32_16x16x32_bf16 a[4:7], v[132:135], v[176:179], a[4:7]
    ds_read_b64_tr_b16 v[100:101], v19 offset:32768
    v_cvt_pk_bf16_f32 v180, v168, v169
    v_mfma_f32_16x16x32_bf16 a[8:11], v[136:139], v[176:179], a[8:11]
    s_and_b32 s100, s99, 0x19fff
    v_exp_f32 v170, v170
    v_mfma_f32_16x16x32_bf16 a[12:15], v[140:143], v[176:179], a[12:15]
    s_or_b32 m0, s100, s43
    v_exp_f32 v171, v171
    v_mfma_f32_16x16x32_bf16 a[16:19], v[144:147], v[176:179], a[16:19]
    ds_read_b64_tr_b16 v[102:103], v19 offset:36864
    v_cvt_pk_bf16_f32 v181, v170, v171
    v_mfma_f32_16x16x32_bf16 a[20:23], v[148:151], v[176:179], a[20:23]
    s_or_b32 s99, s99, 0x6000
    v_mfma_f32_16x16x32_bf16 a[24:27], v[152:155], v[176:179], a[24:27]
    v_mfma_f32_16x16x32_bf16 a[28:31], v[156:159], v[176:179], a[28:31]
    s_waitcnt vmcnt(4)
    buffer_load_dwordx4 v8, s[16:19], s40 offen offset:0 nt lds
    v_mfma_f32_16x16x32_bf16 v[208:211], v[34:37], v[176:179], v[208:211]
    s_add_u32 s40, s40, 1024
    v_mfma_f32_16x16x32_bf16 v[160:163], v[64:67], a[224:227], v[48:51]
    s_add_u32 s99, s99, 1024
    v_exp_f32 v172, v172
    v_mfma_f32_16x16x32_bf16 v[160:163], v[68:71], a[228:231], v[160:163]
    s_and_b32 s100, s99, 0x19fff
    v_exp_f32 v173, v173
    v_mfma_f32_16x16x32_bf16 v[160:163], v[72:75], a[232:235], v[160:163]
    ds_read_b64_tr_b16 v[104:105], v20 offset:32768
    v_cvt_pk_bf16_f32 v182, v172, v173
    v_mfma_f32_16x16x32_bf16 v[160:163], v[76:79], a[236:239], v[160:163]
    s_or_b32 m0, s100, s43
    v_exp_f32 v174, v174
    v_mfma_f32_16x16x32_bf16 v[164:167], v[80:83], a[224:227], v[48:51]
    s_or_b32 s99, s99, 0x6000
    v_exp_f32 v175, v175
    v_mfma_f32_16x16x32_bf16 v[164:167], v[84:87], a[228:231], v[164:167]
    ds_read_b64_tr_b16 v[106:107], v20 offset:36864
    v_cvt_pk_bf16_f32 v183, v174, v175
    v_mfma_f32_16x16x32_bf16 v[164:167], v[88:91], a[232:235], v[164:167]
    s_waitcnt vmcnt(4)
    buffer_load_dwordx4 v9, s[16:19], s40 offen offset:0 nt lds
    v_mfma_f32_16x16x32_bf16 v[164:167], v[92:95], a[236:239], v[164:167]
    s_add_u32 s40, s40, 1024
    v_exp_f32 v160, v160
    v_mfma_f32_16x16x32_bf16 a[32:35], v[128:131], v[180:183], a[32:35]
    s_add_u32 s99, s99, 1024
    v_exp_f32 v161, v161
    v_mfma_f32_16x16x32_bf16 a[36:39], v[132:135], v[180:183], a[36:39]
    ds_read_b64_tr_b16 v[108:109], v21 offset:32768
    v_cvt_pk_bf16_f32 v176, v160, v161
    v_mfma_f32_16x16x32_bf16 a[40:43], v[136:139], v[180:183], a[40:43]
    s_and_b32 s100, s99, 0x19fff
    v_exp_f32 v162, v162
    v_mfma_f32_16x16x32_bf16 a[44:47], v[140:143], v[180:183], a[44:47]
    s_or_b32 m0, s100, s43
    v_exp_f32 v163, v163
    v_mfma_f32_16x16x32_bf16 a[48:51], v[144:147], v[180:183], a[48:51]
    ds_read_b64_tr_b16 v[110:111], v21 offset:36864
    v_cvt_pk_bf16_f32 v177, v162, v163
    v_mfma_f32_16x16x32_bf16 a[52:55], v[148:151], v[180:183], a[52:55]
    s_or_b32 s99, s99, 0x6000
    v_mfma_f32_16x16x32_bf16 a[56:59], v[152:155], v[180:183], a[56:59]
    v_mfma_f32_16x16x32_bf16 a[60:63], v[156:159], v[180:183], a[60:63]
    s_waitcnt vmcnt(4)
    buffer_load_dwordx4 v8, s[16:19], s40 offen offset:0 nt lds
    v_mfma_f32_16x16x32_bf16 v[212:215], v[34:37], v[180:183], v[212:215]
    s_add_u32 s40, s40, 1024
    v_mfma_f32_16x16x32_bf16 v[168:171], v[64:67], a[240:243], v[52:55]
    s_add_u32 s99, s99, 1024
    v_exp_f32 v164, v164
    v_mfma_f32_16x16x32_bf16 v[168:171], v[68:71], a[244:247], v[168:171]
    s_and_b32 s100, s99, 0x19fff
    v_exp_f32 v165, v165
    v_mfma_f32_16x16x32_bf16 v[168:171], v[72:75], a[248:251], v[168:171]
    ds_read_b64_tr_b16 v[112:113], v22 offset:32768
    v_cvt_pk_bf16_f32 v178, v164, v165
    v_mfma_f32_16x16x32_bf16 v[168:171], v[76:79], a[252:255], v[168:171]
    s_or_b32 m0, s100, s43
    v_exp_f32 v166, v166
    v_mfma_f32_16x16x32_bf16 v[172:175], v[80:83], a[240:243], v[52:55]
    s_or_b32 s99, s99, 0x6000
    v_exp_f32 v167, v167
    v_mfma_f32_16x16x32_bf16 v[172:175], v[84:87], a[244:247], v[172:175]
    ds_read_b64_tr_b16 v[114:115], v22 offset:36864
    v_cvt_pk_bf16_f32 v179, v166, v167
    v_mfma_f32_16x16x32_bf16 v[172:175], v[88:91], a[248:251], v[172:175]
    v_mfma_f32_16x16x32_bf16 v[172:175], v[92:95], a[252:255], v[172:175]
    v_exp_f32 v168, v168
    v_mfma_f32_16x16x32_bf16 a[64:67], v[128:131], v[176:179], a[64:67]
    v_exp_f32 v169, v169
    v_mfma_f32_16x16x32_bf16 a[68:71], v[132:135], v[176:179], a[68:71]
    ds_read_b64_tr_b16 v[116:117], v23 offset:32768
    v_cvt_pk_bf16_f32 v180, v168, v169
    v_mfma_f32_16x16x32_bf16 a[72:75], v[136:139], v[176:179], a[72:75]
    v_exp_f32 v170, v170
    v_mfma_f32_16x16x32_bf16 a[76:79], v[140:143], v[176:179], a[76:79]
    v_exp_f32 v171, v171
    v_mfma_f32_16x16x32_bf16 a[80:83], v[144:147], v[176:179], a[80:83]
    ds_read_b64_tr_b16 v[118:119], v23 offset:36864
    v_cvt_pk_bf16_f32 v181, v170, v171
    v_mfma_f32_16x16x32_bf16 a[84:87], v[148:151], v[176:179], a[84:87]
    v_mfma_f32_16x16x32_bf16 a[88:91], v[152:155], v[176:179], a[88:91]
    v_mfma_f32_16x16x32_bf16 a[92:95], v[156:159], v[176:179], a[92:95]
    s_waitcnt vmcnt(4)
    buffer_load_dwordx4 v9, s[16:19], s40 offen offset:0 nt lds
    v_mfma_f32_16x16x32_bf16 v[216:219], v[34:37], v[176:179], v[216:219]
    s_add_u32 s40, s40, 1024
    v_mfma_f32_16x16x32_bf16 v[160:163], v[64:67], v[192:195], v[56:59]
    s_add_u32 s99, s99, 1024
    v_exp_f32 v172, v172
    v_mfma_f32_16x16x32_bf16 v[160:163], v[68:71], v[196:199], v[160:163]
    s_and_b32 s100, s99, 0x19fff
    v_exp_f32 v173, v173
    v_mfma_f32_16x16x32_bf16 v[160:163], v[72:75], v[200:203], v[160:163]
    ds_read_b64_tr_b16 v[120:121], v24 offset:32768
    v_cvt_pk_bf16_f32 v182, v172, v173
    v_mfma_f32_16x16x32_bf16 v[160:163], v[76:79], v[204:207], v[160:163]
    s_or_b32 m0, s100, s43
    v_exp_f32 v174, v174
    v_mfma_f32_16x16x32_bf16 v[164:167], v[80:83], v[192:195], v[56:59]
    s_or_b32 s99, s99, 0x6000
    v_exp_f32 v175, v175
    v_mfma_f32_16x16x32_bf16 v[164:167], v[84:87], v[196:199], v[164:167]
    ds_read_b64_tr_b16 v[122:123], v24 offset:36864
    v_cvt_pk_bf16_f32 v183, v174, v175
    v_mfma_f32_16x16x32_bf16 v[164:167], v[88:91], v[200:203], v[164:167]
    s_waitcnt vmcnt(4)
    buffer_load_dwordx4 v8, s[16:19], s40 offen offset:0 nt lds
    v_mfma_f32_16x16x32_bf16 v[164:167], v[92:95], v[204:207], v[164:167]
    s_add_u32 s40, s40, 1024
    v_exp_f32 v160, v160
    v_mfma_f32_16x16x32_bf16 a[96:99], v[128:131], v[180:183], a[96:99]
    s_add_u32 s99, s99, 1024
    v_exp_f32 v161, v161
    v_mfma_f32_16x16x32_bf16 a[100:103], v[132:135], v[180:183], a[100:103]
    ds_read_b64_tr_b16 v[124:125], v25 offset:32768
    v_cvt_pk_bf16_f32 v176, v160, v161
    v_mfma_f32_16x16x32_bf16 a[104:107], v[136:139], v[180:183], a[104:107]
    s_and_b32 s100, s99, 0x19fff
    v_exp_f32 v162, v162
    v_mfma_f32_16x16x32_bf16 a[108:111], v[140:143], v[180:183], a[108:111]
    s_or_b32 m0, s100, s43
    v_exp_f32 v163, v163
    v_mfma_f32_16x16x32_bf16 a[112:115], v[144:147], v[180:183], a[112:115]
    ds_read_b64_tr_b16 v[126:127], v25 offset:36864
    v_cvt_pk_bf16_f32 v177, v162, v163
    v_mfma_f32_16x16x32_bf16 a[116:119], v[148:151], v[180:183], a[116:119]
    s_or_b32 s99, s99, 0x6000
    v_mfma_f32_16x16x32_bf16 a[120:123], v[152:155], v[180:183], a[120:123]
    v_mfma_f32_16x16x32_bf16 a[124:127], v[156:159], v[180:183], a[124:127]
    s_waitcnt vmcnt(4)
    buffer_load_dwordx4 v9, s[16:19], s40 offen offset:0 nt lds
    v_mfma_f32_16x16x32_bf16 v[220:223], v[34:37], v[180:183], v[220:223]
    s_add_u32 s40, s40, 1024
    v_mfma_f32_16x16x32_bf16 v[168:171], v[64:67], v[224:227], v[60:63]
    s_add_u32 s99, s99, 1024
    v_exp_f32 v164, v164
    v_mfma_f32_16x16x32_bf16 v[168:171], v[68:71], v[228:231], v[168:171]
    s_and_b32 s100, s99, 0x19fff
    v_exp_f32 v165, v165
    v_mfma_f32_16x16x32_bf16 v[168:171], v[72:75], v[232:235], v[168:171]
    ds_read_b128 v[64:67], v10 offset:32768
    v_cvt_pk_bf16_f32 v178, v164, v165
    v_mfma_f32_16x16x32_bf16 v[168:171], v[76:79], v[236:239], v[168:171]
    s_or_b32 m0, s100, s43
    v_exp_f32 v166, v166
    v_mfma_f32_16x16x32_bf16 v[172:175], v[80:83], v[224:227], v[60:63]
    s_or_b32 s99, s99, 0x6000
    v_exp_f32 v167, v167
    v_mfma_f32_16x16x32_bf16 v[172:175], v[84:87], v[228:231], v[172:175]
    ds_read_b128 v[68:71], v11 offset:32768
    v_cvt_pk_bf16_f32 v179, v166, v167
    v_mfma_f32_16x16x32_bf16 v[172:175], v[88:91], v[232:235], v[172:175]
    ds_read_b128 v[72:75], v12 offset:32768
    v_mfma_f32_16x16x32_bf16 v[172:175], v[92:95], v[236:239], v[172:175]
    v_exp_f32 v168, v168
    v_mfma_f32_16x16x32_bf16 a[128:131], v[128:131], v[176:179], a[128:131]
    v_exp_f32 v169, v169
    v_mfma_f32_16x16x32_bf16 a[132:135], v[132:135], v[176:179], a[132:135]
    ds_read_b128 v[76:79], v13 offset:32768
    v_cvt_pk_bf16_f32 v180, v168, v169
    v_mfma_f32_16x16x32_bf16 a[136:139], v[136:139], v[176:179], a[136:139]
    v_exp_f32 v170, v170
    v_mfma_f32_16x16x32_bf16 a[140:143], v[140:143], v[176:179], a[140:143]
    v_exp_f32 v171, v171
    v_mfma_f32_16x16x32_bf16 a[144:147], v[144:147], v[176:179], a[144:147]
    ds_read_b128 v[80:83], v10 offset:36864
    v_cvt_pk_bf16_f32 v181, v170, v171
    v_mfma_f32_16x16x32_bf16 a[148:151], v[148:151], v[176:179], a[148:151]
    ds_read_b128 v[84:87], v11 offset:36864
    v_mfma_f32_16x16x32_bf16 a[152:155], v[152:155], v[176:179], a[152:155]
    ds_read_b128 v[88:91], v12 offset:36864
    v_mfma_f32_16x16x32_bf16 a[156:159], v[156:159], v[176:179], a[156:159]
    ds_read_b128 v[92:95], v13 offset:36864
    v_mfma_f32_16x16x32_bf16 v[240:243], v[34:37], v[176:179], v[240:243]
    s_waitcnt lgkmcnt(6)
    v_mfma_f32_16x16x32_bf16 v[160:163], v[64:67], a[192:195], v[40:43]
    v_exp_f32 v172, v172
    v_mfma_f32_16x16x32_bf16 v[160:163], v[68:71], a[196:199], v[160:163]
    s_waitcnt lgkmcnt(4)
    v_exp_f32 v173, v173
    v_mfma_f32_16x16x32_bf16 v[160:163], v[72:75], a[200:203], v[160:163]
    v_cvt_pk_bf16_f32 v182, v172, v173
    v_mfma_f32_16x16x32_bf16 v[160:163], v[76:79], a[204:207], v[160:163]
    s_waitcnt lgkmcnt(2)
    v_exp_f32 v174, v174
    v_mfma_f32_16x16x32_bf16 v[164:167], v[80:83], a[192:195], v[40:43]
    v_exp_f32 v175, v175
    v_mfma_f32_16x16x32_bf16 v[164:167], v[84:87], a[196:199], v[164:167]
    s_waitcnt lgkmcnt(0)
    v_cvt_pk_bf16_f32 v183, v174, v175
    v_mfma_f32_16x16x32_bf16 v[164:167], v[88:91], a[200:203], v[164:167]
    v_mfma_f32_16x16x32_bf16 v[164:167], v[92:95], a[204:207], v[164:167]
    v_exp_f32 v160, v160
    v_mfma_f32_16x16x32_bf16 a[160:163], v[128:131], v[180:183], a[160:163]
    v_exp_f32 v161, v161
    v_mfma_f32_16x16x32_bf16 a[164:167], v[132:135], v[180:183], a[164:167]
    v_cvt_pk_bf16_f32 v176, v160, v161
    v_mfma_f32_16x16x32_bf16 a[168:171], v[136:139], v[180:183], a[168:171]
    v_exp_f32 v162, v162
    v_mfma_f32_16x16x32_bf16 a[172:175], v[140:143], v[180:183], a[172:175]
    v_exp_f32 v163, v163
    v_mfma_f32_16x16x32_bf16 a[176:179], v[144:147], v[180:183], a[176:179]
    v_cvt_pk_bf16_f32 v177, v162, v163
    v_mfma_f32_16x16x32_bf16 a[180:183], v[148:151], v[180:183], a[180:183]
    s_barrier
    v_mfma_f32_16x16x32_bf16 a[184:187], v[152:155], v[180:183], a[184:187]
    v_mfma_f32_16x16x32_bf16 a[188:191], v[156:159], v[180:183], a[188:191]
    s_waitcnt vmcnt(4)
    buffer_load_dwordx4 v8, s[16:19], s40 offen offset:0 nt lds
    v_mfma_f32_16x16x32_bf16 v[244:247], v[34:37], v[180:183], v[244:247]
    s_add_u32 s40, s40, 1024
    v_mfma_f32_16x16x32_bf16 v[168:171], v[64:67], a[208:211], v[44:47]
    s_add_u32 s99, s99, 1024
    v_exp_f32 v164, v164
    v_mfma_f32_16x16x32_bf16 v[168:171], v[68:71], a[212:215], v[168:171]
    s_and_b32 s100, s99, 0x19fff
    v_exp_f32 v165, v165
    v_mfma_f32_16x16x32_bf16 v[168:171], v[72:75], a[216:219], v[168:171]
    ds_read_b64_tr_b16 v[128:129], v26 offset:0
    v_cvt_pk_bf16_f32 v178, v164, v165
    v_mfma_f32_16x16x32_bf16 v[168:171], v[76:79], a[220:223], v[168:171]
    s_or_b32 m0, s100, s43
    v_exp_f32 v166, v166
    v_mfma_f32_16x16x32_bf16 v[172:175], v[80:83], a[208:211], v[44:47]
    s_or_b32 s99, s99, 0x6000
    v_exp_f32 v167, v167
    v_mfma_f32_16x16x32_bf16 v[172:175], v[84:87], a[212:215], v[172:175]
    ds_read_b64_tr_b16 v[130:131], v26 offset:4096
    v_cvt_pk_bf16_f32 v179, v166, v167
    v_mfma_f32_16x16x32_bf16 v[172:175], v[88:91], a[216:219], v[172:175]
    v_mfma_f32_16x16x32_bf16 v[172:175], v[92:95], a[220:223], v[172:175]
    v_exp_f32 v168, v168
    v_mfma_f32_16x16x32_bf16 a[0:3], v[96:99], v[176:179], a[0:3]
    v_exp_f32 v169, v169
    v_mfma_f32_16x16x32_bf16 a[4:7], v[100:103], v[176:179], a[4:7]
    ds_read_b64_tr_b16 v[132:133], v27 offset:0
    v_cvt_pk_bf16_f32 v180, v168, v169
    v_mfma_f32_16x16x32_bf16 a[8:11], v[104:107], v[176:179], a[8:11]
    v_exp_f32 v170, v170
    v_mfma_f32_16x16x32_bf16 a[12:15], v[108:111], v[176:179], a[12:15]
    v_exp_f32 v171, v171
    v_mfma_f32_16x16x32_bf16 a[16:19], v[112:115], v[176:179], a[16:19]
    ds_read_b64_tr_b16 v[134:135], v27 offset:4096
    v_cvt_pk_bf16_f32 v181, v170, v171
    v_mfma_f32_16x16x32_bf16 a[20:23], v[116:119], v[176:179], a[20:23]
    v_mfma_f32_16x16x32_bf16 a[24:27], v[120:123], v[176:179], a[24:27]
    v_mfma_f32_16x16x32_bf16 a[28:31], v[124:127], v[176:179], a[28:31]
    s_waitcnt vmcnt(4)
    buffer_load_dwordx4 v9, s[16:19], s40 offen offset:0 nt lds
    v_mfma_f32_16x16x32_bf16 v[208:211], v[34:37], v[176:179], v[208:211]
    s_add_u32 s40, s40, 1024
    v_mfma_f32_16x16x32_bf16 v[160:163], v[64:67], a[224:227], v[48:51]
    s_add_u32 s99, s99, 1024
    v_exp_f32 v172, v172
    v_mfma_f32_16x16x32_bf16 v[160:163], v[68:71], a[228:231], v[160:163]
    s_and_b32 s100, s99, 0x19fff
    v_exp_f32 v173, v173
    v_mfma_f32_16x16x32_bf16 v[160:163], v[72:75], a[232:235], v[160:163]
    ds_read_b64_tr_b16 v[136:137], v28 offset:0
    v_cvt_pk_bf16_f32 v182, v172, v173
    v_mfma_f32_16x16x32_bf16 v[160:163], v[76:79], a[236:239], v[160:163]
    s_or_b32 m0, s100, s43
    v_exp_f32 v174, v174
    v_mfma_f32_16x16x32_bf16 v[164:167], v[80:83], a[224:227], v[48:51]
    s_or_b32 s99, s99, 0x6000
    v_exp_f32 v175, v175
    v_mfma_f32_16x16x32_bf16 v[164:167], v[84:87], a[228:231], v[164:167]
    ds_read_b64_tr_b16 v[138:139], v28 offset:4096
    v_cvt_pk_bf16_f32 v183, v174, v175
    v_mfma_f32_16x16x32_bf16 v[164:167], v[88:91], a[232:235], v[164:167]
    s_waitcnt vmcnt(4)
    buffer_load_dwordx4 v8, s[16:19], s40 offen offset:0 nt lds
    v_mfma_f32_16x16x32_bf16 v[164:167], v[92:95], a[236:239], v[164:167]
    s_add_u32 s40, s40, 1024
    v_exp_f32 v160, v160
    v_mfma_f32_16x16x32_bf16 a[32:35], v[96:99], v[180:183], a[32:35]
    s_add_u32 s99, s99, 1024
    v_exp_f32 v161, v161
    v_mfma_f32_16x16x32_bf16 a[36:39], v[100:103], v[180:183], a[36:39]
    ds_read_b64_tr_b16 v[140:141], v29 offset:0
    v_cvt_pk_bf16_f32 v176, v160, v161
    v_mfma_f32_16x16x32_bf16 a[40:43], v[104:107], v[180:183], a[40:43]
    s_and_b32 s100, s99, 0x19fff
    v_exp_f32 v162, v162
    v_mfma_f32_16x16x32_bf16 a[44:47], v[108:111], v[180:183], a[44:47]
    s_or_b32 m0, s100, s43
    v_exp_f32 v163, v163
    v_mfma_f32_16x16x32_bf16 a[48:51], v[112:115], v[180:183], a[48:51]
    ds_read_b64_tr_b16 v[142:143], v29 offset:4096
    v_cvt_pk_bf16_f32 v177, v162, v163
    v_mfma_f32_16x16x32_bf16 a[52:55], v[116:119], v[180:183], a[52:55]
    s_or_b32 s99, s99, 0x6000
    v_mfma_f32_16x16x32_bf16 a[56:59], v[120:123], v[180:183], a[56:59]
    v_mfma_f32_16x16x32_bf16 a[60:63], v[124:127], v[180:183], a[60:63]
    s_waitcnt vmcnt(4)
    buffer_load_dwordx4 v9, s[16:19], s40 offen offset:0 nt lds
    v_mfma_f32_16x16x32_bf16 v[212:215], v[34:37], v[180:183], v[212:215]
    s_add_u32 s40, s40, 1024
    v_mfma_f32_16x16x32_bf16 v[168:171], v[64:67], a[240:243], v[52:55]
    s_add_u32 s99, s99, 1024
    v_exp_f32 v164, v164
    v_mfma_f32_16x16x32_bf16 v[168:171], v[68:71], a[244:247], v[168:171]
    s_and_b32 s100, s99, 0x19fff
    v_exp_f32 v165, v165
    v_mfma_f32_16x16x32_bf16 v[168:171], v[72:75], a[248:251], v[168:171]
    ds_read_b64_tr_b16 v[144:145], v30 offset:0
    v_cvt_pk_bf16_f32 v178, v164, v165
    v_mfma_f32_16x16x32_bf16 v[168:171], v[76:79], a[252:255], v[168:171]
    s_or_b32 m0, s100, s43
    v_exp_f32 v166, v166
    v_mfma_f32_16x16x32_bf16 v[172:175], v[80:83], a[240:243], v[52:55]
    s_or_b32 s99, s99, 0x6000
    v_exp_f32 v167, v167
    v_mfma_f32_16x16x32_bf16 v[172:175], v[84:87], a[244:247], v[172:175]
    ds_read_b64_tr_b16 v[146:147], v30 offset:4096
    v_cvt_pk_bf16_f32 v179, v166, v167
    v_mfma_f32_16x16x32_bf16 v[172:175], v[88:91], a[248:251], v[172:175]
    v_mfma_f32_16x16x32_bf16 v[172:175], v[92:95], a[252:255], v[172:175]
    v_exp_f32 v168, v168
    v_mfma_f32_16x16x32_bf16 a[64:67], v[96:99], v[176:179], a[64:67]
    v_exp_f32 v169, v169
    v_mfma_f32_16x16x32_bf16 a[68:71], v[100:103], v[176:179], a[68:71]
    ds_read_b64_tr_b16 v[148:149], v31 offset:0
    v_cvt_pk_bf16_f32 v180, v168, v169
    v_mfma_f32_16x16x32_bf16 a[72:75], v[104:107], v[176:179], a[72:75]
    v_exp_f32 v170, v170
    v_mfma_f32_16x16x32_bf16 a[76:79], v[108:111], v[176:179], a[76:79]
    v_exp_f32 v171, v171
    v_mfma_f32_16x16x32_bf16 a[80:83], v[112:115], v[176:179], a[80:83]
    ds_read_b64_tr_b16 v[150:151], v31 offset:4096
    v_cvt_pk_bf16_f32 v181, v170, v171
    v_mfma_f32_16x16x32_bf16 a[84:87], v[116:119], v[176:179], a[84:87]
    v_mfma_f32_16x16x32_bf16 a[88:91], v[120:123], v[176:179], a[88:91]
    v_mfma_f32_16x16x32_bf16 a[92:95], v[124:127], v[176:179], a[92:95]
    s_waitcnt vmcnt(4)
    buffer_load_dwordx4 v8, s[16:19], s40 offen offset:0 nt lds
    v_mfma_f32_16x16x32_bf16 v[216:219], v[34:37], v[176:179], v[216:219]
    s_add_u32 s40, s40, 1024
    v_mfma_f32_16x16x32_bf16 v[160:163], v[64:67], v[192:195], v[56:59]
    s_add_u32 s99, s99, 1024
    v_exp_f32 v172, v172
    v_mfma_f32_16x16x32_bf16 v[160:163], v[68:71], v[196:199], v[160:163]
    s_and_b32 s100, s99, 0x19fff
    v_exp_f32 v173, v173
    v_mfma_f32_16x16x32_bf16 v[160:163], v[72:75], v[200:203], v[160:163]
    ds_read_b64_tr_b16 v[152:153], v32 offset:0
    v_cvt_pk_bf16_f32 v182, v172, v173
    v_mfma_f32_16x16x32_bf16 v[160:163], v[76:79], v[204:207], v[160:163]
    s_or_b32 m0, s100, s43
    v_exp_f32 v174, v174
    v_mfma_f32_16x16x32_bf16 v[164:167], v[80:83], v[192:195], v[56:59]
    s_or_b32 s99, s99, 0x6000
    v_exp_f32 v175, v175
    v_mfma_f32_16x16x32_bf16 v[164:167], v[84:87], v[196:199], v[164:167]
    ds_read_b64_tr_b16 v[154:155], v32 offset:4096
    v_cvt_pk_bf16_f32 v183, v174, v175
    v_mfma_f32_16x16x32_bf16 v[164:167], v[88:91], v[200:203], v[164:167]
    s_waitcnt vmcnt(4)
    buffer_load_dwordx4 v9, s[16:19], s40 offen offset:0 nt lds
    v_mfma_f32_16x16x32_bf16 v[164:167], v[92:95], v[204:207], v[164:167]
    s_add_u32 s40, s40, 1024
    v_exp_f32 v160, v160
    v_mfma_f32_16x16x32_bf16 a[96:99], v[96:99], v[180:183], a[96:99]
    s_add_u32 s99, s99, 1024
    v_exp_f32 v161, v161
    v_mfma_f32_16x16x32_bf16 a[100:103], v[100:103], v[180:183], a[100:103]
    ds_read_b64_tr_b16 v[156:157], v33 offset:0
    v_cvt_pk_bf16_f32 v176, v160, v161
    v_mfma_f32_16x16x32_bf16 a[104:107], v[104:107], v[180:183], a[104:107]
    s_and_b32 s100, s99, 0x19fff
    v_exp_f32 v162, v162
    v_mfma_f32_16x16x32_bf16 a[108:111], v[108:111], v[180:183], a[108:111]
    s_or_b32 m0, s100, s43
    v_exp_f32 v163, v163
    v_mfma_f32_16x16x32_bf16 a[112:115], v[112:115], v[180:183], a[112:115]
    ds_read_b64_tr_b16 v[158:159], v33 offset:4096
    v_cvt_pk_bf16_f32 v177, v162, v163
    v_mfma_f32_16x16x32_bf16 a[116:119], v[116:119], v[180:183], a[116:119]
    s_or_b32 s99, s99, 0x6000
    v_mfma_f32_16x16x32_bf16 a[120:123], v[120:123], v[180:183], a[120:123]
    v_mfma_f32_16x16x32_bf16 a[124:127], v[124:127], v[180:183], a[124:127]
    s_waitcnt vmcnt(4)
    buffer_load_dwordx4 v8, s[16:19], s40 offen offset:0 nt lds
    v_mfma_f32_16x16x32_bf16 v[220:223], v[34:37], v[180:183], v[220:223]
    s_add_u32 s40, s40, 1024
    v_mfma_f32_16x16x32_bf16 v[168:171], v[64:67], v[224:227], v[60:63]
    s_add_u32 s99, s99, 1024
    v_exp_f32 v164, v164
    v_mfma_f32_16x16x32_bf16 v[168:171], v[68:71], v[228:231], v[168:171]
    s_and_b32 s100, s99, 0x19fff
    v_exp_f32 v165, v165
    v_mfma_f32_16x16x32_bf16 v[168:171], v[72:75], v[232:235], v[168:171]
    ds_read_b128 v[64:67], v14 offset:0
    v_cvt_pk_bf16_f32 v178, v164, v165
    v_mfma_f32_16x16x32_bf16 v[168:171], v[76:79], v[236:239], v[168:171]
    s_or_b32 m0, s100, s43
    v_exp_f32 v166, v166
    v_mfma_f32_16x16x32_bf16 v[172:175], v[80:83], v[224:227], v[60:63]
    s_or_b32 s99, s99, 0x6000
    v_exp_f32 v167, v167
    v_mfma_f32_16x16x32_bf16 v[172:175], v[84:87], v[228:231], v[172:175]
    ds_read_b128 v[68:71], v15 offset:0
    v_cvt_pk_bf16_f32 v179, v166, v167
    v_mfma_f32_16x16x32_bf16 v[172:175], v[88:91], v[232:235], v[172:175]
    ds_read_b128 v[72:75], v16 offset:0
    v_mfma_f32_16x16x32_bf16 v[172:175], v[92:95], v[236:239], v[172:175]
    v_exp_f32 v168, v168
    v_mfma_f32_16x16x32_bf16 a[128:131], v[96:99], v[176:179], a[128:131]
    v_exp_f32 v169, v169
    v_mfma_f32_16x16x32_bf16 a[132:135], v[100:103], v[176:179], a[132:135]
    ds_read_b128 v[76:79], v17 offset:0
    v_cvt_pk_bf16_f32 v180, v168, v169
    v_mfma_f32_16x16x32_bf16 a[136:139], v[104:107], v[176:179], a[136:139]
    v_exp_f32 v170, v170
    v_mfma_f32_16x16x32_bf16 a[140:143], v[108:111], v[176:179], a[140:143]
    v_exp_f32 v171, v171
    v_mfma_f32_16x16x32_bf16 a[144:147], v[112:115], v[176:179], a[144:147]
    ds_read_b128 v[80:83], v14 offset:4096
    v_cvt_pk_bf16_f32 v181, v170, v171
    v_mfma_f32_16x16x32_bf16 a[148:151], v[116:119], v[176:179], a[148:151]
    ds_read_b128 v[84:87], v15 offset:4096
    v_mfma_f32_16x16x32_bf16 a[152:155], v[120:123], v[176:179], a[152:155]
    ds_read_b128 v[88:91], v16 offset:4096
    v_mfma_f32_16x16x32_bf16 a[156:159], v[124:127], v[176:179], a[156:159]
    ds_read_b128 v[92:95], v17 offset:4096
    v_mfma_f32_16x16x32_bf16 v[240:243], v[34:37], v[176:179], v[240:243]
    s_waitcnt lgkmcnt(6)
    v_mfma_f32_16x16x32_bf16 v[160:163], v[64:67], a[192:195], v[40:43]
    v_exp_f32 v172, v172
    v_mfma_f32_16x16x32_bf16 v[160:163], v[68:71], a[196:199], v[160:163]
    s_waitcnt lgkmcnt(4)
    v_exp_f32 v173, v173
    v_mfma_f32_16x16x32_bf16 v[160:163], v[72:75], a[200:203], v[160:163]
    v_cvt_pk_bf16_f32 v182, v172, v173
    v_mfma_f32_16x16x32_bf16 v[160:163], v[76:79], a[204:207], v[160:163]
    s_waitcnt lgkmcnt(2)
    v_exp_f32 v174, v174
    v_mfma_f32_16x16x32_bf16 v[164:167], v[80:83], a[192:195], v[40:43]
    v_exp_f32 v175, v175
    v_mfma_f32_16x16x32_bf16 v[164:167], v[84:87], a[196:199], v[164:167]
    s_waitcnt lgkmcnt(0)
    v_cvt_pk_bf16_f32 v183, v174, v175
    v_mfma_f32_16x16x32_bf16 v[164:167], v[88:91], a[200:203], v[164:167]
    v_mfma_f32_16x16x32_bf16 v[164:167], v[92:95], a[204:207], v[164:167]
    v_exp_f32 v160, v160
    v_mfma_f32_16x16x32_bf16 a[160:163], v[96:99], v[180:183], a[160:163]
    v_exp_f32 v161, v161
    v_mfma_f32_16x16x32_bf16 a[164:167], v[100:103], v[180:183], a[164:167]
    v_cvt_pk_bf16_f32 v176, v160, v161
    v_mfma_f32_16x16x32_bf16 a[168:171], v[104:107], v[180:183], a[168:171]
    v_exp_f32 v162, v162
    v_mfma_f32_16x16x32_bf16 a[172:175], v[108:111], v[180:183], a[172:175]
    v_exp_f32 v163, v163
    v_mfma_f32_16x16x32_bf16 a[176:179], v[112:115], v[180:183], a[176:179]
    v_cvt_pk_bf16_f32 v177, v162, v163
    v_mfma_f32_16x16x32_bf16 a[180:183], v[116:119], v[180:183], a[180:183]
    s_barrier
    v_mfma_f32_16x16x32_bf16 a[184:187], v[120:123], v[180:183], a[184:187]
    v_mfma_f32_16x16x32_bf16 a[188:191], v[124:127], v[180:183], a[188:191]
    s_waitcnt vmcnt(4)
    buffer_load_dwordx4 v9, s[16:19], s40 offen offset:0 nt lds
    v_mfma_f32_16x16x32_bf16 v[244:247], v[34:37], v[180:183], v[244:247]
    s_add_u32 s40, s40, 1024
    v_mfma_f32_16x16x32_bf16 v[168:171], v[64:67], a[208:211], v[44:47]
    s_add_u32 s99, s99, 1024
    v_exp_f32 v164, v164
    v_mfma_f32_16x16x32_bf16 v[168:171], v[68:71], a[212:215], v[168:171]
    s_and_b32 s100, s99, 0x19fff
    v_exp_f32 v165, v165
    v_mfma_f32_16x16x32_bf16 v[168:171], v[72:75], a[216:219], v[168:171]
    ds_read_b64_tr_b16 v[96:97], v26 offset:32768
    v_cvt_pk_bf16_f32 v178, v164, v165
    v_mfma_f32_16x16x32_bf16 v[168:171], v[76:79], a[220:223], v[168:171]
    s_or_b32 m0, s100, s43
    v_exp_f32 v166, v166
    v_mfma_f32_16x16x32_bf16 v[172:175], v[80:83], a[208:211], v[44:47]
    s_or_b32 s99, s99, 0x6000
    v_exp_f32 v167, v167
    v_mfma_f32_16x16x32_bf16 v[172:175], v[84:87], a[212:215], v[172:175]
    ds_read_b64_tr_b16 v[98:99], v26 offset:36864
    v_cvt_pk_bf16_f32 v179, v166, v167
    v_mfma_f32_16x16x32_bf16 v[172:175], v[88:91], a[216:219], v[172:175]
    s_waitcnt vmcnt(4)
    buffer_load_dwordx4 v8, s[16:19], s40 offen offset:0 nt lds
    v_mfma_f32_16x16x32_bf16 v[172:175], v[92:95], a[220:223], v[172:175]
    s_add_u32 s40, s40, 1024
    v_exp_f32 v168, v168
    v_mfma_f32_16x16x32_bf16 a[0:3], v[128:131], v[176:179], a[0:3]
    s_add_u32 s99, s99, 1024
    v_exp_f32 v169, v169
    v_mfma_f32_16x16x32_bf16 a[4:7], v[132:135], v[176:179], a[4:7]
    ds_read_b64_tr_b16 v[100:101], v27 offset:32768
    v_cvt_pk_bf16_f32 v180, v168, v169
    v_mfma_f32_16x16x32_bf16 a[8:11], v[136:139], v[176:179], a[8:11]
    s_and_b32 s100, s99, 0x19fff
    v_exp_f32 v170, v170
    v_mfma_f32_16x16x32_bf16 a[12:15], v[140:143], v[176:179], a[12:15]
    s_or_b32 m0, s100, s43
    v_exp_f32 v171, v171
    v_mfma_f32_16x16x32_bf16 a[16:19], v[144:147], v[176:179], a[16:19]
    ds_read_b64_tr_b16 v[102:103], v27 offset:36864
    v_cvt_pk_bf16_f32 v181, v170, v171
    v_mfma_f32_16x16x32_bf16 a[20:23], v[148:151], v[176:179], a[20:23]
    s_or_b32 s99, s99, 0x6000
    v_mfma_f32_16x16x32_bf16 a[24:27], v[152:155], v[176:179], a[24:27]
    v_mfma_f32_16x16x32_bf16 a[28:31], v[156:159], v[176:179], a[28:31]
    s_waitcnt vmcnt(4)
    buffer_load_dwordx4 v9, s[16:19], s40 offen offset:0 nt lds
    v_mfma_f32_16x16x32_bf16 v[208:211], v[34:37], v[176:179], v[208:211]
    s_add_u32 s40, s40, 1024
    v_mfma_f32_16x16x32_bf16 v[160:163], v[64:67], a[224:227], v[48:51]
    s_add_u32 s99, s99, 1024
    v_exp_f32 v172, v172
    v_mfma_f32_16x16x32_bf16 v[160:163], v[68:71], a[228:231], v[160:163]
    s_and_b32 s100, s99, 0x19fff
    v_exp_f32 v173, v173
    v_mfma_f32_16x16x32_bf16 v[160:163], v[72:75], a[232:235], v[160:163]
    ds_read_b64_tr_b16 v[104:105], v28 offset:32768
    v_cvt_pk_bf16_f32 v182, v172, v173
    v_mfma_f32_16x16x32_bf16 v[160:163], v[76:79], a[236:239], v[160:163]
    s_or_b32 m0, s100, s43
    v_exp_f32 v174, v174
    v_mfma_f32_16x16x32_bf16 v[164:167], v[80:83], a[224:227], v[48:51]
    s_or_b32 s99, s99, 0x6000
    v_exp_f32 v175, v175
    v_mfma_f32_16x16x32_bf16 v[164:167], v[84:87], a[228:231], v[164:167]
    ds_read_b64_tr_b16 v[106:107], v28 offset:36864
    v_cvt_pk_bf16_f32 v183, v174, v175
    v_mfma_f32_16x16x32_bf16 v[164:167], v[88:91], a[232:235], v[164:167]
    s_waitcnt vmcnt(4)
    buffer_load_dwordx4 v8, s[16:19], s40 offen offset:0 nt lds
    v_mfma_f32_16x16x32_bf16 v[164:167], v[92:95], a[236:239], v[164:167]
    s_add_u32 s40, s40, 1024
    v_exp_f32 v160, v160
    v_mfma_f32_16x16x32_bf16 a[32:35], v[128:131], v[180:183], a[32:35]
    s_add_u32 s99, s99, 1024
    v_exp_f32 v161, v161
    v_mfma_f32_16x16x32_bf16 a[36:39], v[132:135], v[180:183], a[36:39]
    ds_read_b64_tr_b16 v[108:109], v29 offset:32768
    v_cvt_pk_bf16_f32 v176, v160, v161
    v_mfma_f32_16x16x32_bf16 a[40:43], v[136:139], v[180:183], a[40:43]
    s_and_b32 s100, s99, 0x19fff
    v_exp_f32 v162, v162
    v_mfma_f32_16x16x32_bf16 a[44:47], v[140:143], v[180:183], a[44:47]
    s_or_b32 m0, s100, s43
    v_exp_f32 v163, v163
    v_mfma_f32_16x16x32_bf16 a[48:51], v[144:147], v[180:183], a[48:51]
    ds_read_b64_tr_b16 v[110:111], v29 offset:36864
    v_cvt_pk_bf16_f32 v177, v162, v163
    v_mfma_f32_16x16x32_bf16 a[52:55], v[148:151], v[180:183], a[52:55]
    s_or_b32 s99, s99, 0x6000
    v_mfma_f32_16x16x32_bf16 a[56:59], v[152:155], v[180:183], a[56:59]
    v_mfma_f32_16x16x32_bf16 a[60:63], v[156:159], v[180:183], a[60:63]
    s_waitcnt vmcnt(4)
    buffer_load_dwordx4 v9, s[16:19], s40 offen offset:0 nt lds
    v_mfma_f32_16x16x32_bf16 v[212:215], v[34:37], v[180:183], v[212:215]
    s_add_u32 s40, s40, 1024
    v_mfma_f32_16x16x32_bf16 v[168:171], v[64:67], a[240:243], v[52:55]
    s_add_u32 s99, s99, 1024
    v_exp_f32 v164, v164
    v_mfma_f32_16x16x32_bf16 v[168:171], v[68:71], a[244:247], v[168:171]
    s_and_b32 s100, s99, 0x19fff
    v_exp_f32 v165, v165
    v_mfma_f32_16x16x32_bf16 v[168:171], v[72:75], a[248:251], v[168:171]
    ds_read_b64_tr_b16 v[112:113], v30 offset:32768
    v_cvt_pk_bf16_f32 v178, v164, v165
    v_mfma_f32_16x16x32_bf16 v[168:171], v[76:79], a[252:255], v[168:171]
    s_or_b32 m0, s100, s43
    v_exp_f32 v166, v166
    v_mfma_f32_16x16x32_bf16 v[172:175], v[80:83], a[240:243], v[52:55]
    s_or_b32 s99, s99, 0x6000
    v_exp_f32 v167, v167
    v_mfma_f32_16x16x32_bf16 v[172:175], v[84:87], a[244:247], v[172:175]
    ds_read_b64_tr_b16 v[114:115], v30 offset:36864
    v_cvt_pk_bf16_f32 v179, v166, v167
    v_mfma_f32_16x16x32_bf16 v[172:175], v[88:91], a[248:251], v[172:175]
    v_mfma_f32_16x16x32_bf16 v[172:175], v[92:95], a[252:255], v[172:175]
    v_exp_f32 v168, v168
    v_mfma_f32_16x16x32_bf16 a[64:67], v[128:131], v[176:179], a[64:67]
    v_exp_f32 v169, v169
    v_mfma_f32_16x16x32_bf16 a[68:71], v[132:135], v[176:179], a[68:71]
    ds_read_b64_tr_b16 v[116:117], v31 offset:32768
    v_cvt_pk_bf16_f32 v180, v168, v169
    v_mfma_f32_16x16x32_bf16 a[72:75], v[136:139], v[176:179], a[72:75]
    v_exp_f32 v170, v170
    v_mfma_f32_16x16x32_bf16 a[76:79], v[140:143], v[176:179], a[76:79]
    v_exp_f32 v171, v171
    v_mfma_f32_16x16x32_bf16 a[80:83], v[144:147], v[176:179], a[80:83]
    ds_read_b64_tr_b16 v[118:119], v31 offset:36864
    v_cvt_pk_bf16_f32 v181, v170, v171
    v_mfma_f32_16x16x32_bf16 a[84:87], v[148:151], v[176:179], a[84:87]
    v_mfma_f32_16x16x32_bf16 a[88:91], v[152:155], v[176:179], a[88:91]
    v_mfma_f32_16x16x32_bf16 a[92:95], v[156:159], v[176:179], a[92:95]
    s_waitcnt vmcnt(4)
    buffer_load_dwordx4 v8, s[16:19], s40 offen offset:0 nt lds
    v_mfma_f32_16x16x32_bf16 v[216:219], v[34:37], v[176:179], v[216:219]
    s_add_u32 s40, s40, 1024
    v_mfma_f32_16x16x32_bf16 v[160:163], v[64:67], v[192:195], v[56:59]
    s_add_u32 s99, s99, 1024
    v_exp_f32 v172, v172
    v_mfma_f32_16x16x32_bf16 v[160:163], v[68:71], v[196:199], v[160:163]
    s_and_b32 s100, s99, 0x19fff
    v_exp_f32 v173, v173
    v_mfma_f32_16x16x32_bf16 v[160:163], v[72:75], v[200:203], v[160:163]
    ds_read_b64_tr_b16 v[120:121], v32 offset:32768
    v_cvt_pk_bf16_f32 v182, v172, v173
    v_mfma_f32_16x16x32_bf16 v[160:163], v[76:79], v[204:207], v[160:163]
    s_or_b32 m0, s100, s43
    v_exp_f32 v174, v174
    v_mfma_f32_16x16x32_bf16 v[164:167], v[80:83], v[192:195], v[56:59]
    s_or_b32 s99, s99, 0x6000
    v_exp_f32 v175, v175
    v_mfma_f32_16x16x32_bf16 v[164:167], v[84:87], v[196:199], v[164:167]
    ds_read_b64_tr_b16 v[122:123], v32 offset:36864
    v_cvt_pk_bf16_f32 v183, v174, v175
    v_mfma_f32_16x16x32_bf16 v[164:167], v[88:91], v[200:203], v[164:167]
    s_waitcnt vmcnt(4)
    buffer_load_dwordx4 v9, s[16:19], s40 offen offset:0 nt lds
    v_mfma_f32_16x16x32_bf16 v[164:167], v[92:95], v[204:207], v[164:167]
    s_add_u32 s40, s40, 1024
    v_exp_f32 v160, v160
    v_mfma_f32_16x16x32_bf16 a[96:99], v[128:131], v[180:183], a[96:99]
    s_add_u32 s99, s99, 1024
    v_exp_f32 v161, v161
    v_mfma_f32_16x16x32_bf16 a[100:103], v[132:135], v[180:183], a[100:103]
    ds_read_b64_tr_b16 v[124:125], v33 offset:32768
    v_cvt_pk_bf16_f32 v176, v160, v161
    v_mfma_f32_16x16x32_bf16 a[104:107], v[136:139], v[180:183], a[104:107]
    s_and_b32 s100, s99, 0x19fff
    v_exp_f32 v162, v162
    v_mfma_f32_16x16x32_bf16 a[108:111], v[140:143], v[180:183], a[108:111]
    s_or_b32 m0, s100, s43
    v_exp_f32 v163, v163
    v_mfma_f32_16x16x32_bf16 a[112:115], v[144:147], v[180:183], a[112:115]
    ds_read_b64_tr_b16 v[126:127], v33 offset:36864
    v_cvt_pk_bf16_f32 v177, v162, v163
    v_mfma_f32_16x16x32_bf16 a[116:119], v[148:151], v[180:183], a[116:119]
    s_or_b32 s99, s99, 0x6000
    v_mfma_f32_16x16x32_bf16 a[120:123], v[152:155], v[180:183], a[120:123]
    v_mfma_f32_16x16x32_bf16 a[124:127], v[156:159], v[180:183], a[124:127]
    s_waitcnt vmcnt(4)
    buffer_load_dwordx4 v8, s[16:19], s40 offen offset:0 nt lds
    v_mfma_f32_16x16x32_bf16 v[220:223], v[34:37], v[180:183], v[220:223]
    s_add_u32 s40, s40, 1024
    v_mfma_f32_16x16x32_bf16 v[168:171], v[64:67], v[224:227], v[60:63]
    s_add_u32 s99, s99, 1024
    v_exp_f32 v164, v164
    v_mfma_f32_16x16x32_bf16 v[168:171], v[68:71], v[228:231], v[168:171]
    s_and_b32 s100, s99, 0x19fff
    v_exp_f32 v165, v165
    v_mfma_f32_16x16x32_bf16 v[168:171], v[72:75], v[232:235], v[168:171]
    ds_read_b128 v[64:67], v14 offset:32768
    v_cvt_pk_bf16_f32 v178, v164, v165
    v_mfma_f32_16x16x32_bf16 v[168:171], v[76:79], v[236:239], v[168:171]
    s_or_b32 m0, s100, s43
    v_exp_f32 v166, v166
    v_mfma_f32_16x16x32_bf16 v[172:175], v[80:83], v[224:227], v[60:63]
    s_or_b32 s99, s99, 0x6000
    v_exp_f32 v167, v167
    v_mfma_f32_16x16x32_bf16 v[172:175], v[84:87], v[228:231], v[172:175]
    ds_read_b128 v[68:71], v15 offset:32768
    v_cvt_pk_bf16_f32 v179, v166, v167
    v_mfma_f32_16x16x32_bf16 v[172:175], v[88:91], v[232:235], v[172:175]
    ds_read_b128 v[72:75], v16 offset:32768
    v_mfma_f32_16x16x32_bf16 v[172:175], v[92:95], v[236:239], v[172:175]
    v_exp_f32 v168, v168
    v_mfma_f32_16x16x32_bf16 a[128:131], v[128:131], v[176:179], a[128:131]
    v_exp_f32 v169, v169
    v_mfma_f32_16x16x32_bf16 a[132:135], v[132:135], v[176:179], a[132:135]
    ds_read_b128 v[76:79], v17 offset:32768
    v_cvt_pk_bf16_f32 v180, v168, v169
    v_mfma_f32_16x16x32_bf16 a[136:139], v[136:139], v[176:179], a[136:139]
    v_exp_f32 v170, v170
    v_mfma_f32_16x16x32_bf16 a[140:143], v[140:143], v[176:179], a[140:143]
    v_exp_f32 v171, v171
    v_mfma_f32_16x16x32_bf16 a[144:147], v[144:147], v[176:179], a[144:147]
    ds_read_b128 v[80:83], v14 offset:36864
    v_cvt_pk_bf16_f32 v181, v170, v171
    v_mfma_f32_16x16x32_bf16 a[148:151], v[148:151], v[176:179], a[148:151]
    ds_read_b128 v[84:87], v15 offset:36864
    v_mfma_f32_16x16x32_bf16 a[152:155], v[152:155], v[176:179], a[152:155]
    ds_read_b128 v[88:91], v16 offset:36864
    v_mfma_f32_16x16x32_bf16 a[156:159], v[156:159], v[176:179], a[156:159]
    ds_read_b128 v[92:95], v17 offset:36864
    v_mfma_f32_16x16x32_bf16 v[240:243], v[34:37], v[176:179], v[240:243]
    s_waitcnt lgkmcnt(6)
    v_mfma_f32_16x16x32_bf16 v[160:163], v[64:67], a[192:195], v[40:43]
    v_exp_f32 v172, v172
    v_mfma_f32_16x16x32_bf16 v[160:163], v[68:71], a[196:199], v[160:163]
    s_waitcnt lgkmcnt(4)
    v_exp_f32 v173, v173
    v_mfma_f32_16x16x32_bf16 v[160:163], v[72:75], a[200:203], v[160:163]
    v_cvt_pk_bf16_f32 v182, v172, v173
    v_mfma_f32_16x16x32_bf16 v[160:163], v[76:79], a[204:207], v[160:163]
    s_waitcnt lgkmcnt(2)
    v_exp_f32 v174, v174
    v_mfma_f32_16x16x32_bf16 v[164:167], v[80:83], a[192:195], v[40:43]
    v_exp_f32 v175, v175
    v_mfma_f32_16x16x32_bf16 v[164:167], v[84:87], a[196:199], v[164:167]
    s_waitcnt lgkmcnt(0)
    v_cvt_pk_bf16_f32 v183, v174, v175
    v_mfma_f32_16x16x32_bf16 v[164:167], v[88:91], a[200:203], v[164:167]
    v_mfma_f32_16x16x32_bf16 v[164:167], v[92:95], a[204:207], v[164:167]
    v_exp_f32 v160, v160
    v_mfma_f32_16x16x32_bf16 a[160:163], v[128:131], v[180:183], a[160:163]
    v_exp_f32 v161, v161
    v_mfma_f32_16x16x32_bf16 a[164:167], v[132:135], v[180:183], a[164:167]
    v_cvt_pk_bf16_f32 v176, v160, v161
    v_mfma_f32_16x16x32_bf16 a[168:171], v[136:139], v[180:183], a[168:171]
    v_exp_f32 v162, v162
    v_mfma_f32_16x16x32_bf16 a[172:175], v[140:143], v[180:183], a[172:175]
    v_exp_f32 v163, v163
    v_mfma_f32_16x16x32_bf16 a[176:179], v[144:147], v[180:183], a[176:179]
    v_cvt_pk_bf16_f32 v177, v162, v163
    v_mfma_f32_16x16x32_bf16 a[180:183], v[148:151], v[180:183], a[180:183]
    s_barrier
    v_mfma_f32_16x16x32_bf16 a[184:187], v[152:155], v[180:183], a[184:187]
    v_mfma_f32_16x16x32_bf16 a[188:191], v[156:159], v[180:183], a[188:191]
    s_waitcnt vmcnt(4)
    buffer_load_dwordx4 v9, s[16:19], s40 offen offset:0 nt lds
    v_mfma_f32_16x16x32_bf16 v[244:247], v[34:37], v[180:183], v[244:247]
    s_add_u32 s40, s40, 1024
    v_mfma_f32_16x16x32_bf16 v[168:171], v[64:67], a[208:211], v[44:47]
    s_add_u32 s99, s99, 1024
    v_exp_f32 v164, v164
    v_mfma_f32_16x16x32_bf16 v[168:171], v[68:71], a[212:215], v[168:171]
    s_and_b32 s100, s99, 0x19fff
    v_exp_f32 v165, v165
    v_mfma_f32_16x16x32_bf16 v[168:171], v[72:75], a[216:219], v[168:171]
    ds_read_b64_tr_b16 v[128:129], v18 offset:0
    v_cvt_pk_bf16_f32 v178, v164, v165
    v_mfma_f32_16x16x32_bf16 v[168:171], v[76:79], a[220:223], v[168:171]
    s_or_b32 m0, s100, s43
    v_exp_f32 v166, v166
    v_mfma_f32_16x16x32_bf16 v[172:175], v[80:83], a[208:211], v[44:47]
    s_or_b32 s99, s99, 0x6000
    v_exp_f32 v167, v167
    v_mfma_f32_16x16x32_bf16 v[172:175], v[84:87], a[212:215], v[172:175]
    ds_read_b64_tr_b16 v[130:131], v18 offset:4096
    v_cvt_pk_bf16_f32 v179, v166, v167
    v_mfma_f32_16x16x32_bf16 v[172:175], v[88:91], a[216:219], v[172:175]
    v_mfma_f32_16x16x32_bf16 v[172:175], v[92:95], a[220:223], v[172:175]
    v_exp_f32 v168, v168
    v_mfma_f32_16x16x32_bf16 a[0:3], v[96:99], v[176:179], a[0:3]
    v_exp_f32 v169, v169
    v_mfma_f32_16x16x32_bf16 a[4:7], v[100:103], v[176:179], a[4:7]
    ds_read_b64_tr_b16 v[132:133], v19 offset:0
    v_cvt_pk_bf16_f32 v180, v168, v169
    v_mfma_f32_16x16x32_bf16 a[8:11], v[104:107], v[176:179], a[8:11]
    v_exp_f32 v170, v170
    v_mfma_f32_16x16x32_bf16 a[12:15], v[108:111], v[176:179], a[12:15]
    v_exp_f32 v171, v171
    v_mfma_f32_16x16x32_bf16 a[16:19], v[112:115], v[176:179], a[16:19]
    ds_read_b64_tr_b16 v[134:135], v19 offset:4096
    v_cvt_pk_bf16_f32 v181, v170, v171
    v_mfma_f32_16x16x32_bf16 a[20:23], v[116:119], v[176:179], a[20:23]
    v_mfma_f32_16x16x32_bf16 a[24:27], v[120:123], v[176:179], a[24:27]
    v_mfma_f32_16x16x32_bf16 a[28:31], v[124:127], v[176:179], a[28:31]
    s_waitcnt vmcnt(4)
    buffer_load_dwordx4 v8, s[16:19], s40 offen offset:0 nt lds
    v_mfma_f32_16x16x32_bf16 v[208:211], v[34:37], v[176:179], v[208:211]
    s_add_u32 s40, s40, 1024
    v_mfma_f32_16x16x32_bf16 v[160:163], v[64:67], a[224:227], v[48:51]
    s_add_u32 s99, s99, 1024
    v_exp_f32 v172, v172
    v_mfma_f32_16x16x32_bf16 v[160:163], v[68:71], a[228:231], v[160:163]
    s_and_b32 s100, s99, 0x19fff
    v_exp_f32 v173, v173
    v_mfma_f32_16x16x32_bf16 v[160:163], v[72:75], a[232:235], v[160:163]
    ds_read_b64_tr_b16 v[136:137], v20 offset:0
    v_cvt_pk_bf16_f32 v182, v172, v173
    v_mfma_f32_16x16x32_bf16 v[160:163], v[76:79], a[236:239], v[160:163]
    s_or_b32 m0, s100, s43
    v_exp_f32 v174, v174
    v_mfma_f32_16x16x32_bf16 v[164:167], v[80:83], a[224:227], v[48:51]
    s_or_b32 s99, s99, 0x6000
    v_exp_f32 v175, v175
    v_mfma_f32_16x16x32_bf16 v[164:167], v[84:87], a[228:231], v[164:167]
    ds_read_b64_tr_b16 v[138:139], v20 offset:4096
    v_cvt_pk_bf16_f32 v183, v174, v175
    v_mfma_f32_16x16x32_bf16 v[164:167], v[88:91], a[232:235], v[164:167]
    s_waitcnt vmcnt(4)
    buffer_load_dwordx4 v9, s[16:19], s40 offen offset:0 nt lds
    v_mfma_f32_16x16x32_bf16 v[164:167], v[92:95], a[236:239], v[164:167]
    s_add_u32 s40, s40, 1024
    v_exp_f32 v160, v160
    v_mfma_f32_16x16x32_bf16 a[32:35], v[96:99], v[180:183], a[32:35]
    s_add_u32 s99, s99, 1024
    v_exp_f32 v161, v161
    v_mfma_f32_16x16x32_bf16 a[36:39], v[100:103], v[180:183], a[36:39]
    ds_read_b64_tr_b16 v[140:141], v21 offset:0
    v_cvt_pk_bf16_f32 v176, v160, v161
    v_mfma_f32_16x16x32_bf16 a[40:43], v[104:107], v[180:183], a[40:43]
    s_and_b32 s100, s99, 0x19fff
    v_exp_f32 v162, v162
    v_mfma_f32_16x16x32_bf16 a[44:47], v[108:111], v[180:183], a[44:47]
    s_or_b32 m0, s100, s43
    v_exp_f32 v163, v163
    v_mfma_f32_16x16x32_bf16 a[48:51], v[112:115], v[180:183], a[48:51]
    ds_read_b64_tr_b16 v[142:143], v21 offset:4096
    v_cvt_pk_bf16_f32 v177, v162, v163
    v_mfma_f32_16x16x32_bf16 a[52:55], v[116:119], v[180:183], a[52:55]
    s_or_b32 s99, s99, 0x6000
    v_mfma_f32_16x16x32_bf16 a[56:59], v[120:123], v[180:183], a[56:59]
    v_mfma_f32_16x16x32_bf16 a[60:63], v[124:127], v[180:183], a[60:63]
    s_waitcnt vmcnt(4)
    buffer_load_dwordx4 v8, s[16:19], s40 offen offset:0 nt lds
    v_mfma_f32_16x16x32_bf16 v[212:215], v[34:37], v[180:183], v[212:215]
    s_add_u32 s40, s40, 1024
    v_mfma_f32_16x16x32_bf16 v[168:171], v[64:67], a[240:243], v[52:55]
    s_add_u32 s99, s99, 1024
    v_exp_f32 v164, v164
    v_mfma_f32_16x16x32_bf16 v[168:171], v[68:71], a[244:247], v[168:171]
    s_and_b32 s100, s99, 0x19fff
    v_exp_f32 v165, v165
    v_mfma_f32_16x16x32_bf16 v[168:171], v[72:75], a[248:251], v[168:171]
    ds_read_b64_tr_b16 v[144:145], v22 offset:0
    v_cvt_pk_bf16_f32 v178, v164, v165
    v_mfma_f32_16x16x32_bf16 v[168:171], v[76:79], a[252:255], v[168:171]
    s_or_b32 m0, s100, s43
    v_exp_f32 v166, v166
    v_mfma_f32_16x16x32_bf16 v[172:175], v[80:83], a[240:243], v[52:55]
    s_or_b32 s99, s99, 0x6000
    v_exp_f32 v167, v167
    v_mfma_f32_16x16x32_bf16 v[172:175], v[84:87], a[244:247], v[172:175]
    ds_read_b64_tr_b16 v[146:147], v22 offset:4096
    v_cvt_pk_bf16_f32 v179, v166, v167
    v_mfma_f32_16x16x32_bf16 v[172:175], v[88:91], a[248:251], v[172:175]
    v_mfma_f32_16x16x32_bf16 v[172:175], v[92:95], a[252:255], v[172:175]
    v_exp_f32 v168, v168
    v_mfma_f32_16x16x32_bf16 a[64:67], v[96:99], v[176:179], a[64:67]
    v_exp_f32 v169, v169
    v_mfma_f32_16x16x32_bf16 a[68:71], v[100:103], v[176:179], a[68:71]
    ds_read_b64_tr_b16 v[148:149], v23 offset:0
    v_cvt_pk_bf16_f32 v180, v168, v169
    v_mfma_f32_16x16x32_bf16 a[72:75], v[104:107], v[176:179], a[72:75]
    v_exp_f32 v170, v170
    v_mfma_f32_16x16x32_bf16 a[76:79], v[108:111], v[176:179], a[76:79]
    v_exp_f32 v171, v171
    v_mfma_f32_16x16x32_bf16 a[80:83], v[112:115], v[176:179], a[80:83]
    ds_read_b64_tr_b16 v[150:151], v23 offset:4096
    v_cvt_pk_bf16_f32 v181, v170, v171
    v_mfma_f32_16x16x32_bf16 a[84:87], v[116:119], v[176:179], a[84:87]
    v_mfma_f32_16x16x32_bf16 a[88:91], v[120:123], v[176:179], a[88:91]
    v_mfma_f32_16x16x32_bf16 a[92:95], v[124:127], v[176:179], a[92:95]
    s_waitcnt vmcnt(4)
    buffer_load_dwordx4 v9, s[16:19], s40 offen offset:0 nt lds
    v_mfma_f32_16x16x32_bf16 v[216:219], v[34:37], v[176:179], v[216:219]
    s_add_u32 s40, s40, 1024
    v_mfma_f32_16x16x32_bf16 v[160:163], v[64:67], v[192:195], v[56:59]
    s_add_u32 s99, s99, 1024
    v_exp_f32 v172, v172
    v_mfma_f32_16x16x32_bf16 v[160:163], v[68:71], v[196:199], v[160:163]
    s_and_b32 s100, s99, 0x19fff
    v_exp_f32 v173, v173
    v_mfma_f32_16x16x32_bf16 v[160:163], v[72:75], v[200:203], v[160:163]
    ds_read_b64_tr_b16 v[152:153], v24 offset:0
    v_cvt_pk_bf16_f32 v182, v172, v173
    v_mfma_f32_16x16x32_bf16 v[160:163], v[76:79], v[204:207], v[160:163]
    s_or_b32 m0, s100, s43
    v_exp_f32 v174, v174
    v_mfma_f32_16x16x32_bf16 v[164:167], v[80:83], v[192:195], v[56:59]
    s_or_b32 s99, s99, 0x6000
    v_exp_f32 v175, v175
    v_mfma_f32_16x16x32_bf16 v[164:167], v[84:87], v[196:199], v[164:167]
    ds_read_b64_tr_b16 v[154:155], v24 offset:4096
    v_cvt_pk_bf16_f32 v183, v174, v175
    v_mfma_f32_16x16x32_bf16 v[164:167], v[88:91], v[200:203], v[164:167]
    s_waitcnt vmcnt(4)
    buffer_load_dwordx4 v8, s[16:19], s40 offen offset:0 nt lds
    v_mfma_f32_16x16x32_bf16 v[164:167], v[92:95], v[204:207], v[164:167]
    s_add_u32 s40, s40, 1024
    v_exp_f32 v160, v160
    v_mfma_f32_16x16x32_bf16 a[96:99], v[96:99], v[180:183], a[96:99]
    s_add_u32 s99, s99, 1024
    v_exp_f32 v161, v161
    v_mfma_f32_16x16x32_bf16 a[100:103], v[100:103], v[180:183], a[100:103]
    ds_read_b64_tr_b16 v[156:157], v25 offset:0
    v_cvt_pk_bf16_f32 v176, v160, v161
    v_mfma_f32_16x16x32_bf16 a[104:107], v[104:107], v[180:183], a[104:107]
    s_and_b32 s100, s99, 0x19fff
    v_exp_f32 v162, v162
    v_mfma_f32_16x16x32_bf16 a[108:111], v[108:111], v[180:183], a[108:111]
    s_or_b32 m0, s100, s43
    v_exp_f32 v163, v163
    v_mfma_f32_16x16x32_bf16 a[112:115], v[112:115], v[180:183], a[112:115]
    ds_read_b64_tr_b16 v[158:159], v25 offset:4096
    v_cvt_pk_bf16_f32 v177, v162, v163
    v_mfma_f32_16x16x32_bf16 a[116:119], v[116:119], v[180:183], a[116:119]
    s_or_b32 s99, s99, 0x6000
    v_mfma_f32_16x16x32_bf16 a[120:123], v[120:123], v[180:183], a[120:123]
    v_mfma_f32_16x16x32_bf16 a[124:127], v[124:127], v[180:183], a[124:127]
    s_waitcnt vmcnt(4)
    buffer_load_dwordx4 v9, s[16:19], s40 offen offset:0 nt lds
    v_mfma_f32_16x16x32_bf16 v[220:223], v[34:37], v[180:183], v[220:223]
    s_add_u32 s40, s40, 1024
    v_mfma_f32_16x16x32_bf16 v[168:171], v[64:67], v[224:227], v[60:63]
    s_add_u32 s99, s99, 1024
    v_exp_f32 v164, v164
    v_mfma_f32_16x16x32_bf16 v[168:171], v[68:71], v[228:231], v[168:171]
    s_and_b32 s100, s99, 0x19fff
    v_exp_f32 v165, v165
    v_mfma_f32_16x16x32_bf16 v[168:171], v[72:75], v[232:235], v[168:171]
    ds_read_b128 v[64:67], v10 offset:0
    v_cvt_pk_bf16_f32 v178, v164, v165
    v_mfma_f32_16x16x32_bf16 v[168:171], v[76:79], v[236:239], v[168:171]
    s_or_b32 m0, s100, s43
    v_exp_f32 v166, v166
    v_mfma_f32_16x16x32_bf16 v[172:175], v[80:83], v[224:227], v[60:63]
    s_or_b32 s99, s99, 0x6000
    v_exp_f32 v167, v167
    v_mfma_f32_16x16x32_bf16 v[172:175], v[84:87], v[228:231], v[172:175]
    ds_read_b128 v[68:71], v11 offset:0
    v_cvt_pk_bf16_f32 v179, v166, v167
    v_mfma_f32_16x16x32_bf16 v[172:175], v[88:91], v[232:235], v[172:175]
    ds_read_b128 v[72:75], v12 offset:0
    v_mfma_f32_16x16x32_bf16 v[172:175], v[92:95], v[236:239], v[172:175]
    v_exp_f32 v168, v168
    v_mfma_f32_16x16x32_bf16 a[128:131], v[96:99], v[176:179], a[128:131]
    v_exp_f32 v169, v169
    v_mfma_f32_16x16x32_bf16 a[132:135], v[100:103], v[176:179], a[132:135]
    ds_read_b128 v[76:79], v13 offset:0
    v_cvt_pk_bf16_f32 v180, v168, v169
    v_mfma_f32_16x16x32_bf16 a[136:139], v[104:107], v[176:179], a[136:139]
    v_exp_f32 v170, v170
    v_mfma_f32_16x16x32_bf16 a[140:143], v[108:111], v[176:179], a[140:143]
    v_exp_f32 v171, v171
    v_mfma_f32_16x16x32_bf16 a[144:147], v[112:115], v[176:179], a[144:147]
    ds_read_b128 v[80:83], v10 offset:4096
    v_cvt_pk_bf16_f32 v181, v170, v171
    v_mfma_f32_16x16x32_bf16 a[148:151], v[116:119], v[176:179], a[148:151]
    ds_read_b128 v[84:87], v11 offset:4096
    v_mfma_f32_16x16x32_bf16 a[152:155], v[120:123], v[176:179], a[152:155]
    ds_read_b128 v[88:91], v12 offset:4096
    v_mfma_f32_16x16x32_bf16 a[156:159], v[124:127], v[176:179], a[156:159]
    ds_read_b128 v[92:95], v13 offset:4096
    v_mfma_f32_16x16x32_bf16 v[240:243], v[34:37], v[176:179], v[240:243]
    s_waitcnt lgkmcnt(6)
    s_sub_u32 s44, s44, 1
    s_cmp_lg_u32 s44, 0
    s_cbranch_scc1 L_aloop
    s_cmp_eq_u32 s7, 1
    s_cbranch_scc1 L_atail1
    v_mfma_f32_16x16x32_bf16 v[160:163], v[64:67], a[192:195], v[40:43]
    v_exp_f32 v172, v172
    v_mfma_f32_16x16x32_bf16 v[160:163], v[68:71], a[196:199], v[160:163]
    s_waitcnt lgkmcnt(4)
    v_exp_f32 v173, v173
    v_mfma_f32_16x16x32_bf16 v[160:163], v[72:75], a[200:203], v[160:163]
    v_cvt_pk_bf16_f32 v182, v172, v173
    v_mfma_f32_16x16x32_bf16 v[160:163], v[76:79], a[204:207], v[160:163]
    s_waitcnt lgkmcnt(2)
    v_exp_f32 v174, v174
    v_mfma_f32_16x16x32_bf16 v[164:167], v[80:83], a[192:195], v[40:43]
    v_exp_f32 v175, v175
    v_mfma_f32_16x16x32_bf16 v[164:167], v[84:87], a[196:199], v[164:167]
    s_waitcnt lgkmcnt(0)
    v_cvt_pk_bf16_f32 v183, v174, v175
    v_mfma_f32_16x16x32_bf16 v[164:167], v[88:91], a[200:203], v[164:167]
    v_mfma_f32_16x16x32_bf16 v[164:167], v[92:95], a[204:207], v[164:167]
    v_exp_f32 v160, v160
    v_mfma_f32_16x16x32_bf16 a[160:163], v[96:99], v[180:183], a[160:163]
    v_exp_f32 v161, v161
    v_mfma_f32_16x16x32_bf16 a[164:167], v[100:103], v[180:183], a[164:167]
    v_cvt_pk_bf16_f32 v176, v160, v161
    v_mfma_f32_16x16x32_bf16 a[168:171], v[104:107], v[180:183], a[168:171]
    v_exp_f32 v162, v162
    v_mfma_f32_16x16x32_bf16 a[172:175], v[108:111], v[180:183], a[172:175]
    v_exp_f32 v163, v163
    v_mfma_f32_16x16x32_bf16 a[176:179], v[112:115], v[180:183], a[176:179]
    v_cvt_pk_bf16_f32 v177, v162, v163
    v_mfma_f32_16x16x32_bf16 a[180:183], v[116:119], v[180:183], a[180:183]
    s_barrier
    v_mfma_f32_16x16x32_bf16 a[184:187], v[120:123], v[180:183], a[184:187]
    v_mfma_f32_16x16x32_bf16 a[188:191], v[124:127], v[180:183], a[188:191]
    s_waitcnt vmcnt(4)
    buffer_load_dwordx4 v8, s[16:19], s40 offen offset:0 nt lds
    v_mfma_f32_16x16x32_bf16 v[244:247], v[34:37], v[180:183], v[244:247]
    s_add_u32 s40, s40, 1024
    v_mfma_f32_16x16x32_bf16 v[168:171], v[64:67], a[208:211], v[44:47]
    s_add_u32 s99, s99, 1024
    v_exp_f32 v164, v164
    v_mfma_f32_16x16x32_bf16 v[168:171], v[68:71], a[212:215], v[168:171]
    s_and_b32 s100, s99, 0x19fff
    v_exp_f32 v165, v165
    v_mfma_f32_16x16x32_bf16 v[168:171], v[72:75], a[216:219], v[168:171]
    ds_read_b64_tr_b16 v[96:97], v18 offset:32768
    v_cvt_pk_bf16_f32 v178, v164, v165
    v_mfma_f32_16x16x32_bf16 v[168:171], v[76:79], a[220:223], v[168:171]
    s_or_b32 m0, s100, s43
    v_exp_f32 v166, v166
    v_mfma_f32_16x16x32_bf16 v[172:175], v[80:83], a[208:211], v[44:47]
    s_or_b32 s99, s99, 0x6000
    v_exp_f32 v167, v167
    v_mfma_f32_16x16x32_bf16 v[172:175], v[84:87], a[212:215], v[172:175]
    ds_read_b64_tr_b16 v[98:99], v18 offset:36864
    v_cvt_pk_bf16_f32 v179, v166, v167
    v_mfma_f32_16x16x32_bf16 v[172:175], v[88:91], a[216:219], v[172:175]
    s_waitcnt vmcnt(4)
    buffer_load_dwordx4 v9, s[16:19], s40 offen offset:0 nt lds
    v_mfma_f32_16x16x32_bf16 v[172:175], v[92:95], a[220:223], v[172:175]
    s_add_u32 s40, s40, 1024
    v_exp_f32 v168, v168
    v_mfma_f32_16x16x32_bf16 a[0:3], v[128:131], v[176:179], a[0:3]
    s_add_u32 s99, s99, 1024
    v_exp_f32 v169, v169
    v_mfma_f32_16x16x32_bf16 a[4:7], v[132:135], v[176:179], a[4:7]
    ds_read_b64_tr_b16 v[100:101], v19 offset:32768
    v_cvt_pk_bf16_f32 v180, v168, v169
    v_mfma_f32_16x16x32_bf16 a[8:11], v[136:139], v[176:179], a[8:11]
    s_and_b32 s100, s99, 0x19fff
    v_exp_f32 v170, v170
    v_mfma_f32_16x16x32_bf16 a[12:15], v[140:143], v[176:179], a[12:15]
    s_or_b32 s99, s99, 0x6000
    v_exp_f32 v171, v171
    v_mfma_f32_16x16x32_bf16 a[16:19], v[144:147], v[176:179], a[16:19]
    ds_read_b64_tr_b16 v[102:103], v19 offset:36864
    v_cvt_pk_bf16_f32 v181, v170, v171
    s_mov_b32 s39, s84
    s_add_u32 m0, s42, 0
    v_mfma_f32_16x16x32_bf16 a[20:23], v[148:151], v[176:179], a[20:23]
    buffer_load_dwordx4 v5, s[12:15], s39 offen offset:0 lds
    v_mfma_f32_16x16x32_bf16 a[24:27], v[152:155], v[176:179], a[24:27]
    buffer_load_dwordx4 v6, s[12:15], s39 offen offset:1024 lds
    v_mfma_f32_16x16x32_bf16 a[28:31], v[156:159], v[176:179], a[28:31]
    buffer_load_dwordx4 v7, s[12:15], s39 offen offset:2048 lds
    v_mfma_f32_16x16x32_bf16 v[208:211], v[34:37], v[176:179], v[208:211]
    buffer_load_dwordx4 v38, s[12:15], s39 offen offset:3072 lds
    v_mfma_f32_16x16x32_bf16 v[160:163], v[64:67], a[224:227], v[48:51]
    v_exp_f32 v172, v172
    v_mfma_f32_16x16x32_bf16 v[160:163], v[68:71], a[228:231], v[160:163]
    v_exp_f32 v173, v173
    v_mfma_f32_16x16x32_bf16 v[160:163], v[72:75], a[232:235], v[160:163]
    ds_read_b64_tr_b16 v[104:105], v20 offset:32768
    v_cvt_pk_bf16_f32 v182, v172, v173
    v_mfma_f32_16x16x32_bf16 v[160:163], v[76:79], a[236:239], v[160:163]
    v_exp_f32 v174, v174
    v_mfma_f32_16x16x32_bf16 v[164:167], v[80:83], a[224:227], v[48:51]
    v_exp_f32 v175, v175
    v_mfma_f32_16x16x32_bf16 v[164:167], v[84:87], a[228:231], v[164:167]
    ds_read_b64_tr_b16 v[106:107], v20 offset:36864
    v_cvt_pk_bf16_f32 v183, v174, v175
    s_add_u32 s16, s16, 0x200000
    s_addc_u32 s17, s17, 0
    s_mov_b32 s40, 0
    s_add_u32 m0, s43, 131072
    v_mfma_f32_16x16x32_bf16 v[164:167], v[88:91], a[232:235], v[164:167]
    buffer_load_dwordx4 v8, s[16:19], s40 offen offset:0 nt lds
    v_mfma_f32_16x16x32_bf16 v[164:167], v[92:95], a[236:239], v[164:167]
    v_exp_f32 v160, v160
    v_mfma_f32_16x16x32_bf16 a[32:35], v[128:131], v[180:183], a[32:35]
    v_exp_f32 v161, v161
    v_mfma_f32_16x16x32_bf16 a[36:39], v[132:135], v[180:183], a[36:39]
    ds_read_b64_tr_b16 v[108:109], v21 offset:32768
    v_cvt_pk_bf16_f32 v176, v160, v161
    v_mfma_f32_16x16x32_bf16 a[40:43], v[136:139], v[180:183], a[40:43]
    v_exp_f32 v162, v162
    v_mfma_f32_16x16x32_bf16 a[44:47], v[140:143], v[180:183], a[44:47]
    v_exp_f32 v163, v163
    v_mfma_f32_16x16x32_bf16 a[48:51], v[144:147], v[180:183], a[48:51]
    ds_read_b64_tr_b16 v[110:111], v21 offset:36864
    v_cvt_pk_bf16_f32 v177, v162, v163
    v_mfma_f32_16x16x32_bf16 a[52:55], v[148:151], v[180:183], a[52:55]
    buffer_load_dwordx4 v9, s[16:19], s40 offen offset:1024 nt lds
    v_mfma_f32_16x16x32_bf16 a[56:59], v[152:155], v[180:183], a[56:59]
    buffer_load_dwordx4 v8, s[16:19], s40 offen offset:2048 nt lds
    v_mfma_f32_16x16x32_bf16 a[60:63], v[156:159], v[180:183], a[60:63]
    buffer_load_dwordx4 v9, s[16:19], s40 offen offset:3072 nt lds
    v_mfma_f32_16x16x32_bf16 v[212:215], v[34:37], v[180:183], v[212:215]
    v_mfma_f32_16x16x32_bf16 v[168:171], v[64:67], a[240:243], v[52:55]
    v_exp_f32 v164, v164
    v_mfma_f32_16x16x32_bf16 v[168:171], v[68:71], a[244:247], v[168:171]
    v_exp_f32 v165, v165
    v_mfma_f32_16x16x32_bf16 v[168:171], v[72:75], a[248:251], v[168:171]
    ds_read_b64_tr_b16 v[112:113], v22 offset:32768
    v_cvt_pk_bf16_f32 v178, v164, v165
    v_mfma_f32_16x16x32_bf16 v[168:171], v[76:79], a[252:255], v[168:171]
    v_exp_f32 v166, v166
    v_mfma_f32_16x16x32_bf16 v[172:175], v[80:83], a[240:243], v[52:55]
    v_exp_f32 v167, v167
    v_mfma_f32_16x16x32_bf16 v[172:175], v[84:87], a[244:247], v[172:175]
    ds_read_b64_tr_b16 v[114:115], v22 offset:36864
    v_cvt_pk_bf16_f32 v179, v166, v167
    v_mfma_f32_16x16x32_bf16 v[172:175], v[88:91], a[248:251], v[172:175]
    v_mfma_f32_16x16x32_bf16 v[172:175], v[92:95], a[252:255], v[172:175]
    v_exp_f32 v168, v168
    v_mfma_f32_16x16x32_bf16 a[64:67], v[128:131], v[176:179], a[64:67]
    v_exp_f32 v169, v169
    v_mfma_f32_16x16x32_bf16 a[68:71], v[132:135], v[176:179], a[68:71]
    ds_read_b64_tr_b16 v[116:117], v23 offset:32768
    v_cvt_pk_bf16_f32 v180, v168, v169
    v_mfma_f32_16x16x32_bf16 a[72:75], v[136:139], v[176:179], a[72:75]
    v_exp_f32 v170, v170
    v_mfma_f32_16x16x32_bf16 a[76:79], v[140:143], v[176:179], a[76:79]
    v_exp_f32 v171, v171
    v_mfma_f32_16x16x32_bf16 a[80:83], v[144:147], v[176:179], a[80:83]
    ds_read_b64_tr_b16 v[118:119], v23 offset:36864
    v_cvt_pk_bf16_f32 v181, v170, v171
    v_mfma_f32_16x16x32_bf16 a[84:87], v[148:151], v[176:179], a[84:87]
    v_mfma_f32_16x16x32_bf16 a[88:91], v[152:155], v[176:179], a[88:91]
    v_mfma_f32_16x16x32_bf16 a[92:95], v[156:159], v[176:179], a[92:95]
    v_mfma_f32_16x16x32_bf16 v[216:219], v[34:37], v[176:179], v[216:219]
    v_mfma_f32_16x16x32_bf16 v[160:163], v[64:67], v[192:195], v[56:59]
    v_exp_f32 v172, v172
    v_mfma_f32_16x16x32_bf16 v[160:163], v[68:71], v[196:199], v[160:163]
    v_exp_f32 v173, v173
    v_mfma_f32_16x16x32_bf16 v[160:163], v[72:75], v[200:203], v[160:163]
    ds_read_b64_tr_b16 v[120:121], v24 offset:32768
    v_cvt_pk_bf16_f32 v182, v172, v173
    v_mfma_f32_16x16x32_bf16 v[160:163], v[76:79], v[204:207], v[160:163]
    v_exp_f32 v174, v174
    v_mfma_f32_16x16x32_bf16 v[164:167], v[80:83], v[192:195], v[56:59]
    v_exp_f32 v175, v175
    v_mfma_f32_16x16x32_bf16 v[164:167], v[84:87], v[196:199], v[164:167]
    ds_read_b64_tr_b16 v[122:123], v24 offset:36864
    v_cvt_pk_bf16_f32 v183, v174, v175
    v_mfma_f32_16x16x32_bf16 v[164:167], v[88:91], v[200:203], v[164:167]
    v_mfma_f32_16x16x32_bf16 v[164:167], v[92:95], v[204:207], v[164:167]
    v_exp_f32 v160, v160
    v_mfma_f32_16x16x32_bf16 a[96:99], v[128:131], v[180:183], a[96:99]
    v_exp_f32 v161, v161
    v_mfma_f32_16x16x32_bf16 a[100:103], v[132:135], v[180:183], a[100:103]
    ds_read_b64_tr_b16 v[124:125], v25 offset:32768
    v_cvt_pk_bf16_f32 v176, v160, v161
    v_mfma_f32_16x16x32_bf16 a[104:107], v[136:139], v[180:183], a[104:107]
    v_exp_f32 v162, v162
    v_mfma_f32_16x16x32_bf16 a[108:111], v[140:143], v[180:183], a[108:111]
    v_exp_f32 v163, v163
    v_mfma_f32_16x16x32_bf16 a[112:115], v[144:147], v[180:183], a[112:115]
    ds_read_b64_tr_b16 v[126:127], v25 offset:36864
    v_cvt_pk_bf16_f32 v177, v162, v163
    v_mfma_f32_16x16x32_bf16 a[116:119], v[148:151], v[180:183], a[116:119]
    v_mfma_f32_16x16x32_bf16 a[120:123], v[152:155], v[180:183], a[120:123]
    v_mfma_f32_16x16x32_bf16 a[124:127], v[156:159], v[180:183], a[124:127]
    v_mfma_f32_16x16x32_bf16 v[220:223], v[34:37], v[180:183], v[220:223]
    v_mfma_f32_16x16x32_bf16 v[168:171], v[64:67], v[224:227], v[60:63]
    v_exp_f32 v164, v164
    v_mfma_f32_16x16x32_bf16 v[168:171], v[68:71], v[228:231], v[168:171]
    v_exp_f32 v165, v165
    v_mfma_f32_16x16x32_bf16 v[168:171], v[72:75], v[232:235], v[168:171]
    ds_read_b128 v[64:67], v10 offset:32768
    v_cvt_pk_bf16_f32 v178, v164, v165
    v_mfma_f32_16x16x32_bf16 v[168:171], v[76:79], v[236:239], v[168:171]
    v_exp_f32 v166, v166
    v_mfma_f32_16x16x32_bf16 v[172:175], v[80:83], v[224:227], v[60:63]
    v_exp_f32 v167, v167
    v_mfma_f32_16x16x32_bf16 v[172:175], v[84:87], v[228:231], v[172:175]
    ds_read_b128 v[68:71], v11 offset:32768
    v_cvt_pk_bf16_f32 v179, v166, v167
    v_mfma_f32_16x16x32_bf16 v[172:175], v[88:91], v[232:235], v[172:175]
    ds_read_b128 v[72:75], v12 offset:32768
    v_mfma_f32_16x16x32_bf16 v[172:175], v[92:95], v[236:239], v[172:175]
    v_exp_f32 v168, v168
    v_mfma_f32_16x16x32_bf16 a[128:131], v[128:131], v[176:179], a[128:131]
    v_exp_f32 v169, v169
    v_mfma_f32_16x16x32_bf16 a[132:135], v[132:135], v[176:179], a[132:135]
    ds_read_b128 v[76:79], v13 offset:32768
    v_cvt_pk_bf16_f32 v180, v168, v169
    v_mfma_f32_16x16x32_bf16 a[136:139], v[136:139], v[176:179], a[136:139]
    v_exp_f32 v170, v170
    v_mfma_f32_16x16x32_bf16 a[140:143], v[140:143], v[176:179], a[140:143]
    v_exp_f32 v171, v171
    v_mfma_f32_16x16x32_bf16 a[144:147], v[144:147], v[176:179], a[144:147]
    ds_read_b128 v[80:83], v10 offset:36864
    v_cvt_pk_bf16_f32 v181, v170, v171
    v_mfma_f32_16x16x32_bf16 a[148:151], v[148:151], v[176:179], a[148:151]
    ds_read_b128 v[84:87], v11 offset:36864
    v_mfma_f32_16x16x32_bf16 a[152:155], v[152:155], v[176:179], a[152:155]
    ds_read_b128 v[88:91], v12 offset:36864
    v_mfma_f32_16x16x32_bf16 a[156:159], v[156:159], v[176:179], a[156:159]
    ds_read_b128 v[92:95], v13 offset:36864
    v_mfma_f32_16x16x32_bf16 v[240:243], v[34:37], v[176:179], v[240:243]
    s_waitcnt lgkmcnt(6)
    v_mfma_f32_16x16x32_bf16 v[160:163], v[64:67], a[192:195], v[40:43]
    s_and_b32 s95, s36, 15
    v_exp_f32 v172, v172
    v_mfma_f32_16x16x32_bf16 v[160:163], v[68:71], a[196:199], v[160:163]
    s_waitcnt lgkmcnt(4)
    v_exp_f32 v173, v173
    v_mfma_f32_16x16x32_bf16 v[160:163], v[72:75], a[200:203], v[160:163]
    v_cvt_pk_bf16_f32 v182, v172, v173
    v_lshrrev_b32 v255, 1, v1
    v_mfma_f32_16x16x32_bf16 v[160:163], v[76:79], a[204:207], v[160:163]
    s_waitcnt lgkmcnt(2)
    v_exp_f32 v174, v174
    v_mfma_f32_16x16x32_bf16 v[164:167], v[80:83], a[192:195], v[40:43]
    s_lshl_b32 s95, s95, 1
    v_exp_f32 v175, v175
    v_mfma_f32_16x16x32_bf16 v[164:167], v[84:87], a[196:199], v[164:167]
    s_waitcnt lgkmcnt(0)
    v_cvt_pk_bf16_f32 v183, v174, v175
    v_and_b32 v254, 1, v1
    v_mfma_f32_16x16x32_bf16 v[164:167], v[88:91], a[200:203], v[164:167]
    v_lshlrev_b32 v255, 13, v255
    v_lshl_add_u32 v255, v254, 7, v255
    v_mfma_f32_16x16x32_bf16 v[164:167], v[92:95], a[204:207], v[164:167]
    s_add_u32 s95, s95, s6
    v_exp_f32 v160, v160
    v_mfma_f32_16x16x32_bf16 a[160:163], v[128:131], v[180:183], a[160:163]
    v_exp_f32 v161, v161
    v_mfma_f32_16x16x32_bf16 a[164:167], v[132:135], v[180:183], a[164:167]
    v_cvt_pk_bf16_f32 v176, v160, v161
    v_bfrev_b32 v254, 1
    v_mfma_f32_16x16x32_bf16 a[168:171], v[136:139], v[180:183], a[168:171]
    s_mul_i32 s95, s95, 163840
    v_exp_f32 v162, v162
    v_mfma_f32_16x16x32_bf16 a[172:175], v[140:143], v[180:183], a[172:175]
    v_exp_f32 v163, v163
    v_mfma_f32_16x16x32_bf16 a[176:179], v[144:147], v[180:183], a[176:179]
    s_waitcnt vmcnt(8)
    v_cvt_pk_bf16_f32 v177, v162, v163
    v_cmp_gt_u32 vcc, 40, v1
    v_mfma_f32_16x16x32_bf16 a[180:183], v[148:151], v[180:183], a[180:183]
    s_barrier
    v_mfma_f32_16x16x32_bf16 a[184:187], v[152:155], v[180:183], a[184:187]
    v_cndmask_b32 v255, v254, v255, vcc
    s_mov_b32 s39, s70
    s_add_u32 m0, s42, 32768
    v_mfma_f32_16x16x32_bf16 a[188:191], v[156:159], v[180:183], a[188:191]
    buffer_load_dwordx4 v5, s[12:15], s39 offen offset:0 lds
    v_mfma_f32_16x16x32_bf16 v[244:247], v[34:37], v[180:183], v[244:247]
    buffer_load_dwordx4 v6, s[12:15], s39 offen offset:1024 lds
    v_mfma_f32_16x16x32_bf16 v[168:171], v[64:67], a[208:211], v[44:47]
    v_exp_f32 v164, v164
    v_mfma_f32_16x16x32_bf16 v[168:171], v[68:71], a[212:215], v[168:171]
    v_exp_f32 v165, v165
    v_mfma_f32_16x16x32_bf16 v[168:171], v[72:75], a[216:219], v[168:171]
    ds_read_b64_tr_b16 v[128:129], v26 offset:0
    v_cvt_pk_bf16_f32 v178, v164, v165
    v_mfma_f32_16x16x32_bf16 v[168:171], v[76:79], a[220:223], v[168:171]
    v_exp_f32 v166, v166
    v_mfma_f32_16x16x32_bf16 v[172:175], v[80:83], a[208:211], v[44:47]
    v_exp_f32 v167, v167
    v_mfma_f32_16x16x32_bf16 v[172:175], v[84:87], a[212:215], v[172:175]
    ds_read_b64_tr_b16 v[130:131], v26 offset:4096
    v_cvt_pk_bf16_f32 v179, v166, v167
    v_mfma_f32_16x16x32_bf16 v[172:175], v[88:91], a[216:219], v[172:175]
    buffer_load_dwordx4 v7, s[12:15], s39 offen offset:2048 lds
    v_mfma_f32_16x16x32_bf16 v[172:175], v[92:95], a[220:223], v[172:175]
    v_exp_f32 v168, v168
    v_mfma_f32_16x16x32_bf16 a[0:3], v[96:99], v[176:179], a[0:3]
    v_exp_f32 v169, v169
    v_mfma_f32_16x16x32_bf16 a[4:7], v[100:103], v[176:179], a[4:7]
    ds_read_b64_tr_b16 v[132:133], v27 offset:0
    v_cvt_pk_bf16_f32 v180, v168, v169
    v_mfma_f32_16x16x32_bf16 a[8:11], v[104:107], v[176:179], a[8:11]
    v_exp_f32 v170, v170
    v_mfma_f32_16x16x32_bf16 a[12:15], v[108:111], v[176:179], a[12:15]
    v_exp_f32 v171, v171
    v_mfma_f32_16x16x32_bf16 a[16:19], v[112:115], v[176:179], a[16:19]
    ds_read_b64_tr_b16 v[134:135], v27 offset:4096
    v_cvt_pk_bf16_f32 v181, v170, v171
    v_mfma_f32_16x16x32_bf16 a[20:23], v[116:119], v[176:179], a[20:23]
    buffer_load_dwordx4 v38, s[12:15], s39 offen offset:3072 lds
    s_mov_b32 s38, s85
    s_add_u32 s54, s85, 30720
    s_add_u32 m0, s41, 0
    v_mfma_f32_16x16x32_bf16 a[24:27], v[120:123], v[176:179], a[24:27]
    buffer_load_dwordx4 v2, s[8:11], s38 offen offset:0 lds
    v_mfma_f32_16x16x32_bf16 a[28:31], v[124:127], v[176:179], a[28:31]
    buffer_load_dwordx4 v3, s[8:11], s38 offen offset:1024 lds
    v_mfma_f32_16x16x32_bf16 v[208:211], v[34:37], v[176:179], v[208:211]
    buffer_load_dwordx4 v4, s[8:11], s38 offen offset:2048 lds
    v_mfma_f32_16x16x32_bf16 v[160:163], v[64:67], a[224:227], v[48:51]
    v_exp_f32 v172, v172
    v_mfma_f32_16x16x32_bf16 v[160:163], v[68:71], a[228:231], v[160:163]
    v_exp_f32 v173, v173
    v_mfma_f32_16x16x32_bf16 v[160:163], v[72:75], a[232:235], v[160:163]
    ds_read_b64_tr_b16 v[136:137], v28 offset:0
    v_cvt_pk_bf16_f32 v182, v172, v173
    v_mfma_f32_16x16x32_bf16 v[160:163], v[76:79], a[236:239], v[160:163]
    v_exp_f32 v174, v174
    v_mfma_f32_16x16x32_bf16 v[164:167], v[80:83], a[224:227], v[48:51]
    v_exp_f32 v175, v175
    v_mfma_f32_16x16x32_bf16 v[164:167], v[84:87], a[228:231], v[164:167]
    ds_read_b64_tr_b16 v[138:139], v28 offset:4096
    v_cvt_pk_bf16_f32 v183, v174, v175
    s_add_u32 m0, s41, 3072
    v_mfma_f32_16x16x32_bf16 v[164:167], v[88:91], a[232:235], v[164:167]
    buffer_load_dwordx4 v2, s[8:11], s54 offen offset:0 lds
    v_mfma_f32_16x16x32_bf16 v[164:167], v[92:95], a[236:239], v[164:167]
    v_exp_f32 v160, v160
    v_mfma_f32_16x16x32_bf16 a[32:35], v[96:99], v[180:183], a[32:35]
    v_exp_f32 v161, v161
    v_mfma_f32_16x16x32_bf16 a[36:39], v[100:103], v[180:183], a[36:39]
    ds_read_b64_tr_b16 v[140:141], v29 offset:0
    v_cvt_pk_bf16_f32 v176, v160, v161
    v_mfma_f32_16x16x32_bf16 a[40:43], v[104:107], v[180:183], a[40:43]
    v_exp_f32 v162, v162
    v_mfma_f32_16x16x32_bf16 a[44:47], v[108:111], v[180:183], a[44:47]
    v_exp_f32 v163, v163
    v_mfma_f32_16x16x32_bf16 a[48:51], v[112:115], v[180:183], a[48:51]
    ds_read_b64_tr_b16 v[142:143], v29 offset:4096
    v_cvt_pk_bf16_f32 v177, v162, v163
    v_mfma_f32_16x16x32_bf16 a[52:55], v[116:119], v[180:183], a[52:55]
    buffer_load_dwordx4 v3, s[8:11], s54 offen offset:1024 lds
    v_mfma_f32_16x16x32_bf16 a[56:59], v[120:123], v[180:183], a[56:59]
    buffer_load_dwordx4 v4, s[8:11], s54 offen offset:2048 lds
    s_mov_b32 s40, 4096
    s_add_u32 m0, s43, 135168
    v_mfma_f32_16x16x32_bf16 a[60:63], v[124:127], v[180:183], a[60:63]
    buffer_load_dwordx4 v8, s[16:19], s40 offen offset:0 nt lds
    v_mfma_f32_16x16x32_bf16 v[212:215], v[34:37], v[180:183], v[212:215]
    buffer_load_dwordx4 v9, s[16:19], s40 offen offset:1024 nt lds
    v_mfma_f32_16x16x32_bf16 v[168:171], v[64:67], a[240:243], v[52:55]
    v_exp_f32 v164, v164
    v_mfma_f32_16x16x32_bf16 v[168:171], v[68:71], a[244:247], v[168:171]
    v_exp_f32 v165, v165
    v_mfma_f32_16x16x32_bf16 v[168:171], v[72:75], a[248:251], v[168:171]
    ds_read_b64_tr_b16 v[144:145], v30 offset:0
    v_cvt_pk_bf16_f32 v178, v164, v165
    v_mfma_f32_16x16x32_bf16 v[168:171], v[76:79], a[252:255], v[168:171]
    v_exp_f32 v166, v166
    v_mfma_f32_16x16x32_bf16 v[172:175], v[80:83], a[240:243], v[52:55]
    v_exp_f32 v167, v167
    v_mfma_f32_16x16x32_bf16 v[172:175], v[84:87], a[244:247], v[172:175]
    ds_read_b64_tr_b16 v[146:147], v30 offset:4096
    v_cvt_pk_bf16_f32 v179, v166, v167
    v_mfma_f32_16x16x32_bf16 v[172:175], v[88:91], a[248:251], v[172:175]
    buffer_load_dwordx4 v8, s[16:19], s40 offen offset:2048 nt lds
    v_mfma_f32_16x16x32_bf16 v[172:175], v[92:95], a[252:255], v[172:175]
    v_exp_f32 v168, v168
    v_mfma_f32_16x16x32_bf16 a[64:67], v[96:99], v[176:179], a[64:67]
    v_exp_f32 v169, v169
    v_mfma_f32_16x16x32_bf16 a[68:71], v[100:103], v[176:179], a[68:71]
    ds_read_b64_tr_b16 v[148:149], v31 offset:0
    v_cvt_pk_bf16_f32 v180, v168, v169
    v_mfma_f32_16x16x32_bf16 a[72:75], v[104:107], v[176:179], a[72:75]
    v_exp_f32 v170, v170
    v_mfma_f32_16x16x32_bf16 a[76:79], v[108:111], v[176:179], a[76:79]
    v_exp_f32 v171, v171
    v_mfma_f32_16x16x32_bf16 a[80:83], v[112:115], v[176:179], a[80:83]
    ds_read_b64_tr_b16 v[150:151], v31 offset:4096
    v_cvt_pk_bf16_f32 v181, v170, v171
    v_mfma_f32_16x16x32_bf16 a[84:87], v[116:119], v[176:179], a[84:87]
    buffer_load_dwordx4 v9, s[16:19], s40 offen offset:3072 nt lds
    v_mfma_f32_16x16x32_bf16 a[88:91], v[120:123], v[176:179], a[88:91]
    buffer_load_dword v0, v255, s[12:15], s95 offen
    v_mfma_f32_16x16x32_bf16 a[92:95], v[124:127], v[176:179], a[92:95]
    v_lshlrev_b32 v254, 7, v1
    v_bfrev_b32 v255, 1
    v_mfma_f32_16x16x32_bf16 v[216:219], v[34:37], v[176:179], v[216:219]
    v_cmp_gt_u32 vcc, 5, v1
    v_mfma_f32_16x16x32_bf16 v[160:163], v[64:67], v[192:195], v[56:59]
    v_exp_f32 v172, v172
    v_mfma_f32_16x16x32_bf16 v[160:163], v[68:71], v[196:199], v[160:163]
    v_exp_f32 v173, v173
    v_mfma_f32_16x16x32_bf16 v[160:163], v[72:75], v[200:203], v[160:163]
    ds_read_b64_tr_b16 v[152:153], v32 offset:0
    v_cvt_pk_bf16_f32 v182, v172, v173
    v_mfma_f32_16x16x32_bf16 v[160:163], v[76:79], v[204:207], v[160:163]
    v_exp_f32 v174, v174
    v_mfma_f32_16x16x32_bf16 v[164:167], v[80:83], v[192:195], v[56:59]
    v_exp_f32 v175, v175
    v_mfma_f32_16x16x32_bf16 v[164:167], v[84:87], v[196:199], v[164:167]
    ds_read_b64_tr_b16 v[154:155], v32 offset:4096
    v_cvt_pk_bf16_f32 v183, v174, v175
    v_mfma_f32_16x16x32_bf16 v[164:167], v[88:91], v[200:203], v[164:167]
    v_cndmask_b32 v254, v255, v254, vcc
    v_mfma_f32_16x16x32_bf16 v[164:167], v[92:95], v[204:207], v[164:167]
    v_exp_f32 v160, v160
    v_mfma_f32_16x16x32_bf16 a[96:99], v[96:99], v[180:183], a[96:99]
    v_exp_f32 v161, v161
    v_mfma_f32_16x16x32_bf16 a[100:103], v[100:103], v[180:183], a[100:103]
    ds_read_b64_tr_b16 v[156:157], v33 offset:0
    v_cvt_pk_bf16_f32 v176, v160, v161
    v_mfma_f32_16x16x32_bf16 a[104:107], v[104:107], v[180:183], a[104:107]
    v_exp_f32 v162, v162
    v_mfma_f32_16x16x32_bf16 a[108:111], v[108:111], v[180:183], a[108:111]
    v_exp_f32 v163, v163
    v_mfma_f32_16x16x32_bf16 a[112:115], v[112:115], v[180:183], a[112:115]
    ds_read_b64_tr_b16 v[158:159], v33 offset:4096
    v_cvt_pk_bf16_f32 v177, v162, v163
    v_mfma_f32_16x16x32_bf16 a[116:119], v[116:119], v[180:183], a[116:119]
    buffer_load_dword v0, v254, s[64:67], s86 offen
    v_mfma_f32_16x16x32_bf16 a[120:123], v[120:123], v[180:183], a[120:123]
    v_mfma_f32_16x16x32_bf16 a[124:127], v[124:127], v[180:183], a[124:127]
    v_mfma_f32_16x16x32_bf16 v[220:223], v[34:37], v[180:183], v[220:223]
    v_mfma_f32_16x16x32_bf16 v[168:171], v[64:67], v[224:227], v[60:63]
    v_exp_f32 v164, v164
    v_mfma_f32_16x16x32_bf16 v[168:171], v[68:71], v[228:231], v[168:171]
    v_exp_f32 v165, v165
    v_mfma_f32_16x16x32_bf16 v[168:171], v[72:75], v[232:235], v[168:171]
    ds_read_b128 v[64:67], v14 offset:0
    v_cvt_pk_bf16_f32 v178, v164, v165
    v_mfma_f32_16x16x32_bf16 v[168:171], v[76:79], v[236:239], v[168:171]
    v_exp_f32 v166, v166
    v_mfma_f32_16x16x32_bf16 v[172:175], v[80:83], v[224:227], v[60:63]
    v_exp_f32 v167, v167
    v_mfma_f32_16x16x32_bf16 v[172:175], v[84:87], v[228:231], v[172:175]
    ds_read_b128 v[68:71], v15 offset:0
    v_cvt_pk_bf16_f32 v179, v166, v167
    v_mfma_f32_16x16x32_bf16 v[172:175], v[88:91], v[232:235], v[172:175]
    ds_read_b128 v[72:75], v16 offset:0
    v_mfma_f32_16x16x32_bf16 v[172:175], v[92:95], v[236:239], v[172:175]
    v_exp_f32 v168, v168
    v_mfma_f32_16x16x32_bf16 a[128:131], v[96:99], v[176:179], a[128:131]
    v_exp_f32 v169, v169
    v_mfma_f32_16x16x32_bf16 a[132:135], v[100:103], v[176:179], a[132:135]
    ds_read_b128 v[76:79], v17 offset:0
    v_cvt_pk_bf16_f32 v180, v168, v169
    v_mfma_f32_16x16x32_bf16 a[136:139], v[104:107], v[176:179], a[136:139]
    v_exp_f32 v170, v170
    v_mfma_f32_16x16x32_bf16 a[140:143], v[108:111], v[176:179], a[140:143]
    v_exp_f32 v171, v171
    v_mfma_f32_16x16x32_bf16 a[144:147], v[112:115], v[176:179], a[144:147]
    ds_read_b128 v[80:83], v14 offset:4096
    v_cvt_pk_bf16_f32 v181, v170, v171
    v_mfma_f32_16x16x32_bf16 a[148:151], v[116:119], v[176:179], a[148:151]
    ds_read_b128 v[84:87], v15 offset:4096
    v_mfma_f32_16x16x32_bf16 a[152:155], v[120:123], v[176:179], a[152:155]
    ds_read_b128 v[88:91], v16 offset:4096
    v_mfma_f32_16x16x32_bf16 a[156:159], v[124:127], v[176:179], a[156:159]
    ds_read_b128 v[92:95], v17 offset:4096
    v_mfma_f32_16x16x32_bf16 v[240:243], v[34:37], v[176:179], v[240:243]
    s_waitcnt lgkmcnt(6)
    v_mfma_f32_16x16x32_bf16 v[160:163], v[64:67], a[192:195], v[40:43]
    v_exp_f32 v172, v172
    v_mfma_f32_16x16x32_bf16 v[160:163], v[68:71], a[196:199], v[160:163]
    s_waitcnt lgkmcnt(4)
    v_exp_f32 v173, v173
    v_mfma_f32_16x16x32_bf16 v[160:163], v[72:75], a[200:203], v[160:163]
    v_cvt_pk_bf16_f32 v182, v172, v173
    v_mfma_f32_16x16x32_bf16 v[160:163], v[76:79], a[204:207], v[160:163]
    s_waitcnt lgkmcnt(2)
    v_exp_f32 v174, v174
    v_mfma_f32_16x16x32_bf16 v[164:167], v[80:83], a[192:195], v[40:43]
    v_exp_f32 v175, v175
    v_mfma_f32_16x16x32_bf16 v[164:167], v[84:87], a[196:199], v[164:167]
    s_waitcnt lgkmcnt(0)
    v_cvt_pk_bf16_f32 v183, v174, v175
    v_mfma_f32_16x16x32_bf16 v[164:167], v[88:91], a[200:203], v[164:167]
    v_mfma_f32_16x16x32_bf16 v[164:167], v[92:95], a[204:207], v[164:167]
    v_exp_f32 v160, v160
    v_mfma_f32_16x16x32_bf16 a[160:163], v[96:99], v[180:183], a[160:163]
    v_exp_f32 v161, v161
    v_mfma_f32_16x16x32_bf16 a[164:167], v[100:103], v[180:183], a[164:167]
    v_cvt_pk_bf16_f32 v176, v160, v161
    v_mfma_f32_16x16x32_bf16 a[168:171], v[104:107], v[180:183], a[168:171]
    v_exp_f32 v162, v162
    v_mfma_f32_16x16x32_bf16 a[172:175], v[108:111], v[180:183], a[172:175]
    v_exp_f32 v163, v163
    v_mfma_f32_16x16x32_bf16 a[176:179], v[112:115], v[180:183], a[176:179]
    v_cvt_pk_bf16_f32 v177, v162, v163
    v_mfma_f32_16x16x32_bf16 a[180:183], v[116:119], v[180:183], a[180:183]
    s_barrier
    v_mfma_f32_16x16x32_bf16 a[184:187], v[120:123], v[180:183], a[184:187]
    s_mov_b32 s39, s71
    s_add_u32 m0, s42, 65536
    v_mfma_f32_16x16x32_bf16 a[188:191], v[124:127], v[180:183], a[188:191]
    buffer_load_dwordx4 v5, s[12:15], s39 offen offset:0 lds
    v_mfma_f32_16x16x32_bf16 v[244:247], v[34:37], v[180:183], v[244:247]
    v_mfma_f32_16x16x32_bf16 v[168:171], v[64:67], a[208:211], v[44:47]
    v_exp_f32 v164, v164
    v_mfma_f32_16x16x32_bf16 v[168:171], v[68:71], a[212:215], v[168:171]
    v_exp_f32 v165, v165
    v_mfma_f32_16x16x32_bf16 v[168:171], v[72:75], a[216:219], v[168:171]
    v_cvt_pk_bf16_f32 v178, v164, v165
    v_mfma_f32_16x16x32_bf16 v[168:171], v[76:79], a[220:223], v[168:171]
    v_exp_f32 v166, v166
    v_mfma_f32_16x16x32_bf16 v[172:175], v[80:83], a[208:211], v[44:47]
    v_exp_f32 v167, v167
    v_mfma_f32_16x16x32_bf16 v[172:175], v[84:87], a[212:215], v[172:175]
    v_cvt_pk_bf16_f32 v179, v166, v167
    v_mfma_f32_16x16x32_bf16 v[172:175], v[88:91], a[216:219], v[172:175]
    v_mfma_f32_16x16x32_bf16 v[172:175], v[92:95], a[220:223], v[172:175]
    v_exp_f32 v168, v168
    v_mfma_f32_16x16x32_bf16 a[0:3], v[128:131], v[176:179], a[0:3]
    v_exp_f32 v169, v169
    v_mfma_f32_16x16x32_bf16 a[4:7], v[132:135], v[176:179], a[4:7]
    v_cvt_pk_bf16_f32 v180, v168, v169
    v_mfma_f32_16x16x32_bf16 a[8:11], v[136:139], v[176:179], a[8:11]
    v_exp_f32 v170, v170
    v_mfma_f32_16x16x32_bf16 a[12:15], v[140:143], v[176:179], a[12:15]
    v_exp_f32 v171, v171
    v_mfma_f32_16x16x32_bf16 a[16:19], v[144:147], v[176:179], a[16:19]
    v_cvt_pk_bf16_f32 v181, v170, v171
    v_mfma_f32_16x16x32_bf16 a[20:23], v[148:151], v[176:179], a[20:23]
    v_mfma_f32_16x16x32_bf16 a[24:27], v[152:155], v[176:179], a[24:27]
    s_add_u32 m0, s42, 65536
    v_mfma_f32_16x16x32_bf16 a[28:31], v[156:159], v[176:179], a[28:31]
    buffer_load_dwordx4 v6, s[12:15], s39 offen offset:1024 lds
    v_mfma_f32_16x16x32_bf16 v[208:211], v[34:37], v[176:179], v[208:211]
    v_mfma_f32_16x16x32_bf16 v[160:163], v[64:67], a[224:227], v[48:51]
    v_exp_f32 v172, v172
    v_mfma_f32_16x16x32_bf16 v[160:163], v[68:71], a[228:231], v[160:163]
    v_exp_f32 v173, v173
    v_mfma_f32_16x16x32_bf16 v[160:163], v[72:75], a[232:235], v[160:163]
    v_cvt_pk_bf16_f32 v182, v172, v173
    v_mfma_f32_16x16x32_bf16 v[160:163], v[76:79], a[236:239], v[160:163]
    v_exp_f32 v174, v174
    v_mfma_f32_16x16x32_bf16 v[164:167], v[80:83], a[224:227], v[48:51]
    v_exp_f32 v175, v175
    v_mfma_f32_16x16x32_bf16 v[164:167], v[84:87], a[228:231], v[164:167]
    v_cvt_pk_bf16_f32 v183, v174, v175
    v_mfma_f32_16x16x32_bf16 v[164:167], v[88:91], a[232:235], v[164:167]
    v_mfma_f32_16x16x32_bf16 v[164:167], v[92:95], a[236:239], v[164:167]
    v_exp_f32 v160, v160
    v_mfma_f32_16x16x32_bf16 a[32:35], v[128:131], v[180:183], a[32:35]
    v_exp_f32 v161, v161
    v_mfma_f32_16x16x32_bf16 a[36:39], v[132:135], v[180:183], a[36:39]
    v_cvt_pk_bf16_f32 v176, v160, v161
    v_mfma_f32_16x16x32_bf16 a[40:43], v[136:139], v[180:183], a[40:43]
    v_exp_f32 v162, v162
    v_mfma_f32_16x16x32_bf16 a[44:47], v[140:143], v[180:183], a[44:47]
    v_exp_f32 v163, v163
    v_mfma_f32_16x16x32_bf16 a[48:51], v[144:147], v[180:183], a[48:51]
    v_cvt_pk_bf16_f32 v177, v162, v163
    v_mfma_f32_16x16x32_bf16 a[52:55], v[148:151], v[180:183], a[52:55]
    v_mfma_f32_16x16x32_bf16 a[56:59], v[152:155], v[180:183], a[56:59]
    s_add_u32 m0, s42, 65536
    v_mfma_f32_16x16x32_bf16 a[60:63], v[156:159], v[180:183], a[60:63]
    buffer_load_dwordx4 v7, s[12:15], s39 offen offset:2048 lds
    v_mfma_f32_16x16x32_bf16 v[212:215], v[34:37], v[180:183], v[212:215]
    v_mfma_f32_16x16x32_bf16 v[168:171], v[64:67], a[240:243], v[52:55]
    v_exp_f32 v164, v164
    v_mfma_f32_16x16x32_bf16 v[168:171], v[68:71], a[244:247], v[168:171]
    v_exp_f32 v165, v165
    v_mfma_f32_16x16x32_bf16 v[168:171], v[72:75], a[248:251], v[168:171]
    v_cvt_pk_bf16_f32 v178, v164, v165
    v_mfma_f32_16x16x32_bf16 v[168:171], v[76:79], a[252:255], v[168:171]
    v_exp_f32 v166, v166
    v_mfma_f32_16x16x32_bf16 v[172:175], v[80:83], a[240:243], v[52:55]
    v_exp_f32 v167, v167
    v_mfma_f32_16x16x32_bf16 v[172:175], v[84:87], a[244:247], v[172:175]
    v_cvt_pk_bf16_f32 v179, v166, v167
    v_mfma_f32_16x16x32_bf16 v[172:175], v[88:91], a[248:251], v[172:175]
    v_mfma_f32_16x16x32_bf16 v[172:175], v[92:95], a[252:255], v[172:175]
    v_exp_f32 v168, v168
    v_mfma_f32_16x16x32_bf16 a[64:67], v[128:131], v[176:179], a[64:67]
    v_exp_f32 v169, v169
    v_mfma_f32_16x16x32_bf16 a[68:71], v[132:135], v[176:179], a[68:71]
    v_cvt_pk_bf16_f32 v180, v168, v169
    v_mfma_f32_16x16x32_bf16 a[72:75], v[136:139], v[176:179], a[72:75]
    v_exp_f32 v170, v170
    v_mfma_f32_16x16x32_bf16 a[76:79], v[140:143], v[176:179], a[76:79]
    v_exp_f32 v171, v171
    v_mfma_f32_16x16x32_bf16 a[80:83], v[144:147], v[176:179], a[80:83]
    v_cvt_pk_bf16_f32 v181, v170, v171
    v_mfma_f32_16x16x32_bf16 a[84:87], v[148:151], v[176:179], a[84:87]
    v_mfma_f32_16x16x32_bf16 a[88:91], v[152:155], v[176:179], a[88:91]
    s_add_u32 m0, s42, 65536
    v_mfma_f32_16x16x32_bf16 a[92:95], v[156:159], v[176:179], a[92:95]
    buffer_load_dwordx4 v38, s[12:15], s39 offen offset:3072 lds
    v_mfma_f32_16x16x32_bf16 v[216:219], v[34:37], v[176:179], v[216:219]
    v_mfma_f32_16x16x32_bf16 v[160:163], v[64:67], v[192:195], v[56:59]
    v_exp_f32 v172, v172
    v_mfma_f32_16x16x32_bf16 v[160:163], v[68:71], v[196:199], v[160:163]
    v_exp_f32 v173, v173
    v_mfma_f32_16x16x32_bf16 v[160:163], v[72:75], v[200:203], v[160:163]
    v_cvt_pk_bf16_f32 v182, v172, v173
    v_mfma_f32_16x16x32_bf16 v[160:163], v[76:79], v[204:207], v[160:163]
    v_exp_f32 v174, v174
    v_mfma_f32_16x16x32_bf16 v[164:167], v[80:83], v[192:195], v[56:59]
    v_exp_f32 v175, v175
    v_mfma_f32_16x16x32_bf16 v[164:167], v[84:87], v[196:199], v[164:167]
    v_cvt_pk_bf16_f32 v183, v174, v175
    v_mfma_f32_16x16x32_bf16 v[164:167], v[88:91], v[200:203], v[164:167]
    v_mfma_f32_16x16x32_bf16 v[164:167], v[92:95], v[204:207], v[164:167]
    v_exp_f32 v160, v160
    v_mfma_f32_16x16x32_bf16 a[96:99], v[128:131], v[180:183], a[96:99]
    v_exp_f32 v161, v161
    v_mfma_f32_16x16x32_bf16 a[100:103], v[132:135], v[180:183], a[100:103]
    v_cvt_pk_bf16_f32 v176, v160, v161
    v_mfma_f32_16x16x32_bf16 a[104:107], v[136:139], v[180:183], a[104:107]
    v_exp_f32 v162, v162
    v_mfma_f32_16x16x32_bf16 a[108:111], v[140:143], v[180:183], a[108:111]
    v_exp_f32 v163, v163
    v_mfma_f32_16x16x32_bf16 a[112:115], v[144:147], v[180:183], a[112:115]
    v_cvt_pk_bf16_f32 v177, v162, v163
    v_mfma_f32_16x16x32_bf16 a[116:119], v[148:151], v[180:183], a[116:119]
    v_mfma_f32_16x16x32_bf16 a[120:123], v[152:155], v[180:183], a[120:123]
    v_mfma_f32_16x16x32_bf16 a[124:127], v[156:159], v[180:183], a[124:127]
    v_mfma_f32_16x16x32_bf16 v[220:223], v[34:37], v[180:183], v[220:223]
    v_mfma_f32_16x16x32_bf16 v[168:171], v[64:67], v[224:227], v[60:63]
    v_exp_f32 v164, v164
    v_mfma_f32_16x16x32_bf16 v[168:171], v[68:71], v[228:231], v[168:171]
    v_exp_f32 v165, v165
    v_mfma_f32_16x16x32_bf16 v[168:171], v[72:75], v[232:235], v[168:171]
    v_cvt_pk_bf16_f32 v178, v164, v165
    v_mfma_f32_16x16x32_bf16 v[168:171], v[76:79], v[236:239], v[168:171]
    v_exp_f32 v166, v166
    v_mfma_f32_16x16x32_bf16 v[172:175], v[80:83], v[224:227], v[60:63]
    v_exp_f32 v167, v167
    v_mfma_f32_16x16x32_bf16 v[172:175], v[84:87], v[228:231], v[172:175]
    v_cvt_pk_bf16_f32 v179, v166, v167
    v_mfma_f32_16x16x32_bf16 v[172:175], v[88:91], v[232:235], v[172:175]
    v_mfma_f32_16x16x32_bf16 v[172:175], v[92:95], v[236:239], v[172:175]
    v_exp_f32 v168, v168
    v_mfma_f32_16x16x32_bf16 a[128:131], v[128:131], v[176:179], a[128:131]
    v_exp_f32 v169, v169
    v_mfma_f32_16x16x32_bf16 a[132:135], v[132:135], v[176:179], a[132:135]
    v_cvt_pk_bf16_f32 v180, v168, v169
    v_mfma_f32_16x16x32_bf16 a[136:139], v[136:139], v[176:179], a[136:139]
    v_exp_f32 v170, v170
    v_mfma_f32_16x16x32_bf16 a[140:143], v[140:143], v[176:179], a[140:143]
    v_exp_f32 v171, v171
    v_mfma_f32_16x16x32_bf16 a[144:147], v[144:147], v[176:179], a[144:147]
    v_cvt_pk_bf16_f32 v181, v170, v171
    v_mfma_f32_16x16x32_bf16 a[148:151], v[148:151], v[176:179], a[148:151]
    v_mfma_f32_16x16x32_bf16 a[152:155], v[152:155], v[176:179], a[152:155]
    v_mfma_f32_16x16x32_bf16 a[156:159], v[156:159], v[176:179], a[156:159]
    v_mfma_f32_16x16x32_bf16 v[240:243], v[34:37], v[176:179], v[240:243]
    v_exp_f32 v172, v172
    v_exp_f32 v173, v173
    v_exp_f32 v174, v174
    v_exp_f32 v175, v175
    v_cvt_pk_bf16_f32 v182, v172, v173
    v_cvt_pk_bf16_f32 v183, v174, v175
    s_nop 1
    v_mfma_f32_16x16x32_bf16 a[160:163], v[128:131], v[180:183], a[160:163]
    v_mfma_f32_16x16x32_bf16 a[164:167], v[132:135], v[180:183], a[164:167]
    v_mfma_f32_16x16x32_bf16 a[168:171], v[136:139], v[180:183], a[168:171]
    v_mfma_f32_16x16x32_bf16 a[172:175], v[140:143], v[180:183], a[172:175]
    v_mfma_f32_16x16x32_bf16 a[176:179], v[144:147], v[180:183], a[176:179]
    v_mfma_f32_16x16x32_bf16 a[180:183], v[148:151], v[180:183], a[180:183]
    v_mfma_f32_16x16x32_bf16 a[184:187], v[152:155], v[180:183], a[184:187]
    v_mfma_f32_16x16x32_bf16 a[188:191], v[156:159], v[180:183], a[188:191]
    v_mfma_f32_16x16x32_bf16 v[244:247], v[34:37], v[180:183], v[244:247]
    s_mov_b32 s52, 0x4e800000
    v_add_f32 v185, v208, v212
    v_add_f32 v186, v216, v220
    v_add_f32 v185, v185, v240
    v_add_f32 v185, v185, v186
    s_nop 5
    v_add_f32 v185, v185, v244
    v_cmp_nge_f32 vcc, s52, v185
    s_nop 4
    s_cbranch_vccnz L_slow
L_slowret:
    v_rcp_f32 v58, v208
    v_rcp_f32 v59, v212
    v_rcp_f32 v60, v216
    v_rcp_f32 v61, v220
    v_rcp_f32 v62, v240
    v_rcp_f32 v63, v244
    s_mov_b32 s7, 1
    v_lshlrev_b32 v57, 4, v1
    v_lshrrev_b32 v47, 4, v1
    v_and_b32 v48, 6, v1
    v_xor_b32 v48, v48, v47
    v_lshlrev_b32 v48, 4, v48
    v_and_b32 v49, 15, v1
    v_lshl_add_u32 v48, v49, 7, v48
    s_lshl_b32 s52, s6, 15
    s_add_u32 s52, s52, 16384
    v_add_u32 v40, s52, v48
    v_bfe_u32 v48, v1, 2, 2
    v_and_b32 v49, 3, v1
    v_lshl_add_u32 v49, v48, 2, v49
    v_lshlrev_b32 v49, 4, v49
    v_lshl_add_u32 v48, v47, 3, v48
    v_lshl_add_u32 v49, v48, 8, v49
    s_lshl_b32 s52, s5, 13
    v_add_u32 v41, s52, v49
    v_xor_b32 v42, 64, v41
    v_xor_b32 v43, 128, v41
    v_xor_b32 v44, 192, v41
    s_mov_b32 s40, 8192
    s_waitcnt vmcnt(10)
    s_barrier
    ds_read_b64_tr_b16 a[240:241], v41 offset:0
    ds_read_b64_tr_b16 a[242:243], v41 offset:1024
    ds_read_b64_tr_b16 a[244:245], v41 offset:8
    ds_read_b64_tr_b16 a[246:247], v41 offset:1032
    ds_read_b64_tr_b16 a[248:249], v42 offset:0
    ds_read_b64_tr_b16 a[250:251], v42 offset:1024
    ds_read_b128 a[192:195], v40 offset:0
    ds_read_b128 a[196:199], v40 offset:2048
    ds_read_b128 a[200:203], v40 offset:4096
    ds_read_b128 a[204:207], v40 offset:6144
    ds_read_b128 a[208:211], v40 offset:8192
    ds_read_b128 a[212:215], v40 offset:10240
    s_add_u32 s38, s92, 0
    s_add_u32 m0, s41, 65536
    s_nop 0
    buffer_load_dwordx4 v2, s[8:11], s38 offen offset:0 lds
    buffer_load_dwordx4 v3, s[8:11], s38 offen offset:1024 lds
    buffer_load_dwordx4 v4, s[8:11], s38 offen offset:2048 lds
    s_mov_b32 s39, s101
    s_waitcnt lgkmcnt(4)
    v_mfma_f32_16x16x32_bf16 v[64:67], a[240:243], a[192:195], 0
    s_waitcnt lgkmcnt(2)
    s_add_u32 s54, s38, 30720
    v_mfma_f32_16x16x32_bf16 v[96:99], a[240:243], a[196:199], 0
    ds_read_b64_tr_b16 a[252:253], v42 offset:8
    v_mfma_f32_16x16x32_bf16 v[128:131], a[240:243], a[200:203], 0
    ds_read_b64_tr_b16 a[254:255], v42 offset:1032
    s_add_u32 m0, s41, 68608
    v_mfma_f32_16x16x32_bf16 v[160:163], a[240:243], a[204:207], 0
    s_waitcnt lgkmcnt(2)
    buffer_load_dwordx4 v2, s[8:11], s54 offen offset:0 lds
    v_mfma_f32_16x16x32_bf16 v[192:195], a[240:243], a[208:211], 0
    v_mfma_f32_16x16x32_bf16 v[224:227], a[240:243], a[212:215], 0
    v_mfma_f32_16x16x32_bf16 v[68:71], a[244:247], a[192:195], 0
    v_mfma_f32_16x16x32_bf16 v[100:103], a[244:247], a[196:199], 0
    ds_read_b64_tr_b16 a[240:241], v43 offset:0
    v_mfma_f32_16x16x32_bf16 v[132:135], a[244:247], a[200:203], 0
    ds_read_b64_tr_b16 a[242:243], v43 offset:1024
    s_add_u32 m0, s41, 68608
    v_mfma_f32_16x16x32_bf16 v[164:167], a[244:247], a[204:207], 0
    buffer_load_dwordx4 v3, s[8:11], s54 offen offset:1024 lds
    v_mfma_f32_16x16x32_bf16 v[196:199], a[244:247], a[208:211], 0
    v_mfma_f32_16x16x32_bf16 v[228:231], a[244:247], a[212:215], 0
    v_mfma_f32_16x16x32_bf16 v[72:75], a[248:251], a[192:195], 0
    v_mfma_f32_16x16x32_bf16 v[104:107], a[248:251], a[196:199], 0
    ds_read_b64_tr_b16 a[244:245], v43 offset:8
    v_mfma_f32_16x16x32_bf16 v[136:139], a[248:251], a[200:203], 0
    ds_read_b64_tr_b16 a[246:247], v43 offset:1032
    s_add_u32 m0, s41, 68608
    v_mfma_f32_16x16x32_bf16 v[168:171], a[248:251], a[204:207], 0
    buffer_load_dwordx4 v4, s[8:11], s54 offen offset:2048 lds
    v_mfma_f32_16x16x32_bf16 v[200:203], a[248:251], a[208:211], 0
    s_add_u32 s38, s38, 128
    v_mfma_f32_16x16x32_bf16 v[232:235], a[248:251], a[212:215], 0
    s_waitcnt lgkmcnt(4)
    s_cmp_eq_u32 s38, 1280
    s_cselect_b32 s38, 0, s38
    v_mfma_f32_16x16x32_bf16 v[76:79], a[252:255], a[192:195], 0
    v_mfma_f32_16x16x32_bf16 v[108:111], a[252:255], a[196:199], 0
    ds_read_b64_tr_b16 a[248:249], v44 offset:0
    v_mfma_f32_16x16x32_bf16 v[140:143], a[252:255], a[200:203], 0
    ds_read_b64_tr_b16 a[250:251], v44 offset:1024
    s_add_u32 m0, s42, 98304
    v_mfma_f32_16x16x32_bf16 v[172:175], a[252:255], a[204:207], 0
    buffer_load_dwordx4 v5, s[12:15], s39 offen offset:0 lds
    v_mfma_f32_16x16x32_bf16 v[204:207], a[252:255], a[208:211], 0
    v_mfma_f32_16x16x32_bf16 v[236:239], a[252:255], a[212:215], 0
    s_waitcnt lgkmcnt(4)
    v_mfma_f32_16x16x32_bf16 v[80:83], a[240:243], a[192:195], 0
    v_mfma_f32_16x16x32_bf16 v[112:115], a[240:243], a[196:199], 0
    ds_read_b64_tr_b16 a[252:253], v44 offset:8
    v_mfma_f32_16x16x32_bf16 v[144:147], a[240:243], a[200:203], 0
    ds_read_b64_tr_b16 a[254:255], v44 offset:1032
    v_xor_b32 v40, 0x40, v40
    v_mfma_f32_16x16x32_bf16 v[176:179], a[240:243], a[204:207], 0
    v_add_u32 v41, 0x8000, v41
    v_add_u32 v42, 0x8000, v42
    v_mfma_f32_16x16x32_bf16 v[208:211], a[240:243], a[208:211], 0
    v_add_u32 v43, 0x8000, v43
    v_mfma_f32_16x16x32_bf16 v[240:243], a[240:243], a[212:215], 0
    s_waitcnt lgkmcnt(4)
    v_add_u32 v44, 0x8000, v44
    v_mfma_f32_16x16x32_bf16 v[84:87], a[244:247], a[192:195], 0
    v_mfma_f32_16x16x32_bf16 v[116:119], a[244:247], a[196:199], 0
    s_waitcnt lgkmcnt(0)
    s_barrier
    v_mfma_f32_16x16x32_bf16 v[148:151], a[244:247], a[200:203], 0
    ds_read_b64_tr_b16 a[240:241], v41 offset:0
    v_mfma_f32_16x16x32_bf16 v[180:183], a[244:247], a[204:207], 0
    ds_read_b64_tr_b16 a[242:243], v41 offset:1024
    v_mfma_f32_16x16x32_bf16 v[212:215], a[244:247], a[208:211], 0
    ds_read_b128 a[216:219], v40 offset:0
    s_add_u32 m0, s42, 98304
    v_mfma_f32_16x16x32_bf16 v[244:247], a[244:247], a[212:215], 0
    buffer_load_dwordx4 v6, s[12:15], s39 offen offset:1024 lds
    v_mfma_f32_16x16x32_bf16 v[88:91], a[248:251], a[192:195], 0
    ds_read_b64_tr_b16 a[244:245], v41 offset:8
    v_mfma_f32_16x16x32_bf16 v[120:123], a[248:251], a[196:199], 0
    ds_read_b64_tr_b16 a[246:247], v41 offset:1032
    v_mfma_f32_16x16x32_bf16 v[152:155], a[248:251], a[200:203], 0
    ds_read_b128 a[220:223], v40 offset:2048
    v_mfma_f32_16x16x32_bf16 v[184:187], a[248:251], a[204:207], 0
    ds_read_b128 a[224:227], v40 offset:4096
    v_mfma_f32_16x16x32_bf16 v[216:219], a[248:251], a[208:211], 0
    ds_read_b128 a[228:231], v40 offset:6144
    s_add_u32 m0, s42, 98304
    v_mfma_f32_16x16x32_bf16 v[248:251], a[248:251], a[212:215], 0
    buffer_load_dwordx4 v7, s[12:15], s39 offen offset:2048 lds
    v_mfma_f32_16x16x32_bf16 v[92:95], a[252:255], a[192:195], 0
    ds_read_b64_tr_b16 a[248:249], v42 offset:0
    v_mfma_f32_16x16x32_bf16 v[124:127], a[252:255], a[196:199], 0
    ds_read_b64_tr_b16 a[250:251], v42 offset:1024
    v_mfma_f32_16x16x32_bf16 v[156:159], a[252:255], a[200:203], 0
    ds_read_b128 a[232:235], v40 offset:8192
    v_mfma_f32_16x16x32_bf16 v[188:191], a[252:255], a[204:207], 0
    ds_read_b128 a[236:239], v40 offset:10240
    v_mfma_f32_16x16x32_bf16 v[220:223], a[252:255], a[208:211], 0
    s_add_u32 m0, s42, 98304
    s_waitcnt lgkmcnt(6)
    v_mfma_f32_16x16x32_bf16 v[252:255], a[252:255], a[212:215], 0
    buffer_load_dwordx4 v38, s[12:15], s39 offen offset:3072 lds
    v_mfma_f32_16x16x32_bf16 v[64:67], a[240:243], a[216:219], v[64:67]
    s_waitcnt lgkmcnt(4)
    s_add_u32 s39, s39, 262144
    v_mfma_f32_16x16x32_bf16 v[96:99], a[240:243], a[220:223], v[96:99]
    ds_read_b64_tr_b16 a[252:253], v42 offset:8
    s_cmp_eq_u32 s39, 5242880
    s_cselect_b32 s39, 0, s39
    v_mfma_f32_16x16x32_bf16 v[128:131], a[240:243], a[224:227], v[128:131]
    ds_read_b64_tr_b16 a[254:255], v42 offset:1032
    s_add_u32 m0, s42, 0
    v_mfma_f32_16x16x32_bf16 v[160:163], a[240:243], a[228:231], v[160:163]
    s_waitcnt lgkmcnt(2)
    buffer_load_dwordx4 v5, s[12:15], s39 offen offset:0 lds
    v_mfma_f32_16x16x32_bf16 v[192:195], a[240:243], a[232:235], v[192:195]
    v_mfma_f32_16x16x32_bf16 v[224:227], a[240:243], a[236:239], v[224:227]
    v_mfma_f32_16x16x32_bf16 v[68:71], a[244:247], a[216:219], v[68:71]
    v_mfma_f32_16x16x32_bf16 v[100:103], a[244:247], a[220:223], v[100:103]
    ds_read_b64_tr_b16 a[240:241], v43 offset:0
    v_mfma_f32_16x16x32_bf16 v[132:135], a[244:247], a[224:227], v[132:135]
    ds_read_b64_tr_b16 a[242:243], v43 offset:1024
    s_add_u32 m0, s42, 0
    v_mfma_f32_16x16x32_bf16 v[164:167], a[244:247], a[228:231], v[164:167]
    buffer_load_dwordx4 v6, s[12:15], s39 offen offset:1024 lds
    v_mfma_f32_16x16x32_bf16 v[196:199], a[244:247], a[232:235], v[196:199]
    v_mfma_f32_16x16x32_bf16 v[228:231], a[244:247], a[236:239], v[228:231]
    v_mfma_f32_16x16x32_bf16 v[72:75], a[248:251], a[216:219], v[72:75]
    v_mfma_f32_16x16x32_bf16 v[104:107], a[248:251], a[220:223], v[104:107]
    ds_read_b64_tr_b16 a[244:245], v43 offset:8
    v_mfma_f32_16x16x32_bf16 v[136:139], a[248:251], a[224:227], v[136:139]
    ds_read_b64_tr_b16 a[246:247], v43 offset:1032
    s_add_u32 m0, s42, 0
    v_mfma_f32_16x16x32_bf16 v[168:171], a[248:251], a[228:231], v[168:171]
    buffer_load_dwordx4 v7, s[12:15], s39 offen offset:2048 lds
    v_mfma_f32_16x16x32_bf16 v[200:203], a[248:251], a[232:235], v[200:203]
    v_mfma_f32_16x16x32_bf16 v[232:235], a[248:251], a[236:239], v[232:235]
    s_waitcnt lgkmcnt(4)
    v_mfma_f32_16x16x32_bf16 v[76:79], a[252:255], a[216:219], v[76:79]
    v_mfma_f32_16x16x32_bf16 v[108:111], a[252:255], a[220:223], v[108:111]
    ds_read_b64_tr_b16 a[248:249], v44 offset:0
    v_mfma_f32_16x16x32_bf16 v[140:143], a[252:255], a[224:227], v[140:143]
    ds_read_b64_tr_b16 a[250:251], v44 offset:1024
    s_add_u32 m0, s42, 0
    v_mfma_f32_16x16x32_bf16 v[172:175], a[252:255], a[228:231], v[172:175]
    buffer_load_dwordx4 v38, s[12:15], s39 offen offset:3072 lds
    v_mfma_f32_16x16x32_bf16 v[204:207], a[252:255], a[232:235], v[204:207]
    s_add_u32 s39, s39, 262144
    v_mfma_f32_16x16x32_bf16 v[236:239], a[252:255], a[236:239], v[236:239]
    s_waitcnt lgkmcnt(4)
    s_cmp_eq_u32 s39, 5242880
    s_cselect_b32 s39, 0, s39
    v_mfma_f32_16x16x32_bf16 v[80:83], a[240:243], a[216:219], v[80:83]
    v_mfma_f32_16x16x32_bf16 v[112:115], a[240:243], a[220:223], v[112:115]
    ds_read_b64_tr_b16 a[252:253], v44 offset:8
    v_mfma_f32_16x16x32_bf16 v[144:147], a[240:243], a[224:227], v[144:147]
    ds_read_b64_tr_b16 a[254:255], v44 offset:1032
    v_xor_b32 v40, 0x10040, v40
    v_mfma_f32_16x16x32_bf16 v[176:179], a[240:243], a[228:231], v[176:179]
    v_add_u32 v41, 0x8000, v41
    v_add_u32 v42, 0x8000, v42
    v_mfma_f32_16x16x32_bf16 v[208:211], a[240:243], a[232:235], v[208:211]
    v_add_u32 v43, 0x8000, v43
    v_mfma_f32_16x16x32_bf16 v[240:243], a[240:243], a[236:239], v[240:243]
    s_waitcnt vmcnt(8)
    s_waitcnt lgkmcnt(4)
    v_add_u32 v44, 0x8000, v44
    v_mfma_f32_16x16x32_bf16 v[84:87], a[244:247], a[216:219], v[84:87]
    v_mfma_f32_16x16x32_bf16 v[116:119], a[244:247], a[220:223], v[116:119]
    s_waitcnt lgkmcnt(0)
    s_barrier
    v_mfma_f32_16x16x32_bf16 v[148:151], a[244:247], a[224:227], v[148:151]
    ds_read_b64_tr_b16 a[240:241], v41 offset:0
    v_mfma_f32_16x16x32_bf16 v[180:183], a[244:247], a[228:231], v[180:183]
    ds_read_b64_tr_b16 a[242:243], v41 offset:1024
    v_mfma_f32_16x16x32_bf16 v[212:215], a[244:247], a[232:235], v[212:215]
    ds_read_b128 a[192:195], v40 offset:0
    s_add_u32 m0, s41, 0
    v_mfma_f32_16x16x32_bf16 v[244:247], a[244:247], a[236:239], v[244:247]
    buffer_load_dwordx4 v2, s[8:11], s38 offen offset:0 lds
    v_mfma_f32_16x16x32_bf16 v[88:91], a[248:251], a[216:219], v[88:91]
    ds_read_b64_tr_b16 a[244:245], v41 offset:8
    v_mfma_f32_16x16x32_bf16 v[120:123], a[248:251], a[220:223], v[120:123]
    ds_read_b64_tr_b16 a[246:247], v41 offset:1032
    v_mfma_f32_16x16x32_bf16 v[152:155], a[248:251], a[224:227], v[152:155]
    ds_read_b128 a[196:199], v40 offset:2048
    v_mfma_f32_16x16x32_bf16 v[184:187], a[248:251], a[228:231], v[184:187]
    ds_read_b128 a[200:203], v40 offset:4096
    v_mfma_f32_16x16x32_bf16 v[216:219], a[248:251], a[232:235], v[216:219]
    ds_read_b128 a[204:207], v40 offset:6144
    s_add_u32 m0, s41, 0
    v_mfma_f32_16x16x32_bf16 v[248:251], a[248:251], a[236:239], v[248:251]
    buffer_load_dwordx4 v3, s[8:11], s38 offen offset:1024 lds
    v_mfma_f32_16x16x32_bf16 v[92:95], a[252:255], a[216:219], v[92:95]
    ds_read_b64_tr_b16 a[248:249], v42 offset:0
    v_accvgpr_read_b32 v48, a0
    v_mfma_f32_16x16x32_bf16 v[124:127], a[252:255], a[220:223], v[124:127]
    ds_read_b64_tr_b16 a[250:251], v42 offset:1024
    v_accvgpr_read_b32 v49, a1
    v_mfma_f32_16x16x32_bf16 v[156:159], a[252:255], a[224:227], v[156:159]
    ds_read_b128 a[208:211], v40 offset:8192
    v_accvgpr_read_b32 v50, a2
    v_mfma_f32_16x16x32_bf16 v[188:191], a[252:255], a[228:231], v[188:191]
    ds_read_b128 a[212:215], v40 offset:10240
    v_accvgpr_read_b32 v51, a3
    v_mfma_f32_16x16x32_bf16 v[220:223], a[252:255], a[232:235], v[220:223]
    s_add_u32 m0, s41, 0
    s_waitcnt lgkmcnt(6)
    v_accvgpr_read_b32 v52, a4
    v_mfma_f32_16x16x32_bf16 v[252:255], a[252:255], a[236:239], v[252:255]
    buffer_load_dwordx4 v4, s[8:11], s38 offen offset:2048 lds
    v_mfma_f32_16x16x32_bf16 v[64:67], a[240:243], a[192:195], v[64:67]
    s_waitcnt lgkmcnt(4)
    s_add_u32 s54, s38, 30720
    v_accvgpr_read_b32 v53, a5
    v_mfma_f32_16x16x32_bf16 v[96:99], a[240:243], a[196:199], v[96:99]
    ds_read_b64_tr_b16 a[252:253], v42 offset:8
    v_accvgpr_read_b32 v54, a6
    v_mfma_f32_16x16x32_bf16 v[128:131], a[240:243], a[200:203], v[128:131]
    ds_read_b64_tr_b16 a[254:255], v42 offset:1032
    s_add_u32 m0, s41, 3072
    v_mfma_f32_16x16x32_bf16 v[160:163], a[240:243], a[204:207], v[160:163]
    s_waitcnt lgkmcnt(2)
    buffer_load_dwordx4 v2, s[8:11], s54 offen offset:0 lds
    v_mfma_f32_16x16x32_bf16 v[192:195], a[240:243], a[208:211], v[192:195]
    v_accvgpr_read_b32 v55, a7
    v_mul_f32 v48, v58, v48
    v_mfma_f32_16x16x32_bf16 v[224:227], a[240:243], a[212:215], v[224:227]
    v_mul_f32 v49, v58, v49
    v_mul_f32 v50, v58, v50
    v_mfma_f32_16x16x32_bf16 v[68:71], a[244:247], a[192:195], v[68:71]
    v_mul_f32 v51, v58, v51
    v_mul_f32 v52, v58, v52
    v_mfma_f32_16x16x32_bf16 v[100:103], a[244:247], a[196:199], v[100:103]
    ds_read_b64_tr_b16 a[240:241], v43 offset:0
    v_mul_f32 v53, v58, v53
    v_mfma_f32_16x16x32_bf16 v[132:135], a[244:247], a[200:203], v[132:135]
    ds_read_b64_tr_b16 a[242:243], v43 offset:1024
    s_add_u32 m0, s41, 3072
    v_mfma_f32_16x16x32_bf16 v[164:167], a[244:247], a[204:207], v[164:167]
    buffer_load_dwordx4 v3, s[8:11], s54 offen offset:1024 lds
    v_mfma_f32_16x16x32_bf16 v[196:199], a[244:247], a[208:211], v[196:199]
    v_mul_f32 v54, v58, v54
    v_mul_f32 v55, v58, v55
    v_mfma_f32_16x16x32_bf16 v[228:231], a[244:247], a[212:215], v[228:231]
    v_cvt_pk_bf16_f32 v34, v48, v49
    v_cvt_pk_bf16_f32 v35, v50, v51
    v_mfma_f32_16x16x32_bf16 v[72:75], a[248:251], a[192:195], v[72:75]
    v_cvt_pk_bf16_f32 v36, v52, v53
    v_cvt_pk_bf16_f32 v37, v54, v55
    v_mfma_f32_16x16x32_bf16 v[104:107], a[248:251], a[196:199], v[104:107]
    ds_read_b64_tr_b16 a[244:245], v43 offset:8
    v_accvgpr_read_b32 v48, a8
    v_mfma_f32_16x16x32_bf16 v[136:139], a[248:251], a[200:203], v[136:139]
    ds_read_b64_tr_b16 a[246:247], v43 offset:1032
    s_add_u32 m0, s41, 3072
    v_mfma_f32_16x16x32_bf16 v[168:171], a[248:251], a[204:207], v[168:171]
    buffer_load_dwordx4 v4, s[8:11], s54 offen offset:2048 lds
    v_mfma_f32_16x16x32_bf16 v[200:203], a[248:251], a[208:211], v[200:203]
    s_add_u32 s38, s38, 128
    s_add_u32 s56, s48, 0
    buffer_store_dwordx4 v[34:37], v57, s[20:23], s56 offen offset:0 sc1
    v_mfma_f32_16x16x32_bf16 v[232:235], a[248:251], a[212:215], v[232:235]
    s_waitcnt lgkmcnt(4)
    s_cmp_eq_u32 s38, 1280
    s_cselect_b32 s38, 0, s38
    v_mfma_f32_16x16x32_bf16 v[76:79], a[252:255], a[192:195], v[76:79]
    v_accvgpr_read_b32 v49, a9
    v_accvgpr_read_b32 v50, a10
    v_mfma_f32_16x16x32_bf16 v[108:111], a[252:255], a[196:199], v[108:111]
    ds_read_b64_tr_b16 a[248:249], v44 offset:0
    v_accvgpr_read_b32 v51, a11
    v_mfma_f32_16x16x32_bf16 v[140:143], a[252:255], a[200:203], v[140:143]
    ds_read_b64_tr_b16 a[250:251], v44 offset:1024
    s_add_u32 m0, s42, 32768
    v_mfma_f32_16x16x32_bf16 v[172:175], a[252:255], a[204:207], v[172:175]
    buffer_load_dwordx4 v5, s[12:15], s39 offen offset:0 lds
    v_mfma_f32_16x16x32_bf16 v[204:207], a[252:255], a[208:211], v[204:207]
    v_accvgpr_read_b32 v52, a12
    v_accvgpr_read_b32 v53, a13
    v_mfma_f32_16x16x32_bf16 v[236:239], a[252:255], a[212:215], v[236:239]
    s_waitcnt lgkmcnt(4)
    v_accvgpr_read_b32 v54, a14
    v_accvgpr_read_b32 v55, a15
    v_mfma_f32_16x16x32_bf16 v[80:83], a[240:243], a[192:195], v[80:83]
    v_mul_f32 v48, v58, v48
    v_mul_f32 v49, v58, v49
    v_mfma_f32_16x16x32_bf16 v[112:115], a[240:243], a[196:199], v[112:115]
    ds_read_b64_tr_b16 a[252:253], v44 offset:8
    v_mul_f32 v50, v58, v50
    v_mfma_f32_16x16x32_bf16 v[144:147], a[240:243], a[200:203], v[144:147]
    ds_read_b64_tr_b16 a[254:255], v44 offset:1032
    v_xor_b32 v40, 0x40, v40
    v_mfma_f32_16x16x32_bf16 v[176:179], a[240:243], a[204:207], v[176:179]
    v_add_u32 v41, 0x8000, v41
    v_add_u32 v42, 0x8000, v42
    v_mfma_f32_16x16x32_bf16 v[208:211], a[240:243], a[208:211], v[208:211]
    v_add_u32 v43, 0x8000, v43
    v_mul_f32 v51, v58, v51
    v_mfma_f32_16x16x32_bf16 v[240:243], a[240:243], a[212:215], v[240:243]
    s_waitcnt vmcnt(12)
    s_waitcnt lgkmcnt(4)
    v_add_u32 v44, 0x8000, v44
    v_mfma_f32_16x16x32_bf16 v[84:87], a[244:247], a[192:195], v[84:87]
    v_mul_f32 v52, v58, v52
    v_mul_f32 v53, v58, v53
    v_mfma_f32_16x16x32_bf16 v[116:119], a[244:247], a[196:199], v[116:119]
    s_waitcnt lgkmcnt(0)
    s_barrier
    v_mfma_f32_16x16x32_bf16 v[148:151], a[244:247], a[200:203], v[148:151]
    ds_read_b64_tr_b16 a[240:241], v41 offset:0
    v_mul_f32 v54, v58, v54
    v_mfma_f32_16x16x32_bf16 v[180:183], a[244:247], a[204:207], v[180:183]
    ds_read_b64_tr_b16 a[242:243], v41 offset:1024
    v_mul_f32 v55, v58, v55
    v_mfma_f32_16x16x32_bf16 v[212:215], a[244:247], a[208:211], v[212:215]
    ds_read_b128 a[216:219], v40 offset:0
    s_add_u32 m0, s42, 32768
    v_mfma_f32_16x16x32_bf16 v[244:247], a[244:247], a[212:215], v[244:247]
    buffer_load_dwordx4 v6, s[12:15], s39 offen offset:1024 lds
    v_mfma_f32_16x16x32_bf16 v[88:91], a[248:251], a[192:195], v[88:91]
    ds_read_b64_tr_b16 a[244:245], v41 offset:8
    v_cvt_pk_bf16_f32 v34, v48, v49
    v_mfma_f32_16x16x32_bf16 v[120:123], a[248:251], a[196:199], v[120:123]
    ds_read_b64_tr_b16 a[246:247], v41 offset:1032
    v_cvt_pk_bf16_f32 v35, v50, v51
    v_mfma_f32_16x16x32_bf16 v[152:155], a[248:251], a[200:203], v[152:155]
    ds_read_b128 a[220:223], v40 offset:2048
    v_cvt_pk_bf16_f32 v36, v52, v53
    v_mfma_f32_16x16x32_bf16 v[184:187], a[248:251], a[204:207], v[184:187]
    ds_read_b128 a[224:227], v40 offset:4096
    v_cvt_pk_bf16_f32 v37, v54, v55
    v_mfma_f32_16x16x32_bf16 v[216:219], a[248:251], a[208:211], v[216:219]
    ds_read_b128 a[228:231], v40 offset:6144
    s_add_u32 m0, s42, 32768
    v_mfma_f32_16x16x32_bf16 v[248:251], a[248:251], a[212:215], v[248:251]
    buffer_load_dwordx4 v7, s[12:15], s39 offen offset:2048 lds
    v_mfma_f32_16x16x32_bf16 v[92:95], a[252:255], a[192:195], v[92:95]
    ds_read_b64_tr_b16 a[248:249], v42 offset:0
    v_accvgpr_read_b32 v48, a16
    v_mfma_f32_16x16x32_bf16 v[124:127], a[252:255], a[196:199], v[124:127]
    ds_read_b64_tr_b16 a[250:251], v42 offset:1024
    v_accvgpr_read_b32 v49, a17
    v_mfma_f32_16x16x32_bf16 v[156:159], a[252:255], a[200:203], v[156:159]
    ds_read_b128 a[232:235], v40 offset:8192
    v_accvgpr_read_b32 v50, a18
    v_mfma_f32_16x16x32_bf16 v[188:191], a[252:255], a[204:207], v[188:191]
    ds_read_b128 a[236:239], v40 offset:10240
    v_accvgpr_read_b32 v51, a19
    v_mfma_f32_16x16x32_bf16 v[220:223], a[252:255], a[208:211], v[220:223]
    s_add_u32 m0, s42, 32768
    s_waitcnt lgkmcnt(6)
    v_accvgpr_read_b32 v52, a20
    v_mfma_f32_16x16x32_bf16 v[252:255], a[252:255], a[212:215], v[252:255]
    buffer_load_dwordx4 v38, s[12:15], s39 offen offset:3072 lds
    v_mfma_f32_16x16x32_bf16 v[64:67], a[240:243], a[216:219], v[64:67]
    s_waitcnt lgkmcnt(4)
    s_add_u32 s39, s39, 262144
    v_accvgpr_read_b32 v53, a21
    v_mfma_f32_16x16x32_bf16 v[96:99], a[240:243], a[220:223], v[96:99]
    ds_read_b64_tr_b16 a[252:253], v42 offset:8
    s_cmp_eq_u32 s39, 5242880
    s_cselect_b32 s39, 0, s39
    v_mfma_f32_16x16x32_bf16 v[128:131], a[240:243], a[224:227], v[128:131]
    ds_read_b64_tr_b16 a[254:255], v42 offset:1032
    s_add_u32 m0, s42, 65536
    v_mfma_f32_16x16x32_bf16 v[160:163], a[240:243], a[228:231], v[160:163]
    s_waitcnt lgkmcnt(2)
    buffer_load_dwordx4 v5, s[12:15], s39 offen offset:0 lds
    v_mfma_f32_16x16x32_bf16 v[192:195], a[240:243], a[232:235], v[192:195]
    s_add_u32 s56, s48, 4096
    buffer_store_dwordx4 v[34:37], v57, s[20:23], s56 offen offset:2048 sc1
    v_mfma_f32_16x16x32_bf16 v[224:227], a[240:243], a[236:239], v[224:227]
    v_accvgpr_read_b32 v54, a22
    v_accvgpr_read_b32 v55, a23
    v_mfma_f32_16x16x32_bf16 v[68:71], a[244:247], a[216:219], v[68:71]
    v_mul_f32 v48, v58, v48
    v_mul_f32 v49, v58, v49
    v_mfma_f32_16x16x32_bf16 v[100:103], a[244:247], a[220:223], v[100:103]
    ds_read_b64_tr_b16 a[240:241], v43 offset:0
    v_mul_f32 v50, v58, v50
    v_mfma_f32_16x16x32_bf16 v[132:135], a[244:247], a[224:227], v[132:135]
    ds_read_b64_tr_b16 a[242:243], v43 offset:1024
    s_add_u32 m0, s42, 65536
    v_mfma_f32_16x16x32_bf16 v[164:167], a[244:247], a[228:231], v[164:167]
    buffer_load_dwordx4 v6, s[12:15], s39 offen offset:1024 lds
    v_mfma_f32_16x16x32_bf16 v[196:199], a[244:247], a[232:235], v[196:199]
    v_mul_f32 v51, v58, v51
    v_mul_f32 v52, v58, v52
    v_mfma_f32_16x16x32_bf16 v[228:231], a[244:247], a[236:239], v[228:231]
    v_mul_f32 v53, v58, v53
    v_mul_f32 v54, v58, v54
    v_mfma_f32_16x16x32_bf16 v[72:75], a[248:251], a[216:219], v[72:75]
    v_mul_f32 v55, v58, v55
    v_cvt_pk_bf16_f32 v34, v48, v49
    v_mfma_f32_16x16x32_bf16 v[104:107], a[248:251], a[220:223], v[104:107]
    ds_read_b64_tr_b16 a[244:245], v43 offset:8
    v_cvt_pk_bf16_f32 v35, v50, v51
    v_mfma_f32_16x16x32_bf16 v[136:139], a[248:251], a[224:227], v[136:139]
    ds_read_b64_tr_b16 a[246:247], v43 offset:1032
    s_add_u32 m0, s42, 65536
    v_mfma_f32_16x16x32_bf16 v[168:171], a[248:251], a[228:231], v[168:171]
    buffer_load_dwordx4 v7, s[12:15], s39 offen offset:2048 lds
    v_mfma_f32_16x16x32_bf16 v[200:203], a[248:251], a[232:235], v[200:203]
    v_cvt_pk_bf16_f32 v36, v52, v53
    v_cvt_pk_bf16_f32 v37, v54, v55
    v_mfma_f32_16x16x32_bf16 v[232:235], a[248:251], a[236:239], v[232:235]
    s_waitcnt lgkmcnt(4)
    s_add_u32 s56, s48, 12288
    buffer_store_dwordx4 v[34:37], v57, s[20:23], s56 offen offset:0 sc1
    v_mfma_f32_16x16x32_bf16 v[76:79], a[252:255], a[216:219], v[76:79]
    v_accvgpr_read_b32 v48, a24
    v_accvgpr_read_b32 v49, a25
    v_mfma_f32_16x16x32_bf16 v[108:111], a[252:255], a[220:223], v[108:111]
    ds_read_b64_tr_b16 a[248:249], v44 offset:0
    v_accvgpr_read_b32 v50, a26
    v_mfma_f32_16x16x32_bf16 v[140:143], a[252:255], a[224:227], v[140:143]
    ds_read_b64_tr_b16 a[250:251], v44 offset:1024
    s_add_u32 m0, s42, 65536
    v_mfma_f32_16x16x32_bf16 v[172:175], a[252:255], a[228:231], v[172:175]
    buffer_load_dwordx4 v38, s[12:15], s39 offen offset:3072 lds
    v_mfma_f32_16x16x32_bf16 v[204:207], a[252:255], a[232:235], v[204:207]
    s_add_u32 s39, s39, 262144
    v_accvgpr_read_b32 v51, a27
    v_accvgpr_read_b32 v52, a28
    v_mfma_f32_16x16x32_bf16 v[236:239], a[252:255], a[236:239], v[236:239]
    s_waitcnt lgkmcnt(4)
    s_cmp_eq_u32 s39, 5242880
    s_cselect_b32 s39, 0, s39
    v_mfma_f32_16x16x32_bf16 v[80:83], a[240:243], a[216:219], v[80:83]
    v_accvgpr_read_b32 v53, a29
    v_accvgpr_read_b32 v54, a30
    v_mfma_f32_16x16x32_bf16 v[112:115], a[240:243], a[220:223], v[112:115]
    ds_read_b64_tr_b16 a[252:253], v44 offset:8
    v_accvgpr_read_b32 v55, a31
    v_mfma_f32_16x16x32_bf16 v[144:147], a[240:243], a[224:227], v[144:147]
    ds_read_b64_tr_b16 a[254:255], v44 offset:1032
    v_xor_b32 v40, 0x10040, v40
    v_mfma_f32_16x16x32_bf16 v[176:179], a[240:243], a[228:231], v[176:179]
    v_subrev_u32 v41, 0x18000, v41
    v_subrev_u32 v42, 0x18000, v42
    v_mfma_f32_16x16x32_bf16 v[208:211], a[240:243], a[232:235], v[208:211]
    v_subrev_u32 v43, 0x18000, v43
    v_mul_f32 v48, v58, v48
    v_mfma_f32_16x16x32_bf16 v[240:243], a[240:243], a[236:239], v[240:243]
    s_waitcnt vmcnt(11)
    s_waitcnt lgkmcnt(4)
    v_subrev_u32 v44, 0x18000, v44
    v_mfma_f32_16x16x32_bf16 v[84:87], a[244:247], a[216:219], v[84:87]
    v_mul_f32 v49, v58, v49
    v_mul_f32 v50, v58, v50
    v_mfma_f32_16x16x32_bf16 v[116:119], a[244:247], a[220:223], v[116:119]
    s_waitcnt lgkmcnt(0)
    s_barrier
    v_mfma_f32_16x16x32_bf16 v[148:151], a[244:247], a[224:227], v[148:151]
    ds_read_b64_tr_b16 a[240:241], v41 offset:0
    v_mul_f32 v51, v58, v51
    v_mfma_f32_16x16x32_bf16 v[180:183], a[244:247], a[228:231], v[180:183]
    ds_read_b64_tr_b16 a[242:243], v41 offset:1024
    v_mul_f32 v52, v58, v52
    v_mfma_f32_16x16x32_bf16 v[212:215], a[244:247], a[232:235], v[212:215]
    ds_read_b128 a[192:195], v40 offset:0
    s_add_u32 m0, s41, 65536
    v_mfma_f32_16x16x32_bf16 v[244:247], a[244:247], a[236:239], v[244:247]
    buffer_load_dwordx4 v2, s[8:11], s38 offen offset:0 lds
    v_mfma_f32_16x16x32_bf16 v[88:91], a[248:251], a[216:219], v[88:91]
    ds_read_b64_tr_b16 a[244:245], v41 offset:8
    v_mul_f32 v53, v58, v53
    v_mfma_f32_16x16x32_bf16 v[120:123], a[248:251], a[220:223], v[120:123]
    ds_read_b64_tr_b16 a[246:247], v41 offset:1032
    v_mul_f32 v54, v58, v54
    v_mfma_f32_16x16x32_bf16 v[152:155], a[248:251], a[224:227], v[152:155]
    ds_read_b128 a[196:199], v40 offset:2048
    v_mul_f32 v55, v58, v55
    v_mfma_f32_16x16x32_bf16 v[184:187], a[248:251], a[228:231], v[184:187]
    ds_read_b128 a[200:203], v40 offset:4096
    v_cvt_pk_bf16_f32 v34, v48, v49
    v_mfma_f32_16x16x32_bf16 v[216:219], a[248:251], a[232:235], v[216:219]
    ds_read_b128 a[204:207], v40 offset:6144
    s_add_u32 m0, s41, 65536
    v_mfma_f32_16x16x32_bf16 v[248:251], a[248:251], a[236:239], v[248:251]
    buffer_load_dwordx4 v3, s[8:11], s38 offen offset:1024 lds
    v_mfma_f32_16x16x32_bf16 v[92:95], a[252:255], a[216:219], v[92:95]
    ds_read_b64_tr_b16 a[248:249], v42 offset:0
    v_cvt_pk_bf16_f32 v35, v50, v51
    v_mfma_f32_16x16x32_bf16 v[124:127], a[252:255], a[220:223], v[124:127]
    ds_read_b64_tr_b16 a[250:251], v42 offset:1024
    v_cvt_pk_bf16_f32 v36, v52, v53
    v_mfma_f32_16x16x32_bf16 v[156:159], a[252:255], a[224:227], v[156:159]
    ds_read_b128 a[208:211], v40 offset:8192
    v_cvt_pk_bf16_f32 v37, v54, v55
    v_mfma_f32_16x16x32_bf16 v[188:191], a[252:255], a[228:231], v[188:191]
    ds_read_b128 a[212:215], v40 offset:10240
    v_accvgpr_read_b32 v48, a32
    v_mfma_f32_16x16x32_bf16 v[220:223], a[252:255], a[232:235], v[220:223]
    s_add_u32 m0, s41, 65536
    s_waitcnt lgkmcnt(6)
    v_accvgpr_read_b32 v49, a33
    v_mfma_f32_16x16x32_bf16 v[252:255], a[252:255], a[236:239], v[252:255]
    buffer_load_dwordx4 v4, s[8:11], s38 offen offset:2048 lds
    v_mfma_f32_16x16x32_bf16 v[64:67], a[240:243], a[192:195], v[64:67]
    s_waitcnt lgkmcnt(4)
    s_add_u32 s54, s38, 30720
    v_accvgpr_read_b32 v50, a34
    v_mfma_f32_16x16x32_bf16 v[96:99], a[240:243], a[196:199], v[96:99]
    ds_read_b64_tr_b16 a[252:253], v42 offset:8
    v_accvgpr_read_b32 v51, a35
    v_mfma_f32_16x16x32_bf16 v[128:131], a[240:243], a[200:203], v[128:131]
    ds_read_b64_tr_b16 a[254:255], v42 offset:1032
    s_add_u32 m0, s41, 68608
    v_mfma_f32_16x16x32_bf16 v[160:163], a[240:243], a[204:207], v[160:163]
    s_waitcnt lgkmcnt(2)
    buffer_load_dwordx4 v2, s[8:11], s54 offen offset:0 lds
    v_mfma_f32_16x16x32_bf16 v[192:195], a[240:243], a[208:211], v[192:195]
    s_add_u32 s56, s48, 16384
    buffer_store_dwordx4 v[34:37], v57, s[20:23], s56 offen offset:2048 sc1
    v_mfma_f32_16x16x32_bf16 v[224:227], a[240:243], a[212:215], v[224:227]
    v_accvgpr_read_b32 v52, a36
    v_accvgpr_read_b32 v53, a37
    v_mfma_f32_16x16x32_bf16 v[68:71], a[244:247], a[192:195], v[68:71]
    v_accvgpr_read_b32 v54, a38
    v_accvgpr_read_b32 v55, a39
    v_mfma_f32_16x16x32_bf16 v[100:103], a[244:247], a[196:199], v[100:103]
    ds_read_b64_tr_b16 a[240:241], v43 offset:0
    v_mul_f32 v48, v59, v48
    v_mfma_f32_16x16x32_bf16 v[132:135], a[244:247], a[200:203], v[132:135]
    ds_read_b64_tr_b16 a[242:243], v43 offset:1024
    s_add_u32 m0, s41, 68608
    v_mfma_f32_16x16x32_bf16 v[164:167], a[244:247], a[204:207], v[164:167]
    buffer_load_dwordx4 v3, s[8:11], s54 offen offset:1024 lds
    v_mfma_f32_16x16x32_bf16 v[196:199], a[244:247], a[208:211], v[196:199]
    v_mul_f32 v49, v59, v49
    v_mul_f32 v50, v59, v50
    v_mfma_f32_16x16x32_bf16 v[228:231], a[244:247], a[212:215], v[228:231]
    v_mul_f32 v51, v59, v51
    v_mul_f32 v52, v59, v52
    v_mfma_f32_16x16x32_bf16 v[72:75], a[248:251], a[192:195], v[72:75]
    v_mul_f32 v53, v59, v53
    v_mul_f32 v54, v59, v54
    v_mfma_f32_16x16x32_bf16 v[104:107], a[248:251], a[196:199], v[104:107]
    ds_read_b64_tr_b16 a[244:245], v43 offset:8
    v_mul_f32 v55, v59, v55
    v_mfma_f32_16x16x32_bf16 v[136:139], a[248:251], a[200:203], v[136:139]
    ds_read_b64_tr_b16 a[246:247], v43 offset:1032
    s_add_u32 m0, s41, 68608
    v_mfma_f32_16x16x32_bf16 v[168:171], a[248:251], a[204:207], v[168:171]
    buffer_load_dwordx4 v4, s[8:11], s54 offen offset:2048 lds
    v_mfma_f32_16x16x32_bf16 v[200:203], a[248:251], a[208:211], v[200:203]
    s_add_u32 s38, s38, 128
    v_cvt_pk_bf16_f32 v34, v48, v49
    v_cvt_pk_bf16_f32 v35, v50, v51
    v_mfma_f32_16x16x32_bf16 v[232:235], a[248:251], a[212:215], v[232:235]
    s_waitcnt lgkmcnt(4)
    s_cmp_eq_u32 s38, 1280
    s_cselect_b32 s38, 0, s38
    v_mfma_f32_16x16x32_bf16 v[76:79], a[252:255], a[192:195], v[76:79]
    v_cvt_pk_bf16_f32 v36, v52, v53
    v_cvt_pk_bf16_f32 v37, v54, v55
    v_mfma_f32_16x16x32_bf16 v[108:111], a[252:255], a[196:199], v[108:111]
    ds_read_b64_tr_b16 a[248:249], v44 offset:0
    v_accvgpr_read_b32 v48, a40
    v_mfma_f32_16x16x32_bf16 v[140:143], a[252:255], a[200:203], v[140:143]
    ds_read_b64_tr_b16 a[250:251], v44 offset:1024
    s_add_u32 m0, s42, 98304
    v_mfma_f32_16x16x32_bf16 v[172:175], a[252:255], a[204:207], v[172:175]
    buffer_load_dwordx4 v5, s[12:15], s39 offen offset:0 lds
    v_mfma_f32_16x16x32_bf16 v[204:207], a[252:255], a[208:211], v[204:207]
    s_add_u32 s56, s48, 0
    buffer_store_dwordx4 v[34:37], v57, s[20:23], s56 offen offset:1024 sc1
    v_mfma_f32_16x16x32_bf16 v[236:239], a[252:255], a[212:215], v[236:239]
    s_waitcnt lgkmcnt(4)
    v_accvgpr_read_b32 v49, a41
    v_accvgpr_read_b32 v50, a42
    v_mfma_f32_16x16x32_bf16 v[80:83], a[240:243], a[192:195], v[80:83]
    v_accvgpr_read_b32 v51, a43
    v_accvgpr_read_b32 v52, a44
    v_mfma_f32_16x16x32_bf16 v[112:115], a[240:243], a[196:199], v[112:115]
    ds_read_b64_tr_b16 a[252:253], v44 offset:8
    v_accvgpr_read_b32 v53, a45
    v_mfma_f32_16x16x32_bf16 v[144:147], a[240:243], a[200:203], v[144:147]
    ds_read_b64_tr_b16 a[254:255], v44 offset:1032
    v_xor_b32 v40, 0x40, v40
    v_mfma_f32_16x16x32_bf16 v[176:179], a[240:243], a[204:207], v[176:179]
    v_add_u32 v41, 0x8000, v41
    v_add_u32 v42, 0x8000, v42
    v_mfma_f32_16x16x32_bf16 v[208:211], a[240:243], a[208:211], v[208:211]
    v_add_u32 v43, 0x8000, v43
    v_accvgpr_read_b32 v54, a46
    v_mfma_f32_16x16x32_bf16 v[240:243], a[240:243], a[212:215], v[240:243]
    s_waitcnt vmcnt(15)
    s_waitcnt lgkmcnt(4)
    v_add_u32 v44, 0x8000, v44
    v_mfma_f32_16x16x32_bf16 v[84:87], a[244:247], a[192:195], v[84:87]
    v_accvgpr_read_b32 v55, a47
    v_mul_f32 v48, v59, v48
    v_mfma_f32_16x16x32_bf16 v[116:119], a[244:247], a[196:199], v[116:119]
    s_waitcnt lgkmcnt(0)
    s_barrier
    v_mfma_f32_16x16x32_bf16 v[148:151], a[244:247], a[200:203], v[148:151]
    ds_read_b64_tr_b16 a[240:241], v41 offset:0
    v_mul_f32 v49, v59, v49
    v_mfma_f32_16x16x32_bf16 v[180:183], a[244:247], a[204:207], v[180:183]
    ds_read_b64_tr_b16 a[242:243], v41 offset:1024
    v_mul_f32 v50, v59, v50
    v_mfma_f32_16x16x32_bf16 v[212:215], a[244:247], a[208:211], v[212:215]
    ds_read_b128 a[216:219], v40 offset:0
    s_add_u32 m0, s42, 98304
    v_mfma_f32_16x16x32_bf16 v[244:247], a[244:247], a[212:215], v[244:247]
    buffer_load_dwordx4 v6, s[12:15], s39 offen offset:1024 lds
    v_mfma_f32_16x16x32_bf16 v[88:91], a[248:251], a[192:195], v[88:91]
    ds_read_b64_tr_b16 a[244:245], v41 offset:8
    v_mul_f32 v51, v59, v51
    v_mfma_f32_16x16x32_bf16 v[120:123], a[248:251], a[196:199], v[120:123]
    ds_read_b64_tr_b16 a[246:247], v41 offset:1032
    v_mul_f32 v52, v59, v52
    v_mfma_f32_16x16x32_bf16 v[152:155], a[248:251], a[200:203], v[152:155]
    ds_read_b128 a[220:223], v40 offset:2048
    v_mul_f32 v53, v59, v53
    v_mfma_f32_16x16x32_bf16 v[184:187], a[248:251], a[204:207], v[184:187]
    ds_read_b128 a[224:227], v40 offset:4096
    v_mul_f32 v54, v59, v54
    v_mfma_f32_16x16x32_bf16 v[216:219], a[248:251], a[208:211], v[216:219]
    ds_read_b128 a[228:231], v40 offset:6144
    s_add_u32 m0, s42, 98304
    v_mfma_f32_16x16x32_bf16 v[248:251], a[248:251], a[212:215], v[248:251]
    buffer_load_dwordx4 v7, s[12:15], s39 offen offset:2048 lds
    v_mfma_f32_16x16x32_bf16 v[92:95], a[252:255], a[192:195], v[92:95]
    ds_read_b64_tr_b16 a[248:249], v42 offset:0
    v_mul_f32 v55, v59, v55
    v_mfma_f32_16x16x32_bf16 v[124:127], a[252:255], a[196:199], v[124:127]
    ds_read_b64_tr_b16 a[250:251], v42 offset:1024
    v_cvt_pk_bf16_f32 v34, v48, v49
    v_mfma_f32_16x16x32_bf16 v[156:159], a[252:255], a[200:203], v[156:159]
    ds_read_b128 a[232:235], v40 offset:8192
    v_cvt_pk_bf16_f32 v35, v50, v51
    v_mfma_f32_16x16x32_bf16 v[188:191], a[252:255], a[204:207], v[188:191]
    ds_read_b128 a[236:239], v40 offset:10240
    v_cvt_pk_bf16_f32 v36, v52, v53
    v_mfma_f32_16x16x32_bf16 v[220:223], a[252:255], a[208:211], v[220:223]
    s_add_u32 m0, s42, 98304
    s_waitcnt lgkmcnt(6)
    v_cvt_pk_bf16_f32 v37, v54, v55
    v_mfma_f32_16x16x32_bf16 v[252:255], a[252:255], a[212:215], v[252:255]
    buffer_load_dwordx4 v38, s[12:15], s39 offen offset:3072 lds
    v_mfma_f32_16x16x32_bf16 v[64:67], a[240:243], a[216:219], v[64:67]
    s_waitcnt lgkmcnt(4)
    s_add_u32 s39, s39, 262144
    v_accvgpr_read_b32 v48, a48
    v_mfma_f32_16x16x32_bf16 v[96:99], a[240:243], a[220:223], v[96:99]
    ds_read_b64_tr_b16 a[252:253], v42 offset:8
    s_cmp_eq_u32 s39, 5242880
    s_cselect_b32 s39, 0, s39
    v_mfma_f32_16x16x32_bf16 v[128:131], a[240:243], a[224:227], v[128:131]
    ds_read_b64_tr_b16 a[254:255], v42 offset:1032
    s_add_u32 m0, s42, 0
    v_mfma_f32_16x16x32_bf16 v[160:163], a[240:243], a[228:231], v[160:163]
    s_waitcnt lgkmcnt(2)
    buffer_load_dwordx4 v5, s[12:15], s39 offen offset:0 lds
    v_mfma_f32_16x16x32_bf16 v[192:195], a[240:243], a[232:235], v[192:195]
    s_add_u32 s56, s48, 4096
    buffer_store_dwordx4 v[34:37], v57, s[20:23], s56 offen offset:3072 sc1
    v_mfma_f32_16x16x32_bf16 v[224:227], a[240:243], a[236:239], v[224:227]
    v_accvgpr_read_b32 v49, a49
    v_accvgpr_read_b32 v50, a50
    v_mfma_f32_16x16x32_bf16 v[68:71], a[244:247], a[216:219], v[68:71]
    v_accvgpr_read_b32 v51, a51
    v_accvgpr_read_b32 v52, a52
    v_mfma_f32_16x16x32_bf16 v[100:103], a[244:247], a[220:223], v[100:103]
    ds_read_b64_tr_b16 a[240:241], v43 offset:0
    v_accvgpr_read_b32 v53, a53
    v_mfma_f32_16x16x32_bf16 v[132:135], a[244:247], a[224:227], v[132:135]
    ds_read_b64_tr_b16 a[242:243], v43 offset:1024
    s_add_u32 m0, s42, 0
    v_mfma_f32_16x16x32_bf16 v[164:167], a[244:247], a[228:231], v[164:167]
    buffer_load_dwordx4 v6, s[12:15], s39 offen offset:1024 lds
    v_mfma_f32_16x16x32_bf16 v[196:199], a[244:247], a[232:235], v[196:199]
    v_accvgpr_read_b32 v54, a54
    v_accvgpr_read_b32 v55, a55
    v_mfma_f32_16x16x32_bf16 v[228:231], a[244:247], a[236:239], v[228:231]
    v_mul_f32 v48, v59, v48
    v_mul_f32 v49, v59, v49
    v_mfma_f32_16x16x32_bf16 v[72:75], a[248:251], a[216:219], v[72:75]
    v_mul_f32 v50, v59, v50
    v_mul_f32 v51, v59, v51
    v_mfma_f32_16x16x32_bf16 v[104:107], a[248:251], a[220:223], v[104:107]
    ds_read_b64_tr_b16 a[244:245], v43 offset:8
    v_mul_f32 v52, v59, v52
    v_mfma_f32_16x16x32_bf16 v[136:139], a[248:251], a[224:227], v[136:139]
    ds_read_b64_tr_b16 a[246:247], v43 offset:1032
    s_add_u32 m0, s42, 0
    v_mfma_f32_16x16x32_bf16 v[168:171], a[248:251], a[228:231], v[168:171]
    buffer_load_dwordx4 v7, s[12:15], s39 offen offset:2048 lds
    v_mfma_f32_16x16x32_bf16 v[200:203], a[248:251], a[232:235], v[200:203]
    v_mul_f32 v53, v59, v53
    v_mul_f32 v54, v59, v54
    v_mfma_f32_16x16x32_bf16 v[232:235], a[248:251], a[236:239], v[232:235]
    s_waitcnt lgkmcnt(4)
    v_mul_f32 v55, v59, v55
    v_cvt_pk_bf16_f32 v34, v48, v49
    v_mfma_f32_16x16x32_bf16 v[76:79], a[252:255], a[216:219], v[76:79]
    v_cvt_pk_bf16_f32 v35, v50, v51
    v_cvt_pk_bf16_f32 v36, v52, v53
    v_mfma_f32_16x16x32_bf16 v[108:111], a[252:255], a[220:223], v[108:111]
    ds_read_b64_tr_b16 a[248:249], v44 offset:0
    v_cvt_pk_bf16_f32 v37, v54, v55
    v_mfma_f32_16x16x32_bf16 v[140:143], a[252:255], a[224:227], v[140:143]
    ds_read_b64_tr_b16 a[250:251], v44 offset:1024
    s_add_u32 m0, s42, 0
    v_mfma_f32_16x16x32_bf16 v[172:175], a[252:255], a[228:231], v[172:175]
    buffer_load_dwordx4 v38, s[12:15], s39 offen offset:3072 lds
    v_mfma_f32_16x16x32_bf16 v[204:207], a[252:255], a[232:235], v[204:207]
    s_add_u32 s39, s39, 262144
    s_add_u32 s56, s48, 12288
    buffer_store_dwordx4 v[34:37], v57, s[20:23], s56 offen offset:1024 sc1
    v_mfma_f32_16x16x32_bf16 v[236:239], a[252:255], a[236:239], v[236:239]
    s_waitcnt lgkmcnt(4)
    s_cmp_eq_u32 s39, 5242880
    s_cselect_b32 s39, 0, s39
    v_mfma_f32_16x16x32_bf16 v[80:83], a[240:243], a[216:219], v[80:83]
    v_accvgpr_read_b32 v48, a56
    v_accvgpr_read_b32 v49, a57
    v_mfma_f32_16x16x32_bf16 v[112:115], a[240:243], a[220:223], v[112:115]
    ds_read_b64_tr_b16 a[252:253], v44 offset:8
    v_accvgpr_read_b32 v50, a58
    v_mfma_f32_16x16x32_bf16 v[144:147], a[240:243], a[224:227], v[144:147]
    ds_read_b64_tr_b16 a[254:255], v44 offset:1032
    v_xor_b32 v40, 0x10040, v40
    v_mfma_f32_16x16x32_bf16 v[176:179], a[240:243], a[228:231], v[176:179]
    v_add_u32 v41, 0x8000, v41
    v_add_u32 v42, 0x8000, v42
    v_mfma_f32_16x16x32_bf16 v[208:211], a[240:243], a[232:235], v[208:211]
    v_add_u32 v43, 0x8000, v43
    v_accvgpr_read_b32 v51, a59
    v_mfma_f32_16x16x32_bf16 v[240:243], a[240:243], a[236:239], v[240:243]
    s_waitcnt vmcnt(11)
    s_waitcnt lgkmcnt(4)
    v_add_u32 v44, 0x8000, v44
    v_mfma_f32_16x16x32_bf16 v[84:87], a[244:247], a[216:219], v[84:87]
    v_accvgpr_read_b32 v52, a60
    v_accvgpr_read_b32 v53, a61
    v_mfma_f32_16x16x32_bf16 v[116:119], a[244:247], a[220:223], v[116:119]
    s_waitcnt lgkmcnt(0)
    s_barrier
    v_mfma_f32_16x16x32_bf16 v[148:151], a[244:247], a[224:227], v[148:151]
    ds_read_b64_tr_b16 a[240:241], v41 offset:0
    v_accvgpr_read_b32 v54, a62
    v_mfma_f32_16x16x32_bf16 v[180:183], a[244:247], a[228:231], v[180:183]
    ds_read_b64_tr_b16 a[242:243], v41 offset:1024
    v_accvgpr_read_b32 v55, a63
    v_mfma_f32_16x16x32_bf16 v[212:215], a[244:247], a[232:235], v[212:215]
    ds_read_b128 a[192:195], v40 offset:0
    s_add_u32 m0, s41, 0
    v_mfma_f32_16x16x32_bf16 v[244:247], a[244:247], a[236:239], v[244:247]
    buffer_load_dwordx4 v2, s[8:11], s38 offen offset:0 lds
    v_mfma_f32_16x16x32_bf16 v[88:91], a[248:251], a[216:219], v[88:91]
    ds_read_b64_tr_b16 a[244:245], v41 offset:8
    v_mul_f32 v48, v59, v48
    v_mfma_f32_16x16x32_bf16 v[120:123], a[248:251], a[220:223], v[120:123]
    ds_read_b64_tr_b16 a[246:247], v41 offset:1032
    v_mul_f32 v49, v59, v49
    v_mfma_f32_16x16x32_bf16 v[152:155], a[248:251], a[224:227], v[152:155]
    ds_read_b128 a[196:199], v40 offset:2048
    v_mul_f32 v50, v59, v50
    v_mfma_f32_16x16x32_bf16 v[184:187], a[248:251], a[228:231], v[184:187]
    ds_read_b128 a[200:203], v40 offset:4096
    v_mul_f32 v51, v59, v51
    v_mfma_f32_16x16x32_bf16 v[216:219], a[248:251], a[232:235], v[216:219]
    ds_read_b128 a[204:207], v40 offset:6144
    s_add_u32 m0, s41, 0
    v_mfma_f32_16x16x32_bf16 v[248:251], a[248:251], a[236:239], v[248:251]
    buffer_load_dwordx4 v3, s[8:11], s38 offen offset:1024 lds
    v_mfma_f32_16x16x32_bf16 v[92:95], a[252:255], a[216:219], v[92:95]
    ds_read_b64_tr_b16 a[248:249], v42 offset:0
    v_mul_f32 v52, v59, v52
    v_mfma_f32_16x16x32_bf16 v[124:127], a[252:255], a[220:223], v[124:127]
    ds_read_b64_tr_b16 a[250:251], v42 offset:1024
    v_mul_f32 v53, v59, v53
    v_mfma_f32_16x16x32_bf16 v[156:159], a[252:255], a[224:227], v[156:159]
    ds_read_b128 a[208:211], v40 offset:8192
    v_mul_f32 v54, v59, v54
    v_mfma_f32_16x16x32_bf16 v[188:191], a[252:255], a[228:231], v[188:191]
    ds_read_b128 a[212:215], v40 offset:10240
    v_mul_f32 v55, v59, v55
    v_mfma_f32_16x16x32_bf16 v[220:223], a[252:255], a[232:235], v[220:223]
    s_add_u32 m0, s41, 0
    s_waitcnt lgkmcnt(6)
    v_cvt_pk_bf16_f32 v34, v48, v49
    v_mfma_f32_16x16x32_bf16 v[252:255], a[252:255], a[236:239], v[252:255]
    buffer_load_dwordx4 v4, s[8:11], s38 offen offset:2048 lds
    v_mfma_f32_16x16x32_bf16 v[64:67], a[240:243], a[192:195], v[64:67]
    s_waitcnt lgkmcnt(4)
    s_add_u32 s54, s38, 30720
    v_cvt_pk_bf16_f32 v35, v50, v51
    v_mfma_f32_16x16x32_bf16 v[96:99], a[240:243], a[196:199], v[96:99]
    ds_read_b64_tr_b16 a[252:253], v42 offset:8
    v_cvt_pk_bf16_f32 v36, v52, v53
    v_mfma_f32_16x16x32_bf16 v[128:131], a[240:243], a[200:203], v[128:131]
    ds_read_b64_tr_b16 a[254:255], v42 offset:1032
    s_add_u32 m0, s41, 3072
    v_mfma_f32_16x16x32_bf16 v[160:163], a[240:243], a[204:207], v[160:163]
    s_waitcnt lgkmcnt(2)
    buffer_load_dwordx4 v2, s[8:11], s54 offen offset:0 lds
    v_mfma_f32_16x16x32_bf16 v[192:195], a[240:243], a[208:211], v[192:195]
    v_cvt_pk_bf16_f32 v37, v54, v55
    v_accvgpr_read_b32 v48, a64
    v_mfma_f32_16x16x32_bf16 v[224:227], a[240:243], a[212:215], v[224:227]
    s_add_u32 s56, s48, 16384
    buffer_store_dwordx4 v[34:37], v57, s[20:23], s56 offen offset:3072 sc1
    v_mfma_f32_16x16x32_bf16 v[68:71], a[244:247], a[192:195], v[68:71]
    v_accvgpr_read_b32 v49, a65
    v_accvgpr_read_b32 v50, a66
    v_mfma_f32_16x16x32_bf16 v[100:103], a[244:247], a[196:199], v[100:103]
    ds_read_b64_tr_b16 a[240:241], v43 offset:0
    v_accvgpr_read_b32 v51, a67
    v_mfma_f32_16x16x32_bf16 v[132:135], a[244:247], a[200:203], v[132:135]
    ds_read_b64_tr_b16 a[242:243], v43 offset:1024
    s_add_u32 m0, s41, 3072
    v_mfma_f32_16x16x32_bf16 v[164:167], a[244:247], a[204:207], v[164:167]
    buffer_load_dwordx4 v3, s[8:11], s54 offen offset:1024 lds
    v_mfma_f32_16x16x32_bf16 v[196:199], a[244:247], a[208:211], v[196:199]
    v_accvgpr_read_b32 v52, a68
    v_accvgpr_read_b32 v53, a69
    v_mfma_f32_16x16x32_bf16 v[228:231], a[244:247], a[212:215], v[228:231]
    v_accvgpr_read_b32 v54, a70
    v_accvgpr_read_b32 v55, a71
    v_mfma_f32_16x16x32_bf16 v[72:75], a[248:251], a[192:195], v[72:75]
    v_mul_f32 v48, v60, v48
    v_mul_f32 v49, v60, v49
    v_mfma_f32_16x16x32_bf16 v[104:107], a[248:251], a[196:199], v[104:107]
    ds_read_b64_tr_b16 a[244:245], v43 offset:8
    v_mul_f32 v50, v60, v50
    v_mfma_f32_16x16x32_bf16 v[136:139], a[248:251], a[200:203], v[136:139]
    ds_read_b64_tr_b16 a[246:247], v43 offset:1032
    s_add_u32 m0, s41, 3072
    v_mfma_f32_16x16x32_bf16 v[168:171], a[248:251], a[204:207], v[168:171]
    buffer_load_dwordx4 v4, s[8:11], s54 offen offset:2048 lds
    v_mfma_f32_16x16x32_bf16 v[200:203], a[248:251], a[208:211], v[200:203]
    s_add_u32 s38, s38, 128
    v_mul_f32 v51, v60, v51
    v_mul_f32 v52, v60, v52
    v_mfma_f32_16x16x32_bf16 v[232:235], a[248:251], a[212:215], v[232:235]
    s_waitcnt lgkmcnt(4)
    s_cmp_eq_u32 s38, 1280
    s_cselect_b32 s38, 0, s38
    v_mfma_f32_16x16x32_bf16 v[76:79], a[252:255], a[192:195], v[76:79]
    v_mul_f32 v53, v60, v53
    v_mul_f32 v54, v60, v54
    v_mfma_f32_16x16x32_bf16 v[108:111], a[252:255], a[196:199], v[108:111]
    ds_read_b64_tr_b16 a[248:249], v44 offset:0
    v_mul_f32 v55, v60, v55
    v_mfma_f32_16x16x32_bf16 v[140:143], a[252:255], a[200:203], v[140:143]
    ds_read_b64_tr_b16 a[250:251], v44 offset:1024
    s_add_u32 m0, s42, 32768
    v_mfma_f32_16x16x32_bf16 v[172:175], a[252:255], a[204:207], v[172:175]
    buffer_load_dwordx4 v5, s[12:15], s39 offen offset:0 lds
    v_mfma_f32_16x16x32_bf16 v[204:207], a[252:255], a[208:211], v[204:207]
    v_cvt_pk_bf16_f32 v34, v48, v49
    v_cvt_pk_bf16_f32 v35, v50, v51
    v_mfma_f32_16x16x32_bf16 v[236:239], a[252:255], a[212:215], v[236:239]
    s_waitcnt lgkmcnt(4)
    v_cvt_pk_bf16_f32 v36, v52, v53
    v_cvt_pk_bf16_f32 v37, v54, v55
    v_mfma_f32_16x16x32_bf16 v[80:83], a[240:243], a[192:195], v[80:83]
    s_add_u32 s56, s48, 0
    buffer_store_dwordx4 v[34:37], v57, s[20:23], s56 offen offset:2048 sc1
    v_mfma_f32_16x16x32_bf16 v[112:115], a[240:243], a[196:199], v[112:115]
    ds_read_b64_tr_b16 a[252:253], v44 offset:8
    v_accvgpr_read_b32 v48, a72
    v_mfma_f32_16x16x32_bf16 v[144:147], a[240:243], a[200:203], v[144:147]
    ds_read_b64_tr_b16 a[254:255], v44 offset:1032
    v_xor_b32 v40, 0x40, v40
    v_mfma_f32_16x16x32_bf16 v[176:179], a[240:243], a[204:207], v[176:179]
    v_add_u32 v41, 0x8000, v41
    v_add_u32 v42, 0x8000, v42
    v_mfma_f32_16x16x32_bf16 v[208:211], a[240:243], a[208:211], v[208:211]
    v_add_u32 v43, 0x8000, v43
    v_accvgpr_read_b32 v49, a73
    v_mfma_f32_16x16x32_bf16 v[240:243], a[240:243], a[212:215], v[240:243]
    s_waitcnt vmcnt(15)
    s_waitcnt lgkmcnt(4)
    v_add_u32 v44, 0x8000, v44
    v_mfma_f32_16x16x32_bf16 v[84:87], a[244:247], a[192:195], v[84:87]
    v_accvgpr_read_b32 v50, a74
    v_accvgpr_read_b32 v51, a75
    v_mfma_f32_16x16x32_bf16 v[116:119], a[244:247], a[196:199], v[116:119]
    s_waitcnt lgkmcnt(0)
    s_barrier
    v_mfma_f32_16x16x32_bf16 v[148:151], a[244:247], a[200:203], v[148:151]
    ds_read_b64_tr_b16 a[240:241], v41 offset:0
    v_accvgpr_read_b32 v52, a76
    v_mfma_f32_16x16x32_bf16 v[180:183], a[244:247], a[204:207], v[180:183]
    ds_read_b64_tr_b16 a[242:243], v41 offset:1024
    v_accvgpr_read_b32 v53, a77
    v_mfma_f32_16x16x32_bf16 v[212:215], a[244:247], a[208:211], v[212:215]
    ds_read_b128 a[216:219], v40 offset:0
    s_add_u32 m0, s42, 32768
    v_mfma_f32_16x16x32_bf16 v[244:247], a[244:247], a[212:215], v[244:247]
    buffer_load_dwordx4 v6, s[12:15], s39 offen offset:1024 lds
    v_mfma_f32_16x16x32_bf16 v[88:91], a[248:251], a[192:195], v[88:91]
    ds_read_b64_tr_b16 a[244:245], v41 offset:8
    v_accvgpr_read_b32 v54, a78
    v_mfma_f32_16x16x32_bf16 v[120:123], a[248:251], a[196:199], v[120:123]
    ds_read_b64_tr_b16 a[246:247], v41 offset:1032
    v_accvgpr_read_b32 v55, a79
    v_mfma_f32_16x16x32_bf16 v[152:155], a[248:251], a[200:203], v[152:155]
    ds_read_b128 a[220:223], v40 offset:2048
    v_mul_f32 v48, v60, v48
    v_mfma_f32_16x16x32_bf16 v[184:187], a[248:251], a[204:207], v[184:187]
    ds_read_b128 a[224:227], v40 offset:4096
    v_mul_f32 v49, v60, v49
    v_mfma_f32_16x16x32_bf16 v[216:219], a[248:251], a[208:211], v[216:219]
    ds_read_b128 a[228:231], v40 offset:6144
    s_add_u32 m0, s42, 32768
    v_mfma_f32_16x16x32_bf16 v[248:251], a[248:251], a[212:215], v[248:251]
    buffer_load_dwordx4 v7, s[12:15], s39 offen offset:2048 lds
    v_mfma_f32_16x16x32_bf16 v[92:95], a[252:255], a[192:195], v[92:95]
    ds_read_b64_tr_b16 a[248:249], v42 offset:0
    v_mul_f32 v50, v60, v50
    v_mfma_f32_16x16x32_bf16 v[124:127], a[252:255], a[196:199], v[124:127]
    ds_read_b64_tr_b16 a[250:251], v42 offset:1024
    v_mul_f32 v51, v60, v51
    v_mfma_f32_16x16x32_bf16 v[156:159], a[252:255], a[200:203], v[156:159]
    ds_read_b128 a[232:235], v40 offset:8192
    v_mul_f32 v52, v60, v52
    v_mfma_f32_16x16x32_bf16 v[188:191], a[252:255], a[204:207], v[188:191]
    ds_read_b128 a[236:239], v40 offset:10240
    v_mul_f32 v53, v60, v53
    v_mfma_f32_16x16x32_bf16 v[220:223], a[252:255], a[208:211], v[220:223]
    s_add_u32 m0, s42, 32768
    s_waitcnt lgkmcnt(6)
    v_mul_f32 v54, v60, v54
    v_mfma_f32_16x16x32_bf16 v[252:255], a[252:255], a[212:215], v[252:255]
    buffer_load_dwordx4 v38, s[12:15], s39 offen offset:3072 lds
    v_mfma_f32_16x16x32_bf16 v[64:67], a[240:243], a[216:219], v[64:67]
    s_waitcnt lgkmcnt(4)
    s_add_u32 s39, s39, 262144
    v_mul_f32 v55, v60, v55
    v_mfma_f32_16x16x32_bf16 v[96:99], a[240:243], a[220:223], v[96:99]
    ds_read_b64_tr_b16 a[252:253], v42 offset:8
    s_cmp_eq_u32 s39, 5242880
    s_cselect_b32 s39, 0, s39
    v_mfma_f32_16x16x32_bf16 v[128:131], a[240:243], a[224:227], v[128:131]
    ds_read_b64_tr_b16 a[254:255], v42 offset:1032
    s_add_u32 m0, s42, 65536
    v_mfma_f32_16x16x32_bf16 v[160:163], a[240:243], a[228:231], v[160:163]
    s_waitcnt lgkmcnt(2)
    buffer_load_dwordx4 v5, s[12:15], s39 offen offset:0 lds
    v_mfma_f32_16x16x32_bf16 v[192:195], a[240:243], a[232:235], v[192:195]
    v_cvt_pk_bf16_f32 v34, v48, v49
    v_cvt_pk_bf16_f32 v35, v50, v51
    v_mfma_f32_16x16x32_bf16 v[224:227], a[240:243], a[236:239], v[224:227]
    v_cvt_pk_bf16_f32 v36, v52, v53
    v_cvt_pk_bf16_f32 v37, v54, v55
    v_mfma_f32_16x16x32_bf16 v[68:71], a[244:247], a[216:219], v[68:71]
    s_add_u32 s56, s48, 8192
    buffer_store_dwordx4 v[34:37], v57, s[20:23], s56 offen offset:0 sc1
    v_mfma_f32_16x16x32_bf16 v[100:103], a[244:247], a[220:223], v[100:103]
    ds_read_b64_tr_b16 a[240:241], v43 offset:0
    v_accvgpr_read_b32 v48, a80
    v_mfma_f32_16x16x32_bf16 v[132:135], a[244:247], a[224:227], v[132:135]
    ds_read_b64_tr_b16 a[242:243], v43 offset:1024
    s_add_u32 m0, s42, 65536
    v_mfma_f32_16x16x32_bf16 v[164:167], a[244:247], a[228:231], v[164:167]
    buffer_load_dwordx4 v6, s[12:15], s39 offen offset:1024 lds
    v_mfma_f32_16x16x32_bf16 v[196:199], a[244:247], a[232:235], v[196:199]
    v_accvgpr_read_b32 v49, a81
    v_accvgpr_read_b32 v50, a82
    v_mfma_f32_16x16x32_bf16 v[228:231], a[244:247], a[236:239], v[228:231]
    v_accvgpr_read_b32 v51, a83
    v_accvgpr_read_b32 v52, a84
    v_mfma_f32_16x16x32_bf16 v[72:75], a[248:251], a[216:219], v[72:75]
    v_accvgpr_read_b32 v53, a85
    v_accvgpr_read_b32 v54, a86
    v_mfma_f32_16x16x32_bf16 v[104:107], a[248:251], a[220:223], v[104:107]
    ds_read_b64_tr_b16 a[244:245], v43 offset:8
    v_accvgpr_read_b32 v55, a87
    v_mfma_f32_16x16x32_bf16 v[136:139], a[248:251], a[224:227], v[136:139]
    ds_read_b64_tr_b16 a[246:247], v43 offset:1032
    s_add_u32 m0, s42, 65536
    v_mfma_f32_16x16x32_bf16 v[168:171], a[248:251], a[228:231], v[168:171]
    buffer_load_dwordx4 v7, s[12:15], s39 offen offset:2048 lds
    v_mfma_f32_16x16x32_bf16 v[200:203], a[248:251], a[232:235], v[200:203]
    v_mul_f32 v48, v60, v48
    v_mul_f32 v49, v60, v49
    v_mfma_f32_16x16x32_bf16 v[232:235], a[248:251], a[236:239], v[232:235]
    s_waitcnt lgkmcnt(4)
    v_mul_f32 v50, v60, v50
    v_mul_f32 v51, v60, v51
    v_mfma_f32_16x16x32_bf16 v[76:79], a[252:255], a[216:219], v[76:79]
    v_mul_f32 v52, v60, v52
    v_mul_f32 v53, v60, v53
    v_mfma_f32_16x16x32_bf16 v[108:111], a[252:255], a[220:223], v[108:111]
    ds_read_b64_tr_b16 a[248:249], v44 offset:0
    v_mul_f32 v54, v60, v54
    v_mfma_f32_16x16x32_bf16 v[140:143], a[252:255], a[224:227], v[140:143]
    ds_read_b64_tr_b16 a[250:251], v44 offset:1024
    s_add_u32 m0, s42, 65536
    v_mfma_f32_16x16x32_bf16 v[172:175], a[252:255], a[228:231], v[172:175]
    buffer_load_dwordx4 v38, s[12:15], s39 offen offset:3072 lds
    v_mfma_f32_16x16x32_bf16 v[204:207], a[252:255], a[232:235], v[204:207]
    s_add_u32 s39, s39, 262144
    v_mul_f32 v55, v60, v55
    v_cvt_pk_bf16_f32 v34, v48, v49
    v_mfma_f32_16x16x32_bf16 v[236:239], a[252:255], a[236:239], v[236:239]
    s_waitcnt lgkmcnt(4)
    s_cmp_eq_u32 s39, 5242880
    s_cselect_b32 s39, 0, s39
    v_mfma_f32_16x16x32_bf16 v[80:83], a[240:243], a[216:219], v[80:83]
    v_cvt_pk_bf16_f32 v35, v50, v51
    v_cvt_pk_bf16_f32 v36, v52, v53
    v_mfma_f32_16x16x32_bf16 v[112:115], a[240:243], a[220:223], v[112:115]
    ds_read_b64_tr_b16 a[252:253], v44 offset:8
    v_cvt_pk_bf16_f32 v37, v54, v55
    v_mfma_f32_16x16x32_bf16 v[144:147], a[240:243], a[224:227], v[144:147]
    ds_read_b64_tr_b16 a[254:255], v44 offset:1032
    v_xor_b32 v40, 0x10040, v40
    v_mfma_f32_16x16x32_bf16 v[176:179], a[240:243], a[228:231], v[176:179]
    v_subrev_u32 v41, 0x18000, v41
    v_subrev_u32 v42, 0x18000, v42
    v_mfma_f32_16x16x32_bf16 v[208:211], a[240:243], a[232:235], v[208:211]
    v_subrev_u32 v43, 0x18000, v43
    v_accvgpr_read_b32 v48, a88
    v_mfma_f32_16x16x32_bf16 v[240:243], a[240:243], a[236:239], v[240:243]
    s_waitcnt vmcnt(10)
    s_waitcnt lgkmcnt(4)
    v_subrev_u32 v44, 0x18000, v44
    v_mfma_f32_16x16x32_bf16 v[84:87], a[244:247], a[216:219], v[84:87]
    s_add_u32 s56, s48, 12288
    buffer_store_dwordx4 v[34:37], v57, s[20:23], s56 offen offset:2048 sc1
    v_mfma_f32_16x16x32_bf16 v[116:119], a[244:247], a[220:223], v[116:119]
    s_waitcnt lgkmcnt(0)
    s_barrier
    v_mfma_f32_16x16x32_bf16 v[148:151], a[244:247], a[224:227], v[148:151]
    ds_read_b64_tr_b16 a[240:241], v41 offset:0
    v_accvgpr_read_b32 v49, a89
    v_mfma_f32_16x16x32_bf16 v[180:183], a[244:247], a[228:231], v[180:183]
    ds_read_b64_tr_b16 a[242:243], v41 offset:1024
    v_accvgpr_read_b32 v50, a90
    v_mfma_f32_16x16x32_bf16 v[212:215], a[244:247], a[232:235], v[212:215]
    ds_read_b128 a[192:195], v40 offset:0
    s_add_u32 m0, s41, 65536
    v_mfma_f32_16x16x32_bf16 v[244:247], a[244:247], a[236:239], v[244:247]
    buffer_load_dwordx4 v2, s[8:11], s38 offen offset:0 lds
    v_mfma_f32_16x16x32_bf16 v[88:91], a[248:251], a[216:219], v[88:91]
    ds_read_b64_tr_b16 a[244:245], v41 offset:8
    v_accvgpr_read_b32 v51, a91
    v_mfma_f32_16x16x32_bf16 v[120:123], a[248:251], a[220:223], v[120:123]
    ds_read_b64_tr_b16 a[246:247], v41 offset:1032
    v_accvgpr_read_b32 v52, a92
    v_mfma_f32_16x16x32_bf16 v[152:155], a[248:251], a[224:227], v[152:155]
    ds_read_b128 a[196:199], v40 offset:2048
    v_accvgpr_read_b32 v53, a93
    v_mfma_f32_16x16x32_bf16 v[184:187], a[248:251], a[228:231], v[184:187]
    ds_read_b128 a[200:203], v40 offset:4096
    v_accvgpr_read_b32 v54, a94
    v_mfma_f32_16x16x32_bf16 v[216:219], a[248:251], a[232:235], v[216:219]
    ds_read_b128 a[204:207], v40 offset:6144
    s_add_u32 m0, s41, 65536
    v_mfma_f32_16x16x32_bf16 v[248:251], a[248:251], a[236:239], v[248:251]
    buffer_load_dwordx4 v3, s[8:11], s38 offen offset:1024 lds
    v_mfma_f32_16x16x32_bf16 v[92:95], a[252:255], a[216:219], v[92:95]
    ds_read_b64_tr_b16 a[248:249], v42 offset:0
    v_accvgpr_read_b32 v55, a95
    v_mfma_f32_16x16x32_bf16 v[124:127], a[252:255], a[220:223], v[124:127]
    ds_read_b64_tr_b16 a[250:251], v42 offset:1024
    v_mul_f32 v48, v60, v48
    v_mfma_f32_16x16x32_bf16 v[156:159], a[252:255], a[224:227], v[156:159]
    ds_read_b128 a[208:211], v40 offset:8192
    v_mul_f32 v49, v60, v49
    v_mfma_f32_16x16x32_bf16 v[188:191], a[252:255], a[228:231], v[188:191]
    ds_read_b128 a[212:215], v40 offset:10240
    v_mul_f32 v50, v60, v50
    v_mfma_f32_16x16x32_bf16 v[220:223], a[252:255], a[232:235], v[220:223]
    s_add_u32 m0, s41, 65536
    s_waitcnt lgkmcnt(6)
    v_mul_f32 v51, v60, v51
    v_mfma_f32_16x16x32_bf16 v[252:255], a[252:255], a[236:239], v[252:255]
    buffer_load_dwordx4 v4, s[8:11], s38 offen offset:2048 lds
    v_mfma_f32_16x16x32_bf16 v[64:67], a[240:243], a[192:195], v[64:67]
    s_waitcnt lgkmcnt(4)
    s_add_u32 s54, s38, 30720
    v_mul_f32 v52, v60, v52
    v_mfma_f32_16x16x32_bf16 v[96:99], a[240:243], a[196:199], v[96:99]
    ds_read_b64_tr_b16 a[252:253], v42 offset:8
    v_mul_f32 v53, v60, v53
    v_mfma_f32_16x16x32_bf16 v[128:131], a[240:243], a[200:203], v[128:131]
    ds_read_b64_tr_b16 a[254:255], v42 offset:1032
    s_add_u32 m0, s41, 68608
    v_mfma_f32_16x16x32_bf16 v[160:163], a[240:243], a[204:207], v[160:163]
    s_waitcnt lgkmcnt(2)
    buffer_load_dwordx4 v2, s[8:11], s54 offen offset:0 lds
    v_mfma_f32_16x16x32_bf16 v[192:195], a[240:243], a[208:211], v[192:195]
    v_mul_f32 v54, v60, v54
    v_mul_f32 v55, v60, v55
    v_mfma_f32_16x16x32_bf16 v[224:227], a[240:243], a[212:215], v[224:227]
    v_cvt_pk_bf16_f32 v34, v48, v49
    v_cvt_pk_bf16_f32 v35, v50, v51
    v_mfma_f32_16x16x32_bf16 v[68:71], a[244:247], a[192:195], v[68:71]
    v_cvt_pk_bf16_f32 v36, v52, v53
    v_cvt_pk_bf16_f32 v37, v54, v55
    v_mfma_f32_16x16x32_bf16 v[100:103], a[244:247], a[196:199], v[100:103]
    ds_read_b64_tr_b16 a[240:241], v43 offset:0
    v_accvgpr_read_b32 v48, a96
    v_mfma_f32_16x16x32_bf16 v[132:135], a[244:247], a[200:203], v[132:135]
    ds_read_b64_tr_b16 a[242:243], v43 offset:1024
    s_add_u32 m0, s41, 68608
    v_mfma_f32_16x16x32_bf16 v[164:167], a[244:247], a[204:207], v[164:167]
    buffer_load_dwordx4 v3, s[8:11], s54 offen offset:1024 lds
    v_mfma_f32_16x16x32_bf16 v[196:199], a[244:247], a[208:211], v[196:199]
    s_add_u32 s56, s48, 20480
    buffer_store_dwordx4 v[34:37], v57, s[20:23], s56 offen offset:0 sc1
    v_mfma_f32_16x16x32_bf16 v[228:231], a[244:247], a[212:215], v[228:231]
    v_accvgpr_read_b32 v49, a97
    v_accvgpr_read_b32 v50, a98
    v_mfma_f32_16x16x32_bf16 v[72:75], a[248:251], a[192:195], v[72:75]
    v_accvgpr_read_b32 v51, a99
    v_accvgpr_read_b32 v52, a100
    v_mfma_f32_16x16x32_bf16 v[104:107], a[248:251], a[196:199], v[104:107]
    ds_read_b64_tr_b16 a[244:245], v43 offset:8
    v_accvgpr_read_b32 v53, a101
    v_mfma_f32_16x16x32_bf16 v[136:139], a[248:251], a[200:203], v[136:139]
    ds_read_b64_tr_b16 a[246:247], v43 offset:1032
    s_add_u32 m0, s41, 68608
    v_mfma_f32_16x16x32_bf16 v[168:171], a[248:251], a[204:207], v[168:171]
    buffer_load_dwordx4 v4, s[8:11], s54 offen offset:2048 lds
    v_mfma_f32_16x16x32_bf16 v[200:203], a[248:251], a[208:211], v[200:203]
    s_add_u32 s38, s38, 128
    v_accvgpr_read_b32 v54, a102
    v_accvgpr_read_b32 v55, a103
    v_mfma_f32_16x16x32_bf16 v[232:235], a[248:251], a[212:215], v[232:235]
    s_waitcnt lgkmcnt(4)
    s_cmp_eq_u32 s38, 1280
    s_cselect_b32 s38, 0, s38
    v_mfma_f32_16x16x32_bf16 v[76:79], a[252:255], a[192:195], v[76:79]
    v_mul_f32 v48, v61, v48
    v_mul_f32 v49, v61, v49
    v_mfma_f32_16x16x32_bf16 v[108:111], a[252:255], a[196:199], v[108:111]
    ds_read_b64_tr_b16 a[248:249], v44 offset:0
    v_mul_f32 v50, v61, v50
    v_mfma_f32_16x16x32_bf16 v[140:143], a[252:255], a[200:203], v[140:143]
    ds_read_b64_tr_b16 a[250:251], v44 offset:1024
    s_add_u32 m0, s42, 98304
    v_mfma_f32_16x16x32_bf16 v[172:175], a[252:255], a[204:207], v[172:175]
    buffer_load_dwordx4 v5, s[12:15], s39 offen offset:0 lds
    v_mfma_f32_16x16x32_bf16 v[204:207], a[252:255], a[208:211], v[204:207]
    v_mul_f32 v51, v61, v51
    v_mul_f32 v52, v61, v52
    v_mfma_f32_16x16x32_bf16 v[236:239], a[252:255], a[212:215], v[236:239]
    s_waitcnt lgkmcnt(4)
    v_mul_f32 v53, v61, v53
    v_mul_f32 v54, v61, v54
    v_mfma_f32_16x16x32_bf16 v[80:83], a[240:243], a[192:195], v[80:83]
    v_mul_f32 v55, v61, v55
    v_cvt_pk_bf16_f32 v34, v48, v49
    v_mfma_f32_16x16x32_bf16 v[112:115], a[240:243], a[196:199], v[112:115]
    ds_read_b64_tr_b16 a[252:253], v44 offset:8
    v_cvt_pk_bf16_f32 v35, v50, v51
    v_mfma_f32_16x16x32_bf16 v[144:147], a[240:243], a[200:203], v[144:147]
    ds_read_b64_tr_b16 a[254:255], v44 offset:1032
    v_xor_b32 v40, 0x40, v40
    v_mfma_f32_16x16x32_bf16 v[176:179], a[240:243], a[204:207], v[176:179]
    v_add_u32 v41, 0x8000, v41
    v_add_u32 v42, 0x8000, v42
    v_mfma_f32_16x16x32_bf16 v[208:211], a[240:243], a[208:211], v[208:211]
    v_add_u32 v43, 0x8000, v43
    v_cvt_pk_bf16_f32 v36, v52, v53
    v_mfma_f32_16x16x32_bf16 v[240:243], a[240:243], a[212:215], v[240:243]
    s_waitcnt vmcnt(14)
    s_waitcnt lgkmcnt(4)
    v_add_u32 v44, 0x8000, v44
    v_mfma_f32_16x16x32_bf16 v[84:87], a[244:247], a[192:195], v[84:87]
    v_cvt_pk_bf16_f32 v37, v54, v55
    v_accvgpr_read_b32 v48, a104
    v_mfma_f32_16x16x32_bf16 v[116:119], a[244:247], a[196:199], v[116:119]
    s_waitcnt lgkmcnt(0)
    s_barrier
    v_mfma_f32_16x16x32_bf16 v[148:151], a[244:247], a[200:203], v[148:151]
    ds_read_b64_tr_b16 a[240:241], v41 offset:0
    v_accvgpr_read_b32 v49, a105
    v_mfma_f32_16x16x32_bf16 v[180:183], a[244:247], a[204:207], v[180:183]
    ds_read_b64_tr_b16 a[242:243], v41 offset:1024
    v_accvgpr_read_b32 v50, a106
    v_mfma_f32_16x16x32_bf16 v[212:215], a[244:247], a[208:211], v[212:215]
    ds_read_b128 a[216:219], v40 offset:0
    s_add_u32 m0, s42, 98304
    v_mfma_f32_16x16x32_bf16 v[244:247], a[244:247], a[212:215], v[244:247]
    buffer_load_dwordx4 v6, s[12:15], s39 offen offset:1024 lds
    v_mfma_f32_16x16x32_bf16 v[88:91], a[248:251], a[192:195], v[88:91]
    ds_read_b64_tr_b16 a[244:245], v41 offset:8
    v_accvgpr_read_b32 v51, a107
    v_mfma_f32_16x16x32_bf16 v[120:123], a[248:251], a[196:199], v[120:123]
    ds_read_b64_tr_b16 a[246:247], v41 offset:1032
    v_accvgpr_read_b32 v52, a108
    v_mfma_f32_16x16x32_bf16 v[152:155], a[248:251], a[200:203], v[152:155]
    ds_read_b128 a[220:223], v40 offset:2048
    v_accvgpr_read_b32 v53, a109
    v_mfma_f32_16x16x32_bf16 v[184:187], a[248:251], a[204:207], v[184:187]
    ds_read_b128 a[224:227], v40 offset:4096
    v_accvgpr_read_b32 v54, a110
    v_mfma_f32_16x16x32_bf16 v[216:219], a[248:251], a[208:211], v[216:219]
    ds_read_b128 a[228:231], v40 offset:6144
    s_add_u32 m0, s42, 98304
    v_mfma_f32_16x16x32_bf16 v[248:251], a[248:251], a[212:215], v[248:251]
    buffer_load_dwordx4 v7, s[12:15], s39 offen offset:2048 lds
    v_mfma_f32_16x16x32_bf16 v[92:95], a[252:255], a[192:195], v[92:95]
    ds_read_b64_tr_b16 a[248:249], v42 offset:0
    v_accvgpr_read_b32 v55, a111
    v_mfma_f32_16x16x32_bf16 v[124:127], a[252:255], a[196:199], v[124:127]
    ds_read_b64_tr_b16 a[250:251], v42 offset:1024
    v_mul_f32 v48, v61, v48
    v_mfma_f32_16x16x32_bf16 v[156:159], a[252:255], a[200:203], v[156:159]
    ds_read_b128 a[232:235], v40 offset:8192
    v_mul_f32 v49, v61, v49
    v_mfma_f32_16x16x32_bf16 v[188:191], a[252:255], a[204:207], v[188:191]
    ds_read_b128 a[236:239], v40 offset:10240
    v_mul_f32 v50, v61, v50
    v_mfma_f32_16x16x32_bf16 v[220:223], a[252:255], a[208:211], v[220:223]
    s_add_u32 m0, s42, 98304
    s_waitcnt lgkmcnt(6)
    v_mul_f32 v51, v61, v51
    v_mfma_f32_16x16x32_bf16 v[252:255], a[252:255], a[212:215], v[252:255]
    buffer_load_dwordx4 v38, s[12:15], s39 offen offset:3072 lds
    v_mfma_f32_16x16x32_bf16 v[64:67], a[240:243], a[216:219], v[64:67]
    s_waitcnt lgkmcnt(4)
    s_add_u32 s39, s39, 262144
    v_mul_f32 v52, v61, v52
    v_mfma_f32_16x16x32_bf16 v[96:99], a[240:243], a[220:223], v[96:99]
    ds_read_b64_tr_b16 a[252:253], v42 offset:8
    s_cmp_eq_u32 s39, 5242880
    s_cselect_b32 s39, 0, s39
    v_mfma_f32_16x16x32_bf16 v[128:131], a[240:243], a[224:227], v[128:131]
    ds_read_b64_tr_b16 a[254:255], v42 offset:1032
    s_add_u32 m0, s42, 0
    v_mfma_f32_16x16x32_bf16 v[160:163], a[240:243], a[228:231], v[160:163]
    s_waitcnt lgkmcnt(2)
    buffer_load_dwordx4 v5, s[12:15], s39 offen offset:0 lds
    v_mfma_f32_16x16x32_bf16 v[192:195], a[240:243], a[232:235], v[192:195]
    s_add_u32 s56, s48, 0
    buffer_store_dwordx4 v[34:37], v57, s[20:23], s56 offen offset:3072 sc1
    v_mfma_f32_16x16x32_bf16 v[224:227], a[240:243], a[236:239], v[224:227]
    v_mul_f32 v53, v61, v53
    v_mul_f32 v54, v61, v54
    v_mfma_f32_16x16x32_bf16 v[68:71], a[244:247], a[216:219], v[68:71]
    v_mul_f32 v55, v61, v55
    v_cvt_pk_bf16_f32 v34, v48, v49
    v_mfma_f32_16x16x32_bf16 v[100:103], a[244:247], a[220:223], v[100:103]
    ds_read_b64_tr_b16 a[240:241], v43 offset:0
    v_cvt_pk_bf16_f32 v35, v50, v51
    v_mfma_f32_16x16x32_bf16 v[132:135], a[244:247], a[224:227], v[132:135]
    ds_read_b64_tr_b16 a[242:243], v43 offset:1024
    s_add_u32 m0, s42, 0
    v_mfma_f32_16x16x32_bf16 v[164:167], a[244:247], a[228:231], v[164:167]
    buffer_load_dwordx4 v6, s[12:15], s39 offen offset:1024 lds
    v_mfma_f32_16x16x32_bf16 v[196:199], a[244:247], a[232:235], v[196:199]
    v_cvt_pk_bf16_f32 v36, v52, v53
    v_cvt_pk_bf16_f32 v37, v54, v55
    v_mfma_f32_16x16x32_bf16 v[228:231], a[244:247], a[236:239], v[228:231]
    s_add_u32 s56, s48, 8192
    buffer_store_dwordx4 v[34:37], v57, s[20:23], s56 offen offset:1024 sc1
    v_mfma_f32_16x16x32_bf16 v[72:75], a[248:251], a[216:219], v[72:75]
    v_accvgpr_read_b32 v48, a112
    v_accvgpr_read_b32 v49, a113
    v_mfma_f32_16x16x32_bf16 v[104:107], a[248:251], a[220:223], v[104:107]
    ds_read_b64_tr_b16 a[244:245], v43 offset:8
    v_accvgpr_read_b32 v50, a114
    v_mfma_f32_16x16x32_bf16 v[136:139], a[248:251], a[224:227], v[136:139]
    ds_read_b64_tr_b16 a[246:247], v43 offset:1032
    s_add_u32 m0, s42, 0
    v_mfma_f32_16x16x32_bf16 v[168:171], a[248:251], a[228:231], v[168:171]
    buffer_load_dwordx4 v7, s[12:15], s39 offen offset:2048 lds
    v_mfma_f32_16x16x32_bf16 v[200:203], a[248:251], a[232:235], v[200:203]
    v_accvgpr_read_b32 v51, a115
    v_accvgpr_read_b32 v52, a116
    v_mfma_f32_16x16x32_bf16 v[232:235], a[248:251], a[236:239], v[232:235]
    s_waitcnt lgkmcnt(4)
    v_accvgpr_read_b32 v53, a117
    v_accvgpr_read_b32 v54, a118
    v_mfma_f32_16x16x32_bf16 v[76:79], a[252:255], a[216:219], v[76:79]
    v_accvgpr_read_b32 v55, a119
    v_mul_f32 v48, v61, v48
    v_mfma_f32_16x16x32_bf16 v[108:111], a[252:255], a[220:223], v[108:111]
    ds_read_b64_tr_b16 a[248:249], v44 offset:0
    v_mul_f32 v49, v61, v49
    v_mfma_f32_16x16x32_bf16 v[140:143], a[252:255], a[224:227], v[140:143]
    ds_read_b64_tr_b16 a[250:251], v44 offset:1024
    s_add_u32 m0, s42, 0
    v_mfma_f32_16x16x32_bf16 v[172:175], a[252:255], a[228:231], v[172:175]
    buffer_load_dwordx4 v38, s[12:15], s39 offen offset:3072 lds
    v_mfma_f32_16x16x32_bf16 v[204:207], a[252:255], a[232:235], v[204:207]
    s_add_u32 s39, s39, 262144
    v_mul_f32 v50, v61, v50
    v_mul_f32 v51, v61, v51
    v_mfma_f32_16x16x32_bf16 v[236:239], a[252:255], a[236:239], v[236:239]
    s_waitcnt lgkmcnt(4)
    s_cmp_eq_u32 s39, 5242880
    s_cselect_b32 s39, 0, s39
    v_mfma_f32_16x16x32_bf16 v[80:83], a[240:243], a[216:219], v[80:83]
    v_mul_f32 v52, v61, v52
    v_mul_f32 v53, v61, v53
    v_mfma_f32_16x16x32_bf16 v[112:115], a[240:243], a[220:223], v[112:115]
    ds_read_b64_tr_b16 a[252:253], v44 offset:8
    v_mul_f32 v54, v61, v54
    v_mfma_f32_16x16x32_bf16 v[144:147], a[240:243], a[224:227], v[144:147]
    ds_read_b64_tr_b16 a[254:255], v44 offset:1032
    v_xor_b32 v40, 0x10040, v40
    v_mfma_f32_16x16x32_bf16 v[176:179], a[240:243], a[228:231], v[176:179]
    v_add_u32 v41, 0x8000, v41
    v_add_u32 v42, 0x8000, v42
    v_mfma_f32_16x16x32_bf16 v[208:211], a[240:243], a[232:235], v[208:211]
    v_add_u32 v43, 0x8000, v43
    v_mul_f32 v55, v61, v55
    v_mfma_f32_16x16x32_bf16 v[240:243], a[240:243], a[236:239], v[240:243]
    s_waitcnt vmcnt(10)
    s_waitcnt lgkmcnt(4)
    v_add_u32 v44, 0x8000, v44
    v_mfma_f32_16x16x32_bf16 v[84:87], a[244:247], a[216:219], v[84:87]
    v_cvt_pk_bf16_f32 v34, v48, v49
    v_cvt_pk_bf16_f32 v35, v50, v51
    v_mfma_f32_16x16x32_bf16 v[116:119], a[244:247], a[220:223], v[116:119]
    s_waitcnt lgkmcnt(0)
    s_barrier
    v_mfma_f32_16x16x32_bf16 v[148:151], a[244:247], a[224:227], v[148:151]
    ds_read_b64_tr_b16 a[240:241], v41 offset:0
    v_cvt_pk_bf16_f32 v36, v52, v53
    v_mfma_f32_16x16x32_bf16 v[180:183], a[244:247], a[228:231], v[180:183]
    ds_read_b64_tr_b16 a[242:243], v41 offset:1024
    v_cvt_pk_bf16_f32 v37, v54, v55
    v_mfma_f32_16x16x32_bf16 v[212:215], a[244:247], a[232:235], v[212:215]
    ds_read_b128 a[192:195], v40 offset:0
    s_add_u32 m0, s41, 0
    v_mfma_f32_16x16x32_bf16 v[244:247], a[244:247], a[236:239], v[244:247]
    buffer_load_dwordx4 v2, s[8:11], s38 offen offset:0 lds
    v_mfma_f32_16x16x32_bf16 v[88:91], a[248:251], a[216:219], v[88:91]
    ds_read_b64_tr_b16 a[244:245], v41 offset:8
    v_accvgpr_read_b32 v48, a120
    v_mfma_f32_16x16x32_bf16 v[120:123], a[248:251], a[220:223], v[120:123]
    ds_read_b64_tr_b16 a[246:247], v41 offset:1032
    v_accvgpr_read_b32 v49, a121
    v_mfma_f32_16x16x32_bf16 v[152:155], a[248:251], a[224:227], v[152:155]
    ds_read_b128 a[196:199], v40 offset:2048
    v_accvgpr_read_b32 v50, a122
    v_mfma_f32_16x16x32_bf16 v[184:187], a[248:251], a[228:231], v[184:187]
    ds_read_b128 a[200:203], v40 offset:4096
    v_accvgpr_read_b32 v51, a123
    v_mfma_f32_16x16x32_bf16 v[216:219], a[248:251], a[232:235], v[216:219]
    ds_read_b128 a[204:207], v40 offset:6144
    s_add_u32 m0, s41, 0
    v_mfma_f32_16x16x32_bf16 v[248:251], a[248:251], a[236:239], v[248:251]
    buffer_load_dwordx4 v3, s[8:11], s38 offen offset:1024 lds
    v_mfma_f32_16x16x32_bf16 v[92:95], a[252:255], a[216:219], v[92:95]
    ds_read_b64_tr_b16 a[248:249], v42 offset:0
    v_accvgpr_read_b32 v52, a124
    v_mfma_f32_16x16x32_bf16 v[124:127], a[252:255], a[220:223], v[124:127]
    ds_read_b64_tr_b16 a[250:251], v42 offset:1024
    v_accvgpr_read_b32 v53, a125
    v_mfma_f32_16x16x32_bf16 v[156:159], a[252:255], a[224:227], v[156:159]
    ds_read_b128 a[208:211], v40 offset:8192
    v_accvgpr_read_b32 v54, a126
    v_mfma_f32_16x16x32_bf16 v[188:191], a[252:255], a[228:231], v[188:191]
    ds_read_b128 a[212:215], v40 offset:10240
    v_accvgpr_read_b32 v55, a127
    v_mfma_f32_16x16x32_bf16 v[220:223], a[252:255], a[232:235], v[220:223]
    s_add_u32 m0, s41, 0
    s_waitcnt lgkmcnt(6)
    v_mul_f32 v48, v61, v48
    v_mfma_f32_16x16x32_bf16 v[252:255], a[252:255], a[236:239], v[252:255]
    buffer_load_dwordx4 v4, s[8:11], s38 offen offset:2048 lds
    v_mfma_f32_16x16x32_bf16 v[64:67], a[240:243], a[192:195], v[64:67]
    s_waitcnt lgkmcnt(4)
    s_add_u32 s54, s38, 30720
    v_mul_f32 v49, v61, v49
    v_mfma_f32_16x16x32_bf16 v[96:99], a[240:243], a[196:199], v[96:99]
    ds_read_b64_tr_b16 a[252:253], v42 offset:8
    v_mul_f32 v50, v61, v50
    v_mfma_f32_16x16x32_bf16 v[128:131], a[240:243], a[200:203], v[128:131]
    ds_read_b64_tr_b16 a[254:255], v42 offset:1032
    s_add_u32 m0, s41, 3072
    v_mfma_f32_16x16x32_bf16 v[160:163], a[240:243], a[204:207], v[160:163]
    s_waitcnt lgkmcnt(2)
    buffer_load_dwordx4 v2, s[8:11], s54 offen offset:0 lds
    v_mfma_f32_16x16x32_bf16 v[192:195], a[240:243], a[208:211], v[192:195]
    s_add_u32 s56, s48, 12288
    buffer_store_dwordx4 v[34:37], v57, s[20:23], s56 offen offset:3072 sc1
    v_mfma_f32_16x16x32_bf16 v[224:227], a[240:243], a[212:215], v[224:227]
    v_mul_f32 v51, v61, v51
    v_mul_f32 v52, v61, v52
    v_mfma_f32_16x16x32_bf16 v[68:71], a[244:247], a[192:195], v[68:71]
    v_mul_f32 v53, v61, v53
    v_mul_f32 v54, v61, v54
    v_mfma_f32_16x16x32_bf16 v[100:103], a[244:247], a[196:199], v[100:103]
    ds_read_b64_tr_b16 a[240:241], v43 offset:0
    v_mul_f32 v55, v61, v55
    v_mfma_f32_16x16x32_bf16 v[132:135], a[244:247], a[200:203], v[132:135]
    ds_read_b64_tr_b16 a[242:243], v43 offset:1024
    s_add_u32 m0, s41, 3072
    v_mfma_f32_16x16x32_bf16 v[164:167], a[244:247], a[204:207], v[164:167]
    buffer_load_dwordx4 v3, s[8:11], s54 offen offset:1024 lds
    v_mfma_f32_16x16x32_bf16 v[196:199], a[244:247], a[208:211], v[196:199]
    v_cvt_pk_bf16_f32 v34, v48, v49
    v_cvt_pk_bf16_f32 v35, v50, v51
    v_mfma_f32_16x16x32_bf16 v[228:231], a[244:247], a[212:215], v[228:231]
    v_cvt_pk_bf16_f32 v36, v52, v53
    v_cvt_pk_bf16_f32 v37, v54, v55
    v_mfma_f32_16x16x32_bf16 v[72:75], a[248:251], a[192:195], v[72:75]
    s_add_u32 s56, s48, 20480
    buffer_store_dwordx4 v[34:37], v57, s[20:23], s56 offen offset:1024 sc1
    v_mfma_f32_16x16x32_bf16 v[104:107], a[248:251], a[196:199], v[104:107]
    ds_read_b64_tr_b16 a[244:245], v43 offset:8
    v_accvgpr_read_b32 v48, a128
    v_mfma_f32_16x16x32_bf16 v[136:139], a[248:251], a[200:203], v[136:139]
    ds_read_b64_tr_b16 a[246:247], v43 offset:1032
    s_add_u32 m0, s41, 3072
    v_mfma_f32_16x16x32_bf16 v[168:171], a[248:251], a[204:207], v[168:171]
    buffer_load_dwordx4 v4, s[8:11], s54 offen offset:2048 lds
    v_mfma_f32_16x16x32_bf16 v[200:203], a[248:251], a[208:211], v[200:203]
    s_add_u32 s38, s38, 128
    v_accvgpr_read_b32 v49, a129
    v_accvgpr_read_b32 v50, a130
    v_mfma_f32_16x16x32_bf16 v[232:235], a[248:251], a[212:215], v[232:235]
    s_waitcnt lgkmcnt(4)
    s_cmp_eq_u32 s38, 1280
    s_cselect_b32 s38, 0, s38
    v_mfma_f32_16x16x32_bf16 v[76:79], a[252:255], a[192:195], v[76:79]
    v_accvgpr_read_b32 v51, a131
    v_accvgpr_read_b32 v52, a132
    v_mfma_f32_16x16x32_bf16 v[108:111], a[252:255], a[196:199], v[108:111]
    ds_read_b64_tr_b16 a[248:249], v44 offset:0
    v_accvgpr_read_b32 v53, a133
    v_mfma_f32_16x16x32_bf16 v[140:143], a[252:255], a[200:203], v[140:143]
    ds_read_b64_tr_b16 a[250:251], v44 offset:1024
    s_add_u32 m0, s42, 32768
    v_mfma_f32_16x16x32_bf16 v[172:175], a[252:255], a[204:207], v[172:175]
    buffer_load_dwordx4 v5, s[12:15], s39 offen offset:0 lds
    v_mfma_f32_16x16x32_bf16 v[204:207], a[252:255], a[208:211], v[204:207]
    v_accvgpr_read_b32 v54, a134
    v_accvgpr_read_b32 v55, a135
    v_mfma_f32_16x16x32_bf16 v[236:239], a[252:255], a[212:215], v[236:239]
    s_waitcnt lgkmcnt(4)
    v_mul_f32 v48, v62, v48
    v_mul_f32 v49, v62, v49
    v_mfma_f32_16x16x32_bf16 v[80:83], a[240:243], a[192:195], v[80:83]
    v_mul_f32 v50, v62, v50
    v_mul_f32 v51, v62, v51
    v_mfma_f32_16x16x32_bf16 v[112:115], a[240:243], a[196:199], v[112:115]
    ds_read_b64_tr_b16 a[252:253], v44 offset:8
    v_mul_f32 v52, v62, v52
    v_mfma_f32_16x16x32_bf16 v[144:147], a[240:243], a[200:203], v[144:147]
    ds_read_b64_tr_b16 a[254:255], v44 offset:1032
    v_xor_b32 v40, 0x40, v40
    v_mfma_f32_16x16x32_bf16 v[176:179], a[240:243], a[204:207], v[176:179]
    v_add_u32 v41, 0x8000, v41
    v_add_u32 v42, 0x8000, v42
    v_mfma_f32_16x16x32_bf16 v[208:211], a[240:243], a[208:211], v[208:211]
    v_add_u32 v43, 0x8000, v43
    v_mul_f32 v53, v62, v53
    v_mfma_f32_16x16x32_bf16 v[240:243], a[240:243], a[212:215], v[240:243]
    s_waitcnt vmcnt(15)
    s_waitcnt lgkmcnt(4)
    v_add_u32 v44, 0x8000, v44
    v_mfma_f32_16x16x32_bf16 v[84:87], a[244:247], a[192:195], v[84:87]
    v_mul_f32 v54, v62, v54
    v_mul_f32 v55, v62, v55
    v_mfma_f32_16x16x32_bf16 v[116:119], a[244:247], a[196:199], v[116:119]
    s_waitcnt lgkmcnt(0)
    s_barrier
    v_mfma_f32_16x16x32_bf16 v[148:151], a[244:247], a[200:203], v[148:151]
    ds_read_b64_tr_b16 a[240:241], v41 offset:0
    v_cvt_pk_bf16_f32 v34, v48, v49
    v_mfma_f32_16x16x32_bf16 v[180:183], a[244:247], a[204:207], v[180:183]
    ds_read_b64_tr_b16 a[242:243], v41 offset:1024
    v_cvt_pk_bf16_f32 v35, v50, v51
    v_mfma_f32_16x16x32_bf16 v[212:215], a[244:247], a[208:211], v[212:215]
    ds_read_b128 a[216:219], v40 offset:0
    s_add_u32 m0, s42, 32768
    v_mfma_f32_16x16x32_bf16 v[244:247], a[244:247], a[212:215], v[244:247]
    buffer_load_dwordx4 v6, s[12:15], s39 offen offset:1024 lds
    v_mfma_f32_16x16x32_bf16 v[88:91], a[248:251], a[192:195], v[88:91]
    ds_read_b64_tr_b16 a[244:245], v41 offset:8
    v_cvt_pk_bf16_f32 v36, v52, v53
    v_mfma_f32_16x16x32_bf16 v[120:123], a[248:251], a[196:199], v[120:123]
    ds_read_b64_tr_b16 a[246:247], v41 offset:1032
    v_cvt_pk_bf16_f32 v37, v54, v55
    v_mfma_f32_16x16x32_bf16 v[152:155], a[248:251], a[200:203], v[152:155]
    ds_read_b128 a[220:223], v40 offset:2048
    v_accvgpr_read_b32 v48, a136
    v_mfma_f32_16x16x32_bf16 v[184:187], a[248:251], a[204:207], v[184:187]
    ds_read_b128 a[224:227], v40 offset:4096
    v_accvgpr_read_b32 v49, a137
    v_mfma_f32_16x16x32_bf16 v[216:219], a[248:251], a[208:211], v[216:219]
    ds_read_b128 a[228:231], v40 offset:6144
    s_add_u32 m0, s42, 32768
    v_mfma_f32_16x16x32_bf16 v[248:251], a[248:251], a[212:215], v[248:251]
    buffer_load_dwordx4 v7, s[12:15], s39 offen offset:2048 lds
    v_mfma_f32_16x16x32_bf16 v[92:95], a[252:255], a[192:195], v[92:95]
    ds_read_b64_tr_b16 a[248:249], v42 offset:0
    v_accvgpr_read_b32 v50, a138
    v_mfma_f32_16x16x32_bf16 v[124:127], a[252:255], a[196:199], v[124:127]
    ds_read_b64_tr_b16 a[250:251], v42 offset:1024
    v_accvgpr_read_b32 v51, a139
    v_mfma_f32_16x16x32_bf16 v[156:159], a[252:255], a[200:203], v[156:159]
    ds_read_b128 a[232:235], v40 offset:8192
    v_accvgpr_read_b32 v52, a140
    v_mfma_f32_16x16x32_bf16 v[188:191], a[252:255], a[204:207], v[188:191]
    ds_read_b128 a[236:239], v40 offset:10240
    v_accvgpr_read_b32 v53, a141
    v_mfma_f32_16x16x32_bf16 v[220:223], a[252:255], a[208:211], v[220:223]
    s_add_u32 m0, s42, 32768
    s_waitcnt lgkmcnt(6)
    v_accvgpr_read_b32 v54, a142
    v_mfma_f32_16x16x32_bf16 v[252:255], a[252:255], a[212:215], v[252:255]
    buffer_load_dwordx4 v38, s[12:15], s39 offen offset:3072 lds
    v_mfma_f32_16x16x32_bf16 v[64:67], a[240:243], a[216:219], v[64:67]
    s_waitcnt lgkmcnt(4)
    s_add_u32 s39, s39, 262144
    v_accvgpr_read_b32 v55, a143
    v_mfma_f32_16x16x32_bf16 v[96:99], a[240:243], a[220:223], v[96:99]
    ds_read_b64_tr_b16 a[252:253], v42 offset:8
    s_cmp_eq_u32 s39, 5242880
    s_cselect_b32 s39, 0, s39
    v_mfma_f32_16x16x32_bf16 v[128:131], a[240:243], a[224:227], v[128:131]
    ds_read_b64_tr_b16 a[254:255], v42 offset:1032
    s_add_u32 m0, s42, 65536
    v_mfma_f32_16x16x32_bf16 v[160:163], a[240:243], a[228:231], v[160:163]
    s_waitcnt lgkmcnt(2)
    buffer_load_dwordx4 v5, s[12:15], s39 offen offset:0 lds
    v_mfma_f32_16x16x32_bf16 v[192:195], a[240:243], a[232:235], v[192:195]
    s_add_u32 s56, s48, 4096
    buffer_store_dwordx4 v[34:37], v57, s[20:23], s56 offen offset:0 sc1
    v_mfma_f32_16x16x32_bf16 v[224:227], a[240:243], a[236:239], v[224:227]
    v_mul_f32 v48, v62, v48
    v_mul_f32 v49, v62, v49
    v_mfma_f32_16x16x32_bf16 v[68:71], a[244:247], a[216:219], v[68:71]
    v_mul_f32 v50, v62, v50
    v_mul_f32 v51, v62, v51
    v_mfma_f32_16x16x32_bf16 v[100:103], a[244:247], a[220:223], v[100:103]
    ds_read_b64_tr_b16 a[240:241], v43 offset:0
    v_mul_f32 v52, v62, v52
    v_mfma_f32_16x16x32_bf16 v[132:135], a[244:247], a[224:227], v[132:135]
    ds_read_b64_tr_b16 a[242:243], v43 offset:1024
    s_add_u32 m0, s42, 65536
    v_mfma_f32_16x16x32_bf16 v[164:167], a[244:247], a[228:231], v[164:167]
    buffer_load_dwordx4 v6, s[12:15], s39 offen offset:1024 lds
    v_mfma_f32_16x16x32_bf16 v[196:199], a[244:247], a[232:235], v[196:199]
    v_mul_f32 v53, v62, v53
    v_mul_f32 v54, v62, v54
    v_mfma_f32_16x16x32_bf16 v[228:231], a[244:247], a[236:239], v[228:231]
    v_mul_f32 v55, v62, v55
    v_cvt_pk_bf16_f32 v34, v48, v49
    v_mfma_f32_16x16x32_bf16 v[72:75], a[248:251], a[216:219], v[72:75]
    v_cvt_pk_bf16_f32 v35, v50, v51
    v_cvt_pk_bf16_f32 v36, v52, v53
    v_mfma_f32_16x16x32_bf16 v[104:107], a[248:251], a[220:223], v[104:107]
    ds_read_b64_tr_b16 a[244:245], v43 offset:8
    v_cvt_pk_bf16_f32 v37, v54, v55
    v_mfma_f32_16x16x32_bf16 v[136:139], a[248:251], a[224:227], v[136:139]
    ds_read_b64_tr_b16 a[246:247], v43 offset:1032
    s_add_u32 m0, s42, 65536
    v_mfma_f32_16x16x32_bf16 v[168:171], a[248:251], a[228:231], v[168:171]
    buffer_load_dwordx4 v7, s[12:15], s39 offen offset:2048 lds
    v_mfma_f32_16x16x32_bf16 v[200:203], a[248:251], a[232:235], v[200:203]
    s_add_u32 s56, s48, 8192
    buffer_store_dwordx4 v[34:37], v57, s[20:23], s56 offen offset:2048 sc1
    v_mfma_f32_16x16x32_bf16 v[232:235], a[248:251], a[236:239], v[232:235]
    s_waitcnt lgkmcnt(4)
    v_accvgpr_read_b32 v48, a144
    v_accvgpr_read_b32 v49, a145
    v_mfma_f32_16x16x32_bf16 v[76:79], a[252:255], a[216:219], v[76:79]
    v_accvgpr_read_b32 v50, a146
    v_accvgpr_read_b32 v51, a147
    v_mfma_f32_16x16x32_bf16 v[108:111], a[252:255], a[220:223], v[108:111]
    ds_read_b64_tr_b16 a[248:249], v44 offset:0
    v_accvgpr_read_b32 v52, a148
    v_mfma_f32_16x16x32_bf16 v[140:143], a[252:255], a[224:227], v[140:143]
    ds_read_b64_tr_b16 a[250:251], v44 offset:1024
    s_add_u32 m0, s42, 65536
    v_mfma_f32_16x16x32_bf16 v[172:175], a[252:255], a[228:231], v[172:175]
    buffer_load_dwordx4 v38, s[12:15], s39 offen offset:3072 lds
    v_mfma_f32_16x16x32_bf16 v[204:207], a[252:255], a[232:235], v[204:207]
    s_add_u32 s39, s39, 262144
    v_accvgpr_read_b32 v53, a149
    v_accvgpr_read_b32 v54, a150
    v_mfma_f32_16x16x32_bf16 v[236:239], a[252:255], a[236:239], v[236:239]
    s_waitcnt lgkmcnt(4)
    s_cmp_eq_u32 s39, 5242880
    s_cselect_b32 s39, 0, s39
    v_mfma_f32_16x16x32_bf16 v[80:83], a[240:243], a[216:219], v[80:83]
    v_accvgpr_read_b32 v55, a151
    v_mul_f32 v48, v62, v48
    v_mfma_f32_16x16x32_bf16 v[112:115], a[240:243], a[220:223], v[112:115]
    ds_read_b64_tr_b16 a[252:253], v44 offset:8
    v_mul_f32 v49, v62, v49
    v_mfma_f32_16x16x32_bf16 v[144:147], a[240:243], a[224:227], v[144:147]
    ds_read_b64_tr_b16 a[254:255], v44 offset:1032
    v_xor_b32 v40, 0x10040, v40
    v_mfma_f32_16x16x32_bf16 v[176:179], a[240:243], a[228:231], v[176:179]
    v_subrev_u32 v41, 0x18000, v41
    v_subrev_u32 v42, 0x18000, v42
    v_mfma_f32_16x16x32_bf16 v[208:211], a[240:243], a[232:235], v[208:211]
    v_subrev_u32 v43, 0x18000, v43
    v_mul_f32 v50, v62, v50
    v_mfma_f32_16x16x32_bf16 v[240:243], a[240:243], a[236:239], v[240:243]
    s_waitcnt vmcnt(10)
    s_waitcnt lgkmcnt(4)
    v_subrev_u32 v44, 0x18000, v44
    v_mfma_f32_16x16x32_bf16 v[84:87], a[244:247], a[216:219], v[84:87]
    v_mul_f32 v51, v62, v51
    v_mul_f32 v52, v62, v52
    v_mfma_f32_16x16x32_bf16 v[116:119], a[244:247], a[220:223], v[116:119]
    s_waitcnt lgkmcnt(0)
    s_barrier
    v_mfma_f32_16x16x32_bf16 v[148:151], a[244:247], a[224:227], v[148:151]
    ds_read_b64_tr_b16 a[240:241], v41 offset:0
    v_mul_f32 v53, v62, v53
    v_mfma_f32_16x16x32_bf16 v[180:183], a[244:247], a[228:231], v[180:183]
    ds_read_b64_tr_b16 a[242:243], v41 offset:1024
    v_mul_f32 v54, v62, v54
    v_mfma_f32_16x16x32_bf16 v[212:215], a[244:247], a[232:235], v[212:215]
    ds_read_b128 a[192:195], v40 offset:0
    s_add_u32 m0, s41, 65536
    v_mfma_f32_16x16x32_bf16 v[244:247], a[244:247], a[236:239], v[244:247]
    buffer_load_dwordx4 v2, s[8:11], s38 offen offset:0 lds
    v_mfma_f32_16x16x32_bf16 v[88:91], a[248:251], a[216:219], v[88:91]
    ds_read_b64_tr_b16 a[244:245], v41 offset:8
    v_mul_f32 v55, v62, v55
    v_mfma_f32_16x16x32_bf16 v[120:123], a[248:251], a[220:223], v[120:123]
    ds_read_b64_tr_b16 a[246:247], v41 offset:1032
    v_cvt_pk_bf16_f32 v34, v48, v49
    v_mfma_f32_16x16x32_bf16 v[152:155], a[248:251], a[224:227], v[152:155]
    ds_read_b128 a[196:199], v40 offset:2048
    v_cvt_pk_bf16_f32 v35, v50, v51
    v_mfma_f32_16x16x32_bf16 v[184:187], a[248:251], a[228:231], v[184:187]
    ds_read_b128 a[200:203], v40 offset:4096
    v_cvt_pk_bf16_f32 v36, v52, v53
    v_mfma_f32_16x16x32_bf16 v[216:219], a[248:251], a[232:235], v[216:219]
    ds_read_b128 a[204:207], v40 offset:6144
    s_add_u32 m0, s41, 65536
    v_mfma_f32_16x16x32_bf16 v[248:251], a[248:251], a[236:239], v[248:251]
    buffer_load_dwordx4 v3, s[8:11], s38 offen offset:1024 lds
    v_mfma_f32_16x16x32_bf16 v[92:95], a[252:255], a[216:219], v[92:95]
    ds_read_b64_tr_b16 a[248:249], v42 offset:0
    v_cvt_pk_bf16_f32 v37, v54, v55
    v_mfma_f32_16x16x32_bf16 v[124:127], a[252:255], a[220:223], v[124:127]
    ds_read_b64_tr_b16 a[250:251], v42 offset:1024
    v_accvgpr_read_b32 v48, a152
    v_mfma_f32_16x16x32_bf16 v[156:159], a[252:255], a[224:227], v[156:159]
    ds_read_b128 a[208:211], v40 offset:8192
    v_accvgpr_read_b32 v49, a153
    v_mfma_f32_16x16x32_bf16 v[188:191], a[252:255], a[228:231], v[188:191]
    ds_read_b128 a[212:215], v40 offset:10240
    v_accvgpr_read_b32 v50, a154
    v_mfma_f32_16x16x32_bf16 v[220:223], a[252:255], a[232:235], v[220:223]
    s_add_u32 m0, s41, 65536
    s_waitcnt lgkmcnt(6)
    v_accvgpr_read_b32 v51, a155
    v_mfma_f32_16x16x32_bf16 v[252:255], a[252:255], a[236:239], v[252:255]
    buffer_load_dwordx4 v4, s[8:11], s38 offen offset:2048 lds
    v_mfma_f32_16x16x32_bf16 v[64:67], a[240:243], a[192:195], v[64:67]
    s_waitcnt lgkmcnt(4)
    s_add_u32 s54, s38, 30720
    v_accvgpr_read_b32 v52, a156
    v_mfma_f32_16x16x32_bf16 v[96:99], a[240:243], a[196:199], v[96:99]
    ds_read_b64_tr_b16 a[252:253], v42 offset:8
    v_accvgpr_read_b32 v53, a157
    v_mfma_f32_16x16x32_bf16 v[128:131], a[240:243], a[200:203], v[128:131]
    ds_read_b64_tr_b16 a[254:255], v42 offset:1032
    s_add_u32 m0, s41, 68608
    v_mfma_f32_16x16x32_bf16 v[160:163], a[240:243], a[204:207], v[160:163]
    s_waitcnt lgkmcnt(2)
    buffer_load_dwordx4 v2, s[8:11], s54 offen offset:0 lds
    v_mfma_f32_16x16x32_bf16 v[192:195], a[240:243], a[208:211], v[192:195]
    s_add_u32 s56, s48, 16384
    buffer_store_dwordx4 v[34:37], v57, s[20:23], s56 offen offset:0 sc1
    v_mfma_f32_16x16x32_bf16 v[224:227], a[240:243], a[212:215], v[224:227]
    v_accvgpr_read_b32 v54, a158
    v_accvgpr_read_b32 v55, a159
    v_mfma_f32_16x16x32_bf16 v[68:71], a[244:247], a[192:195], v[68:71]
    v_mul_f32 v48, v62, v48
    v_mul_f32 v49, v62, v49
    v_mfma_f32_16x16x32_bf16 v[100:103], a[244:247], a[196:199], v[100:103]
    ds_read_b64_tr_b16 a[240:241], v43 offset:0
    v_mul_f32 v50, v62, v50
    v_mfma_f32_16x16x32_bf16 v[132:135], a[244:247], a[200:203], v[132:135]
    ds_read_b64_tr_b16 a[242:243], v43 offset:1024
    s_add_u32 m0, s41, 68608
    v_mfma_f32_16x16x32_bf16 v[164:167], a[244:247], a[204:207], v[164:167]
    buffer_load_dwordx4 v3, s[8:11], s54 offen offset:1024 lds
    v_mfma_f32_16x16x32_bf16 v[196:199], a[244:247], a[208:211], v[196:199]
    v_mul_f32 v51, v62, v51
    v_mul_f32 v52, v62, v52
    v_mfma_f32_16x16x32_bf16 v[228:231], a[244:247], a[212:215], v[228:231]
    v_mul_f32 v53, v62, v53
    v_mul_f32 v54, v62, v54
    v_mfma_f32_16x16x32_bf16 v[72:75], a[248:251], a[192:195], v[72:75]
    v_mul_f32 v55, v62, v55
    v_cvt_pk_bf16_f32 v34, v48, v49
    v_mfma_f32_16x16x32_bf16 v[104:107], a[248:251], a[196:199], v[104:107]
    ds_read_b64_tr_b16 a[244:245], v43 offset:8
    v_cvt_pk_bf16_f32 v35, v50, v51
    v_mfma_f32_16x16x32_bf16 v[136:139], a[248:251], a[200:203], v[136:139]
    ds_read_b64_tr_b16 a[246:247], v43 offset:1032
    s_add_u32 m0, s41, 68608
    v_mfma_f32_16x16x32_bf16 v[168:171], a[248:251], a[204:207], v[168:171]
    buffer_load_dwordx4 v4, s[8:11], s54 offen offset:2048 lds
    v_mfma_f32_16x16x32_bf16 v[200:203], a[248:251], a[208:211], v[200:203]
    s_add_u32 s38, s38, 128
    v_cvt_pk_bf16_f32 v36, v52, v53
    v_cvt_pk_bf16_f32 v37, v54, v55
    v_mfma_f32_16x16x32_bf16 v[232:235], a[248:251], a[212:215], v[232:235]
    s_waitcnt lgkmcnt(4)
    s_cmp_eq_u32 s38, 1280
    s_cselect_b32 s38, 0, s38
    v_mfma_f32_16x16x32_bf16 v[76:79], a[252:255], a[192:195], v[76:79]
    s_add_u32 s56, s48, 20480
    buffer_store_dwordx4 v[34:37], v57, s[20:23], s56 offen offset:2048 sc1
    v_mfma_f32_16x16x32_bf16 v[108:111], a[252:255], a[196:199], v[108:111]
    ds_read_b64_tr_b16 a[248:249], v44 offset:0
    v_accvgpr_read_b32 v48, a160
    v_mfma_f32_16x16x32_bf16 v[140:143], a[252:255], a[200:203], v[140:143]
    ds_read_b64_tr_b16 a[250:251], v44 offset:1024
    s_add_u32 m0, s42, 98304
    v_mfma_f32_16x16x32_bf16 v[172:175], a[252:255], a[204:207], v[172:175]
    buffer_load_dwordx4 v5, s[12:15], s39 offen offset:0 lds
    v_mfma_f32_16x16x32_bf16 v[204:207], a[252:255], a[208:211], v[204:207]
    v_accvgpr_read_b32 v49, a161
    v_accvgpr_read_b32 v50, a162
    v_mfma_f32_16x16x32_bf16 v[236:239], a[252:255], a[212:215], v[236:239]
    s_waitcnt lgkmcnt(4)
    v_accvgpr_read_b32 v51, a163
    v_accvgpr_read_b32 v52, a164
    v_mfma_f32_16x16x32_bf16 v[80:83], a[240:243], a[192:195], v[80:83]
    v_accvgpr_read_b32 v53, a165
    v_accvgpr_read_b32 v54, a166
    v_mfma_f32_16x16x32_bf16 v[112:115], a[240:243], a[196:199], v[112:115]
    ds_read_b64_tr_b16 a[252:253], v44 offset:8
    v_accvgpr_read_b32 v55, a167
    v_mfma_f32_16x16x32_bf16 v[144:147], a[240:243], a[200:203], v[144:147]
    ds_read_b64_tr_b16 a[254:255], v44 offset:1032
    v_xor_b32 v40, 0x40, v40
    v_mfma_f32_16x16x32_bf16 v[176:179], a[240:243], a[204:207], v[176:179]
    v_add_u32 v41, 0x8000, v41
    v_add_u32 v42, 0x8000, v42
    v_mfma_f32_16x16x32_bf16 v[208:211], a[240:243], a[208:211], v[208:211]
    v_add_u32 v43, 0x8000, v43
    v_mul_f32 v48, v63, v48
    v_mfma_f32_16x16x32_bf16 v[240:243], a[240:243], a[212:215], v[240:243]
    s_waitcnt vmcnt(15)
    s_waitcnt lgkmcnt(4)
    v_add_u32 v44, 0x8000, v44
    v_mfma_f32_16x16x32_bf16 v[84:87], a[244:247], a[192:195], v[84:87]
    v_mul_f32 v49, v63, v49
    v_mul_f32 v50, v63, v50
    v_mfma_f32_16x16x32_bf16 v[116:119], a[244:247], a[196:199], v[116:119]
    s_waitcnt lgkmcnt(0)
    s_barrier
    v_mfma_f32_16x16x32_bf16 v[148:151], a[244:247], a[200:203], v[148:151]
    ds_read_b64_tr_b16 a[240:241], v41 offset:0
    v_mul_f32 v51, v63, v51
    v_mfma_f32_16x16x32_bf16 v[180:183], a[244:247], a[204:207], v[180:183]
    ds_read_b64_tr_b16 a[242:243], v41 offset:1024
    v_mul_f32 v52, v63, v52
    v_mfma_f32_16x16x32_bf16 v[212:215], a[244:247], a[208:211], v[212:215]
    ds_read_b128 a[216:219], v40 offset:0
    s_add_u32 m0, s42, 98304
    v_mfma_f32_16x16x32_bf16 v[244:247], a[244:247], a[212:215], v[244:247]
    buffer_load_dwordx4 v6, s[12:15], s39 offen offset:1024 lds
    v_mfma_f32_16x16x32_bf16 v[88:91], a[248:251], a[192:195], v[88:91]
    ds_read_b64_tr_b16 a[244:245], v41 offset:8
    v_mul_f32 v53, v63, v53
    v_mfma_f32_16x16x32_bf16 v[120:123], a[248:251], a[196:199], v[120:123]
    ds_read_b64_tr_b16 a[246:247], v41 offset:1032
    v_mul_f32 v54, v63, v54
    v_mfma_f32_16x16x32_bf16 v[152:155], a[248:251], a[200:203], v[152:155]
    ds_read_b128 a[220:223], v40 offset:2048
    v_mul_f32 v55, v63, v55
    v_mfma_f32_16x16x32_bf16 v[184:187], a[248:251], a[204:207], v[184:187]
    ds_read_b128 a[224:227], v40 offset:4096
    v_cvt_pk_bf16_f32 v34, v48, v49
    v_mfma_f32_16x16x32_bf16 v[216:219], a[248:251], a[208:211], v[216:219]
    ds_read_b128 a[228:231], v40 offset:6144
    s_add_u32 m0, s42, 98304
    v_mfma_f32_16x16x32_bf16 v[248:251], a[248:251], a[212:215], v[248:251]
    buffer_load_dwordx4 v7, s[12:15], s39 offen offset:2048 lds
    v_mfma_f32_16x16x32_bf16 v[92:95], a[252:255], a[192:195], v[92:95]
    ds_read_b64_tr_b16 a[248:249], v42 offset:0
    v_cvt_pk_bf16_f32 v35, v50, v51
    v_mfma_f32_16x16x32_bf16 v[124:127], a[252:255], a[196:199], v[124:127]
    ds_read_b64_tr_b16 a[250:251], v42 offset:1024
    v_cvt_pk_bf16_f32 v36, v52, v53
    v_mfma_f32_16x16x32_bf16 v[156:159], a[252:255], a[200:203], v[156:159]
    ds_read_b128 a[232:235], v40 offset:8192
    v_cvt_pk_bf16_f32 v37, v54, v55
    v_mfma_f32_16x16x32_bf16 v[188:191], a[252:255], a[204:207], v[188:191]
    ds_read_b128 a[236:239], v40 offset:10240
    v_accvgpr_read_b32 v48, a168
    v_mfma_f32_16x16x32_bf16 v[220:223], a[252:255], a[208:211], v[220:223]
    s_add_u32 m0, s42, 98304
    s_waitcnt lgkmcnt(6)
    v_accvgpr_read_b32 v49, a169
    v_mfma_f32_16x16x32_bf16 v[252:255], a[252:255], a[212:215], v[252:255]
    buffer_load_dwordx4 v38, s[12:15], s39 offen offset:3072 lds
    v_mfma_f32_16x16x32_bf16 v[64:67], a[240:243], a[216:219], v[64:67]
    s_waitcnt lgkmcnt(4)
    s_add_u32 s39, s39, 262144
    v_accvgpr_read_b32 v50, a170
    v_mfma_f32_16x16x32_bf16 v[96:99], a[240:243], a[220:223], v[96:99]
    ds_read_b64_tr_b16 a[252:253], v42 offset:8
    s_cmp_eq_u32 s39, 5242880
    s_cselect_b32 s39, 0, s39
    v_mfma_f32_16x16x32_bf16 v[128:131], a[240:243], a[224:227], v[128:131]
    ds_read_b64_tr_b16 a[254:255], v42 offset:1032
    s_add_u32 m0, s42, 0
    v_mfma_f32_16x16x32_bf16 v[160:163], a[240:243], a[228:231], v[160:163]
    s_waitcnt lgkmcnt(2)
    buffer_load_dwordx4 v5, s[12:15], s39 offen offset:0 lds
    v_mfma_f32_16x16x32_bf16 v[192:195], a[240:243], a[232:235], v[192:195]
    s_add_u32 s56, s48, 4096
    buffer_store_dwordx4 v[34:37], v57, s[20:23], s56 offen offset:1024 sc1
    v_mfma_f32_16x16x32_bf16 v[224:227], a[240:243], a[236:239], v[224:227]
    v_accvgpr_read_b32 v51, a171
    v_accvgpr_read_b32 v52, a172
    v_mfma_f32_16x16x32_bf16 v[68:71], a[244:247], a[216:219], v[68:71]
    v_accvgpr_read_b32 v53, a173
    v_accvgpr_read_b32 v54, a174
    v_mfma_f32_16x16x32_bf16 v[100:103], a[244:247], a[220:223], v[100:103]
    ds_read_b64_tr_b16 a[240:241], v43 offset:0
    v_accvgpr_read_b32 v55, a175
    v_mfma_f32_16x16x32_bf16 v[132:135], a[244:247], a[224:227], v[132:135]
    ds_read_b64_tr_b16 a[242:243], v43 offset:1024
    s_add_u32 m0, s42, 0
    v_mfma_f32_16x16x32_bf16 v[164:167], a[244:247], a[228:231], v[164:167]
    buffer_load_dwordx4 v6, s[12:15], s39 offen offset:1024 lds
    v_mfma_f32_16x16x32_bf16 v[196:199], a[244:247], a[232:235], v[196:199]
    v_mul_f32 v48, v63, v48
    v_mul_f32 v49, v63, v49
    v_mfma_f32_16x16x32_bf16 v[228:231], a[244:247], a[236:239], v[228:231]
    v_mul_f32 v50, v63, v50
    v_mul_f32 v51, v63, v51
    v_mfma_f32_16x16x32_bf16 v[72:75], a[248:251], a[216:219], v[72:75]
    v_mul_f32 v52, v63, v52
    v_mul_f32 v53, v63, v53
    v_mfma_f32_16x16x32_bf16 v[104:107], a[248:251], a[220:223], v[104:107]
    ds_read_b64_tr_b16 a[244:245], v43 offset:8
    v_mul_f32 v54, v63, v54
    v_mfma_f32_16x16x32_bf16 v[136:139], a[248:251], a[224:227], v[136:139]
    ds_read_b64_tr_b16 a[246:247], v43 offset:1032
    s_add_u32 m0, s42, 0
    v_mfma_f32_16x16x32_bf16 v[168:171], a[248:251], a[228:231], v[168:171]
    buffer_load_dwordx4 v7, s[12:15], s39 offen offset:2048 lds
    v_mfma_f32_16x16x32_bf16 v[200:203], a[248:251], a[232:235], v[200:203]
    v_mul_f32 v55, v63, v55
    v_cvt_pk_bf16_f32 v34, v48, v49
    v_mfma_f32_16x16x32_bf16 v[232:235], a[248:251], a[236:239], v[232:235]
    s_waitcnt lgkmcnt(4)
    v_cvt_pk_bf16_f32 v35, v50, v51
    v_cvt_pk_bf16_f32 v36, v52, v53
    v_mfma_f32_16x16x32_bf16 v[76:79], a[252:255], a[216:219], v[76:79]
    v_cvt_pk_bf16_f32 v37, v54, v55
    v_accvgpr_read_b32 v48, a176
    v_mfma_f32_16x16x32_bf16 v[108:111], a[252:255], a[220:223], v[108:111]
    ds_read_b64_tr_b16 a[248:249], v44 offset:0
    v_accvgpr_read_b32 v49, a177
    v_mfma_f32_16x16x32_bf16 v[140:143], a[252:255], a[224:227], v[140:143]
    ds_read_b64_tr_b16 a[250:251], v44 offset:1024
    s_add_u32 m0, s42, 0
    v_mfma_f32_16x16x32_bf16 v[172:175], a[252:255], a[228:231], v[172:175]
    buffer_load_dwordx4 v38, s[12:15], s39 offen offset:3072 lds
    v_mfma_f32_16x16x32_bf16 v[204:207], a[252:255], a[232:235], v[204:207]
    s_add_u32 s39, s39, 262144
    s_add_u32 s56, s48, 8192
    buffer_store_dwordx4 v[34:37], v57, s[20:23], s56 offen offset:3072 sc1
    v_mfma_f32_16x16x32_bf16 v[236:239], a[252:255], a[236:239], v[236:239]
    s_waitcnt lgkmcnt(4)
    s_cmp_eq_u32 s39, 5242880
    s_cselect_b32 s39, 0, s39
    v_mfma_f32_16x16x32_bf16 v[80:83], a[240:243], a[216:219], v[80:83]
    v_accvgpr_read_b32 v50, a178
    v_accvgpr_read_b32 v51, a179
    v_mfma_f32_16x16x32_bf16 v[112:115], a[240:243], a[220:223], v[112:115]
    ds_read_b64_tr_b16 a[252:253], v44 offset:8
    v_accvgpr_read_b32 v52, a180
    v_mfma_f32_16x16x32_bf16 v[144:147], a[240:243], a[224:227], v[144:147]
    ds_read_b64_tr_b16 a[254:255], v44 offset:1032
    v_xor_b32 v40, 0x10040, v40
    v_mfma_f32_16x16x32_bf16 v[176:179], a[240:243], a[228:231], v[176:179]
    v_add_u32 v41, 0x8000, v41
    v_add_u32 v42, 0x8000, v42
    v_mfma_f32_16x16x32_bf16 v[208:211], a[240:243], a[232:235], v[208:211]
    v_add_u32 v43, 0x8000, v43
    v_accvgpr_read_b32 v53, a181
    v_mfma_f32_16x16x32_bf16 v[240:243], a[240:243], a[236:239], v[240:243]
    s_waitcnt vmcnt(11)
    s_waitcnt lgkmcnt(4)
    v_add_u32 v44, 0x8000, v44
    v_mfma_f32_16x16x32_bf16 v[84:87], a[244:247], a[216:219], v[84:87]
    v_accvgpr_read_b32 v54, a182
    v_accvgpr_read_b32 v55, a183
    v_mfma_f32_16x16x32_bf16 v[116:119], a[244:247], a[220:223], v[116:119]
    s_waitcnt lgkmcnt(0)
    s_barrier
    v_mfma_f32_16x16x32_bf16 v[148:151], a[244:247], a[224:227], v[148:151]
    ds_read_b64_tr_b16 a[240:241], v41 offset:0
    v_mul_f32 v48, v63, v48
    v_mfma_f32_16x16x32_bf16 v[180:183], a[244:247], a[228:231], v[180:183]
    ds_read_b64_tr_b16 a[242:243], v41 offset:1024
    v_mul_f32 v49, v63, v49
    v_mfma_f32_16x16x32_bf16 v[212:215], a[244:247], a[232:235], v[212:215]
    ds_read_b128 a[192:195], v40 offset:0
    s_add_u32 m0, s41, 0
    v_mfma_f32_16x16x32_bf16 v[244:247], a[244:247], a[236:239], v[244:247]
    buffer_load_dwordx4 v2, s[8:11], s38 offen offset:0 lds
    v_mfma_f32_16x16x32_bf16 v[88:91], a[248:251], a[216:219], v[88:91]
    ds_read_b64_tr_b16 a[244:245], v41 offset:8
    v_mul_f32 v50, v63, v50
    v_mfma_f32_16x16x32_bf16 v[120:123], a[248:251], a[220:223], v[120:123]
    ds_read_b64_tr_b16 a[246:247], v41 offset:1032
    v_mul_f32 v51, v63, v51
    v_mfma_f32_16x16x32_bf16 v[152:155], a[248:251], a[224:227], v[152:155]
    ds_read_b128 a[196:199], v40 offset:2048
    v_mul_f32 v52, v63, v52
    v_mfma_f32_16x16x32_bf16 v[184:187], a[248:251], a[228:231], v[184:187]
    ds_read_b128 a[200:203], v40 offset:4096
    v_mul_f32 v53, v63, v53
    v_mfma_f32_16x16x32_bf16 v[216:219], a[248:251], a[232:235], v[216:219]
    ds_read_b128 a[204:207], v40 offset:6144
    s_add_u32 m0, s41, 0
    v_mfma_f32_16x16x32_bf16 v[248:251], a[248:251], a[236:239], v[248:251]
    buffer_load_dwordx4 v3, s[8:11], s38 offen offset:1024 lds
    v_mfma_f32_16x16x32_bf16 v[92:95], a[252:255], a[216:219], v[92:95]
    ds_read_b64_tr_b16 a[248:249], v42 offset:0
    v_mul_f32 v54, v63, v54
    v_mfma_f32_16x16x32_bf16 v[124:127], a[252:255], a[220:223], v[124:127]
    ds_read_b64_tr_b16 a[250:251], v42 offset:1024
    v_mul_f32 v55, v63, v55
    v_mfma_f32_16x16x32_bf16 v[156:159], a[252:255], a[224:227], v[156:159]
    ds_read_b128 a[208:211], v40 offset:8192
    v_cvt_pk_bf16_f32 v34, v48, v49
    v_mfma_f32_16x16x32_bf16 v[188:191], a[252:255], a[228:231], v[188:191]
    ds_read_b128 a[212:215], v40 offset:10240
    v_cvt_pk_bf16_f32 v35, v50, v51
    v_mfma_f32_16x16x32_bf16 v[220:223], a[252:255], a[232:235], v[220:223]
    s_add_u32 m0, s41, 0
    s_waitcnt lgkmcnt(6)
    v_cvt_pk_bf16_f32 v36, v52, v53
    v_mfma_f32_16x16x32_bf16 v[252:255], a[252:255], a[236:239], v[252:255]
    buffer_load_dwordx4 v4, s[8:11], s38 offen offset:2048 lds
    v_mfma_f32_16x16x32_bf16 v[64:67], a[240:243], a[192:195], v[64:67]
    s_waitcnt lgkmcnt(4)
    s_add_u32 s54, s38, 30720
    v_cvt_pk_bf16_f32 v37, v54, v55
    v_mfma_f32_16x16x32_bf16 v[96:99], a[240:243], a[196:199], v[96:99]
    ds_read_b64_tr_b16 a[252:253], v42 offset:8
    v_accvgpr_read_b32 v48, a184
    v_mfma_f32_16x16x32_bf16 v[128:131], a[240:243], a[200:203], v[128:131]
    ds_read_b64_tr_b16 a[254:255], v42 offset:1032
    s_add_u32 m0, s41, 3072
    v_mfma_f32_16x16x32_bf16 v[160:163], a[240:243], a[204:207], v[160:163]
    s_waitcnt lgkmcnt(2)
    buffer_load_dwordx4 v2, s[8:11], s54 offen offset:0 lds
    v_mfma_f32_16x16x32_bf16 v[192:195], a[240:243], a[208:211], v[192:195]
    s_add_u32 s56, s48, 16384
    buffer_store_dwordx4 v[34:37], v57, s[20:23], s56 offen offset:1024 sc1
    v_mfma_f32_16x16x32_bf16 v[224:227], a[240:243], a[212:215], v[224:227]
    v_accvgpr_read_b32 v49, a185
    v_accvgpr_read_b32 v50, a186
    v_mfma_f32_16x16x32_bf16 v[68:71], a[244:247], a[192:195], v[68:71]
    v_accvgpr_read_b32 v51, a187
    v_accvgpr_read_b32 v52, a188
    v_mfma_f32_16x16x32_bf16 v[100:103], a[244:247], a[196:199], v[100:103]
    ds_read_b64_tr_b16 a[240:241], v43 offset:0
    v_accvgpr_read_b32 v53, a189
    v_mfma_f32_16x16x32_bf16 v[132:135], a[244:247], a[200:203], v[132:135]
    ds_read_b64_tr_b16 a[242:243], v43 offset:1024
    s_add_u32 m0, s41, 3072
    v_mfma_f32_16x16x32_bf16 v[164:167], a[244:247], a[204:207], v[164:167]
    buffer_load_dwordx4 v3, s[8:11], s54 offen offset:1024 lds
    v_mfma_f32_16x16x32_bf16 v[196:199], a[244:247], a[208:211], v[196:199]
    v_accvgpr_read_b32 v54, a190
    v_accvgpr_read_b32 v55, a191
    v_mfma_f32_16x16x32_bf16 v[228:231], a[244:247], a[212:215], v[228:231]
    v_mul_f32 v48, v63, v48
    v_mul_f32 v49, v63, v49
    v_mfma_f32_16x16x32_bf16 v[72:75], a[248:251], a[192:195], v[72:75]
    v_mul_f32 v50, v63, v50
    v_mul_f32 v51, v63, v51
    v_mfma_f32_16x16x32_bf16 v[104:107], a[248:251], a[196:199], v[104:107]
    ds_read_b64_tr_b16 a[244:245], v43 offset:8
    v_mul_f32 v52, v63, v52
    v_mfma_f32_16x16x32_bf16 v[136:139], a[248:251], a[200:203], v[136:139]
    ds_read_b64_tr_b16 a[246:247], v43 offset:1032
    s_add_u32 m0, s41, 3072
    v_mfma_f32_16x16x32_bf16 v[168:171], a[248:251], a[204:207], v[168:171]
    buffer_load_dwordx4 v4, s[8:11], s54 offen offset:2048 lds
    v_mfma_f32_16x16x32_bf16 v[200:203], a[248:251], a[208:211], v[200:203]
    s_add_u32 s38, s38, 128
    v_mul_f32 v53, v63, v53
    v_mul_f32 v54, v63, v54
    v_mfma_f32_16x16x32_bf16 v[232:235], a[248:251], a[212:215], v[232:235]
    s_waitcnt lgkmcnt(4)
    s_cmp_eq_u32 s38, 1280
    s_cselect_b32 s38, 0, s38
    v_mfma_f32_16x16x32_bf16 v[76:79], a[252:255], a[192:195], v[76:79]
    v_mul_f32 v55, v63, v55
    v_cvt_pk_bf16_f32 v34, v48, v49
    v_mfma_f32_16x16x32_bf16 v[108:111], a[252:255], a[196:199], v[108:111]
    ds_read_b64_tr_b16 a[248:249], v44 offset:0
    v_cvt_pk_bf16_f32 v35, v50, v51
    v_mfma_f32_16x16x32_bf16 v[140:143], a[252:255], a[200:203], v[140:143]
    ds_read_b64_tr_b16 a[250:251], v44 offset:1024
    s_add_u32 m0, s42, 32768
    v_mfma_f32_16x16x32_bf16 v[172:175], a[252:255], a[204:207], v[172:175]
    buffer_load_dwordx4 v5, s[12:15], s39 offen offset:0 lds
    v_mfma_f32_16x16x32_bf16 v[204:207], a[252:255], a[208:211], v[204:207]
    v_cvt_pk_bf16_f32 v36, v52, v53
    v_cvt_pk_bf16_f32 v37, v54, v55
    v_mfma_f32_16x16x32_bf16 v[236:239], a[252:255], a[212:215], v[236:239]
    s_waitcnt lgkmcnt(4)
    s_add_u32 s56, s48, 20480
    buffer_store_dwordx4 v[34:37], v57, s[20:23], s56 offen offset:3072 sc1
    v_mfma_f32_16x16x32_bf16 v[80:83], a[240:243], a[192:195], v[80:83]
    v_mfma_f32_16x16x32_bf16 v[112:115], a[240:243], a[196:199], v[112:115]
    ds_read_b64_tr_b16 a[252:253], v44 offset:8
    v_mfma_f32_16x16x32_bf16 v[144:147], a[240:243], a[200:203], v[144:147]
    ds_read_b64_tr_b16 a[254:255], v44 offset:1032
    v_xor_b32 v40, 0x40, v40
    v_mfma_f32_16x16x32_bf16 v[176:179], a[240:243], a[204:207], v[176:179]
    v_add_u32 v41, 0x8000, v41
    v_add_u32 v42, 0x8000, v42
    v_mfma_f32_16x16x32_bf16 v[208:211], a[240:243], a[208:211], v[208:211]
    v_add_u32 v43, 0x8000, v43
    v_mfma_f32_16x16x32_bf16 v[240:243], a[240:243], a[212:215], v[240:243]
    s_waitcnt vmcnt(15)
    s_waitcnt lgkmcnt(4)
    v_add_u32 v44, 0x8000, v44
    v_mfma_f32_16x16x32_bf16 v[84:87], a[244:247], a[192:195], v[84:87]
    v_mfma_f32_16x16x32_bf16 v[116:119], a[244:247], a[196:199], v[116:119]
    s_waitcnt lgkmcnt(0)
    s_barrier
    v_mfma_f32_16x16x32_bf16 v[148:151], a[244:247], a[200:203], v[148:151]
    ds_read_b64_tr_b16 a[240:241], v41 offset:0
    v_mfma_f32_16x16x32_bf16 v[180:183], a[244:247], a[204:207], v[180:183]
    ds_read_b64_tr_b16 a[242:243], v41 offset:1024
    v_mfma_f32_16x16x32_bf16 v[212:215], a[244:247], a[208:211], v[212:215]
    ds_read_b128 a[216:219], v40 offset:0
    s_add_u32 m0, s42, 32768
    v_mfma_f32_16x16x32_bf16 v[244:247], a[244:247], a[212:215], v[244:247]
    buffer_load_dwordx4 v6, s[12:15], s39 offen offset:1024 lds
    v_mfma_f32_16x16x32_bf16 v[88:91], a[248:251], a[192:195], v[88:91]
    ds_read_b64_tr_b16 a[244:245], v41 offset:8
    v_mfma_f32_16x16x32_bf16 v[120:123], a[248:251], a[196:199], v[120:123]
    ds_read_b64_tr_b16 a[246:247], v41 offset:1032
    v_mfma_f32_16x16x32_bf16 v[152:155], a[248:251], a[200:203], v[152:155]
    ds_read_b128 a[220:223], v40 offset:2048
    v_mfma_f32_16x16x32_bf16 v[184:187], a[248:251], a[204:207], v[184:187]
    ds_read_b128 a[224:227], v40 offset:4096
    v_mfma_f32_16x16x32_bf16 v[216:219], a[248:251], a[208:211], v[216:219]
    ds_read_b128 a[228:231], v40 offset:6144
    s_add_u32 m0, s42, 32768
    v_mfma_f32_16x16x32_bf16 v[248:251], a[248:251], a[212:215], v[248:251]
    buffer_load_dwordx4 v7, s[12:15], s39 offen offset:2048 lds
    v_mfma_f32_16x16x32_bf16 v[92:95], a[252:255], a[192:195], v[92:95]
    ds_read_b64_tr_b16 a[248:249], v42 offset:0
    v_mfma_f32_16x16x32_bf16 v[124:127], a[252:255], a[196:199], v[124:127]
    ds_read_b64_tr_b16 a[250:251], v42 offset:1024
    v_mfma_f32_16x16x32_bf16 v[156:159], a[252:255], a[200:203], v[156:159]
    ds_read_b128 a[232:235], v40 offset:8192
    v_mfma_f32_16x16x32_bf16 v[188:191], a[252:255], a[204:207], v[188:191]
    ds_read_b128 a[236:239], v40 offset:10240
    v_mfma_f32_16x16x32_bf16 v[220:223], a[252:255], a[208:211], v[220:223]
    s_add_u32 m0, s42, 32768
    s_waitcnt lgkmcnt(6)
    v_mfma_f32_16x16x32_bf16 v[252:255], a[252:255], a[212:215], v[252:255]
    buffer_load_dwordx4 v38, s[12:15], s39 offen offset:3072 lds
    v_mfma_f32_16x16x32_bf16 v[64:67], a[240:243], a[216:219], v[64:67]
    s_waitcnt lgkmcnt(4)
    s_add_u32 s39, s39, 262144
    v_mfma_f32_16x16x32_bf16 v[96:99], a[240:243], a[220:223], v[96:99]
    ds_read_b64_tr_b16 a[252:253], v42 offset:8
    s_cmp_eq_u32 s39, 5242880
    s_cselect_b32 s39, 0, s39
    v_mfma_f32_16x16x32_bf16 v[128:131], a[240:243], a[224:227], v[128:131]
    ds_read_b64_tr_b16 a[254:255], v42 offset:1032
    s_add_u32 m0, s42, 65536
    v_mfma_f32_16x16x32_bf16 v[160:163], a[240:243], a[228:231], v[160:163]
    s_waitcnt lgkmcnt(2)
    buffer_load_dwordx4 v5, s[12:15], s39 offen offset:0 lds
    v_mfma_f32_16x16x32_bf16 v[192:195], a[240:243], a[232:235], v[192:195]
    v_mfma_f32_16x16x32_bf16 v[224:227], a[240:243], a[236:239], v[224:227]
    v_mfma_f32_16x16x32_bf16 v[68:71], a[244:247], a[216:219], v[68:71]
    v_mfma_f32_16x16x32_bf16 v[100:103], a[244:247], a[220:223], v[100:103]
    ds_read_b64_tr_b16 a[240:241], v43 offset:0
    v_mfma_f32_16x16x32_bf16 v[132:135], a[244:247], a[224:227], v[132:135]
    ds_read_b64_tr_b16 a[242:243], v43 offset:1024
    s_add_u32 m0, s42, 65536
    v_mfma_f32_16x16x32_bf16 v[164:167], a[244:247], a[228:231], v[164:167]
    buffer_load_dwordx4 v6, s[12:15], s39 offen offset:1024 lds
    v_mfma_f32_16x16x32_bf16 v[196:199], a[244:247], a[232:235], v[196:199]
    v_mfma_f32_16x16x32_bf16 v[228:231], a[244:247], a[236:239], v[228:231]
    v_mfma_f32_16x16x32_bf16 v[72:75], a[248:251], a[216:219], v[72:75]
    v_mfma_f32_16x16x32_bf16 v[104:107], a[248:251], a[220:223], v[104:107]
    ds_read_b64_tr_b16 a[244:245], v43 offset:8
    v_mfma_f32_16x16x32_bf16 v[136:139], a[248:251], a[224:227], v[136:139]
    ds_read_b64_tr_b16 a[246:247], v43 offset:1032
    s_add_u32 m0, s42, 65536
    v_mfma_f32_16x16x32_bf16 v[168:171], a[248:251], a[228:231], v[168:171]
    buffer_load_dwordx4 v7, s[12:15], s39 offen offset:2048 lds
    v_mfma_f32_16x16x32_bf16 v[200:203], a[248:251], a[232:235], v[200:203]
    v_mfma_f32_16x16x32_bf16 v[232:235], a[248:251], a[236:239], v[232:235]
    s_waitcnt lgkmcnt(4)
    v_mfma_f32_16x16x32_bf16 v[76:79], a[252:255], a[216:219], v[76:79]
    v_mfma_f32_16x16x32_bf16 v[108:111], a[252:255], a[220:223], v[108:111]
    ds_read_b64_tr_b16 a[248:249], v44 offset:0
    v_mfma_f32_16x16x32_bf16 v[140:143], a[252:255], a[224:227], v[140:143]
    ds_read_b64_tr_b16 a[250:251], v44 offset:1024
    s_add_u32 m0, s42, 65536
    v_mfma_f32_16x16x32_bf16 v[172:175], a[252:255], a[228:231], v[172:175]
    buffer_load_dwordx4 v38, s[12:15], s39 offen offset:3072 lds
    v_mfma_f32_16x16x32_bf16 v[204:207], a[252:255], a[232:235], v[204:207]
    s_add_u32 s39, s39, 262144
    v_mfma_f32_16x16x32_bf16 v[236:239], a[252:255], a[236:239], v[236:239]
    s_waitcnt lgkmcnt(4)
    s_cmp_eq_u32 s39, 5242880
    s_cselect_b32 s39, 0, s39
    v_mfma_f32_16x16x32_bf16 v[80:83], a[240:243], a[216:219], v[80:83]
    v_mfma_f32_16x16x32_bf16 v[112:115], a[240:243], a[220:223], v[112:115]
    ds_read_b64_tr_b16 a[252:253], v44 offset:8
    v_mfma_f32_16x16x32_bf16 v[144:147], a[240:243], a[224:227], v[144:147]
    ds_read_b64_tr_b16 a[254:255], v44 offset:1032
    v_xor_b32 v40, 0x10040, v40
    v_mfma_f32_16x16x32_bf16 v[176:179], a[240:243], a[228:231], v[176:179]
    v_subrev_u32 v41, 0x18000, v41
    v_subrev_u32 v42, 0x18000, v42
    v_mfma_f32_16x16x32_bf16 v[208:211], a[240:243], a[232:235], v[208:211]
    v_subrev_u32 v43, 0x18000, v43
    v_mfma_f32_16x16x32_bf16 v[240:243], a[240:243], a[236:239], v[240:243]
    s_waitcnt vmcnt(9)
    s_waitcnt lgkmcnt(4)
    v_subrev_u32 v44, 0x18000, v44
    v_mfma_f32_16x16x32_bf16 v[84:87], a[244:247], a[216:219], v[84:87]
    v_mfma_f32_16x16x32_bf16 v[116:119], a[244:247], a[220:223], v[116:119]
    s_waitcnt lgkmcnt(0)
    s_barrier
    v_mfma_f32_16x16x32_bf16 v[148:151], a[244:247], a[224:227], v[148:151]
    ds_read_b64_tr_b16 a[240:241], v41 offset:0
    v_mfma_f32_16x16x32_bf16 v[180:183], a[244:247], a[228:231], v[180:183]
    ds_read_b64_tr_b16 a[242:243], v41 offset:1024
    v_mfma_f32_16x16x32_bf16 v[212:215], a[244:247], a[232:235], v[212:215]
    ds_read_b128 a[192:195], v40 offset:0
    s_add_u32 m0, s41, 65536
    v_mfma_f32_16x16x32_bf16 v[244:247], a[244:247], a[236:239], v[244:247]
    buffer_load_dwordx4 v2, s[8:11], s38 offen offset:0 lds
    v_mfma_f32_16x16x32_bf16 v[88:91], a[248:251], a[216:219], v[88:91]
    ds_read_b64_tr_b16 a[244:245], v41 offset:8
    v_mfma_f32_16x16x32_bf16 v[120:123], a[248:251], a[220:223], v[120:123]
    ds_read_b64_tr_b16 a[246:247], v41 offset:1032
    v_mfma_f32_16x16x32_bf16 v[152:155], a[248:251], a[224:227], v[152:155]
    ds_read_b128 a[196:199], v40 offset:2048
    v_mfma_f32_16x16x32_bf16 v[184:187], a[248:251], a[228:231], v[184:187]
    ds_read_b128 a[200:203], v40 offset:4096
    v_mfma_f32_16x16x32_bf16 v[216:219], a[248:251], a[232:235], v[216:219]
    ds_read_b128 a[204:207], v40 offset:6144
    s_add_u32 m0, s41, 65536
    v_mfma_f32_16x16x32_bf16 v[248:251], a[248:251], a[236:239], v[248:251]
    buffer_load_dwordx4 v3, s[8:11], s38 offen offset:1024 lds
    v_mfma_f32_16x16x32_bf16 v[92:95], a[252:255], a[216:219], v[92:95]
    ds_read_b64_tr_b16 a[248:249], v42 offset:0
    v_mfma_f32_16x16x32_bf16 v[124:127], a[252:255], a[220:223], v[124:127]
    ds_read_b64_tr_b16 a[250:251], v42 offset:1024
    v_mfma_f32_16x16x32_bf16 v[156:159], a[252:255], a[224:227], v[156:159]
    ds_read_b128 a[208:211], v40 offset:8192
    v_mfma_f32_16x16x32_bf16 v[188:191], a[252:255], a[228:231], v[188:191]
    ds_read_b128 a[212:215], v40 offset:10240
    v_mfma_f32_16x16x32_bf16 v[220:223], a[252:255], a[232:235], v[220:223]
    s_add_u32 m0, s41, 65536
    s_waitcnt lgkmcnt(6)
    v_mfma_f32_16x16x32_bf16 v[252:255], a[252:255], a[236:239], v[252:255]
    buffer_load_dwordx4 v4, s[8:11], s38 offen offset:2048 lds
    s_branch L_qtail
L_atail1:
    v_mfma_f32_16x16x32_bf16 v[160:163], v[64:67], a[192:195], v[40:43]
    s_lshr_b32 s53, s36, 4
    v_exp_f32 v172, v172
    v_mfma_f32_16x16x32_bf16 v[160:163], v[68:71], a[196:199], v[160:163]
    s_waitcnt lgkmcnt(4)
    v_exp_f32 v173, v173
    v_mfma_f32_16x16x32_bf16 v[160:163], v[72:75], a[200:203], v[160:163]
    v_cvt_pk_bf16_f32 v182, v172, v173
    v_mfma_f32_16x16x32_bf16 v[160:163], v[76:79], a[204:207], v[160:163]
    s_waitcnt lgkmcnt(2)
    v_exp_f32 v174, v174
    v_mfma_f32_16x16x32_bf16 v[164:167], v[80:83], a[192:195], v[40:43]
    s_lshl_b32 s53, s53, 6
    v_exp_f32 v175, v175
    v_mfma_f32_16x16x32_bf16 v[164:167], v[84:87], a[196:199], v[164:167]
    s_waitcnt lgkmcnt(0)
    v_cvt_pk_bf16_f32 v183, v174, v175
    v_mfma_f32_16x16x32_bf16 v[164:167], v[88:91], a[200:203], v[164:167]
    v_mfma_f32_16x16x32_bf16 v[164:167], v[92:95], a[204:207], v[164:167]
    s_lshl_b32 s54, s4, 28
    v_exp_f32 v160, v160
    v_mfma_f32_16x16x32_bf16 a[160:163], v[96:99], v[180:183], a[160:163]
    s_add_u32 s54, s54, s53
    v_exp_f32 v161, v161
    v_mfma_f32_16x16x32_bf16 a[164:167], v[100:103], v[180:183], a[164:167]
    v_cvt_pk_bf16_f32 v176, v160, v161
    v_mfma_f32_16x16x32_bf16 a[168:171], v[104:107], v[180:183], a[168:171]
    v_exp_f32 v162, v162
    v_mfma_f32_16x16x32_bf16 a[172:175], v[108:111], v[180:183], a[172:175]
    v_exp_f32 v163, v163
    v_mfma_f32_16x16x32_bf16 a[176:179], v[112:115], v[180:183], a[176:179]
    v_cvt_pk_bf16_f32 v177, v162, v163
    v_mfma_f32_16x16x32_bf16 a[180:183], v[116:119], v[180:183], a[180:183]
    s_barrier
    v_mfma_f32_16x16x32_bf16 a[184:187], v[120:123], v[180:183], a[184:187]
    v_and_b32 v0, 15, v1
    v_lshlrev_b32 v0, 2, v0
    v_mfma_f32_16x16x32_bf16 a[188:191], v[124:127], v[180:183], a[188:191]
    s_waitcnt vmcnt(4)
    buffer_load_dwordx4 v8, s[16:19], s40 offen offset:0 nt lds
    v_mfma_f32_16x16x32_bf16 v[244:247], v[34:37], v[180:183], v[244:247]
    buffer_load_dword v0, v0, s[32:35], s54 offen sc1
    v_mfma_f32_16x16x32_bf16 v[168:171], v[64:67], a[208:211], v[44:47]
    s_add_u32 s40, s40, 1024
    v_exp_f32 v164, v164
    v_mfma_f32_16x16x32_bf16 v[168:171], v[68:71], a[212:215], v[168:171]
    s_add_u32 s99, s99, 1024
    v_exp_f32 v165, v165
    v_mfma_f32_16x16x32_bf16 v[168:171], v[72:75], a[216:219], v[168:171]
    ds_read_b64_tr_b16 v[96:97], v18 offset:32768
    v_cvt_pk_bf16_f32 v178, v164, v165
    v_mfma_f32_16x16x32_bf16 v[168:171], v[76:79], a[220:223], v[168:171]
    s_and_b32 s100, s99, 0x19fff
    v_exp_f32 v166, v166
    v_mfma_f32_16x16x32_bf16 v[172:175], v[80:83], a[208:211], v[44:47]
    s_or_b32 m0, s100, s43
    v_exp_f32 v167, v167
    v_mfma_f32_16x16x32_bf16 v[172:175], v[84:87], a[212:215], v[172:175]
    ds_read_b64_tr_b16 v[98:99], v18 offset:36864
    v_cvt_pk_bf16_f32 v179, v166, v167
    v_mfma_f32_16x16x32_bf16 v[172:175], v[88:91], a[216:219], v[172:175]
    s_waitcnt vmcnt(4)
    buffer_load_dwordx4 v9, s[16:19], s40 offen offset:0 nt lds
    s_or_b32 s99, s99, 0x6000
    s_lshr_b32 s52, s37, 1
    v_mfma_f32_16x16x32_bf16 v[172:175], v[92:95], a[220:223], v[172:175]
    s_add_u32 s40, s40, 1024
    v_exp_f32 v168, v168
    v_mfma_f32_16x16x32_bf16 a[0:3], v[128:131], v[176:179], a[0:3]
    s_add_u32 s99, s99, 1024
    v_exp_f32 v169, v169
    v_mfma_f32_16x16x32_bf16 a[4:7], v[132:135], v[176:179], a[4:7]
    ds_read_b64_tr_b16 v[100:101], v19 offset:32768
    v_cvt_pk_bf16_f32 v180, v168, v169
    v_mfma_f32_16x16x32_bf16 a[8:11], v[136:139], v[176:179], a[8:11]
    s_and_b32 s100, s99, 0x19fff
    v_exp_f32 v170, v170
    v_mfma_f32_16x16x32_bf16 a[12:15], v[140:143], v[176:179], a[12:15]
    s_or_b32 s99, s99, 0x6000
    v_exp_f32 v171, v171
    v_mfma_f32_16x16x32_bf16 a[16:19], v[144:147], v[176:179], a[16:19]
    ds_read_b64_tr_b16 v[102:103], v19 offset:36864
    v_cvt_pk_bf16_f32 v181, v170, v171
    v_mfma_f32_16x16x32_bf16 a[20:23], v[148:151], v[176:179], a[20:23]
    s_mul_i32 s52, s52, 1310720
    v_mfma_f32_16x16x32_bf16 a[24:27], v[152:155], v[176:179], a[24:27]
    s_add_u32 s24, s24, s52
    s_addc_u32 s25, s25, 0
    v_mfma_f32_16x16x32_bf16 a[28:31], v[156:159], v[176:179], a[28:31]
    s_mov_b32 s26, 1310720
    v_mfma_f32_16x16x32_bf16 v[208:211], v[34:37], v[176:179], v[208:211]
    s_and_b32 s52, s37, 1
    v_mfma_f32_16x16x32_bf16 v[160:163], v[64:67], a[224:227], v[48:51]
    v_exp_f32 v172, v172
    v_mfma_f32_16x16x32_bf16 v[160:163], v[68:71], a[228:231], v[160:163]
    v_exp_f32 v173, v173
    v_mfma_f32_16x16x32_bf16 v[160:163], v[72:75], a[232:235], v[160:163]
    ds_read_b64_tr_b16 v[104:105], v20 offset:32768
    v_cvt_pk_bf16_f32 v182, v172, v173
    v_mfma_f32_16x16x32_bf16 v[160:163], v[76:79], a[236:239], v[160:163]
    v_exp_f32 v174, v174
    v_mfma_f32_16x16x32_bf16 v[164:167], v[80:83], a[224:227], v[48:51]
    v_exp_f32 v175, v175
    v_mfma_f32_16x16x32_bf16 v[164:167], v[84:87], a[228:231], v[164:167]
    ds_read_b64_tr_b16 v[106:107], v20 offset:36864
    v_cvt_pk_bf16_f32 v183, v174, v175
    v_mfma_f32_16x16x32_bf16 v[164:167], v[88:91], a[232:235], v[164:167]
    s_lshl_b32 s52, s52, 1
    v_mfma_f32_16x16x32_bf16 v[164:167], v[92:95], a[236:239], v[164:167]
    v_exp_f32 v160, v160
    v_mfma_f32_16x16x32_bf16 a[32:35], v[128:131], v[180:183], a[32:35]
    v_exp_f32 v161, v161
    v_mfma_f32_16x16x32_bf16 a[36:39], v[132:135], v[180:183], a[36:39]
    ds_read_b64_tr_b16 v[108:109], v21 offset:32768
    v_cvt_pk_bf16_f32 v176, v160, v161
    v_mfma_f32_16x16x32_bf16 a[40:43], v[136:139], v[180:183], a[40:43]
    v_exp_f32 v162, v162
    v_mfma_f32_16x16x32_bf16 a[44:47], v[140:143], v[180:183], a[44:47]
    v_exp_f32 v163, v163
    v_mfma_f32_16x16x32_bf16 a[48:51], v[144:147], v[180:183], a[48:51]
    ds_read_b64_tr_b16 v[110:111], v21 offset:36864
    v_cvt_pk_bf16_f32 v177, v162, v163
    v_mfma_f32_16x16x32_bf16 a[52:55], v[148:151], v[180:183], a[52:55]
    s_add_u32 s52, s52, s5
    v_mfma_f32_16x16x32_bf16 a[56:59], v[152:155], v[180:183], a[56:59]
    s_mul_i32 s49, s52, 163840
    v_mfma_f32_16x16x32_bf16 a[60:63], v[156:159], v[180:183], a[60:63]
    s_mul_i32 s96, s4, 5120
    v_mfma_f32_16x16x32_bf16 v[212:215], v[34:37], v[180:183], v[212:215]
    s_mul_i32 s52, s6, 5120
    v_mfma_f32_16x16x32_bf16 v[168:171], v[64:67], a[240:243], v[52:55]
    v_exp_f32 v164, v164
    v_mfma_f32_16x16x32_bf16 v[168:171], v[68:71], a[244:247], v[168:171]
    v_exp_f32 v165, v165
    v_mfma_f32_16x16x32_bf16 v[168:171], v[72:75], a[248:251], v[168:171]
    ds_read_b64_tr_b16 v[112:113], v22 offset:32768
    v_cvt_pk_bf16_f32 v178, v164, v165
    v_mfma_f32_16x16x32_bf16 v[168:171], v[76:79], a[252:255], v[168:171]
    v_exp_f32 v166, v166
    v_mfma_f32_16x16x32_bf16 v[172:175], v[80:83], a[240:243], v[52:55]
    v_exp_f32 v167, v167
    v_mfma_f32_16x16x32_bf16 v[172:175], v[84:87], a[244:247], v[172:175]
    ds_read_b64_tr_b16 v[114:115], v22 offset:36864
    v_cvt_pk_bf16_f32 v179, v166, v167
    v_mfma_f32_16x16x32_bf16 v[172:175], v[88:91], a[248:251], v[172:175]
    s_min_u32 s98, s4, 1
    v_mfma_f32_16x16x32_bf16 v[172:175], v[92:95], a[252:255], v[172:175]
    v_exp_f32 v168, v168
    v_mfma_f32_16x16x32_bf16 a[64:67], v[128:131], v[176:179], a[64:67]
    v_exp_f32 v169, v169
    v_mfma_f32_16x16x32_bf16 a[68:71], v[132:135], v[176:179], a[68:71]
    ds_read_b64_tr_b16 v[116:117], v23 offset:32768
    v_cvt_pk_bf16_f32 v180, v168, v169
    v_mfma_f32_16x16x32_bf16 a[72:75], v[136:139], v[176:179], a[72:75]
    v_exp_f32 v170, v170
    v_mfma_f32_16x16x32_bf16 a[76:79], v[140:143], v[176:179], a[76:79]
    v_exp_f32 v171, v171
    v_mfma_f32_16x16x32_bf16 a[80:83], v[144:147], v[176:179], a[80:83]
    ds_read_b64_tr_b16 v[118:119], v23 offset:36864
    v_cvt_pk_bf16_f32 v181, v170, v171
    v_mfma_f32_16x16x32_bf16 a[84:87], v[148:151], v[176:179], a[84:87]
    s_mul_i32 s98, s98, 0xff
    v_mfma_f32_16x16x32_bf16 a[88:91], v[152:155], v[176:179], a[88:91]
    v_mfma_f32_16x16x32_bf16 a[92:95], v[156:159], v[176:179], a[92:95]
    v_mfma_f32_16x16x32_bf16 v[216:219], v[34:37], v[176:179], v[216:219]
    v_mfma_f32_16x16x32_bf16 v[160:163], v[64:67], v[192:195], v[56:59]
    v_exp_f32 v172, v172
    v_mfma_f32_16x16x32_bf16 v[160:163], v[68:71], v[196:199], v[160:163]
    v_exp_f32 v173, v173
    v_mfma_f32_16x16x32_bf16 v[160:163], v[72:75], v[200:203], v[160:163]
    ds_read_b64_tr_b16 v[120:121], v24 offset:32768
    v_cvt_pk_bf16_f32 v182, v172, v173
    v_mfma_f32_16x16x32_bf16 v[160:163], v[76:79], v[204:207], v[160:163]
    v_exp_f32 v174, v174
    v_mfma_f32_16x16x32_bf16 v[164:167], v[80:83], v[192:195], v[56:59]
    v_exp_f32 v175, v175
    v_mfma_f32_16x16x32_bf16 v[164:167], v[84:87], v[196:199], v[164:167]
    ds_read_b64_tr_b16 v[122:123], v24 offset:36864
    v_cvt_pk_bf16_f32 v183, v174, v175
    v_mfma_f32_16x16x32_bf16 v[164:167], v[88:91], v[200:203], v[164:167]
    v_lshlrev_b32 v186, 4, v1
    v_mfma_f32_16x16x32_bf16 v[164:167], v[92:95], v[204:207], v[164:167]
    v_exp_f32 v160, v160
    v_mfma_f32_16x16x32_bf16 a[96:99], v[128:131], v[180:183], a[96:99]
    v_exp_f32 v161, v161
    v_mfma_f32_16x16x32_bf16 a[100:103], v[132:135], v[180:183], a[100:103]
    ds_read_b64_tr_b16 v[124:125], v25 offset:32768
    v_cvt_pk_bf16_f32 v176, v160, v161
    v_mfma_f32_16x16x32_bf16 a[104:107], v[136:139], v[180:183], a[104:107]
    v_exp_f32 v162, v162
    v_mfma_f32_16x16x32_bf16 a[108:111], v[140:143], v[180:183], a[108:111]
    v_exp_f32 v163, v163
    v_mfma_f32_16x16x32_bf16 a[112:115], v[144:147], v[180:183], a[112:115]
    ds_read_b64_tr_b16 v[126:127], v25 offset:36864
    v_cvt_pk_bf16_f32 v177, v162, v163
    v_mfma_f32_16x16x32_bf16 a[116:119], v[148:151], v[180:183], a[116:119]
    v_add_u32 v184, s52, v186
    v_mfma_f32_16x16x32_bf16 a[120:123], v[152:155], v[180:183], a[120:123]
    v_mfma_f32_16x16x32_bf16 a[124:127], v[156:159], v[180:183], a[124:127]
    v_mfma_f32_16x16x32_bf16 v[220:223], v[34:37], v[180:183], v[220:223]
    v_mfma_f32_16x16x32_bf16 v[168:171], v[64:67], v[224:227], v[60:63]
    v_exp_f32 v164, v164
    v_mfma_f32_16x16x32_bf16 v[168:171], v[68:71], v[228:231], v[168:171]
    v_exp_f32 v165, v165
    v_mfma_f32_16x16x32_bf16 v[168:171], v[72:75], v[232:235], v[168:171]
    ds_read_b128 v[64:67], v10 offset:32768
    v_cvt_pk_bf16_f32 v178, v164, v165
    v_mfma_f32_16x16x32_bf16 v[168:171], v[76:79], v[236:239], v[168:171]
    v_exp_f32 v166, v166
    v_mfma_f32_16x16x32_bf16 v[172:175], v[80:83], v[224:227], v[60:63]
    v_exp_f32 v167, v167
    v_mfma_f32_16x16x32_bf16 v[172:175], v[84:87], v[228:231], v[172:175]
    ds_read_b128 v[68:71], v11 offset:32768
    v_cvt_pk_bf16_f32 v179, v166, v167
    v_mfma_f32_16x16x32_bf16 v[172:175], v[88:91], v[232:235], v[172:175]
    ds_read_b128 v[72:75], v12 offset:32768
    v_mfma_f32_16x16x32_bf16 v[172:175], v[92:95], v[236:239], v[172:175]
    v_exp_f32 v168, v168
    v_mfma_f32_16x16x32_bf16 a[128:131], v[128:131], v[176:179], a[128:131]
    v_exp_f32 v169, v169
    v_mfma_f32_16x16x32_bf16 a[132:135], v[132:135], v[176:179], a[132:135]
    ds_read_b128 v[76:79], v13 offset:32768
    v_cvt_pk_bf16_f32 v180, v168, v169
    v_mfma_f32_16x16x32_bf16 a[136:139], v[136:139], v[176:179], a[136:139]
    v_exp_f32 v170, v170
    v_mfma_f32_16x16x32_bf16 a[140:143], v[140:143], v[176:179], a[140:143]
    v_exp_f32 v171, v171
    v_mfma_f32_16x16x32_bf16 a[144:147], v[144:147], v[176:179], a[144:147]
    ds_read_b128 v[80:83], v10 offset:36864
    v_cvt_pk_bf16_f32 v181, v170, v171
    v_mfma_f32_16x16x32_bf16 a[148:151], v[148:151], v[176:179], a[148:151]
    ds_read_b128 v[84:87], v11 offset:36864
    v_mfma_f32_16x16x32_bf16 a[152:155], v[152:155], v[176:179], a[152:155]
    ds_read_b128 v[88:91], v12 offset:36864
    v_mfma_f32_16x16x32_bf16 a[156:159], v[156:159], v[176:179], a[156:159]
    ds_read_b128 v[92:95], v13 offset:36864
    v_mfma_f32_16x16x32_bf16 v[240:243], v[34:37], v[176:179], v[240:243]
    s_waitcnt lgkmcnt(6)
    v_mfma_f32_16x16x32_bf16 v[160:163], v[64:67], a[192:195], v[40:43]
    v_exp_f32 v172, v172
    v_mfma_f32_16x16x32_bf16 v[160:163], v[68:71], a[196:199], v[160:163]
    s_waitcnt lgkmcnt(4)
    v_exp_f32 v173, v173
    v_mfma_f32_16x16x32_bf16 v[160:163], v[72:75], a[200:203], v[160:163]
    v_cvt_pk_bf16_f32 v182, v172, v173
    v_mfma_f32_16x16x32_bf16 v[160:163], v[76:79], a[204:207], v[160:163]
    s_waitcnt lgkmcnt(2)
    v_exp_f32 v174, v174
    v_mfma_f32_16x16x32_bf16 v[164:167], v[80:83], a[192:195], v[40:43]
    v_exp_f32 v175, v175
    v_mfma_f32_16x16x32_bf16 v[164:167], v[84:87], a[196:199], v[164:167]
    s_waitcnt lgkmcnt(0)
    v_cvt_pk_bf16_f32 v183, v174, v175
    v_mfma_f32_16x16x32_bf16 v[164:167], v[88:91], a[200:203], v[164:167]
    s_waitcnt vmcnt(1)
    v_and_b32 v0, 0xff, v0
    v_or_b32 v0, s98, v0
    v_mfma_f32_16x16x32_bf16 v[164:167], v[92:95], a[204:207], v[164:167]
    v_exp_f32 v160, v160
    v_mfma_f32_16x16x32_bf16 a[160:163], v[128:131], v[180:183], a[160:163]
    v_exp_f32 v161, v161
    v_mfma_f32_16x16x32_bf16 a[164:167], v[132:135], v[180:183], a[164:167]
    v_cvt_pk_bf16_f32 v176, v160, v161
    v_cmp_gt_u32 vcc, 8, v0
    v_mfma_f32_16x16x32_bf16 a[168:171], v[136:139], v[180:183], a[168:171]
    v_exp_f32 v162, v162
    v_mfma_f32_16x16x32_bf16 a[172:175], v[140:143], v[180:183], a[172:175]
    v_exp_f32 v163, v163
    v_mfma_f32_16x16x32_bf16 a[176:179], v[144:147], v[180:183], a[176:179]
    s_waitcnt vmcnt(0)
    v_cvt_pk_bf16_f32 v177, v162, v163
    s_cbranch_vccnz L_polla0
L_pollret0:
    v_mfma_f32_16x16x32_bf16 a[180:183], v[148:151], v[180:183], a[180:183]
    s_barrier
    v_mfma_f32_16x16x32_bf16 a[184:187], v[152:155], v[180:183], a[184:187]
    s_add_u32 s53, s49, 0
    s_add_u32 s54, s49, 4096
    s_add_u32 m0, s96, 0
    v_mfma_f32_16x16x32_bf16 a[188:191], v[156:159], v[180:183], a[188:191]
    buffer_load_dwordx4 v184, s[24:27], s53 offen offset:0 sc1 lds
    v_mfma_f32_16x16x32_bf16 v[244:247], v[34:37], v[180:183], v[244:247]
    v_mfma_f32_16x16x32_bf16 v[168:171], v[64:67], a[208:211], v[44:47]
    v_exp_f32 v164, v164
    v_mfma_f32_16x16x32_bf16 v[168:171], v[68:71], a[212:215], v[168:171]
    v_exp_f32 v165, v165
    v_mfma_f32_16x16x32_bf16 v[168:171], v[72:75], a[216:219], v[168:171]
    ds_read_b64_tr_b16 v[128:129], v26 offset:0
    v_cvt_pk_bf16_f32 v178, v164, v165
    v_mfma_f32_16x16x32_bf16 v[168:171], v[76:79], a[220:223], v[168:171]
    v_exp_f32 v166, v166
    v_mfma_f32_16x16x32_bf16 v[172:175], v[80:83], a[208:211], v[44:47]
    v_exp_f32 v167, v167
    v_mfma_f32_16x16x32_bf16 v[172:175], v[84:87], a[212:215], v[172:175]
    ds_read_b64_tr_b16 v[130:131], v26 offset:4096
    v_cvt_pk_bf16_f32 v179, v166, v167
    v_mfma_f32_16x16x32_bf16 v[172:175], v[88:91], a[216:219], v[172:175]
    buffer_load_dwordx4 v184, s[24:27], s53 offen offset:1024 sc1 lds
    v_mfma_f32_16x16x32_bf16 v[172:175], v[92:95], a[220:223], v[172:175]
    v_exp_f32 v168, v168
    v_mfma_f32_16x16x32_bf16 a[0:3], v[96:99], v[176:179], a[0:3]
    v_exp_f32 v169, v169
    v_mfma_f32_16x16x32_bf16 a[4:7], v[100:103], v[176:179], a[4:7]
    ds_read_b64_tr_b16 v[132:133], v27 offset:0
    v_cvt_pk_bf16_f32 v180, v168, v169
    v_mfma_f32_16x16x32_bf16 a[8:11], v[104:107], v[176:179], a[8:11]
    v_exp_f32 v170, v170
    v_mfma_f32_16x16x32_bf16 a[12:15], v[108:111], v[176:179], a[12:15]
    v_exp_f32 v171, v171
    v_mfma_f32_16x16x32_bf16 a[16:19], v[112:115], v[176:179], a[16:19]
    ds_read_b64_tr_b16 v[134:135], v27 offset:4096
    v_cvt_pk_bf16_f32 v181, v170, v171
    v_mfma_f32_16x16x32_bf16 a[20:23], v[116:119], v[176:179], a[20:23]
    buffer_load_dwordx4 v184, s[24:27], s53 offen offset:2048 sc1 lds
    v_mfma_f32_16x16x32_bf16 a[24:27], v[120:123], v[176:179], a[24:27]
    buffer_load_dwordx4 v184, s[24:27], s53 offen offset:3072 sc1 lds
    s_add_u32 m0, s96, 4096
    v_mfma_f32_16x16x32_bf16 a[28:31], v[124:127], v[176:179], a[28:31]
    buffer_load_dwordx4 v184, s[24:27], s54 offen offset:0 sc1 lds
    s_add_u32 s53, s49, 10240
    s_add_u32 s54, s49, 14336
    s_add_u32 m0, s96, 20480
    v_mfma_f32_16x16x32_bf16 v[208:211], v[34:37], v[176:179], v[208:211]
    buffer_load_dwordx4 v184, s[24:27], s53 offen offset:0 sc1 lds
    v_mfma_f32_16x16x32_bf16 v[160:163], v[64:67], a[224:227], v[48:51]
    v_exp_f32 v172, v172
    v_mfma_f32_16x16x32_bf16 v[160:163], v[68:71], a[228:231], v[160:163]
    v_exp_f32 v173, v173
    v_mfma_f32_16x16x32_bf16 v[160:163], v[72:75], a[232:235], v[160:163]
    ds_read_b64_tr_b16 v[136:137], v28 offset:0
    v_cvt_pk_bf16_f32 v182, v172, v173
    v_mfma_f32_16x16x32_bf16 v[160:163], v[76:79], a[236:239], v[160:163]
    v_exp_f32 v174, v174
    v_mfma_f32_16x16x32_bf16 v[164:167], v[80:83], a[224:227], v[48:51]
    v_exp_f32 v175, v175
    v_mfma_f32_16x16x32_bf16 v[164:167], v[84:87], a[228:231], v[164:167]
    ds_read_b64_tr_b16 v[138:139], v28 offset:4096
    v_cvt_pk_bf16_f32 v183, v174, v175
    v_mfma_f32_16x16x32_bf16 v[164:167], v[88:91], a[232:235], v[164:167]
    buffer_load_dwordx4 v184, s[24:27], s53 offen offset:1024 sc1 lds
    v_mfma_f32_16x16x32_bf16 v[164:167], v[92:95], a[236:239], v[164:167]
    v_exp_f32 v160, v160
    v_mfma_f32_16x16x32_bf16 a[32:35], v[96:99], v[180:183], a[32:35]
    v_exp_f32 v161, v161
    v_mfma_f32_16x16x32_bf16 a[36:39], v[100:103], v[180:183], a[36:39]
    ds_read_b64_tr_b16 v[140:141], v29 offset:0
    v_cvt_pk_bf16_f32 v176, v160, v161
    v_mfma_f32_16x16x32_bf16 a[40:43], v[104:107], v[180:183], a[40:43]
    v_exp_f32 v162, v162
    v_mfma_f32_16x16x32_bf16 a[44:47], v[108:111], v[180:183], a[44:47]
    v_exp_f32 v163, v163
    v_mfma_f32_16x16x32_bf16 a[48:51], v[112:115], v[180:183], a[48:51]
    ds_read_b64_tr_b16 v[142:143], v29 offset:4096
    v_cvt_pk_bf16_f32 v177, v162, v163
    v_mfma_f32_16x16x32_bf16 a[52:55], v[116:119], v[180:183], a[52:55]
    buffer_load_dwordx4 v184, s[24:27], s53 offen offset:2048 sc1 lds
    v_mfma_f32_16x16x32_bf16 a[56:59], v[120:123], v[180:183], a[56:59]
    buffer_load_dwordx4 v184, s[24:27], s53 offen offset:3072 sc1 lds
    s_add_u32 m0, s96, 24576
    v_mfma_f32_16x16x32_bf16 a[60:63], v[124:127], v[180:183], a[60:63]
    buffer_load_dwordx4 v184, s[24:27], s54 offen offset:0 sc1 lds
    s_add_u32 s53, s49, 20480
    s_add_u32 s54, s49, 24576
    s_add_u32 m0, s96, 40960
    v_mfma_f32_16x16x32_bf16 v[212:215], v[34:37], v[180:183], v[212:215]
    buffer_load_dwordx4 v184, s[24:27], s53 offen offset:0 sc1 lds
    v_mfma_f32_16x16x32_bf16 v[168:171], v[64:67], a[240:243], v[52:55]
    v_exp_f32 v164, v164
    v_mfma_f32_16x16x32_bf16 v[168:171], v[68:71], a[244:247], v[168:171]
    v_exp_f32 v165, v165
    v_mfma_f32_16x16x32_bf16 v[168:171], v[72:75], a[248:251], v[168:171]
    ds_read_b64_tr_b16 v[144:145], v30 offset:0
    v_cvt_pk_bf16_f32 v178, v164, v165
    v_mfma_f32_16x16x32_bf16 v[168:171], v[76:79], a[252:255], v[168:171]
    v_exp_f32 v166, v166
    v_mfma_f32_16x16x32_bf16 v[172:175], v[80:83], a[240:243], v[52:55]
    v_exp_f32 v167, v167
    v_mfma_f32_16x16x32_bf16 v[172:175], v[84:87], a[244:247], v[172:175]
    ds_read_b64_tr_b16 v[146:147], v30 offset:4096
    v_cvt_pk_bf16_f32 v179, v166, v167
    v_mfma_f32_16x16x32_bf16 v[172:175], v[88:91], a[248:251], v[172:175]
    buffer_load_dwordx4 v184, s[24:27], s53 offen offset:1024 sc1 lds
    v_mfma_f32_16x16x32_bf16 v[172:175], v[92:95], a[252:255], v[172:175]
    v_exp_f32 v168, v168
    v_mfma_f32_16x16x32_bf16 a[64:67], v[96:99], v[176:179], a[64:67]
    v_exp_f32 v169, v169
    v_mfma_f32_16x16x32_bf16 a[68:71], v[100:103], v[176:179], a[68:71]
    ds_read_b64_tr_b16 v[148:149], v31 offset:0
    v_cvt_pk_bf16_f32 v180, v168, v169
    v_mfma_f32_16x16x32_bf16 a[72:75], v[104:107], v[176:179], a[72:75]
    v_exp_f32 v170, v170
    v_mfma_f32_16x16x32_bf16 a[76:79], v[108:111], v[176:179], a[76:79]
    v_exp_f32 v171, v171
    v_mfma_f32_16x16x32_bf16 a[80:83], v[112:115], v[176:179], a[80:83]
    ds_read_b64_tr_b16 v[150:151], v31 offset:4096
    v_cvt_pk_bf16_f32 v181, v170, v171
    v_mfma_f32_16x16x32_bf16 a[84:87], v[116:119], v[176:179], a[84:87]
    buffer_load_dwordx4 v184, s[24:27], s53 offen offset:2048 sc1 lds
    v_mfma_f32_16x16x32_bf16 a[88:91], v[120:123], v[176:179], a[88:91]
    buffer_load_dwordx4 v184, s[24:27], s53 offen offset:3072 sc1 lds
    s_add_u32 m0, s96, 45056
    v_mfma_f32_16x16x32_bf16 a[92:95], v[124:127], v[176:179], a[92:95]
    buffer_load_dwordx4 v184, s[24:27], s54 offen offset:0 sc1 lds
    v_mfma_f32_16x16x32_bf16 v[216:219], v[34:37], v[176:179], v[216:219]
    v_lshlrev_b32 v254, 7, v1
    v_bfrev_b32 v255, 1
    v_mfma_f32_16x16x32_bf16 v[160:163], v[64:67], v[192:195], v[56:59]
    v_exp_f32 v172, v172
    v_mfma_f32_16x16x32_bf16 v[160:163], v[68:71], v[196:199], v[160:163]
    v_exp_f32 v173, v173
    v_mfma_f32_16x16x32_bf16 v[160:163], v[72:75], v[200:203], v[160:163]
    ds_read_b64_tr_b16 v[152:153], v32 offset:0
    v_cvt_pk_bf16_f32 v182, v172, v173
    v_mfma_f32_16x16x32_bf16 v[160:163], v[76:79], v[204:207], v[160:163]
    v_exp_f32 v174, v174
    v_mfma_f32_16x16x32_bf16 v[164:167], v[80:83], v[192:195], v[56:59]
    v_exp_f32 v175, v175
    v_mfma_f32_16x16x32_bf16 v[164:167], v[84:87], v[196:199], v[164:167]
    ds_read_b64_tr_b16 v[154:155], v32 offset:4096
    v_cvt_pk_bf16_f32 v183, v174, v175
    v_mfma_f32_16x16x32_bf16 v[164:167], v[88:91], v[200:203], v[164:167]
    v_cmp_gt_u32 vcc, 5, v1
    v_mfma_f32_16x16x32_bf16 v[164:167], v[92:95], v[204:207], v[164:167]
    v_exp_f32 v160, v160
    v_mfma_f32_16x16x32_bf16 a[96:99], v[96:99], v[180:183], a[96:99]
    v_exp_f32 v161, v161
    v_mfma_f32_16x16x32_bf16 a[100:103], v[100:103], v[180:183], a[100:103]
    ds_read_b64_tr_b16 v[156:157], v33 offset:0
    v_cvt_pk_bf16_f32 v176, v160, v161
    v_mfma_f32_16x16x32_bf16 a[104:107], v[104:107], v[180:183], a[104:107]
    v_exp_f32 v162, v162
    v_mfma_f32_16x16x32_bf16 a[108:111], v[108:111], v[180:183], a[108:111]
    v_exp_f32 v163, v163
    v_mfma_f32_16x16x32_bf16 a[112:115], v[112:115], v[180:183], a[112:115]
    ds_read_b64_tr_b16 v[158:159], v33 offset:4096
    v_cvt_pk_bf16_f32 v177, v162, v163
    v_mfma_f32_16x16x32_bf16 a[116:119], v[116:119], v[180:183], a[116:119]
    v_cndmask_b32 v254, v255, v254, vcc
    v_mfma_f32_16x16x32_bf16 a[120:123], v[120:123], v[180:183], a[120:123]
    buffer_load_dword v0, v254, s[64:67], s86 offen
    v_mfma_f32_16x16x32_bf16 a[124:127], v[124:127], v[180:183], a[124:127]
    v_mfma_f32_16x16x32_bf16 v[220:223], v[34:37], v[180:183], v[220:223]
    v_mfma_f32_16x16x32_bf16 v[168:171], v[64:67], v[224:227], v[60:63]
    v_exp_f32 v164, v164
    v_mfma_f32_16x16x32_bf16 v[168:171], v[68:71], v[228:231], v[168:171]
    v_exp_f32 v165, v165
    v_mfma_f32_16x16x32_bf16 v[168:171], v[72:75], v[232:235], v[168:171]
    ds_read_b128 v[64:67], v14 offset:0
    v_cvt_pk_bf16_f32 v178, v164, v165
    v_mfma_f32_16x16x32_bf16 v[168:171], v[76:79], v[236:239], v[168:171]
    v_exp_f32 v166, v166
    v_mfma_f32_16x16x32_bf16 v[172:175], v[80:83], v[224:227], v[60:63]
    v_exp_f32 v167, v167
    v_mfma_f32_16x16x32_bf16 v[172:175], v[84:87], v[228:231], v[172:175]
    ds_read_b128 v[68:71], v15 offset:0
    v_cvt_pk_bf16_f32 v179, v166, v167
    v_mfma_f32_16x16x32_bf16 v[172:175], v[88:91], v[232:235], v[172:175]
    ds_read_b128 v[72:75], v16 offset:0
    v_mfma_f32_16x16x32_bf16 v[172:175], v[92:95], v[236:239], v[172:175]
    v_exp_f32 v168, v168
    v_mfma_f32_16x16x32_bf16 a[128:131], v[96:99], v[176:179], a[128:131]
    v_exp_f32 v169, v169
    v_mfma_f32_16x16x32_bf16 a[132:135], v[100:103], v[176:179], a[132:135]
    ds_read_b128 v[76:79], v17 offset:0
    v_cvt_pk_bf16_f32 v180, v168, v169
    v_mfma_f32_16x16x32_bf16 a[136:139], v[104:107], v[176:179], a[136:139]
    v_exp_f32 v170, v170
    v_mfma_f32_16x16x32_bf16 a[140:143], v[108:111], v[176:179], a[140:143]
    v_exp_f32 v171, v171
    v_mfma_f32_16x16x32_bf16 a[144:147], v[112:115], v[176:179], a[144:147]
    ds_read_b128 v[80:83], v14 offset:4096
    v_cvt_pk_bf16_f32 v181, v170, v171
    v_mfma_f32_16x16x32_bf16 a[148:151], v[116:119], v[176:179], a[148:151]
    ds_read_b128 v[84:87], v15 offset:4096
    v_mfma_f32_16x16x32_bf16 a[152:155], v[120:123], v[176:179], a[152:155]
    ds_read_b128 v[88:91], v16 offset:4096
    v_mfma_f32_16x16x32_bf16 a[156:159], v[124:127], v[176:179], a[156:159]
    ds_read_b128 v[92:95], v17 offset:4096
    v_mfma_f32_16x16x32_bf16 v[240:243], v[34:37], v[176:179], v[240:243]
    s_waitcnt lgkmcnt(6)
    v_mfma_f32_16x16x32_bf16 v[160:163], v[64:67], a[192:195], v[40:43]
    v_exp_f32 v172, v172
    v_mfma_f32_16x16x32_bf16 v[160:163], v[68:71], a[196:199], v[160:163]
    s_waitcnt lgkmcnt(4)
    v_exp_f32 v173, v173
    v_mfma_f32_16x16x32_bf16 v[160:163], v[72:75], a[200:203], v[160:163]
    v_cvt_pk_bf16_f32 v182, v172, v173
    v_mfma_f32_16x16x32_bf16 v[160:163], v[76:79], a[204:207], v[160:163]
    s_waitcnt lgkmcnt(2)
    v_exp_f32 v174, v174
    v_mfma_f32_16x16x32_bf16 v[164:167], v[80:83], a[192:195], v[40:43]
    v_exp_f32 v175, v175
    v_mfma_f32_16x16x32_bf16 v[164:167], v[84:87], a[196:199], v[164:167]
    s_waitcnt lgkmcnt(0)
    v_cvt_pk_bf16_f32 v183, v174, v175
    v_mfma_f32_16x16x32_bf16 v[164:167], v[88:91], a[200:203], v[164:167]
    v_mfma_f32_16x16x32_bf16 v[164:167], v[92:95], a[204:207], v[164:167]
    v_exp_f32 v160, v160
    v_mfma_f32_16x16x32_bf16 a[160:163], v[96:99], v[180:183], a[160:163]
    v_exp_f32 v161, v161
    v_mfma_f32_16x16x32_bf16 a[164:167], v[100:103], v[180:183], a[164:167]
    v_cvt_pk_bf16_f32 v176, v160, v161
    v_mfma_f32_16x16x32_bf16 a[168:171], v[104:107], v[180:183], a[168:171]
    v_exp_f32 v162, v162
    v_mfma_f32_16x16x32_bf16 a[172:175], v[108:111], v[180:183], a[172:175]
    v_exp_f32 v163, v163
    v_mfma_f32_16x16x32_bf16 a[176:179], v[112:115], v[180:183], a[176:179]
    v_cvt_pk_bf16_f32 v177, v162, v163
    v_mfma_f32_16x16x32_bf16 a[180:183], v[116:119], v[180:183], a[180:183]
    s_barrier
    v_mfma_f32_16x16x32_bf16 a[184:187], v[120:123], v[180:183], a[184:187]
    s_add_u32 s53, s49, 30720
    s_add_u32 s54, s49, 34816
    s_add_u32 m0, s96, 61440
    v_mfma_f32_16x16x32_bf16 a[188:191], v[124:127], v[180:183], a[188:191]
    buffer_load_dwordx4 v184, s[24:27], s53 offen offset:0 sc1 lds
    v_mfma_f32_16x16x32_bf16 v[244:247], v[34:37], v[180:183], v[244:247]
    v_mfma_f32_16x16x32_bf16 v[168:171], v[64:67], a[208:211], v[44:47]
    v_exp_f32 v164, v164
    v_mfma_f32_16x16x32_bf16 v[168:171], v[68:71], a[212:215], v[168:171]
    v_exp_f32 v165, v165
    v_mfma_f32_16x16x32_bf16 v[168:171], v[72:75], a[216:219], v[168:171]
    v_cvt_pk_bf16_f32 v178, v164, v165
    v_mfma_f32_16x16x32_bf16 v[168:171], v[76:79], a[220:223], v[168:171]
    v_exp_f32 v166, v166
    v_mfma_f32_16x16x32_bf16 v[172:175], v[80:83], a[208:211], v[44:47]
    v_exp_f32 v167, v167
    v_mfma_f32_16x16x32_bf16 v[172:175], v[84:87], a[212:215], v[172:175]
    v_cvt_pk_bf16_f32 v179, v166, v167
    v_mfma_f32_16x16x32_bf16 v[172:175], v[88:91], a[216:219], v[172:175]
    buffer_load_dwordx4 v184, s[24:27], s53 offen offset:1024 sc1 lds
    v_mfma_f32_16x16x32_bf16 v[172:175], v[92:95], a[220:223], v[172:175]
    v_exp_f32 v168, v168
    v_mfma_f32_16x16x32_bf16 a[0:3], v[128:131], v[176:179], a[0:3]
    v_exp_f32 v169, v169
    v_mfma_f32_16x16x32_bf16 a[4:7], v[132:135], v[176:179], a[4:7]
    v_cvt_pk_bf16_f32 v180, v168, v169
    v_mfma_f32_16x16x32_bf16 a[8:11], v[136:139], v[176:179], a[8:11]
    v_exp_f32 v170, v170
    v_mfma_f32_16x16x32_bf16 a[12:15], v[140:143], v[176:179], a[12:15]
    v_exp_f32 v171, v171
    v_mfma_f32_16x16x32_bf16 a[16:19], v[144:147], v[176:179], a[16:19]
    v_cvt_pk_bf16_f32 v181, v170, v171
    v_mfma_f32_16x16x32_bf16 a[20:23], v[148:151], v[176:179], a[20:23]
    buffer_load_dwordx4 v184, s[24:27], s53 offen offset:2048 sc1 lds
    v_mfma_f32_16x16x32_bf16 a[24:27], v[152:155], v[176:179], a[24:27]
    buffer_load_dwordx4 v184, s[24:27], s53 offen offset:3072 sc1 lds
    s_add_u32 m0, s96, 65536
    v_mfma_f32_16x16x32_bf16 a[28:31], v[156:159], v[176:179], a[28:31]
    buffer_load_dwordx4 v184, s[24:27], s54 offen offset:0 sc1 lds
    s_add_u32 s53, s49, 40960
    s_add_u32 s54, s49, 45056
    s_add_u32 m0, s96, 81920
    v_mfma_f32_16x16x32_bf16 v[208:211], v[34:37], v[176:179], v[208:211]
    buffer_load_dwordx4 v184, s[24:27], s53 offen offset:0 sc1 lds
    v_mfma_f32_16x16x32_bf16 v[160:163], v[64:67], a[224:227], v[48:51]
    v_exp_f32 v172, v172
    v_mfma_f32_16x16x32_bf16 v[160:163], v[68:71], a[228:231], v[160:163]
    v_exp_f32 v173, v173
    v_mfma_f32_16x16x32_bf16 v[160:163], v[72:75], a[232:235], v[160:163]
    v_cvt_pk_bf16_f32 v182, v172, v173
    v_mfma_f32_16x16x32_bf16 v[160:163], v[76:79], a[236:239], v[160:163]
    v_exp_f32 v174, v174
    v_mfma_f32_16x16x32_bf16 v[164:167], v[80:83], a[224:227], v[48:51]
    v_exp_f32 v175, v175
    v_mfma_f32_16x16x32_bf16 v[164:167], v[84:87], a[228:231], v[164:167]
    v_cvt_pk_bf16_f32 v183, v174, v175
    v_mfma_f32_16x16x32_bf16 v[164:167], v[88:91], a[232:235], v[164:167]
    buffer_load_dwordx4 v184, s[24:27], s53 offen offset:1024 sc1 lds
    v_mfma_f32_16x16x32_bf16 v[164:167], v[92:95], a[236:239], v[164:167]
    v_exp_f32 v160, v160
    v_mfma_f32_16x16x32_bf16 a[32:35], v[128:131], v[180:183], a[32:35]
    v_exp_f32 v161, v161
    v_mfma_f32_16x16x32_bf16 a[36:39], v[132:135], v[180:183], a[36:39]
    v_cvt_pk_bf16_f32 v176, v160, v161
    v_mfma_f32_16x16x32_bf16 a[40:43], v[136:139], v[180:183], a[40:43]
    v_exp_f32 v162, v162
    v_mfma_f32_16x16x32_bf16 a[44:47], v[140:143], v[180:183], a[44:47]
    v_exp_f32 v163, v163
    v_mfma_f32_16x16x32_bf16 a[48:51], v[144:147], v[180:183], a[48:51]
    v_cvt_pk_bf16_f32 v177, v162, v163
    v_mfma_f32_16x16x32_bf16 a[52:55], v[148:151], v[180:183], a[52:55]
    buffer_load_dwordx4 v184, s[24:27], s53 offen offset:2048 sc1 lds
    v_mfma_f32_16x16x32_bf16 a[56:59], v[152:155], v[180:183], a[56:59]
    buffer_load_dwordx4 v184, s[24:27], s53 offen offset:3072 sc1 lds
    s_add_u32 m0, s96, 86016
    v_mfma_f32_16x16x32_bf16 a[60:63], v[156:159], v[180:183], a[60:63]
    buffer_load_dwordx4 v184, s[24:27], s54 offen offset:0 sc1 lds
    s_add_u32 s53, s49, 51200
    s_add_u32 s54, s49, 55296
    s_add_u32 m0, s96, 102400
    v_mfma_f32_16x16x32_bf16 v[212:215], v[34:37], v[180:183], v[212:215]
    buffer_load_dwordx4 v184, s[24:27], s53 offen offset:0 sc1 lds
    v_mfma_f32_16x16x32_bf16 v[168:171], v[64:67], a[240:243], v[52:55]
    v_exp_f32 v164, v164
    v_mfma_f32_16x16x32_bf16 v[168:171], v[68:71], a[244:247], v[168:171]
    v_exp_f32 v165, v165
    v_mfma_f32_16x16x32_bf16 v[168:171], v[72:75], a[248:251], v[168:171]
    v_cvt_pk_bf16_f32 v178, v164, v165
    v_mfma_f32_16x16x32_bf16 v[168:171], v[76:79], a[252:255], v[168:171]
    v_exp_f32 v166, v166
    v_mfma_f32_16x16x32_bf16 v[172:175], v[80:83], a[240:243], v[52:55]
    v_exp_f32 v167, v167
    v_mfma_f32_16x16x32_bf16 v[172:175], v[84:87], a[244:247], v[172:175]
    v_cvt_pk_bf16_f32 v179, v166, v167
    v_mfma_f32_16x16x32_bf16 v[172:175], v[88:91], a[248:251], v[172:175]
    buffer_load_dwordx4 v184, s[24:27], s53 offen offset:1024 sc1 lds
    v_mfma_f32_16x16x32_bf16 v[172:175], v[92:95], a[252:255], v[172:175]
    v_exp_f32 v168, v168
    v_mfma_f32_16x16x32_bf16 a[64:67], v[128:131], v[176:179], a[64:67]
    v_exp_f32 v169, v169
    v_mfma_f32_16x16x32_bf16 a[68:71], v[132:135], v[176:179], a[68:71]
    v_cvt_pk_bf16_f32 v180, v168, v169
    v_mfma_f32_16x16x32_bf16 a[72:75], v[136:139], v[176:179], a[72:75]
    v_exp_f32 v170, v170
    v_mfma_f32_16x16x32_bf16 a[76:79], v[140:143], v[176:179], a[76:79]
    v_exp_f32 v171, v171
    v_mfma_f32_16x16x32_bf16 a[80:83], v[144:147], v[176:179], a[80:83]
    v_cvt_pk_bf16_f32 v181, v170, v171
    v_mfma_f32_16x16x32_bf16 a[84:87], v[148:151], v[176:179], a[84:87]
    buffer_load_dwordx4 v184, s[24:27], s53 offen offset:2048 sc1 lds
    v_mfma_f32_16x16x32_bf16 a[88:91], v[152:155], v[176:179], a[88:91]
    buffer_load_dwordx4 v184, s[24:27], s53 offen offset:3072 sc1 lds
    s_add_u32 m0, s96, 106496
    v_mfma_f32_16x16x32_bf16 a[92:95], v[156:159], v[176:179], a[92:95]
    buffer_load_dwordx4 v184, s[24:27], s54 offen offset:0 sc1 lds
    s_add_u32 s53, s49, 61440
    s_add_u32 s54, s49, 65536
    s_add_u32 m0, s96, 122880
    v_mfma_f32_16x16x32_bf16 v[216:219], v[34:37], v[176:179], v[216:219]
    buffer_load_dwordx4 v184, s[24:27], s53 offen offset:0 sc1 lds
    v_mfma_f32_16x16x32_bf16 v[160:163], v[64:67], v[192:195], v[56:59]
    v_exp_f32 v172, v172
    v_mfma_f32_16x16x32_bf16 v[160:163], v[68:71], v[196:199], v[160:163]
    v_exp_f32 v173, v173
    v_mfma_f32_16x16x32_bf16 v[160:163], v[72:75], v[200:203], v[160:163]
    v_cvt_pk_bf16_f32 v182, v172, v173
    v_mfma_f32_16x16x32_bf16 v[160:163], v[76:79], v[204:207], v[160:163]
    v_exp_f32 v174, v174
    v_mfma_f32_16x16x32_bf16 v[164:167], v[80:83], v[192:195], v[56:59]
    v_exp_f32 v175, v175
    v_mfma_f32_16x16x32_bf16 v[164:167], v[84:87], v[196:199], v[164:167]
    v_cvt_pk_bf16_f32 v183, v174, v175
    v_mfma_f32_16x16x32_bf16 v[164:167], v[88:91], v[200:203], v[164:167]
    buffer_load_dwordx4 v184, s[24:27], s53 offen offset:1024 sc1 lds
    v_mfma_f32_16x16x32_bf16 v[164:167], v[92:95], v[204:207], v[164:167]
    v_exp_f32 v160, v160
    v_mfma_f32_16x16x32_bf16 a[96:99], v[128:131], v[180:183], a[96:99]
    v_exp_f32 v161, v161
    v_mfma_f32_16x16x32_bf16 a[100:103], v[132:135], v[180:183], a[100:103]
    v_cvt_pk_bf16_f32 v176, v160, v161
    v_mfma_f32_16x16x32_bf16 a[104:107], v[136:139], v[180:183], a[104:107]
    v_exp_f32 v162, v162
    v_mfma_f32_16x16x32_bf16 a[108:111], v[140:143], v[180:183], a[108:111]
    v_exp_f32 v163, v163
    v_mfma_f32_16x16x32_bf16 a[112:115], v[144:147], v[180:183], a[112:115]
    v_cvt_pk_bf16_f32 v177, v162, v163
    v_mfma_f32_16x16x32_bf16 a[116:119], v[148:151], v[180:183], a[116:119]
    buffer_load_dwordx4 v184, s[24:27], s53 offen offset:2048 sc1 lds
    v_mfma_f32_16x16x32_bf16 a[120:123], v[152:155], v[180:183], a[120:123]
    buffer_load_dwordx4 v184, s[24:27], s53 offen offset:3072 sc1 lds
    s_add_u32 m0, s96, 126976
    v_mfma_f32_16x16x32_bf16 a[124:127], v[156:159], v[180:183], a[124:127]
    buffer_load_dwordx4 v184, s[24:27], s54 offen offset:0 sc1 lds
    v_mfma_f32_16x16x32_bf16 v[220:223], v[34:37], v[180:183], v[220:223]
    v_mfma_f32_16x16x32_bf16 v[168:171], v[64:67], v[224:227], v[60:63]
    v_exp_f32 v164, v164
    v_mfma_f32_16x16x32_bf16 v[168:171], v[68:71], v[228:231], v[168:171]
    v_exp_f32 v165, v165
    v_mfma_f32_16x16x32_bf16 v[168:171], v[72:75], v[232:235], v[168:171]
    v_cvt_pk_bf16_f32 v178, v164, v165
    v_mfma_f32_16x16x32_bf16 v[168:171], v[76:79], v[236:239], v[168:171]
    v_exp_f32 v166, v166
    v_mfma_f32_16x16x32_bf16 v[172:175], v[80:83], v[224:227], v[60:63]
    v_exp_f32 v167, v167
    v_mfma_f32_16x16x32_bf16 v[172:175], v[84:87], v[228:231], v[172:175]
    v_cvt_pk_bf16_f32 v179, v166, v167
    v_mfma_f32_16x16x32_bf16 v[172:175], v[88:91], v[232:235], v[172:175]
    v_mfma_f32_16x16x32_bf16 v[172:175], v[92:95], v[236:239], v[172:175]
    v_exp_f32 v168, v168
    v_mfma_f32_16x16x32_bf16 a[128:131], v[128:131], v[176:179], a[128:131]
    v_exp_f32 v169, v169
    v_mfma_f32_16x16x32_bf16 a[132:135], v[132:135], v[176:179], a[132:135]
    v_cvt_pk_bf16_f32 v180, v168, v169
    v_mfma_f32_16x16x32_bf16 a[136:139], v[136:139], v[176:179], a[136:139]
    v_exp_f32 v170, v170
    v_mfma_f32_16x16x32_bf16 a[140:143], v[140:143], v[176:179], a[140:143]
    v_exp_f32 v171, v171
    v_mfma_f32_16x16x32_bf16 a[144:147], v[144:147], v[176:179], a[144:147]
    v_cvt_pk_bf16_f32 v181, v170, v171
    v_mfma_f32_16x16x32_bf16 a[148:151], v[148:151], v[176:179], a[148:151]
    v_mfma_f32_16x16x32_bf16 a[152:155], v[152:155], v[176:179], a[152:155]
    v_mfma_f32_16x16x32_bf16 a[156:159], v[156:159], v[176:179], a[156:159]
    v_mfma_f32_16x16x32_bf16 v[240:243], v[34:37], v[176:179], v[240:243]
    v_exp_f32 v172, v172
    v_exp_f32 v173, v173
    v_exp_f32 v174, v174
    v_exp_f32 v175, v175
    v_cvt_pk_bf16_f32 v182, v172, v173
    v_cvt_pk_bf16_f32 v183, v174, v175
    s_nop 1
    v_mfma_f32_16x16x32_bf16 a[160:163], v[128:131], v[180:183], a[160:163]
    v_mfma_f32_16x16x32_bf16 a[164:167], v[132:135], v[180:183], a[164:167]
    v_mfma_f32_16x16x32_bf16 a[168:171], v[136:139], v[180:183], a[168:171]
    v_mfma_f32_16x16x32_bf16 a[172:175], v[140:143], v[180:183], a[172:175]
    v_mfma_f32_16x16x32_bf16 a[176:179], v[144:147], v[180:183], a[176:179]
    v_mfma_f32_16x16x32_bf16 a[180:183], v[148:151], v[180:183], a[180:183]
    v_mfma_f32_16x16x32_bf16 a[184:187], v[152:155], v[180:183], a[184:187]
    v_mfma_f32_16x16x32_bf16 a[188:191], v[156:159], v[180:183], a[188:191]
    v_mfma_f32_16x16x32_bf16 v[244:247], v[34:37], v[180:183], v[244:247]
    s_mov_b32 s52, 0x4e800000
    v_add_f32 v185, v208, v212
    v_add_f32 v186, v216, v220
    v_add_f32 v185, v185, v240
    v_add_f32 v185, v185, v186
    s_nop 5
    v_add_f32 v185, v185, v244
    v_cmp_nge_f32 vcc, s52, v185
    s_nop 4
    s_cbranch_vccnz L_slow
L_slowret1:
    v_rcp_f32 v2, v208
    v_rcp_f32 v3, v212
    v_rcp_f32 v4, v216
    v_rcp_f32 v5, v220
    v_rcp_f32 v6, v240
    v_rcp_f32 v7, v244
    s_add_u32 s48, s48, 393216
    v_lshlrev_b32 v60, 4, v1
    s_and_b32 s55, s37, 1
    s_mul_i32 s52, s55, 3072
    v_add_u32 v10, s52, v60
    s_sub_u32 s52, 3072, s52
    v_add_u32 v11, s52, v60
    s_lshl_b32 s50, s6, 5
    s_lshl_b32 s52, s55, 3
    s_add_u32 s50, s50, s52
    s_lshl_b32 s52, s5, 2
    s_add_u32 s50, s50, s52
    s_mul_i32 s50, s50, 24576
    s_waitcnt vmcnt(0)
    buffer_load_dwordx4 v[184:187], v10, s[20:23], s50 offen offset:0 sc1
    buffer_load_dwordx4 v[188:191], v10, s[20:23], s50 offen offset:1024 sc1
    buffer_load_dwordx4 v[192:195], v10, s[20:23], s50 offen offset:2048 sc1
    buffer_load_dwordx4 v[196:199], v11, s[20:23], s50 offen offset:0 sc1
    buffer_load_dwordx4 v[200:203], v11, s[20:23], s50 offen offset:1024 sc1
    buffer_load_dwordx4 v[204:207], v11, s[20:23], s50 offen offset:2048 sc1
    s_barrier
    s_mul_i32 s52, s6, 5120
    v_add_u32 v8, s52, v60
    s_mul_i32 s52, s5, 15360
    v_add_u32 v62, s52, v60
    s_mul_i32 s52, s5, 5120
    s_add_u32 s52, s52, 5120
    v_add_u32 v63, s52, v60
    s_add_u32 s49, s49, 61440
    s_mov_b32 s97, 122880
    ds_read_b128 a[192:195], v62 offset:0
    ds_read_b128 a[196:199], v62 offset:1024
    ds_read_b128 a[200:203], v62 offset:2048
    v_accvgpr_read_b32 v64, a0
    v_accvgpr_read_b32 v65, a1
    v_accvgpr_read_b32 v66, a2
    v_accvgpr_read_b32 v67, a3
    v_accvgpr_read_b32 v68, a4
    v_accvgpr_read_b32 v69, a5
    v_accvgpr_read_b32 v70, a6
    v_accvgpr_read_b32 v71, a7
    v_pk_mul_f32 v[64:65], v[64:65], v[2:3] op_sel:[0,0] op_sel_hi:[1,0]
    v_pk_mul_f32 v[66:67], v[66:67], v[2:3] op_sel:[0,0] op_sel_hi:[1,0]
    v_pk_mul_f32 v[68:69], v[68:69], v[2:3] op_sel:[0,0] op_sel_hi:[1,0]
    v_pk_mul_f32 v[70:71], v[70:71], v[2:3] op_sel:[0,0] op_sel_hi:[1,0]
    v_cvt_pk_bf16_f32 v96, v64, v65
    v_cvt_pk_bf16_f32 v97, v66, v67
    v_cvt_pk_bf16_f32 v98, v68, v69
    v_cvt_pk_bf16_f32 v99, v70, v71
    v_accvgpr_write_b32 a212, v96
    v_accvgpr_write_b32 a213, v97
    v_accvgpr_write_b32 a214, v98
    v_accvgpr_write_b32 a215, v99
    s_add_u32 s50, s50, 6144
    buffer_load_dwordx4 v[208:211], v10, s[20:23], s50 offen offset:0 sc1
    buffer_load_dwordx4 v[212:215], v10, s[20:23], s50 offen offset:1024 sc1
    v_accvgpr_read_b32 v72, a8
    v_accvgpr_read_b32 v73, a9
    v_accvgpr_read_b32 v74, a10
    v_accvgpr_read_b32 v75, a11
    v_accvgpr_read_b32 v76, a12
    v_accvgpr_read_b32 v77, a13
    v_accvgpr_read_b32 v78, a14
    v_accvgpr_read_b32 v79, a15
    v_pk_mul_f32 v[72:73], v[72:73], v[2:3] op_sel:[0,0] op_sel_hi:[1,0]
    v_pk_mul_f32 v[74:75], v[74:75], v[2:3] op_sel:[0,0] op_sel_hi:[1,0]
    v_pk_mul_f32 v[76:77], v[76:77], v[2:3] op_sel:[0,0] op_sel_hi:[1,0]
    v_pk_mul_f32 v[78:79], v[78:79], v[2:3] op_sel:[0,0] op_sel_hi:[1,0]
    v_cvt_pk_bf16_f32 v96, v72, v73
    v_cvt_pk_bf16_f32 v97, v74, v75
    v_cvt_pk_bf16_f32 v98, v76, v77
    v_cvt_pk_bf16_f32 v99, v78, v79
    v_accvgpr_write_b32 a216, v96
    v_accvgpr_write_b32 a217, v97
    v_accvgpr_write_b32 a218, v98
    v_accvgpr_write_b32 a219, v99
    buffer_load_dwordx4 v[216:219], v10, s[20:23], s50 offen offset:2048 sc1
    buffer_load_dwordx4 v[220:223], v11, s[20:23], s50 offen offset:0 sc1
    v_accvgpr_read_b32 v64, a16
    v_accvgpr_read_b32 v65, a17
    v_accvgpr_read_b32 v66, a18
    v_accvgpr_read_b32 v67, a19
    v_accvgpr_read_b32 v68, a20
    v_accvgpr_read_b32 v69, a21
    v_accvgpr_read_b32 v70, a22
    v_accvgpr_read_b32 v71, a23
    v_pk_mul_f32 v[64:65], v[64:65], v[2:3] op_sel:[0,0] op_sel_hi:[1,0]
    v_pk_mul_f32 v[66:67], v[66:67], v[2:3] op_sel:[0,0] op_sel_hi:[1,0]
    v_pk_mul_f32 v[68:69], v[68:69], v[2:3] op_sel:[0,0] op_sel_hi:[1,0]
    v_pk_mul_f32 v[70:71], v[70:71], v[2:3] op_sel:[0,0] op_sel_hi:[1,0]
    v_cvt_pk_bf16_f32 v96, v64, v65
    v_cvt_pk_bf16_f32 v97, v66, v67
    v_cvt_pk_bf16_f32 v98, v68, v69
    v_cvt_pk_bf16_f32 v99, v70, v71
    v_accvgpr_write_b32 a220, v96
    v_accvgpr_write_b32 a221, v97
    v_accvgpr_write_b32 a222, v98
    v_accvgpr_write_b32 a223, v99
    buffer_load_dwordx4 v[224:227], v11, s[20:23], s50 offen offset:1024 sc1
    buffer_load_dwordx4 v[228:231], v11, s[20:23], s50 offen offset:2048 sc1
    v_accvgpr_read_b32 v72, a24
    v_accvgpr_read_b32 v73, a25
    v_accvgpr_read_b32 v74, a26
    v_accvgpr_read_b32 v75, a27
    v_accvgpr_read_b32 v76, a28
    v_accvgpr_read_b32 v77, a29
    v_accvgpr_read_b32 v78, a30
    v_accvgpr_read_b32 v79, a31
    v_pk_mul_f32 v[72:73], v[72:73], v[2:3] op_sel:[0,0] op_sel_hi:[1,0]
    v_pk_mul_f32 v[74:75], v[74:75], v[2:3] op_sel:[0,0] op_sel_hi:[1,0]
    v_pk_mul_f32 v[76:77], v[76:77], v[2:3] op_sel:[0,0] op_sel_hi:[1,0]
    v_pk_mul_f32 v[78:79], v[78:79], v[2:3] op_sel:[0,0] op_sel_hi:[1,0]
    v_cvt_pk_bf16_f32 v96, v72, v73
    v_cvt_pk_bf16_f32 v97, v74, v75
    v_cvt_pk_bf16_f32 v98, v76, v77
    v_cvt_pk_bf16_f32 v99, v78, v79
    v_accvgpr_write_b32 a224, v96
    v_accvgpr_write_b32 a225, v97
    v_accvgpr_write_b32 a226, v98
    v_accvgpr_write_b32 a227, v99
    s_add_u32 s50, s50, 6144
    buffer_load_dwordx4 v[232:235], v10, s[20:23], s50 offen offset:0 sc1
    buffer_load_dwordx4 v[236:239], v10, s[20:23], s50 offen offset:1024 sc1
    v_accvgpr_read_b32 v64, a32
    v_accvgpr_read_b32 v65, a33
    v_accvgpr_read_b32 v66, a34
    v_accvgpr_read_b32 v67, a35
    v_accvgpr_read_b32 v68, a36
    v_accvgpr_read_b32 v69, a37
    v_accvgpr_read_b32 v70, a38
    v_accvgpr_read_b32 v71, a39
    v_pk_mul_f32 v[64:65], v[64:65], v[2:3] op_sel:[0,1] op_sel_hi:[1,1]
    v_pk_mul_f32 v[66:67], v[66:67], v[2:3] op_sel:[0,1] op_sel_hi:[1,1]
    v_pk_mul_f32 v[68:69], v[68:69], v[2:3] op_sel:[0,1] op_sel_hi:[1,1]
    v_pk_mul_f32 v[70:71], v[70:71], v[2:3] op_sel:[0,1] op_sel_hi:[1,1]
    v_cvt_pk_bf16_f32 v96, v64, v65
    v_cvt_pk_bf16_f32 v97, v66, v67
    v_cvt_pk_bf16_f32 v98, v68, v69
    v_cvt_pk_bf16_f32 v99, v70, v71
    v_accvgpr_write_b32 a228, v96
    v_accvgpr_write_b32 a229, v97
    v_accvgpr_write_b32 a230, v98
    v_accvgpr_write_b32 a231, v99
    buffer_load_dwordx4 v[240:243], v10, s[20:23], s50 offen offset:2048 sc1
    buffer_load_dwordx4 v[244:247], v11, s[20:23], s50 offen offset:0 sc1
    v_accvgpr_read_b32 v72, a40
    v_accvgpr_read_b32 v73, a41
    v_accvgpr_read_b32 v74, a42
    v_accvgpr_read_b32 v75, a43
    v_accvgpr_read_b32 v76, a44
    v_accvgpr_read_b32 v77, a45
    v_accvgpr_read_b32 v78, a46
    v_accvgpr_read_b32 v79, a47
    v_pk_mul_f32 v[72:73], v[72:73], v[2:3] op_sel:[0,1] op_sel_hi:[1,1]
    v_pk_mul_f32 v[74:75], v[74:75], v[2:3] op_sel:[0,1] op_sel_hi:[1,1]
    v_pk_mul_f32 v[76:77], v[76:77], v[2:3] op_sel:[0,1] op_sel_hi:[1,1]
    v_pk_mul_f32 v[78:79], v[78:79], v[2:3] op_sel:[0,1] op_sel_hi:[1,1]
    v_cvt_pk_bf16_f32 v96, v72, v73
    v_cvt_pk_bf16_f32 v97, v74, v75
    v_cvt_pk_bf16_f32 v98, v76, v77
    v_cvt_pk_bf16_f32 v99, v78, v79
    v_accvgpr_write_b32 a232, v96
    v_accvgpr_write_b32 a233, v97
    v_accvgpr_write_b32 a234, v98
    v_accvgpr_write_b32 a235, v99
    buffer_load_dwordx4 v[248:251], v11, s[20:23], s50 offen offset:1024 sc1
    buffer_load_dwordx4 v[252:255], v11, s[20:23], s50 offen offset:2048 sc1
    s_mov_b32 s76, 501760
    s_mov_b32 s77, 0x10000000
    s_mov_b32 s78, 301056
    s_mov_b32 s79, s77
    s_mov_b32 s95, 0xfffdd000
    s_mov_b32 s44, 3
    s_mov_b32 s99, 61440
    s_waitcnt vmcnt(12)
    s_waitcnt lgkmcnt(2)
    v_mfma_f32_16x16x32_bf16 v[64:67], a[192:195], v[184:187], 0
    ds_read_b128 a[204:207], v62 offset:3072
    v_accvgpr_read_b32 v52, a48
    v_mfma_f32_16x16x32_bf16 v[68:71], a[192:195], v[188:191], 0
    v_accvgpr_read_b32 v53, a49
    v_accvgpr_read_b32 v54, a50
    v_mfma_f32_16x16x32_bf16 v[72:75], a[192:195], v[192:195], 0
    v_accvgpr_read_b32 v55, a51
    v_accvgpr_read_b32 v56, a52
    v_mfma_f32_16x16x32_bf16 v[76:79], a[192:195], v[196:199], 0
    v_accvgpr_read_b32 v57, a53
    v_accvgpr_read_b32 v58, a54
    v_mfma_f32_16x16x32_bf16 v[80:83], a[192:195], v[200:203], 0
    v_accvgpr_read_b32 v59, a55
    v_mul_f32 v52, v3, v52
    v_mfma_f32_16x16x32_bf16 v[84:87], a[192:195], v[204:207], 0
    s_waitcnt lgkmcnt(2)
    v_mul_f32 v53, v3, v53
    v_mul_f32 v54, v3, v54
    v_mfma_f32_16x16x32_bf16 v[88:91], a[196:199], v[184:187], 0
    ds_read_b128 a[208:211], v62 offset:4096
    v_mul_f32 v55, v3, v55
    v_mfma_f32_16x16x32_bf16 v[92:95], a[196:199], v[188:191], 0
    v_mul_f32 v56, v3, v56
    v_mul_f32 v57, v3, v57
    v_mfma_f32_16x16x32_bf16 v[96:99], a[196:199], v[192:195], 0
    v_mul_f32 v58, v3, v58
    v_mul_f32 v59, v3, v59
    v_mfma_f32_16x16x32_bf16 v[100:103], a[196:199], v[196:199], 0
    v_cvt_pk_bf16_f32 v12, v52, v53
    v_cvt_pk_bf16_f32 v13, v54, v55
    v_mfma_f32_16x16x32_bf16 v[104:107], a[196:199], v[200:203], 0
    v_cvt_pk_bf16_f32 v14, v56, v57
    v_cvt_pk_bf16_f32 v15, v58, v59
    v_mfma_f32_16x16x32_bf16 v[108:111], a[196:199], v[204:207], 0
    s_waitcnt lgkmcnt(2)
    v_accvgpr_read_b32 v52, a56
    v_accvgpr_read_b32 v53, a57
    v_mfma_f32_16x16x32_bf16 v[112:115], a[200:203], v[184:187], 0
    ds_read_b128 a[192:195], v62 offset:20480
    v_accvgpr_read_b32 v54, a58
    v_mfma_f32_16x16x32_bf16 v[116:119], a[200:203], v[188:191], 0
    v_accvgpr_read_b32 v55, a59
    v_accvgpr_read_b32 v56, a60
    v_mfma_f32_16x16x32_bf16 v[120:123], a[200:203], v[192:195], 0
    v_accvgpr_read_b32 v57, a61
    v_accvgpr_read_b32 v58, a62
    v_mfma_f32_16x16x32_bf16 v[124:127], a[200:203], v[196:199], 0
    v_accvgpr_read_b32 v59, a63
    v_mul_f32 v52, v3, v52
    v_mfma_f32_16x16x32_bf16 v[128:131], a[200:203], v[200:203], 0
    v_mul_f32 v53, v3, v53
    v_mul_f32 v54, v3, v54
    v_mfma_f32_16x16x32_bf16 v[132:135], a[200:203], v[204:207], 0
    s_waitcnt lgkmcnt(2)
    v_mul_f32 v55, v3, v55
    v_mul_f32 v56, v3, v56
    v_mfma_f32_16x16x32_bf16 v[136:139], a[204:207], v[184:187], 0
    ds_read_b128 a[196:199], v62 offset:21504
    v_mul_f32 v57, v3, v57
    v_mfma_f32_16x16x32_bf16 v[140:143], a[204:207], v[188:191], 0
    v_mul_f32 v58, v3, v58
    v_mul_f32 v59, v3, v59
    v_mfma_f32_16x16x32_bf16 v[144:147], a[204:207], v[192:195], 0
    v_cvt_pk_bf16_f32 v16, v52, v53
    v_cvt_pk_bf16_f32 v17, v54, v55
    v_mfma_f32_16x16x32_bf16 v[148:151], a[204:207], v[196:199], 0
    v_cvt_pk_bf16_f32 v18, v56, v57
    v_cvt_pk_bf16_f32 v19, v58, v59
    v_mfma_f32_16x16x32_bf16 v[152:155], a[204:207], v[200:203], 0
    v_accvgpr_read_b32 v52, a64
    v_accvgpr_read_b32 v53, a65
    v_mfma_f32_16x16x32_bf16 v[156:159], a[204:207], v[204:207], 0
    s_waitcnt lgkmcnt(2)
    v_accvgpr_read_b32 v54, a66
    v_accvgpr_read_b32 v55, a67
    v_mfma_f32_16x16x32_bf16 v[160:163], a[208:211], v[184:187], 0
    ds_read_b128 a[200:203], v62 offset:22528
    v_accvgpr_read_b32 v56, a68
    v_mfma_f32_16x16x32_bf16 v[164:167], a[208:211], v[188:191], 0
    v_accvgpr_read_b32 v57, a69
    v_accvgpr_read_b32 v58, a70
    v_mfma_f32_16x16x32_bf16 v[168:171], a[208:211], v[192:195], 0
    v_accvgpr_read_b32 v59, a71
    v_mul_f32 v52, v4, v52
    v_mfma_f32_16x16x32_bf16 v[172:175], a[208:211], v[196:199], 0
    v_mul_f32 v53, v4, v53
    v_mul_f32 v54, v4, v54
    v_mfma_f32_16x16x32_bf16 v[176:179], a[208:211], v[200:203], 0
    s_waitcnt vmcnt(6)
    v_mul_f32 v55, v4, v55
    v_mul_f32 v56, v4, v56
    v_mfma_f32_16x16x32_bf16 v[180:183], a[208:211], v[204:207], 0
    s_waitcnt lgkmcnt(2)
    v_mul_f32 v57, v4, v57
    v_mul_f32 v58, v4, v58
    v_mfma_f32_16x16x32_bf16 v[64:67], a[192:195], v[208:211], v[64:67]
    ds_read_b128 a[204:207], v62 offset:23552
    v_mul_f32 v59, v4, v59
    v_mfma_f32_16x16x32_bf16 v[68:71], a[192:195], v[212:215], v[68:71]
    v_cvt_pk_bf16_f32 v20, v52, v53
    v_cvt_pk_bf16_f32 v21, v54, v55
    v_mfma_f32_16x16x32_bf16 v[72:75], a[192:195], v[216:219], v[72:75]
    v_cvt_pk_bf16_f32 v22, v56, v57
    v_cvt_pk_bf16_f32 v23, v58, v59
    v_mfma_f32_16x16x32_bf16 v[76:79], a[192:195], v[220:223], v[76:79]
    v_accvgpr_read_b32 v52, a72
    v_accvgpr_read_b32 v53, a73
    v_mfma_f32_16x16x32_bf16 v[80:83], a[192:195], v[224:227], v[80:83]
    v_accvgpr_read_b32 v54, a74
    v_accvgpr_read_b32 v55, a75
    v_mfma_f32_16x16x32_bf16 v[84:87], a[192:195], v[228:231], v[84:87]
    s_waitcnt lgkmcnt(2)
    v_accvgpr_read_b32 v56, a76
    v_accvgpr_read_b32 v57, a77
    v_mfma_f32_16x16x32_bf16 v[88:91], a[196:199], v[208:211], v[88:91]
    ds_read_b128 a[208:211], v62 offset:24576
    v_accvgpr_read_b32 v58, a78
    v_mfma_f32_16x16x32_bf16 v[92:95], a[196:199], v[212:215], v[92:95]
    v_accvgpr_read_b32 v59, a79
    v_mul_f32 v52, v4, v52
    v_mfma_f32_16x16x32_bf16 v[96:99], a[196:199], v[216:219], v[96:99]
    v_mul_f32 v53, v4, v53
    v_mul_f32 v54, v4, v54
    v_mfma_f32_16x16x32_bf16 v[100:103], a[196:199], v[220:223], v[100:103]
    v_mul_f32 v55, v4, v55
    v_mul_f32 v56, v4, v56
    v_mfma_f32_16x16x32_bf16 v[104:107], a[196:199], v[224:227], v[104:107]
    v_mul_f32 v57, v4, v57
    v_mul_f32 v58, v4, v58
    v_mfma_f32_16x16x32_bf16 v[108:111], a[196:199], v[228:231], v[108:111]
    s_waitcnt lgkmcnt(2)
    v_mul_f32 v59, v4, v59
    v_cvt_pk_bf16_f32 v24, v52, v53
    v_mfma_f32_16x16x32_bf16 v[112:115], a[200:203], v[208:211], v[112:115]
    ds_read_b128 a[192:195], v62 offset:40960
    v_cvt_pk_bf16_f32 v25, v54, v55
    v_mfma_f32_16x16x32_bf16 v[116:119], a[200:203], v[212:215], v[116:119]
    v_cvt_pk_bf16_f32 v26, v56, v57
    v_cvt_pk_bf16_f32 v27, v58, v59
    v_mfma_f32_16x16x32_bf16 v[120:123], a[200:203], v[216:219], v[120:123]
    v_accvgpr_read_b32 v52, a80
    v_accvgpr_read_b32 v53, a81
    v_mfma_f32_16x16x32_bf16 v[124:127], a[200:203], v[220:223], v[124:127]
    v_accvgpr_read_b32 v54, a82
    v_accvgpr_read_b32 v55, a83
    v_mfma_f32_16x16x32_bf16 v[128:131], a[200:203], v[224:227], v[128:131]
    v_accvgpr_read_b32 v56, a84
    v_accvgpr_read_b32 v57, a85
    v_mfma_f32_16x16x32_bf16 v[132:135], a[200:203], v[228:231], v[132:135]
    s_waitcnt lgkmcnt(2)
    v_accvgpr_read_b32 v58, a86
    v_accvgpr_read_b32 v59, a87
    v_mfma_f32_16x16x32_bf16 v[136:139], a[204:207], v[208:211], v[136:139]
    ds_read_b128 a[196:199], v62 offset:41984
    v_mul_f32 v52, v4, v52
    v_mfma_f32_16x16x32_bf16 v[140:143], a[204:207], v[212:215], v[140:143]
    v_mul_f32 v53, v4, v53
    v_mul_f32 v54, v4, v54
    v_mfma_f32_16x16x32_bf16 v[144:147], a[204:207], v[216:219], v[144:147]
    v_mul_f32 v55, v4, v55
    v_mul_f32 v56, v4, v56
    v_mfma_f32_16x16x32_bf16 v[148:151], a[204:207], v[220:223], v[148:151]
    v_mul_f32 v57, v4, v57
    v_mul_f32 v58, v4, v58
    v_mfma_f32_16x16x32_bf16 v[152:155], a[204:207], v[224:227], v[152:155]
    v_mul_f32 v59, v4, v59
    v_cvt_pk_bf16_f32 v28, v52, v53
    v_mfma_f32_16x16x32_bf16 v[156:159], a[204:207], v[228:231], v[156:159]
    s_waitcnt lgkmcnt(2)
    v_cvt_pk_bf16_f32 v29, v54, v55
    v_cvt_pk_bf16_f32 v30, v56, v57
    v_mfma_f32_16x16x32_bf16 v[160:163], a[208:211], v[208:211], v[160:163]
    ds_read_b128 a[200:203], v62 offset:43008
    v_cvt_pk_bf16_f32 v31, v58, v59
    v_mfma_f32_16x16x32_bf16 v[164:167], a[208:211], v[212:215], v[164:167]
    v_accvgpr_read_b32 v52, a88
    v_accvgpr_read_b32 v53, a89
    v_mfma_f32_16x16x32_bf16 v[168:171], a[208:211], v[216:219], v[168:171]
    v_accvgpr_read_b32 v54, a90
    v_accvgpr_read_b32 v55, a91
    v_mfma_f32_16x16x32_bf16 v[172:175], a[208:211], v[220:223], v[172:175]
    v_accvgpr_read_b32 v56, a92
    v_accvgpr_read_b32 v57, a93
    v_mfma_f32_16x16x32_bf16 v[176:179], a[208:211], v[224:227], v[176:179]
    s_waitcnt vmcnt(0)
    v_accvgpr_read_b32 v58, a94
    v_accvgpr_read_b32 v59, a95
    v_mfma_f32_16x16x32_bf16 v[180:183], a[208:211], v[228:231], v[180:183]
    s_waitcnt lgkmcnt(2)
    v_mul_f32 v52, v4, v52
    v_mul_f32 v53, v4, v53
    v_mfma_f32_16x16x32_bf16 v[64:67], a[192:195], v[232:235], v[64:67]
    ds_read_b128 a[204:207], v62 offset:44032
    v_mul_f32 v54, v4, v54
    v_mfma_f32_16x16x32_bf16 v[68:71], a[192:195], v[236:239], v[68:71]
    s_add_u32 s49, s49, 10240
    v_mul_f32 v55, v4, v55
    v_mul_f32 v56, v4, v56
    v_mfma_f32_16x16x32_bf16 v[72:75], a[192:195], v[240:243], v[72:75]
    s_add_u32 s54, s49, 4096
    v_mul_f32 v57, v4, v57
    v_mul_f32 v58, v4, v58
    v_mfma_f32_16x16x32_bf16 v[76:79], a[192:195], v[244:247], v[76:79]
    s_add_u32 s97, s97, 20480
    v_mul_f32 v59, v4, v59
    v_cvt_pk_bf16_f32 v32, v52, v53
    v_mfma_f32_16x16x32_bf16 v[80:83], a[192:195], v[248:251], v[80:83]
    s_add_u32 m0, s97, s96
    v_cvt_pk_bf16_f32 v33, v54, v55
    v_cvt_pk_bf16_f32 v34, v56, v57
    v_mfma_f32_16x16x32_bf16 v[84:87], a[192:195], v[252:255], v[84:87]
    s_waitcnt lgkmcnt(2)
    v_cvt_pk_bf16_f32 v35, v58, v59
    v_accvgpr_read_b32 v52, a96
    v_mfma_f32_16x16x32_bf16 v[88:91], a[196:199], v[232:235], v[88:91]
    ds_read_b128 a[208:211], v62 offset:45056
    v_accvgpr_read_b32 v53, a97
    v_mfma_f32_16x16x32_bf16 v[92:95], a[196:199], v[236:239], v[92:95]
    v_accvgpr_read_b32 v54, a98
    v_accvgpr_read_b32 v55, a99
    v_mfma_f32_16x16x32_bf16 v[96:99], a[196:199], v[240:243], v[96:99]
    buffer_load_dwordx4 v8, s[24:27], s49 offen offset:0 sc1 lds
    v_mfma_f32_16x16x32_bf16 v[100:103], a[196:199], v[244:247], v[100:103]
    v_accvgpr_read_b32 v56, a100
    v_accvgpr_read_b32 v57, a101
    v_mfma_f32_16x16x32_bf16 v[104:107], a[196:199], v[248:251], v[104:107]
    v_accvgpr_read_b32 v58, a102
    v_accvgpr_read_b32 v59, a103
    v_mfma_f32_16x16x32_bf16 v[108:111], a[196:199], v[252:255], v[108:111]
    s_waitcnt lgkmcnt(2)
    v_mul_f32 v52, v5, v52
    v_mul_f32 v53, v5, v53
    v_mfma_f32_16x16x32_bf16 v[112:115], a[200:203], v[232:235], v[112:115]
    ds_read_b128 a[192:195], v63 offset:0
    v_mul_f32 v54, v5, v54
    v_mfma_f32_16x16x32_bf16 v[116:119], a[200:203], v[236:239], v[116:119]
    v_mul_f32 v55, v5, v55
    v_mul_f32 v56, v5, v56
    v_mfma_f32_16x16x32_bf16 v[120:123], a[200:203], v[240:243], v[120:123]
    v_mul_f32 v57, v5, v57
    v_mul_f32 v58, v5, v58
    v_mfma_f32_16x16x32_bf16 v[124:127], a[200:203], v[244:247], v[124:127]
    v_mul_f32 v59, v5, v59
    v_cvt_pk_bf16_f32 v40, v52, v53
    v_mfma_f32_16x16x32_bf16 v[128:131], a[200:203], v[248:251], v[128:131]
    v_cvt_pk_bf16_f32 v41, v54, v55
    v_cvt_pk_bf16_f32 v42, v56, v57
    v_mfma_f32_16x16x32_bf16 v[132:135], a[200:203], v[252:255], v[132:135]
    s_waitcnt lgkmcnt(2)
    v_cvt_pk_bf16_f32 v43, v58, v59
    v_accvgpr_read_b32 v52, a104
    v_mfma_f32_16x16x32_bf16 v[136:139], a[204:207], v[232:235], v[136:139]
    ds_read_b128 a[196:199], v63 offset:1024
    v_accvgpr_read_b32 v53, a105
    v_mfma_f32_16x16x32_bf16 v[140:143], a[204:207], v[236:239], v[140:143]
    v_accvgpr_read_b32 v54, a106
    v_accvgpr_read_b32 v55, a107
    v_mfma_f32_16x16x32_bf16 v[144:147], a[204:207], v[240:243], v[144:147]
    buffer_load_dwordx4 v8, s[24:27], s49 offen offset:1024 sc1 lds
    v_mfma_f32_16x16x32_bf16 v[148:151], a[204:207], v[244:247], v[148:151]
    v_accvgpr_read_b32 v56, a108
    v_accvgpr_read_b32 v57, a109
    v_mfma_f32_16x16x32_bf16 v[152:155], a[204:207], v[248:251], v[152:155]
    v_accvgpr_read_b32 v58, a110
    v_accvgpr_read_b32 v59, a111
    v_mfma_f32_16x16x32_bf16 v[156:159], a[204:207], v[252:255], v[156:159]
    s_waitcnt lgkmcnt(2)
    v_mul_f32 v52, v5, v52
    v_mul_f32 v53, v5, v53
    v_mfma_f32_16x16x32_bf16 v[160:163], a[208:211], v[232:235], v[160:163]
    ds_read_b128 a[200:203], v63 offset:2048
    v_mul_f32 v54, v5, v54
    v_mfma_f32_16x16x32_bf16 v[164:167], a[208:211], v[236:239], v[164:167]
    v_mul_f32 v55, v5, v55
    v_mul_f32 v56, v5, v56
    v_mfma_f32_16x16x32_bf16 v[168:171], a[208:211], v[240:243], v[168:171]
    v_mul_f32 v57, v5, v57
    v_mul_f32 v58, v5, v58
    v_mfma_f32_16x16x32_bf16 v[172:175], a[208:211], v[244:247], v[172:175]
    v_mul_f32 v59, v5, v59
    v_cvt_pk_bf16_f32 v44, v52, v53
    v_mfma_f32_16x16x32_bf16 v[176:179], a[208:211], v[248:251], v[176:179]
    v_cvt_pk_bf16_f32 v45, v54, v55
    v_cvt_pk_bf16_f32 v46, v56, v57
    v_mfma_f32_16x16x32_bf16 v[180:183], a[208:211], v[252:255], v[180:183]
    s_waitcnt lgkmcnt(2)
    v_cvt_pk_bf16_f32 v47, v58, v59
    v_accvgpr_read_b32 v52, a112
    v_mfma_f32_16x16x32_bf16 a[0:3], a[192:195], v[184:187], 0
    ds_read_b128 a[204:207], v63 offset:3072
    v_accvgpr_read_b32 v53, a113
    v_mfma_f32_16x16x32_bf16 a[4:7], a[192:195], v[188:191], 0
    v_accvgpr_read_b32 v54, a114
    v_accvgpr_read_b32 v55, a115
    v_mfma_f32_16x16x32_bf16 a[8:11], a[192:195], v[192:195], 0
    buffer_load_dwordx4 v8, s[24:27], s49 offen offset:2048 sc1 lds
    v_mfma_f32_16x16x32_bf16 a[12:15], a[192:195], v[196:199], 0
    v_accvgpr_read_b32 v56, a116
    v_accvgpr_read_b32 v57, a117
    v_mfma_f32_16x16x32_bf16 a[16:19], a[192:195], v[200:203], 0
    v_accvgpr_read_b32 v58, a118
    v_accvgpr_read_b32 v59, a119
    v_mfma_f32_16x16x32_bf16 a[20:23], a[192:195], v[204:207], 0
    s_waitcnt lgkmcnt(2)
    v_mul_f32 v52, v5, v52
    v_mul_f32 v53, v5, v53
    v_mfma_f32_16x16x32_bf16 a[24:27], a[196:199], v[184:187], 0
    ds_read_b128 a[208:211], v63 offset:4096
    v_mul_f32 v54, v5, v54
    v_mfma_f32_16x16x32_bf16 a[28:31], a[196:199], v[188:191], 0
    v_mul_f32 v55, v5, v55
    v_mul_f32 v56, v5, v56
    v_mfma_f32_16x16x32_bf16 a[32:35], a[196:199], v[192:195], 0
    v_mul_f32 v57, v5, v57
    v_mul_f32 v58, v5, v58
    v_mfma_f32_16x16x32_bf16 a[36:39], a[196:199], v[196:199], 0
    v_mul_f32 v59, v5, v59
    v_cvt_pk_bf16_f32 v48, v52, v53
    v_mfma_f32_16x16x32_bf16 a[40:43], a[196:199], v[200:203], 0
    v_cvt_pk_bf16_f32 v49, v54, v55
    v_cvt_pk_bf16_f32 v50, v56, v57
    v_mfma_f32_16x16x32_bf16 a[44:47], a[196:199], v[204:207], 0
    s_waitcnt lgkmcnt(2)
    v_cvt_pk_bf16_f32 v51, v58, v59
    v_accvgpr_read_b32 v52, a120
    v_mfma_f32_16x16x32_bf16 a[48:51], a[200:203], v[184:187], 0
    ds_read_b128 a[192:195], v63 offset:20480
    v_accvgpr_read_b32 v53, a121
    v_mfma_f32_16x16x32_bf16 a[52:55], a[200:203], v[188:191], 0
    v_accvgpr_read_b32 v54, a122
    v_accvgpr_read_b32 v55, a123
    v_mfma_f32_16x16x32_bf16 a[56:59], a[200:203], v[192:195], 0
    buffer_load_dwordx4 v8, s[24:27], s49 offen offset:3072 sc1 lds
    v_mfma_f32_16x16x32_bf16 a[60:63], a[200:203], v[196:199], 0
    v_accvgpr_read_b32 v56, a124
    v_accvgpr_read_b32 v57, a125
    v_mfma_f32_16x16x32_bf16 a[64:67], a[200:203], v[200:203], 0
    v_accvgpr_read_b32 v58, a126
    v_accvgpr_read_b32 v59, a127
    v_mfma_f32_16x16x32_bf16 a[68:71], a[200:203], v[204:207], 0
    s_waitcnt lgkmcnt(2)
    v_mul_f32 v52, v5, v52
    v_mul_f32 v53, v5, v53
    v_mfma_f32_16x16x32_bf16 a[72:75], a[204:207], v[184:187], 0
    ds_read_b128 a[196:199], v63 offset:21504
    v_mul_f32 v54, v5, v54
    v_mfma_f32_16x16x32_bf16 a[76:79], a[204:207], v[188:191], 0
    v_mul_f32 v55, v5, v55
    v_mul_f32 v56, v5, v56
    v_mfma_f32_16x16x32_bf16 a[80:83], a[204:207], v[192:195], 0
    v_mul_f32 v57, v5, v57
    v_mul_f32 v58, v5, v58
    v_mfma_f32_16x16x32_bf16 a[84:87], a[204:207], v[196:199], 0
    v_mul_f32 v59, v5, v59
    v_cvt_pk_bf16_f32 v52, v52, v53
    v_mfma_f32_16x16x32_bf16 a[88:91], a[204:207], v[200:203], 0
    v_cvt_pk_bf16_f32 v53, v54, v55
    v_cvt_pk_bf16_f32 v54, v56, v57
    v_mfma_f32_16x16x32_bf16 a[92:95], a[204:207], v[204:207], 0
    s_waitcnt lgkmcnt(2)
    v_cvt_pk_bf16_f32 v55, v58, v59
    v_accvgpr_write_b32 a236, v52
    v_mfma_f32_16x16x32_bf16 a[96:99], a[208:211], v[184:187], 0
    ds_read_b128 a[200:203], v63 offset:22528
    v_accvgpr_write_b32 a237, v53
    v_mfma_f32_16x16x32_bf16 a[100:103], a[208:211], v[188:191], 0
    s_add_u32 m0, m0, 4096
    v_accvgpr_write_b32 a238, v54
    v_accvgpr_write_b32 a239, v55
    v_mfma_f32_16x16x32_bf16 a[104:107], a[208:211], v[192:195], 0
    buffer_load_dwordx4 v8, s[24:27], s54 offen offset:0 sc1 lds
    v_mfma_f32_16x16x32_bf16 a[108:111], a[208:211], v[196:199], 0
    v_accvgpr_read_b32 v52, a128
    v_accvgpr_read_b32 v53, a129
    v_mfma_f32_16x16x32_bf16 a[112:115], a[208:211], v[200:203], 0
    v_accvgpr_read_b32 v54, a130
    v_accvgpr_read_b32 v55, a131
    v_mfma_f32_16x16x32_bf16 a[116:119], a[208:211], v[204:207], 0
    s_waitcnt lgkmcnt(2)
    v_accvgpr_read_b32 v56, a132
    v_accvgpr_read_b32 v57, a133
    v_mfma_f32_16x16x32_bf16 a[0:3], a[192:195], v[208:211], a[0:3]
    ds_read_b128 a[204:207], v63 offset:23552
    v_accvgpr_read_b32 v58, a134
    v_mfma_f32_16x16x32_bf16 a[4:7], a[192:195], v[212:215], a[4:7]
    s_add_u32 s50, s50, 6144
    v_accvgpr_read_b32 v59, a135
    v_mul_f32 v52, v6, v52
    v_mfma_f32_16x16x32_bf16 a[8:11], a[192:195], v[216:219], a[8:11]
    buffer_load_dwordx4 v[184:187], v10, s[20:23], s50 offen offset:0 sc1
    v_mfma_f32_16x16x32_bf16 a[12:15], a[192:195], v[220:223], a[12:15]
    v_mul_f32 v53, v6, v53
    v_mul_f32 v54, v6, v54
    v_mfma_f32_16x16x32_bf16 a[16:19], a[192:195], v[224:227], a[16:19]
    buffer_load_dwordx4 v[188:191], v10, s[20:23], s50 offen offset:1024 sc1
    v_mfma_f32_16x16x32_bf16 a[20:23], a[192:195], v[228:231], a[20:23]
    s_waitcnt lgkmcnt(2)
    v_mul_f32 v55, v6, v55
    v_mul_f32 v56, v6, v56
    v_mfma_f32_16x16x32_bf16 a[24:27], a[196:199], v[208:211], a[24:27]
    ds_read_b128 a[208:211], v63 offset:24576
    v_mul_f32 v57, v6, v57
    v_mfma_f32_16x16x32_bf16 a[28:31], a[196:199], v[212:215], a[28:31]
    buffer_load_dwordx4 v[192:195], v10, s[20:23], s50 offen offset:2048 sc1
    v_mfma_f32_16x16x32_bf16 a[32:35], a[196:199], v[216:219], a[32:35]
    v_mul_f32 v58, v6, v58
    v_mul_f32 v59, v6, v59
    v_mfma_f32_16x16x32_bf16 a[36:39], a[196:199], v[220:223], a[36:39]
    v_cvt_pk_bf16_f32 v52, v52, v53
    v_cvt_pk_bf16_f32 v53, v54, v55
    v_mfma_f32_16x16x32_bf16 a[40:43], a[196:199], v[224:227], a[40:43]
    buffer_load_dwordx4 v[196:199], v11, s[20:23], s50 offen offset:0 sc1
    v_mfma_f32_16x16x32_bf16 a[44:47], a[196:199], v[228:231], a[44:47]
    s_waitcnt lgkmcnt(2)
    v_cvt_pk_bf16_f32 v54, v56, v57
    v_cvt_pk_bf16_f32 v55, v58, v59
    v_mfma_f32_16x16x32_bf16 a[48:51], a[200:203], v[208:211], a[48:51]
    ds_read_b128 a[192:195], v63 offset:40960
    v_accvgpr_write_b32 a240, v52
    v_mfma_f32_16x16x32_bf16 a[52:55], a[200:203], v[212:215], a[52:55]
    buffer_load_dwordx4 v[200:203], v11, s[20:23], s50 offen offset:1024 sc1
    v_mfma_f32_16x16x32_bf16 a[56:59], a[200:203], v[216:219], a[56:59]
    v_accvgpr_write_b32 a241, v53
    v_accvgpr_write_b32 a242, v54
    v_mfma_f32_16x16x32_bf16 a[60:63], a[200:203], v[220:223], a[60:63]
    v_accvgpr_write_b32 a243, v55
    v_accvgpr_read_b32 v52, a136
    v_mfma_f32_16x16x32_bf16 a[64:67], a[200:203], v[224:227], a[64:67]
    buffer_load_dwordx4 v[204:207], v11, s[20:23], s50 offen offset:2048 sc1
    v_mfma_f32_16x16x32_bf16 a[68:71], a[200:203], v[228:231], a[68:71]
    s_waitcnt lgkmcnt(2)
    v_accvgpr_read_b32 v53, a137
    v_accvgpr_read_b32 v54, a138
    v_mfma_f32_16x16x32_bf16 a[72:75], a[204:207], v[208:211], a[72:75]
    ds_read_b128 a[196:199], v63 offset:41984
    v_accvgpr_read_b32 v55, a139
    v_mfma_f32_16x16x32_bf16 a[76:79], a[204:207], v[212:215], a[76:79]
    v_accvgpr_read_b32 v56, a140
    v_accvgpr_read_b32 v57, a141
    v_mfma_f32_16x16x32_bf16 a[80:83], a[204:207], v[216:219], a[80:83]
    v_accvgpr_read_b32 v58, a142
    v_accvgpr_read_b32 v59, a143
    v_mfma_f32_16x16x32_bf16 a[84:87], a[204:207], v[220:223], a[84:87]
    v_mul_f32 v52, v6, v52
    v_mul_f32 v53, v6, v53
    v_mfma_f32_16x16x32_bf16 a[88:91], a[204:207], v[224:227], a[88:91]
    v_mul_f32 v54, v6, v54
    v_mul_f32 v55, v6, v55
    v_mfma_f32_16x16x32_bf16 a[92:95], a[204:207], v[228:231], a[92:95]
    s_waitcnt lgkmcnt(2)
    v_mul_f32 v56, v6, v56
    v_mul_f32 v57, v6, v57
    v_mfma_f32_16x16x32_bf16 a[96:99], a[208:211], v[208:211], a[96:99]
    ds_read_b128 a[200:203], v63 offset:43008
    v_mul_f32 v58, v6, v58
    v_mfma_f32_16x16x32_bf16 a[100:103], a[208:211], v[212:215], a[100:103]
    v_mul_f32 v59, v6, v59
    v_cvt_pk_bf16_f32 v52, v52, v53
    v_mfma_f32_16x16x32_bf16 a[104:107], a[208:211], v[216:219], a[104:107]
    v_cvt_pk_bf16_f32 v53, v54, v55
    v_cvt_pk_bf16_f32 v54, v56, v57
    v_mfma_f32_16x16x32_bf16 a[108:111], a[208:211], v[220:223], a[108:111]
    v_cvt_pk_bf16_f32 v55, v58, v59
    v_accvgpr_write_b32 a244, v52
    v_mfma_f32_16x16x32_bf16 a[112:115], a[208:211], v[224:227], a[112:115]
    v_accvgpr_write_b32 a245, v53
    v_accvgpr_write_b32 a246, v54
    v_mfma_f32_16x16x32_bf16 a[116:119], a[208:211], v[228:231], a[116:119]
    s_waitcnt lgkmcnt(2)
    v_accvgpr_write_b32 a247, v55
    v_accvgpr_read_b32 v52, a144
    v_mfma_f32_16x16x32_bf16 a[0:3], a[192:195], v[232:235], a[0:3]
    ds_read_b128 a[204:207], v63 offset:44032
    v_accvgpr_read_b32 v53, a145
    v_mfma_f32_16x16x32_bf16 a[4:7], a[192:195], v[236:239], a[4:7]
    s_add_u32 s50, s50, 6144
    v_accvgpr_read_b32 v54, a146
    v_accvgpr_read_b32 v55, a147
    v_mfma_f32_16x16x32_bf16 a[8:11], a[192:195], v[240:243], a[8:11]
    buffer_load_dwordx4 v[208:211], v10, s[20:23], s50 offen offset:0 sc1
    v_mfma_f32_16x16x32_bf16 a[12:15], a[192:195], v[244:247], a[12:15]
    s_add_u32 s56, s48, 0
    buffer_store_dwordx4 a[212:215], v60, s[20:23], s56 offen offset:0 sc1
    v_mfma_f32_16x16x32_bf16 a[16:19], a[192:195], v[248:251], a[16:19]
    buffer_load_dwordx4 v[212:215], v10, s[20:23], s50 offen offset:1024 sc1
    v_mfma_f32_16x16x32_bf16 a[20:23], a[192:195], v[252:255], a[20:23]
    s_waitcnt lgkmcnt(2)
    v_accvgpr_read_b32 v56, a148
    v_accvgpr_read_b32 v57, a149
    v_mfma_f32_16x16x32_bf16 a[24:27], a[196:199], v[232:235], a[24:27]
    ds_read_b128 a[208:211], v63 offset:45056
    v_accvgpr_read_b32 v58, a150
    v_mfma_f32_16x16x32_bf16 a[28:31], a[196:199], v[236:239], a[28:31]
    buffer_load_dwordx4 v[216:219], v10, s[20:23], s50 offen offset:2048 sc1
    v_mfma_f32_16x16x32_bf16 a[32:35], a[196:199], v[240:243], a[32:35]
    v_accvgpr_read_b32 v59, a151
    v_mul_f32 v52, v6, v52
    v_mfma_f32_16x16x32_bf16 a[36:39], a[196:199], v[244:247], a[36:39]
    v_mul_f32 v53, v6, v53
    v_mul_f32 v54, v6, v54
    v_mfma_f32_16x16x32_bf16 a[40:43], a[196:199], v[248:251], a[40:43]
    buffer_load_dwordx4 v[220:223], v11, s[20:23], s50 offen offset:0 sc1
    v_mfma_f32_16x16x32_bf16 a[44:47], a[196:199], v[252:255], a[44:47]
    s_waitcnt lgkmcnt(2)
    v_mul_f32 v55, v6, v55
    v_mul_f32 v56, v6, v56
    v_mfma_f32_16x16x32_bf16 a[48:51], a[200:203], v[232:235], a[48:51]
    ds_read_b128 a[192:195], v62 offset:61440
    v_mul_f32 v57, v6, v57
    v_mfma_f32_16x16x32_bf16 a[52:55], a[200:203], v[236:239], a[52:55]
    buffer_load_dwordx4 v[224:227], v11, s[20:23], s50 offen offset:1024 sc1
    v_mfma_f32_16x16x32_bf16 a[56:59], a[200:203], v[240:243], a[56:59]
    v_mul_f32 v58, v6, v58
    v_mul_f32 v59, v6, v59
    v_mfma_f32_16x16x32_bf16 a[60:63], a[200:203], v[244:247], a[60:63]
    v_cvt_pk_bf16_f32 v52, v52, v53
    v_cvt_pk_bf16_f32 v53, v54, v55
    v_mfma_f32_16x16x32_bf16 a[64:67], a[200:203], v[248:251], a[64:67]
    buffer_load_dwordx4 v[228:231], v11, s[20:23], s50 offen offset:2048 sc1
    v_mfma_f32_16x16x32_bf16 a[68:71], a[200:203], v[252:255], a[68:71]
    s_waitcnt lgkmcnt(2)
    v_cvt_pk_bf16_f32 v54, v56, v57
    v_cvt_pk_bf16_f32 v55, v58, v59
    v_mfma_f32_16x16x32_bf16 a[72:75], a[204:207], v[232:235], a[72:75]
    ds_read_b128 a[196:199], v62 offset:62464
    v_accvgpr_write_b32 a248, v52
    v_mfma_f32_16x16x32_bf16 a[76:79], a[204:207], v[236:239], a[76:79]
    v_accvgpr_write_b32 a249, v53
    v_accvgpr_write_b32 a250, v54
    v_mfma_f32_16x16x32_bf16 a[80:83], a[204:207], v[240:243], a[80:83]
    s_add_u32 s56, s48, 4096
    buffer_store_dwordx4 a[216:219], v60, s[20:23], s56 offen offset:2048 sc1
    v_mfma_f32_16x16x32_bf16 a[84:87], a[204:207], v[244:247], a[84:87]
    v_accvgpr_write_b32 a251, v55
    v_accvgpr_read_b32 v52, a152
    v_mfma_f32_16x16x32_bf16 a[88:91], a[204:207], v[248:251], a[88:91]
    v_accvgpr_read_b32 v53, a153
    v_accvgpr_read_b32 v54, a154
    v_mfma_f32_16x16x32_bf16 a[92:95], a[204:207], v[252:255], a[92:95]
    s_waitcnt lgkmcnt(2)
    v_accvgpr_read_b32 v55, a155
    v_accvgpr_read_b32 v56, a156
    v_mfma_f32_16x16x32_bf16 a[96:99], a[208:211], v[232:235], a[96:99]
    ds_read_b128 a[200:203], v62 offset:63488
    v_accvgpr_read_b32 v57, a157
    v_mfma_f32_16x16x32_bf16 a[100:103], a[208:211], v[236:239], a[100:103]
    v_accvgpr_read_b32 v58, a158
    v_accvgpr_read_b32 v59, a159
    v_mfma_f32_16x16x32_bf16 a[104:107], a[208:211], v[240:243], a[104:107]
    v_add_u32 v62, 61440, v62
    v_add_u32 v63, 61440, v63
    v_mfma_f32_16x16x32_bf16 a[108:111], a[208:211], v[244:247], a[108:111]
    v_mul_f32 v52, v6, v52
    v_mul_f32 v53, v6, v53
    v_mfma_f32_16x16x32_bf16 a[112:115], a[208:211], v[248:251], a[112:115]
    s_waitcnt vmcnt(8)
    v_mul_f32 v54, v6, v54
    v_mul_f32 v55, v6, v55
    v_mfma_f32_16x16x32_bf16 a[116:119], a[208:211], v[252:255], a[116:119]
    s_waitcnt lgkmcnt(2)
    v_mul_f32 v56, v6, v56
    v_mul_f32 v57, v6, v57
    v_mfma_f32_16x16x32_bf16 v[64:67], a[192:195], v[184:187], v[64:67]
    ds_read_b128 a[204:207], v62 offset:3072
    v_mul_f32 v58, v6, v58
    v_mfma_f32_16x16x32_bf16 v[68:71], a[192:195], v[188:191], v[68:71]
    v_mul_f32 v59, v6, v59
    v_cvt_pk_bf16_f32 v52, v52, v53
    v_mfma_f32_16x16x32_bf16 v[72:75], a[192:195], v[192:195], v[72:75]
    s_barrier
    v_mfma_f32_16x16x32_bf16 v[76:79], a[192:195], v[196:199], v[76:79]
    s_cmp_eq_u32 s44, 11
    s_cselect_b32 s55, s76, 10240
    v_cvt_pk_bf16_f32 v53, v54, v55
    v_mfma_f32_16x16x32_bf16 v[80:83], a[192:195], v[200:203], v[80:83]
    v_cvt_pk_bf16_f32 v54, v56, v57
    v_cvt_pk_bf16_f32 v55, v58, v59
    v_mfma_f32_16x16x32_bf16 v[84:87], a[192:195], v[204:207], v[84:87]
    s_waitcnt lgkmcnt(2)
    v_accvgpr_write_b32 a252, v52
    v_accvgpr_write_b32 a253, v53
    v_mfma_f32_16x16x32_bf16 v[88:91], a[196:199], v[184:187], v[88:91]
    ds_read_b128 a[208:211], v62 offset:4096
    v_accvgpr_write_b32 a254, v54
    v_mfma_f32_16x16x32_bf16 v[92:95], a[196:199], v[188:191], v[92:95]
    s_add_u32 s49, s49, s55
    s_add_u32 s56, s48, 12288
    buffer_store_dwordx4 a[220:223], v60, s[20:23], s56 offen offset:0 sc1
    v_mfma_f32_16x16x32_bf16 v[96:99], a[196:199], v[192:195], v[96:99]
    s_add_u32 s54, s49, 4096
    v_accvgpr_write_b32 a255, v55
    v_accvgpr_read_b32 v52, a160
    v_mfma_f32_16x16x32_bf16 v[100:103], a[196:199], v[196:199], v[100:103]
    s_add_u32 s97, s97, 20480
    v_accvgpr_read_b32 v53, a161
    v_accvgpr_read_b32 v54, a162
    v_mfma_f32_16x16x32_bf16 v[104:107], a[196:199], v[200:203], v[104:107]
    s_cmp_eq_u32 s97, 163840
    s_cselect_b32 s97, 0, s97
    v_accvgpr_read_b32 v55, a163
    v_mfma_f32_16x16x32_bf16 v[108:111], a[196:199], v[204:207], v[108:111]
    s_waitcnt lgkmcnt(2)
    v_accvgpr_read_b32 v56, a164
    v_accvgpr_read_b32 v57, a165
    v_mfma_f32_16x16x32_bf16 v[112:115], a[200:203], v[184:187], v[112:115]
    ds_read_b128 a[192:195], v63 offset:0
    v_accvgpr_read_b32 v58, a166
    v_mfma_f32_16x16x32_bf16 v[116:119], a[200:203], v[188:191], v[116:119]
    s_add_u32 m0, s97, s96
    v_accvgpr_read_b32 v59, a167
    v_mul_f32 v52, v7, v52
    v_mfma_f32_16x16x32_bf16 v[120:123], a[200:203], v[192:195], v[120:123]
    buffer_load_dwordx4 v8, s[24:27], s49 offen offset:0 sc1 lds
    v_mfma_f32_16x16x32_bf16 v[124:127], a[200:203], v[196:199], v[124:127]
    s_cmp_eq_u32 s44, 14
    s_cselect_b32 s55, s78, 6144
    v_mul_f32 v53, v7, v53
    v_mfma_f32_16x16x32_bf16 v[128:131], a[200:203], v[200:203], v[128:131]
    s_add_u32 s50, s50, s55
    v_mul_f32 v54, v7, v54
    v_mul_f32 v55, v7, v55
    v_mfma_f32_16x16x32_bf16 v[132:135], a[200:203], v[204:207], v[132:135]
    s_waitcnt lgkmcnt(2)
    v_mul_f32 v56, v7, v56
    v_mul_f32 v57, v7, v57
    v_mfma_f32_16x16x32_bf16 v[136:139], a[204:207], v[184:187], v[136:139]
    ds_read_b128 a[196:199], v63 offset:1024
    v_mul_f32 v58, v7, v58
    v_mfma_f32_16x16x32_bf16 v[140:143], a[204:207], v[188:191], v[140:143]
    buffer_load_dwordx4 v[232:235], v10, s[20:23], s50 offen offset:0 sc1
    v_mfma_f32_16x16x32_bf16 v[144:147], a[204:207], v[192:195], v[144:147]
    v_mul_f32 v59, v7, v59
    v_cvt_pk_bf16_f32 v52, v52, v53
    v_mfma_f32_16x16x32_bf16 v[148:151], a[204:207], v[196:199], v[148:151]
    v_cvt_pk_bf16_f32 v53, v54, v55
    v_cvt_pk_bf16_f32 v54, v56, v57
    v_mfma_f32_16x16x32_bf16 v[152:155], a[204:207], v[200:203], v[152:155]
    buffer_load_dwordx4 v[236:239], v10, s[20:23], s50 offen offset:1024 sc1
    v_mfma_f32_16x16x32_bf16 v[156:159], a[204:207], v[204:207], v[156:159]
    s_waitcnt lgkmcnt(2)
    v_cvt_pk_bf16_f32 v55, v58, v59
    v_accvgpr_write_b32 a160, v52
    v_mfma_f32_16x16x32_bf16 v[160:163], a[208:211], v[184:187], v[160:163]
    ds_read_b128 a[200:203], v63 offset:2048
    v_accvgpr_write_b32 a161, v53
    v_mfma_f32_16x16x32_bf16 v[164:167], a[208:211], v[188:191], v[164:167]
    buffer_load_dwordx4 v8, s[24:27], s49 offen offset:1024 sc1 lds
    v_mfma_f32_16x16x32_bf16 v[168:171], a[208:211], v[192:195], v[168:171]
    s_add_u32 s56, s48, 16384
    buffer_store_dwordx4 a[224:227], v60, s[20:23], s56 offen offset:2048 sc1
    v_mfma_f32_16x16x32_bf16 v[172:175], a[208:211], v[196:199], v[172:175]
    v_accvgpr_write_b32 a162, v54
    v_accvgpr_write_b32 a163, v55
    v_mfma_f32_16x16x32_bf16 v[176:179], a[208:211], v[200:203], v[176:179]
    buffer_load_dwordx4 v[240:243], v10, s[20:23], s50 offen offset:2048 sc1
    v_mfma_f32_16x16x32_bf16 v[180:183], a[208:211], v[204:207], v[180:183]
    s_waitcnt lgkmcnt(2)
    v_accvgpr_read_b32 v52, a168
    v_accvgpr_read_b32 v53, a169
    v_mfma_f32_16x16x32_bf16 a[0:3], a[192:195], v[184:187], a[0:3]
    ds_read_b128 a[204:207], v63 offset:3072
    v_accvgpr_read_b32 v54, a170
    v_mfma_f32_16x16x32_bf16 a[4:7], a[192:195], v[188:191], a[4:7]
    v_accvgpr_read_b32 v55, a171
    v_accvgpr_read_b32 v56, a172
    v_mfma_f32_16x16x32_bf16 a[8:11], a[192:195], v[192:195], a[8:11]
    s_add_u32 s99, s99, 20480
    v_accvgpr_read_b32 v57, a173
    v_accvgpr_read_b32 v58, a174
    v_mfma_f32_16x16x32_bf16 a[12:15], a[192:195], v[196:199], a[12:15]
    v_accvgpr_read_b32 v59, a175
    v_mul_f32 v52, v7, v52
    v_mfma_f32_16x16x32_bf16 a[16:19], a[192:195], v[200:203], a[16:19]
    s_cmp_eq_u32 s99, 163840
    s_cselect_b32 s52, s95, 20480
    s_cselect_b32 s99, 0, s99
    v_mfma_f32_16x16x32_bf16 a[20:23], a[192:195], v[204:207], a[20:23]
    buffer_load_dwordx4 v8, s[24:27], s49 offen offset:2048 sc1 lds
    s_waitcnt lgkmcnt(2)
    v_mfma_f32_16x16x32_bf16 a[24:27], a[196:199], v[184:187], a[24:27]
    ds_read_b128 a[208:211], v63 offset:4096
    v_mul_f32 v53, v7, v53
    v_mfma_f32_16x16x32_bf16 a[28:31], a[196:199], v[188:191], a[28:31]
    v_mul_f32 v54, v7, v54
    v_mul_f32 v55, v7, v55
    v_mfma_f32_16x16x32_bf16 a[32:35], a[196:199], v[192:195], a[32:35]
    v_add_u32 v62, s52, v62
    v_add_u32 v63, s52, v63
    v_mfma_f32_16x16x32_bf16 a[36:39], a[196:199], v[196:199], a[36:39]
    v_mul_f32 v56, v7, v56
    v_mul_f32 v57, v7, v57
    v_mfma_f32_16x16x32_bf16 a[40:43], a[196:199], v[200:203], a[40:43]
    buffer_load_dwordx4 v[244:247], v11, s[20:23], s50 offen offset:0 sc1
    v_mfma_f32_16x16x32_bf16 a[44:47], a[196:199], v[204:207], a[44:47]
    s_waitcnt lgkmcnt(2)
    v_mul_f32 v58, v7, v58
    v_mul_f32 v59, v7, v59
    v_mfma_f32_16x16x32_bf16 a[48:51], a[200:203], v[184:187], a[48:51]
    ds_read_b128 a[192:195], v62 offset:0
    v_cvt_pk_bf16_f32 v52, v52, v53
    v_mfma_f32_16x16x32_bf16 a[52:55], a[200:203], v[188:191], a[52:55]
    buffer_load_dwordx4 v[248:251], v11, s[20:23], s50 offen offset:1024 sc1
    v_mfma_f32_16x16x32_bf16 a[56:59], a[200:203], v[192:195], a[56:59]
    s_add_u32 s56, s48, 0
    buffer_store_dwordx4 a[228:231], v60, s[20:23], s56 offen offset:1024 sc1
    v_mfma_f32_16x16x32_bf16 a[60:63], a[200:203], v[196:199], a[60:63]
    v_cvt_pk_bf16_f32 v53, v54, v55
    v_cvt_pk_bf16_f32 v54, v56, v57
    v_mfma_f32_16x16x32_bf16 a[64:67], a[200:203], v[200:203], a[64:67]
    buffer_load_dwordx4 v8, s[24:27], s49 offen offset:3072 sc1 lds
    v_mfma_f32_16x16x32_bf16 a[68:71], a[200:203], v[204:207], a[68:71]
    s_waitcnt lgkmcnt(2)
    v_cvt_pk_bf16_f32 v55, v58, v59
    v_accvgpr_write_b32 a168, v52
    v_mfma_f32_16x16x32_bf16 a[72:75], a[204:207], v[184:187], a[72:75]
    ds_read_b128 a[196:199], v62 offset:1024
    v_accvgpr_write_b32 a169, v53
    v_mfma_f32_16x16x32_bf16 a[76:79], a[204:207], v[188:191], a[76:79]
    v_accvgpr_write_b32 a170, v54
    v_accvgpr_write_b32 a171, v55
    v_mfma_f32_16x16x32_bf16 a[80:83], a[204:207], v[192:195], a[80:83]
    v_accvgpr_read_b32 v52, a176
    v_accvgpr_read_b32 v53, a177
    v_mfma_f32_16x16x32_bf16 a[84:87], a[204:207], v[196:199], a[84:87]
    buffer_load_dwordx4 v[252:255], v11, s[20:23], s50 offen offset:2048 sc1
    v_mfma_f32_16x16x32_bf16 a[88:91], a[204:207], v[200:203], a[88:91]
    v_accvgpr_read_b32 v54, a178
    v_accvgpr_read_b32 v55, a179
    v_mfma_f32_16x16x32_bf16 a[92:95], a[204:207], v[204:207], a[92:95]
    s_waitcnt lgkmcnt(2)
    v_accvgpr_read_b32 v56, a180
    v_accvgpr_read_b32 v57, a181
    v_mfma_f32_16x16x32_bf16 a[96:99], a[208:211], v[184:187], a[96:99]
    ds_read_b128 a[200:203], v62 offset:2048
    v_accvgpr_read_b32 v58, a182
    v_mfma_f32_16x16x32_bf16 a[100:103], a[208:211], v[188:191], a[100:103]
    s_add_u32 m0, m0, 4096
    v_accvgpr_read_b32 v59, a183
    v_mul_f32 v52, v7, v52
    v_mfma_f32_16x16x32_bf16 a[104:107], a[208:211], v[192:195], a[104:107]
    buffer_load_dwordx4 v8, s[24:27], s54 offen offset:0 sc1 lds
    v_mfma_f32_16x16x32_bf16 a[108:111], a[208:211], v[196:199], a[108:111]
    s_add_u32 s44, s44, 1
    v_mul_f32 v53, v7, v53
    v_mul_f32 v54, v7, v54
    v_mfma_f32_16x16x32_bf16 a[112:115], a[208:211], v[200:203], a[112:115]
    s_waitcnt vmcnt(15)
    v_mul_f32 v55, v7, v55
    v_mul_f32 v56, v7, v56
    v_mfma_f32_16x16x32_bf16 a[116:119], a[208:211], v[204:207], a[116:119]
    s_waitcnt lgkmcnt(2)
    v_mul_f32 v57, v7, v57
    v_mul_f32 v58, v7, v58
    v_mfma_f32_16x16x32_bf16 v[64:67], a[192:195], v[208:211], v[64:67]
    ds_read_b128 a[204:207], v62 offset:3072
    v_mul_f32 v59, v7, v59
    v_mfma_f32_16x16x32_bf16 v[68:71], a[192:195], v[212:215], v[68:71]
    s_add_u32 s56, s48, 4096
    buffer_store_dwordx4 a[232:235], v60, s[20:23], s56 offen offset:3072 sc1
    v_mfma_f32_16x16x32_bf16 v[72:75], a[192:195], v[216:219], v[72:75]
    v_cvt_pk_bf16_f32 v52, v52, v53
    v_cvt_pk_bf16_f32 v53, v54, v55
    v_mfma_f32_16x16x32_bf16 v[76:79], a[192:195], v[220:223], v[76:79]
    s_cmp_eq_u32 s44, 11
    s_cselect_b32 s55, s76, 10240
    v_cvt_pk_bf16_f32 v54, v56, v57
    v_mfma_f32_16x16x32_bf16 v[80:83], a[192:195], v[224:227], v[80:83]
    v_cvt_pk_bf16_f32 v55, v58, v59
    v_accvgpr_write_b32 a176, v52
    v_mfma_f32_16x16x32_bf16 v[84:87], a[192:195], v[228:231], v[84:87]
    s_waitcnt lgkmcnt(2)
    v_accvgpr_write_b32 a177, v53
    v_accvgpr_write_b32 a178, v54
    v_mfma_f32_16x16x32_bf16 v[88:91], a[196:199], v[208:211], v[88:91]
    ds_read_b128 a[208:211], v62 offset:4096
    v_accvgpr_write_b32 a179, v55
    v_mfma_f32_16x16x32_bf16 v[92:95], a[196:199], v[212:215], v[92:95]
    s_add_u32 s49, s49, s55
    v_accvgpr_read_b32 v52, a184
    v_accvgpr_read_b32 v53, a185
    v_mfma_f32_16x16x32_bf16 v[96:99], a[196:199], v[216:219], v[96:99]
    s_add_u32 s54, s49, 4096
    v_accvgpr_read_b32 v54, a186
    v_accvgpr_read_b32 v55, a187
    v_mfma_f32_16x16x32_bf16 v[100:103], a[196:199], v[220:223], v[100:103]
    s_add_u32 s97, s97, 20480
    v_accvgpr_read_b32 v56, a188
    v_accvgpr_read_b32 v57, a189
    v_mfma_f32_16x16x32_bf16 v[104:107], a[196:199], v[224:227], v[104:107]
    s_cmp_eq_u32 s97, 163840
    s_cselect_b32 s97, 0, s97
    v_accvgpr_read_b32 v58, a190
    v_mfma_f32_16x16x32_bf16 v[108:111], a[196:199], v[228:231], v[108:111]
    s_waitcnt lgkmcnt(2)
    v_accvgpr_read_b32 v59, a191
    v_mul_f32 v52, v7, v52
    v_mfma_f32_16x16x32_bf16 v[112:115], a[200:203], v[208:211], v[112:115]
    ds_read_b128 a[192:195], v63 offset:0
    v_mul_f32 v53, v7, v53
    v_mfma_f32_16x16x32_bf16 v[116:119], a[200:203], v[212:215], v[116:119]
    s_add_u32 m0, s97, s96
    v_mul_f32 v54, v7, v54
    v_mul_f32 v55, v7, v55
    v_mfma_f32_16x16x32_bf16 v[120:123], a[200:203], v[216:219], v[120:123]
    buffer_load_dwordx4 v8, s[24:27], s49 offen offset:0 sc1 lds
    v_mfma_f32_16x16x32_bf16 v[124:127], a[200:203], v[220:223], v[124:127]
    s_cmp_eq_u32 s44, 14
    s_cselect_b32 s55, s78, 6144
    v_mul_f32 v56, v7, v56
    v_mfma_f32_16x16x32_bf16 v[128:131], a[200:203], v[224:227], v[128:131]
    s_add_u32 s50, s50, s55
    v_mul_f32 v57, v7, v57
    v_mul_f32 v58, v7, v58
    v_mfma_f32_16x16x32_bf16 v[132:135], a[200:203], v[228:231], v[132:135]
    s_waitcnt lgkmcnt(2)
    v_mul_f32 v59, v7, v59
    v_cvt_pk_bf16_f32 v52, v52, v53
    v_mfma_f32_16x16x32_bf16 v[136:139], a[204:207], v[208:211], v[136:139]
    ds_read_b128 a[196:199], v63 offset:1024
    v_cvt_pk_bf16_f32 v53, v54, v55
    v_mfma_f32_16x16x32_bf16 v[140:143], a[204:207], v[212:215], v[140:143]
    buffer_load_dwordx4 v[184:187], v10, s[20:23], s50 offen offset:0 sc1
    v_mfma_f32_16x16x32_bf16 v[144:147], a[204:207], v[216:219], v[144:147]
    s_add_u32 s56, s48, 12288
    buffer_store_dwordx4 v[12:15], v60, s[20:23], s56 offen offset:1024 sc1
    v_mfma_f32_16x16x32_bf16 v[148:151], a[204:207], v[220:223], v[148:151]
    v_cvt_pk_bf16_f32 v54, v56, v57
    v_cvt_pk_bf16_f32 v55, v58, v59
    v_mfma_f32_16x16x32_bf16 v[152:155], a[204:207], v[224:227], v[152:155]
    buffer_load_dwordx4 v[188:191], v10, s[20:23], s50 offen offset:1024 sc1
    v_mfma_f32_16x16x32_bf16 v[156:159], a[204:207], v[228:231], v[156:159]
    s_waitcnt lgkmcnt(2)
    v_accvgpr_write_b32 a184, v52
    v_accvgpr_write_b32 a185, v53
    v_mfma_f32_16x16x32_bf16 v[160:163], a[208:211], v[208:211], v[160:163]
    ds_read_b128 a[200:203], v63 offset:2048
    v_accvgpr_write_b32 a186, v54
    v_mfma_f32_16x16x32_bf16 v[164:167], a[208:211], v[212:215], v[164:167]
    buffer_load_dwordx4 v8, s[24:27], s49 offen offset:1024 sc1 lds
    v_mfma_f32_16x16x32_bf16 v[168:171], a[208:211], v[216:219], v[168:171]
    v_accvgpr_write_b32 a187, v55
    v_mfma_f32_16x16x32_bf16 v[172:175], a[208:211], v[220:223], v[172:175]
    s_and_b32 s70, s2, 0xc7
    v_mfma_f32_16x16x32_bf16 v[176:179], a[208:211], v[224:227], v[176:179]
    buffer_load_dwordx4 v[192:195], v10, s[20:23], s50 offen offset:2048 sc1
    v_mfma_f32_16x16x32_bf16 v[180:183], a[208:211], v[228:231], v[180:183]
    s_waitcnt lgkmcnt(2)
    v_mfma_f32_16x16x32_bf16 a[0:3], a[192:195], v[208:211], a[0:3]
    ds_read_b128 a[204:207], v63 offset:3072
    s_and_b32 s71, s37, 1
    v_mfma_f32_16x16x32_bf16 a[4:7], a[192:195], v[212:215], a[4:7]
    s_lshl_b32 s71, s71, 1
    v_mfma_f32_16x16x32_bf16 a[8:11], a[192:195], v[216:219], a[8:11]
    s_add_u32 s99, s99, 20480
    v_mfma_f32_16x16x32_bf16 a[12:15], a[192:195], v[220:223], a[12:15]
    s_add_u32 s71, s71, s5
    v_mfma_f32_16x16x32_bf16 a[16:19], a[192:195], v[224:227], a[16:19]
    s_cmp_eq_u32 s99, 163840
    s_cselect_b32 s52, s95, 20480
    s_cselect_b32 s99, 0, s99
    v_mfma_f32_16x16x32_bf16 a[20:23], a[192:195], v[228:231], a[20:23]
    buffer_load_dwordx4 v8, s[24:27], s49 offen offset:2048 sc1 lds
    s_waitcnt lgkmcnt(2)
    v_mfma_f32_16x16x32_bf16 a[24:27], a[196:199], v[208:211], a[24:27]
    ds_read_b128 a[208:211], v63 offset:4096
    s_lshl_b32 s71, s71, 4
    v_mfma_f32_16x16x32_bf16 a[28:31], a[196:199], v[212:215], a[28:31]
    s_add_u32 s56, s48, 16384
    buffer_store_dwordx4 v[16:19], v60, s[20:23], s56 offen offset:3072 sc1
    v_mfma_f32_16x16x32_bf16 a[32:35], a[196:199], v[216:219], a[32:35]
    v_add_u32 v62, s52, v62
    v_add_u32 v63, s52, v63
    s_add_u32 s70, s70, s71
    v_mfma_f32_16x16x32_bf16 a[36:39], a[196:199], v[220:223], a[36:39]
    s_lshl_b32 s70, s70, 7
    v_mfma_f32_16x16x32_bf16 a[40:43], a[196:199], v[224:227], a[40:43]
    buffer_load_dwordx4 v[196:199], v11, s[20:23], s50 offen offset:0 sc1
    v_mfma_f32_16x16x32_bf16 a[44:47], a[196:199], v[228:231], a[44:47]
    s_waitcnt lgkmcnt(2)
    v_mfma_f32_16x16x32_bf16 a[48:51], a[200:203], v[208:211], a[48:51]
    ds_read_b128 a[192:195], v62 offset:0
    s_lshl_b32 s71, s6, 2
    v_mfma_f32_16x16x32_bf16 a[52:55], a[200:203], v[212:215], a[52:55]
    buffer_load_dwordx4 v[200:203], v11, s[20:23], s50 offen offset:1024 sc1
    v_mfma_f32_16x16x32_bf16 a[56:59], a[200:203], v[216:219], a[56:59]
    s_add_u32 s70, s70, s71
    v_mfma_f32_16x16x32_bf16 a[60:63], a[200:203], v[220:223], a[60:63]
    s_add_u32 s71, s70, 8388624
    v_mfma_f32_16x16x32_bf16 a[64:67], a[200:203], v[224:227], a[64:67]
    buffer_load_dwordx4 v8, s[24:27], s49 offen offset:3072 sc1 lds
    v_mfma_f32_16x16x32_bf16 a[68:71], a[200:203], v[228:231], a[68:71]
    s_waitcnt lgkmcnt(2)
    v_lshrrev_b32 v2, 1, v1
    v_lshlrev_b32 v2, 10, v2
    v_mfma_f32_16x16x32_bf16 a[72:75], a[204:207], v[208:211], a[72:75]
    ds_read_b128 a[196:199], v62 offset:1024
    v_and_b32 v3, 1, v1
    v_mfma_f32_16x16x32_bf16 a[76:79], a[204:207], v[212:215], a[76:79]
    v_lshl_add_u32 v2, v3, 3, v2
    v_add_u32 v2, s71, v2
    v_mfma_f32_16x16x32_bf16 a[80:83], a[204:207], v[216:219], a[80:83]
    v_bfrev_b32 v3, 1
    v_cmp_gt_u32 vcc, 4, v1
    v_mfma_f32_16x16x32_bf16 a[84:87], a[204:207], v[220:223], a[84:87]
    buffer_load_dwordx4 v[204:207], v11, s[20:23], s50 offen offset:2048 sc1
    v_mfma_f32_16x16x32_bf16 a[88:91], a[204:207], v[224:227], a[88:91]
    v_mov_b32 v4, 1
    v_mfma_f32_16x16x32_bf16 a[92:95], a[204:207], v[228:231], a[92:95]
    s_waitcnt lgkmcnt(2)
    v_mfma_f32_16x16x32_bf16 a[96:99], a[208:211], v[208:211], a[96:99]
    ds_read_b128 a[200:203], v62 offset:2048
    v_cndmask_b32 v2, v3, v2, vcc
    v_mfma_f32_16x16x32_bf16 a[100:103], a[208:211], v[212:215], a[100:103]
    s_add_u32 m0, m0, 4096
    s_add_u32 s56, s48, 0
    buffer_store_dwordx4 v[20:23], v60, s[20:23], s56 offen offset:2048 sc1
    v_mfma_f32_16x16x32_bf16 a[104:107], a[208:211], v[216:219], a[104:107]
    buffer_load_dwordx4 v8, s[24:27], s54 offen offset:0 sc1 lds
    v_mfma_f32_16x16x32_bf16 a[108:111], a[208:211], v[220:223], a[108:111]
    s_add_u32 s44, s44, 1
    v_writelane_b32 v3, 0, 0
    v_mfma_f32_16x16x32_bf16 a[112:115], a[208:211], v[224:227], a[112:115]
    s_waitcnt vmcnt(16)
    v_mfma_f32_16x16x32_bf16 a[116:119], a[208:211], v[228:231], a[116:119]
    s_waitcnt lgkmcnt(2)
    v_mfma_f32_16x16x32_bf16 v[64:67], a[192:195], v[232:235], v[64:67]
    ds_read_b128 a[204:207], v62 offset:3072
    v_mfma_f32_16x16x32_bf16 v[68:71], a[192:195], v[236:239], v[68:71]
    s_waitcnt vmcnt(15)
    v_mfma_f32_16x16x32_bf16 v[72:75], a[192:195], v[240:243], v[72:75]
    s_barrier
    v_mfma_f32_16x16x32_bf16 v[76:79], a[192:195], v[244:247], v[76:79]
    s_cmp_eq_u32 s44, 11
    s_cselect_b32 s55, s76, 10240
    v_mfma_f32_16x16x32_bf16 v[80:83], a[192:195], v[248:251], v[80:83]
    v_mfma_f32_16x16x32_bf16 v[84:87], a[192:195], v[252:255], v[84:87]
    s_waitcnt lgkmcnt(2)
    v_mfma_f32_16x16x32_bf16 v[88:91], a[196:199], v[232:235], v[88:91]
    ds_read_b128 a[208:211], v62 offset:4096
    v_mfma_f32_16x16x32_bf16 v[92:95], a[196:199], v[236:239], v[92:95]
    s_add_u32 s49, s49, s55
    v_mfma_f32_16x16x32_bf16 v[96:99], a[196:199], v[240:243], v[96:99]
    s_add_u32 s54, s49, 4096
    v_mfma_f32_16x16x32_bf16 v[100:103], a[196:199], v[244:247], v[100:103]
    s_add_u32 s97, s97, 20480
    v_mfma_f32_16x16x32_bf16 v[104:107], a[196:199], v[248:251], v[104:107]
    s_cmp_eq_u32 s97, 163840
    s_cselect_b32 s97, 0, s97
    v_mfma_f32_16x16x32_bf16 v[108:111], a[196:199], v[252:255], v[108:111]
    s_waitcnt lgkmcnt(2)
    v_mfma_f32_16x16x32_bf16 v[112:115], a[200:203], v[232:235], v[112:115]
    ds_read_b128 a[192:195], v63 offset:0
    v_mfma_f32_16x16x32_bf16 v[116:119], a[200:203], v[236:239], v[116:119]
    s_add_u32 m0, s97, s96
    s_add_u32 s56, s48, 8192
    buffer_store_dwordx4 v[24:27], v60, s[20:23], s56 offen offset:0 sc1
    v_mfma_f32_16x16x32_bf16 v[120:123], a[200:203], v[240:243], v[120:123]
    buffer_load_dwordx4 v8, s[24:27], s49 offen offset:0 sc1 lds
    v_mfma_f32_16x16x32_bf16 v[124:127], a[200:203], v[244:247], v[124:127]
    s_cmp_eq_u32 s44, 14
    s_cselect_b32 s55, s78, 6144
    v_mfma_f32_16x16x32_bf16 v[128:131], a[200:203], v[248:251], v[128:131]
    s_add_u32 s50, s50, s55
    v_mfma_f32_16x16x32_bf16 v[132:135], a[200:203], v[252:255], v[132:135]
    s_waitcnt lgkmcnt(2)
    v_mfma_f32_16x16x32_bf16 v[136:139], a[204:207], v[232:235], v[136:139]
    ds_read_b128 a[196:199], v63 offset:1024
    v_mfma_f32_16x16x32_bf16 v[140:143], a[204:207], v[236:239], v[140:143]
    buffer_load_dwordx4 v[208:211], v10, s[20:23], s50 offen offset:0 sc1
    v_mfma_f32_16x16x32_bf16 v[144:147], a[204:207], v[240:243], v[144:147]
    v_mfma_f32_16x16x32_bf16 v[148:151], a[204:207], v[244:247], v[148:151]
    v_mfma_f32_16x16x32_bf16 v[152:155], a[204:207], v[248:251], v[152:155]
    buffer_load_dwordx4 v[212:215], v10, s[20:23], s50 offen offset:1024 sc1
    v_mfma_f32_16x16x32_bf16 v[156:159], a[204:207], v[252:255], v[156:159]
    s_waitcnt lgkmcnt(2)
    v_mfma_f32_16x16x32_bf16 v[160:163], a[208:211], v[232:235], v[160:163]
    ds_read_b128 a[200:203], v63 offset:2048
    v_mfma_f32_16x16x32_bf16 v[164:167], a[208:211], v[236:239], v[164:167]
    buffer_load_dwordx4 v8, s[24:27], s49 offen offset:1024 sc1 lds
    v_mfma_f32_16x16x32_bf16 v[168:171], a[208:211], v[240:243], v[168:171]
    v_mfma_f32_16x16x32_bf16 v[172:175], a[208:211], v[244:247], v[172:175]
    v_mfma_f32_16x16x32_bf16 v[176:179], a[208:211], v[248:251], v[176:179]
    buffer_load_dwordx4 v[216:219], v10, s[20:23], s50 offen offset:2048 sc1
    v_mfma_f32_16x16x32_bf16 v[180:183], a[208:211], v[252:255], v[180:183]
    s_waitcnt lgkmcnt(2)
    v_mfma_f32_16x16x32_bf16 a[0:3], a[192:195], v[232:235], a[0:3]
    ds_read_b128 a[204:207], v63 offset:3072
    v_mfma_f32_16x16x32_bf16 a[4:7], a[192:195], v[236:239], a[4:7]
    s_add_u32 s56, s48, 12288
    buffer_store_dwordx4 v[28:31], v60, s[20:23], s56 offen offset:2048 sc1
    v_mfma_f32_16x16x32_bf16 a[8:11], a[192:195], v[240:243], a[8:11]
    s_add_u32 s99, s99, 20480
    v_mfma_f32_16x16x32_bf16 a[12:15], a[192:195], v[244:247], a[12:15]
    v_mfma_f32_16x16x32_bf16 a[16:19], a[192:195], v[248:251], a[16:19]
    s_cmp_eq_u32 s99, 163840
    s_cselect_b32 s52, s95, 20480
    s_cselect_b32 s99, 0, s99
    v_mfma_f32_16x16x32_bf16 a[20:23], a[192:195], v[252:255], a[20:23]
    buffer_load_dwordx4 v8, s[24:27], s49 offen offset:2048 sc1 lds
    s_waitcnt lgkmcnt(2)
    v_mfma_f32_16x16x32_bf16 a[24:27], a[196:199], v[232:235], a[24:27]
    ds_read_b128 a[208:211], v63 offset:4096
    v_mfma_f32_16x16x32_bf16 a[28:31], a[196:199], v[236:239], a[28:31]
    v_mfma_f32_16x16x32_bf16 a[32:35], a[196:199], v[240:243], a[32:35]
    v_add_u32 v62, s52, v62
    v_add_u32 v63, s52, v63
    v_mfma_f32_16x16x32_bf16 a[36:39], a[196:199], v[244:247], a[36:39]
    v_mfma_f32_16x16x32_bf16 a[40:43], a[196:199], v[248:251], a[40:43]
    buffer_load_dwordx4 v[220:223], v11, s[20:23], s50 offen offset:0 sc1
    v_mfma_f32_16x16x32_bf16 a[44:47], a[196:199], v[252:255], a[44:47]
    s_waitcnt lgkmcnt(2)
    v_mfma_f32_16x16x32_bf16 a[48:51], a[200:203], v[232:235], a[48:51]
    ds_read_b128 a[192:195], v62 offset:0
    v_mfma_f32_16x16x32_bf16 a[52:55], a[200:203], v[236:239], a[52:55]
    buffer_load_dwordx4 v[224:227], v11, s[20:23], s50 offen offset:1024 sc1
    v_mfma_f32_16x16x32_bf16 a[56:59], a[200:203], v[240:243], a[56:59]
    v_mfma_f32_16x16x32_bf16 a[60:63], a[200:203], v[244:247], a[60:63]
    v_mfma_f32_16x16x32_bf16 a[64:67], a[200:203], v[248:251], a[64:67]
    buffer_load_dwordx4 v8, s[24:27], s49 offen offset:3072 sc1 lds
    v_mfma_f32_16x16x32_bf16 a[68:71], a[200:203], v[252:255], a[68:71]
    s_waitcnt lgkmcnt(2)
    v_mfma_f32_16x16x32_bf16 a[72:75], a[204:207], v[232:235], a[72:75]
    ds_read_b128 a[196:199], v62 offset:1024
    v_mfma_f32_16x16x32_bf16 a[76:79], a[204:207], v[236:239], a[76:79]
    s_add_u32 s56, s48, 20480
    buffer_store_dwordx4 v[32:35], v60, s[20:23], s56 offen offset:0 sc1
    v_mfma_f32_16x16x32_bf16 a[80:83], a[204:207], v[240:243], a[80:83]
    v_mfma_f32_16x16x32_bf16 a[84:87], a[204:207], v[244:247], a[84:87]
    buffer_load_dwordx4 v[228:231], v11, s[20:23], s50 offen offset:2048 sc1
    v_mfma_f32_16x16x32_bf16 a[88:91], a[204:207], v[248:251], a[88:91]
    v_mfma_f32_16x16x32_bf16 a[92:95], a[204:207], v[252:255], a[92:95]
    s_waitcnt lgkmcnt(2)
    v_mfma_f32_16x16x32_bf16 a[96:99], a[208:211], v[232:235], a[96:99]
    ds_read_b128 a[200:203], v62 offset:2048
    v_mfma_f32_16x16x32_bf16 a[100:103], a[208:211], v[236:239], a[100:103]
    s_add_u32 m0, m0, 4096
    v_mfma_f32_16x16x32_bf16 a[104:107], a[208:211], v[240:243], a[104:107]
    buffer_load_dwordx4 v8, s[24:27], s54 offen offset:0 sc1 lds
    v_mfma_f32_16x16x32_bf16 a[108:111], a[208:211], v[244:247], a[108:111]
    s_add_u32 s44, s44, 1
    v_mfma_f32_16x16x32_bf16 a[112:115], a[208:211], v[248:251], a[112:115]
    s_waitcnt vmcnt(16)
    v_mfma_f32_16x16x32_bf16 a[116:119], a[208:211], v[252:255], a[116:119]
    s_waitcnt lgkmcnt(2)
    v_mfma_f32_16x16x32_bf16 v[64:67], a[192:195], v[184:187], v[64:67]
    ds_read_b128 a[204:207], v62 offset:3072
    v_mfma_f32_16x16x32_bf16 v[68:71], a[192:195], v[188:191], v[68:71]
    v_mfma_f32_16x16x32_bf16 v[72:75], a[192:195], v[192:195], v[72:75]
    v_mfma_f32_16x16x32_bf16 v[76:79], a[192:195], v[196:199], v[76:79]
    s_cmp_eq_u32 s44, 11
    s_cselect_b32 s55, s76, 10240
    v_mfma_f32_16x16x32_bf16 v[80:83], a[192:195], v[200:203], v[80:83]
    v_mfma_f32_16x16x32_bf16 v[84:87], a[192:195], v[204:207], v[84:87]
    s_waitcnt lgkmcnt(2)
    v_mfma_f32_16x16x32_bf16 v[88:91], a[196:199], v[184:187], v[88:91]
    ds_read_b128 a[208:211], v62 offset:4096
    v_mfma_f32_16x16x32_bf16 v[92:95], a[196:199], v[188:191], v[92:95]
    s_add_u32 s49, s49, s55
    s_add_u32 s56, s48, 0
    buffer_store_dwordx4 v[40:43], v60, s[20:23], s56 offen offset:3072 sc1
    v_mfma_f32_16x16x32_bf16 v[96:99], a[196:199], v[192:195], v[96:99]
    s_add_u32 s54, s49, 4096
    v_mfma_f32_16x16x32_bf16 v[100:103], a[196:199], v[196:199], v[100:103]
    s_add_u32 s97, s97, 20480
    v_mfma_f32_16x16x32_bf16 v[104:107], a[196:199], v[200:203], v[104:107]
    s_cmp_eq_u32 s97, 163840
    s_cselect_b32 s97, 0, s97
    v_mfma_f32_16x16x32_bf16 v[108:111], a[196:199], v[204:207], v[108:111]
    s_waitcnt lgkmcnt(2)
    v_mfma_f32_16x16x32_bf16 v[112:115], a[200:203], v[184:187], v[112:115]
    ds_read_b128 a[192:195], v63 offset:0
    v_mfma_f32_16x16x32_bf16 v[116:119], a[200:203], v[188:191], v[116:119]
    s_add_u32 m0, s97, s96
    v_mfma_f32_16x16x32_bf16 v[120:123], a[200:203], v[192:195], v[120:123]
    buffer_load_dwordx4 v8, s[24:27], s49 offen offset:0 sc1 lds
    v_mfma_f32_16x16x32_bf16 v[124:127], a[200:203], v[196:199], v[124:127]
    s_cmp_eq_u32 s44, 14
    s_cselect_b32 s55, s78, 6144
    v_mfma_f32_16x16x32_bf16 v[128:131], a[200:203], v[200:203], v[128:131]
    s_add_u32 s50, s50, s55
    v_mfma_f32_16x16x32_bf16 v[132:135], a[200:203], v[204:207], v[132:135]
    s_waitcnt lgkmcnt(2)
    v_mfma_f32_16x16x32_bf16 v[136:139], a[204:207], v[184:187], v[136:139]
    ds_read_b128 a[196:199], v63 offset:1024
    v_mfma_f32_16x16x32_bf16 v[140:143], a[204:207], v[188:191], v[140:143]
    buffer_load_dwordx4 v[232:235], v10, s[20:23], s50 offen offset:0 sc1
    v_mfma_f32_16x16x32_bf16 v[144:147], a[204:207], v[192:195], v[144:147]
    v_mfma_f32_16x16x32_bf16 v[148:151], a[204:207], v[196:199], v[148:151]
    v_mfma_f32_16x16x32_bf16 v[152:155], a[204:207], v[200:203], v[152:155]
    buffer_load_dwordx4 v[236:239], v10, s[20:23], s50 offen offset:1024 sc1
    v_mfma_f32_16x16x32_bf16 v[156:159], a[204:207], v[204:207], v[156:159]
    s_waitcnt lgkmcnt(2)
    v_mfma_f32_16x16x32_bf16 v[160:163], a[208:211], v[184:187], v[160:163]
    ds_read_b128 a[200:203], v63 offset:2048
    v_mfma_f32_16x16x32_bf16 v[164:167], a[208:211], v[188:191], v[164:167]
    buffer_load_dwordx4 v8, s[24:27], s49 offen offset:1024 sc1 lds
    v_mfma_f32_16x16x32_bf16 v[168:171], a[208:211], v[192:195], v[168:171]
    s_add_u32 s56, s48, 8192
    buffer_store_dwordx4 v[44:47], v60, s[20:23], s56 offen offset:1024 sc1
    v_mfma_f32_16x16x32_bf16 v[172:175], a[208:211], v[196:199], v[172:175]
    v_mfma_f32_16x16x32_bf16 v[176:179], a[208:211], v[200:203], v[176:179]
    buffer_load_dwordx4 v[240:243], v10, s[20:23], s50 offen offset:2048 sc1
    v_mfma_f32_16x16x32_bf16 v[180:183], a[208:211], v[204:207], v[180:183]
    s_waitcnt lgkmcnt(2)
    v_mfma_f32_16x16x32_bf16 a[0:3], a[192:195], v[184:187], a[0:3]
    ds_read_b128 a[204:207], v63 offset:3072
    v_mfma_f32_16x16x32_bf16 a[4:7], a[192:195], v[188:191], a[4:7]
    v_mfma_f32_16x16x32_bf16 a[8:11], a[192:195], v[192:195], a[8:11]
    s_add_u32 s99, s99, 20480
    v_mfma_f32_16x16x32_bf16 a[12:15], a[192:195], v[196:199], a[12:15]
    v_mfma_f32_16x16x32_bf16 a[16:19], a[192:195], v[200:203], a[16:19]
    s_cmp_eq_u32 s99, 163840
    s_cselect_b32 s52, s95, 20480
    s_cselect_b32 s99, 0, s99
    v_mfma_f32_16x16x32_bf16 a[20:23], a[192:195], v[204:207], a[20:23]
    buffer_load_dwordx4 v8, s[24:27], s49 offen offset:2048 sc1 lds
    s_waitcnt lgkmcnt(2)
    v_mfma_f32_16x16x32_bf16 a[24:27], a[196:199], v[184:187], a[24:27]
    ds_read_b128 a[208:211], v63 offset:4096
    v_mfma_f32_16x16x32_bf16 a[28:31], a[196:199], v[188:191], a[28:31]
    v_mfma_f32_16x16x32_bf16 a[32:35], a[196:199], v[192:195], a[32:35]
    v_add_u32 v62, s52, v62
    v_add_u32 v63, s52, v63
    v_mfma_f32_16x16x32_bf16 a[36:39], a[196:199], v[196:199], a[36:39]
    v_mfma_f32_16x16x32_bf16 a[40:43], a[196:199], v[200:203], a[40:43]
    buffer_load_dwordx4 v[244:247], v11, s[20:23], s50 offen offset:0 sc1
    v_mfma_f32_16x16x32_bf16 a[44:47], a[196:199], v[204:207], a[44:47]
    s_waitcnt lgkmcnt(2)
    v_mfma_f32_16x16x32_bf16 a[48:51], a[200:203], v[184:187], a[48:51]
    ds_read_b128 a[192:195], v62 offset:0
    v_mfma_f32_16x16x32_bf16 a[52:55], a[200:203], v[188:191], a[52:55]
    buffer_load_dwordx4 v[248:251], v11, s[20:23], s50 offen offset:1024 sc1
    v_mfma_f32_16x16x32_bf16 a[56:59], a[200:203], v[192:195], a[56:59]
    s_add_u32 s56, s48, 12288
    buffer_store_dwordx4 v[48:51], v60, s[20:23], s56 offen offset:3072 sc1
    v_mfma_f32_16x16x32_bf16 a[60:63], a[200:203], v[196:199], a[60:63]
    v_mfma_f32_16x16x32_bf16 a[64:67], a[200:203], v[200:203], a[64:67]
    buffer_load_dwordx4 v8, s[24:27], s49 offen offset:3072 sc1 lds
    v_mfma_f32_16x16x32_bf16 a[68:71], a[200:203], v[204:207], a[68:71]
    s_waitcnt lgkmcnt(2)
    v_mfma_f32_16x16x32_bf16 a[72:75], a[204:207], v[184:187], a[72:75]
    ds_read_b128 a[196:199], v62 offset:1024
    v_mfma_f32_16x16x32_bf16 a[76:79], a[204:207], v[188:191], a[76:79]
    v_mfma_f32_16x16x32_bf16 a[80:83], a[204:207], v[192:195], a[80:83]
    v_mfma_f32_16x16x32_bf16 a[84:87], a[204:207], v[196:199], a[84:87]
    buffer_load_dwordx4 v[252:255], v11, s[20:23], s50 offen offset:2048 sc1
    v_mfma_f32_16x16x32_bf16 a[88:91], a[204:207], v[200:203], a[88:91]
    v_mfma_f32_16x16x32_bf16 a[92:95], a[204:207], v[204:207], a[92:95]
    s_waitcnt lgkmcnt(2)
    v_mfma_f32_16x16x32_bf16 a[96:99], a[208:211], v[184:187], a[96:99]
    ds_read_b128 a[200:203], v62 offset:2048
    v_mfma_f32_16x16x32_bf16 a[100:103], a[208:211], v[188:191], a[100:103]
    s_add_u32 m0, m0, 4096
    v_mfma_f32_16x16x32_bf16 a[104:107], a[208:211], v[192:195], a[104:107]
    buffer_load_dwordx4 v8, s[24:27], s54 offen offset:0 sc1 lds
    v_mfma_f32_16x16x32_bf16 a[108:111], a[208:211], v[196:199], a[108:111]
    s_add_u32 s44, s44, 1
    v_mfma_f32_16x16x32_bf16 a[112:115], a[208:211], v[200:203], a[112:115]
    s_waitcnt vmcnt(15)
    v_mfma_f32_16x16x32_bf16 a[116:119], a[208:211], v[204:207], a[116:119]
    s_waitcnt lgkmcnt(2)
    v_mfma_f32_16x16x32_bf16 v[64:67], a[192:195], v[208:211], v[64:67]
    ds_read_b128 a[204:207], v62 offset:3072
    v_mfma_f32_16x16x32_bf16 v[68:71], a[192:195], v[212:215], v[68:71]
    s_add_u32 s56, s48, 20480
    buffer_store_dwordx4 a[236:239], v60, s[20:23], s56 offen offset:1024 sc1
    v_mfma_f32_16x16x32_bf16 v[72:75], a[192:195], v[216:219], v[72:75]
    v_mfma_f32_16x16x32_bf16 v[76:79], a[192:195], v[220:223], v[76:79]
    s_cmp_eq_u32 s44, 11
    s_cselect_b32 s55, s76, 10240
    v_mfma_f32_16x16x32_bf16 v[80:83], a[192:195], v[224:227], v[80:83]
    v_mfma_f32_16x16x32_bf16 v[84:87], a[192:195], v[228:231], v[84:87]
    s_waitcnt lgkmcnt(2)
    v_mfma_f32_16x16x32_bf16 v[88:91], a[196:199], v[208:211], v[88:91]
    ds_read_b128 a[208:211], v62 offset:4096
    v_mfma_f32_16x16x32_bf16 v[92:95], a[196:199], v[212:215], v[92:95]
    s_add_u32 s49, s49, s55
    v_mfma_f32_16x16x32_bf16 v[96:99], a[196:199], v[216:219], v[96:99]
    s_add_u32 s54, s49, 4096
    v_mfma_f32_16x16x32_bf16 v[100:103], a[196:199], v[220:223], v[100:103]
    s_add_u32 s97, s97, 20480
    v_mfma_f32_16x16x32_bf16 v[104:107], a[196:199], v[224:227], v[104:107]
    s_cmp_eq_u32 s97, 163840
    s_cselect_b32 s97, 0, s97
    v_mfma_f32_16x16x32_bf16 v[108:111], a[196:199], v[228:231], v[108:111]
    s_waitcnt lgkmcnt(2)
    v_mfma_f32_16x16x32_bf16 v[112:115], a[200:203], v[208:211], v[112:115]
    ds_read_b128 a[192:195], v63 offset:0
    v_mfma_f32_16x16x32_bf16 v[116:119], a[200:203], v[212:215], v[116:119]
    s_add_u32 m0, s97, s96
    v_mfma_f32_16x16x32_bf16 v[120:123], a[200:203], v[216:219], v[120:123]
    buffer_load_dwordx4 v8, s[24:27], s49 offen offset:0 sc1 lds
    v_mfma_f32_16x16x32_bf16 v[124:127], a[200:203], v[220:223], v[124:127]
    s_cmp_eq_u32 s44, 14
    s_cselect_b32 s55, s78, 6144
    v_mfma_f32_16x16x32_bf16 v[128:131], a[200:203], v[224:227], v[128:131]
    s_add_u32 s50, s50, s55
    v_mfma_f32_16x16x32_bf16 v[132:135], a[200:203], v[228:231], v[132:135]
    s_waitcnt lgkmcnt(2)
    v_mfma_f32_16x16x32_bf16 v[136:139], a[204:207], v[208:211], v[136:139]
    ds_read_b128 a[196:199], v63 offset:1024
    v_mfma_f32_16x16x32_bf16 v[140:143], a[204:207], v[212:215], v[140:143]
    buffer_load_dwordx4 v[184:187], v10, s[20:23], s50 offen offset:0 sc1
    v_mfma_f32_16x16x32_bf16 v[144:147], a[204:207], v[216:219], v[144:147]
    s_add_u32 s56, s48, 4096
    buffer_store_dwordx4 a[240:243], v60, s[20:23], s56 offen offset:0 sc1
    v_mfma_f32_16x16x32_bf16 v[148:151], a[204:207], v[220:223], v[148:151]
    v_mfma_f32_16x16x32_bf16 v[152:155], a[204:207], v[224:227], v[152:155]
    buffer_load_dwordx4 v[188:191], v10, s[20:23], s50 offen offset:1024 sc1
    v_mfma_f32_16x16x32_bf16 v[156:159], a[204:207], v[228:231], v[156:159]
    s_waitcnt lgkmcnt(2)
    v_mfma_f32_16x16x32_bf16 v[160:163], a[208:211], v[208:211], v[160:163]
    ds_read_b128 a[200:203], v63 offset:2048
    v_mfma_f32_16x16x32_bf16 v[164:167], a[208:211], v[212:215], v[164:167]
    buffer_load_dwordx4 v8, s[24:27], s49 offen offset:1024 sc1 lds
    v_mfma_f32_16x16x32_bf16 v[168:171], a[208:211], v[216:219], v[168:171]
    v_mfma_f32_16x16x32_bf16 v[172:175], a[208:211], v[220:223], v[172:175]
    v_mfma_f32_16x16x32_bf16 v[176:179], a[208:211], v[224:227], v[176:179]
    buffer_load_dwordx4 v[192:195], v10, s[20:23], s50 offen offset:2048 sc1
    v_mfma_f32_16x16x32_bf16 v[180:183], a[208:211], v[228:231], v[180:183]
    s_waitcnt lgkmcnt(2)
    v_mfma_f32_16x16x32_bf16 a[0:3], a[192:195], v[208:211], a[0:3]
    ds_read_b128 a[204:207], v63 offset:3072
    v_mfma_f32_16x16x32_bf16 a[4:7], a[192:195], v[212:215], a[4:7]
    v_mfma_f32_16x16x32_bf16 a[8:11], a[192:195], v[216:219], a[8:11]
    s_add_u32 s99, s99, 20480
    v_mfma_f32_16x16x32_bf16 a[12:15], a[192:195], v[220:223], a[12:15]
    v_mfma_f32_16x16x32_bf16 a[16:19], a[192:195], v[224:227], a[16:19]
    s_cmp_eq_u32 s99, 163840
    s_cselect_b32 s52, s95, 20480
    s_cselect_b32 s99, 0, s99
    v_mfma_f32_16x16x32_bf16 a[20:23], a[192:195], v[228:231], a[20:23]
    buffer_load_dwordx4 v8, s[24:27], s49 offen offset:2048 sc1 lds
    s_waitcnt lgkmcnt(2)
    v_mfma_f32_16x16x32_bf16 a[24:27], a[196:199], v[208:211], a[24:27]
    ds_read_b128 a[208:211], v63 offset:4096
    v_mfma_f32_16x16x32_bf16 a[28:31], a[196:199], v[212:215], a[28:31]
    s_add_u32 s56, s48, 8192
    buffer_store_dwordx4 a[244:247], v60, s[20:23], s56 offen offset:2048 sc1
    v_mfma_f32_16x16x32_bf16 a[32:35], a[196:199], v[216:219], a[32:35]
    v_add_u32 v62, s52, v62
    v_add_u32 v63, s52, v63
    v_mfma_f32_16x16x32_bf16 a[36:39], a[196:199], v[220:223], a[36:39]
    v_mfma_f32_16x16x32_bf16 a[40:43], a[196:199], v[224:227], a[40:43]
    buffer_load_dwordx4 v[196:199], v11, s[20:23], s50 offen offset:0 sc1
    v_mfma_f32_16x16x32_bf16 a[44:47], a[196:199], v[228:231], a[44:47]
    s_waitcnt lgkmcnt(2)
    v_mfma_f32_16x16x32_bf16 a[48:51], a[200:203], v[208:211], a[48:51]
    ds_read_b128 a[192:195], v62 offset:0
    v_mfma_f32_16x16x32_bf16 a[52:55], a[200:203], v[212:215], a[52:55]
    buffer_load_dwordx4 v[200:203], v11, s[20:23], s50 offen offset:1024 sc1
    v_mfma_f32_16x16x32_bf16 a[56:59], a[200:203], v[216:219], a[56:59]
    v_mfma_f32_16x16x32_bf16 a[60:63], a[200:203], v[220:223], a[60:63]
    v_mfma_f32_16x16x32_bf16 a[64:67], a[200:203], v[224:227], a[64:67]
    buffer_load_dwordx4 v8, s[24:27], s49 offen offset:3072 sc1 lds
    v_mfma_f32_16x16x32_bf16 a[68:71], a[200:203], v[228:231], a[68:71]
    s_waitcnt lgkmcnt(2)
    v_mfma_f32_16x16x32_bf16 a[72:75], a[204:207], v[208:211], a[72:75]
    ds_read_b128 a[196:199], v62 offset:1024
    v_mfma_f32_16x16x32_bf16 a[76:79], a[204:207], v[212:215], a[76:79]
    v_mfma_f32_16x16x32_bf16 a[80:83], a[204:207], v[216:219], a[80:83]
    v_mfma_f32_16x16x32_bf16 a[84:87], a[204:207], v[220:223], a[84:87]
    buffer_load_dwordx4 v[204:207], v11, s[20:23], s50 offen offset:2048 sc1
    v_mfma_f32_16x16x32_bf16 a[88:91], a[204:207], v[224:227], a[88:91]
    v_mfma_f32_16x16x32_bf16 a[92:95], a[204:207], v[228:231], a[92:95]
    s_waitcnt lgkmcnt(2)
    v_mfma_f32_16x16x32_bf16 a[96:99], a[208:211], v[208:211], a[96:99]
    ds_read_b128 a[200:203], v62 offset:2048
    v_mfma_f32_16x16x32_bf16 a[100:103], a[208:211], v[212:215], a[100:103]
    s_add_u32 m0, m0, 4096
    s_add_u32 s56, s48, 16384
    buffer_store_dwordx4 a[248:251], v60, s[20:23], s56 offen offset:0 sc1
    v_mfma_f32_16x16x32_bf16 a[104:107], a[208:211], v[216:219], a[104:107]
    buffer_load_dwordx4 v8, s[24:27], s54 offen offset:0 sc1 lds
    v_mfma_f32_16x16x32_bf16 a[108:111], a[208:211], v[220:223], a[108:111]
    s_add_u32 s44, s44, 1
    v_mfma_f32_16x16x32_bf16 a[112:115], a[208:211], v[224:227], a[112:115]
    s_waitcnt vmcnt(16)
    v_mfma_f32_16x16x32_bf16 a[116:119], a[208:211], v[228:231], a[116:119]
    s_waitcnt lgkmcnt(2)
    v_mfma_f32_16x16x32_bf16 v[64:67], a[192:195], v[232:235], v[64:67]
    ds_read_b128 a[204:207], v62 offset:3072
    v_mfma_f32_16x16x32_bf16 v[68:71], a[192:195], v[236:239], v[68:71]
    s_waitcnt vmcnt(15)
    v_mfma_f32_16x16x32_bf16 v[72:75], a[192:195], v[240:243], v[72:75]
    s_barrier
    v_mfma_f32_16x16x32_bf16 v[76:79], a[192:195], v[244:247], v[76:79]
    s_cmp_eq_u32 s44, 11
    s_cselect_b32 s55, s76, 10240
    v_mfma_f32_16x16x32_bf16 v[80:83], a[192:195], v[248:251], v[80:83]
    v_mfma_f32_16x16x32_bf16 v[84:87], a[192:195], v[252:255], v[84:87]
    s_waitcnt lgkmcnt(2)
    v_mfma_f32_16x16x32_bf16 v[88:91], a[196:199], v[232:235], v[88:91]
    ds_read_b128 a[208:211], v62 offset:4096
    v_mfma_f32_16x16x32_bf16 v[92:95], a[196:199], v[236:239], v[92:95]
    s_add_u32 s49, s49, s55
    v_mfma_f32_16x16x32_bf16 v[96:99], a[196:199], v[240:243], v[96:99]
    s_add_u32 s54, s49, 4096
    v_mfma_f32_16x16x32_bf16 v[100:103], a[196:199], v[244:247], v[100:103]
    s_add_u32 s97, s97, 20480
    v_mfma_f32_16x16x32_bf16 v[104:107], a[196:199], v[248:251], v[104:107]
    s_cmp_eq_u32 s97, 163840
    s_cselect_b32 s97, 0, s97
    v_mfma_f32_16x16x32_bf16 v[108:111], a[196:199], v[252:255], v[108:111]
    s_waitcnt lgkmcnt(2)
    v_mfma_f32_16x16x32_bf16 v[112:115], a[200:203], v[232:235], v[112:115]
    ds_read_b128 a[192:195], v63 offset:0
    v_mfma_f32_16x16x32_bf16 v[116:119], a[200:203], v[236:239], v[116:119]
    s_add_u32 m0, s97, s96
    s_add_u32 s56, s48, 20480
    buffer_store_dwordx4 a[252:255], v60, s[20:23], s56 offen offset:2048 sc1
    v_mfma_f32_16x16x32_bf16 v[120:123], a[200:203], v[240:243], v[120:123]
    buffer_load_dwordx4 v8, s[24:27], s49 offen offset:0 sc1 lds
    v_mfma_f32_16x16x32_bf16 v[124:127], a[200:203], v[244:247], v[124:127]
    s_cmp_eq_u32 s44, 14
    s_cselect_b32 s55, s78, 6144
    v_mfma_f32_16x16x32_bf16 v[128:131], a[200:203], v[248:251], v[128:131]
    s_add_u32 s50, s50, s55
    v_mfma_f32_16x16x32_bf16 v[132:135], a[200:203], v[252:255], v[132:135]
    s_waitcnt lgkmcnt(2)
    v_mfma_f32_16x16x32_bf16 v[136:139], a[204:207], v[232:235], v[136:139]
    ds_read_b128 a[196:199], v63 offset:1024
    v_mfma_f32_16x16x32_bf16 v[140:143], a[204:207], v[236:239], v[140:143]
    buffer_load_dwordx4 v[208:211], v10, s[20:23], s50 offen offset:0 sc1
    v_mfma_f32_16x16x32_bf16 v[144:147], a[204:207], v[240:243], v[144:147]
    v_mfma_f32_16x16x32_bf16 v[148:151], a[204:207], v[244:247], v[148:151]
    v_mfma_f32_16x16x32_bf16 v[152:155], a[204:207], v[248:251], v[152:155]
    buffer_load_dwordx4 v[212:215], v10, s[20:23], s50 offen offset:1024 sc1
    v_mfma_f32_16x16x32_bf16 v[156:159], a[204:207], v[252:255], v[156:159]
    s_waitcnt lgkmcnt(2)
    v_mfma_f32_16x16x32_bf16 v[160:163], a[208:211], v[232:235], v[160:163]
    ds_read_b128 a[200:203], v63 offset:2048
    v_mfma_f32_16x16x32_bf16 v[164:167], a[208:211], v[236:239], v[164:167]
    buffer_load_dwordx4 v8, s[24:27], s49 offen offset:1024 sc1 lds
    v_mfma_f32_16x16x32_bf16 v[168:171], a[208:211], v[240:243], v[168:171]
    v_mfma_f32_16x16x32_bf16 v[172:175], a[208:211], v[244:247], v[172:175]
    v_mfma_f32_16x16x32_bf16 v[176:179], a[208:211], v[248:251], v[176:179]
    buffer_load_dwordx4 v[216:219], v10, s[20:23], s50 offen offset:2048 sc1
    v_mfma_f32_16x16x32_bf16 v[180:183], a[208:211], v[252:255], v[180:183]
    s_waitcnt lgkmcnt(2)
    v_mfma_f32_16x16x32_bf16 a[0:3], a[192:195], v[232:235], a[0:3]
    ds_read_b128 a[204:207], v63 offset:3072
    v_mfma_f32_16x16x32_bf16 a[4:7], a[192:195], v[236:239], a[4:7]
    s_add_u32 s56, s48, 4096
    buffer_store_dwordx4 a[160:163], v60, s[20:23], s56 offen offset:1024 sc1
    v_mfma_f32_16x16x32_bf16 a[8:11], a[192:195], v[240:243], a[8:11]
    s_add_u32 s99, s99, 20480
    v_mfma_f32_16x16x32_bf16 a[12:15], a[192:195], v[244:247], a[12:15]
    v_mfma_f32_16x16x32_bf16 a[16:19], a[192:195], v[248:251], a[16:19]
    s_cmp_eq_u32 s99, 163840
    s_cselect_b32 s52, s95, 20480
    s_cselect_b32 s99, 0, s99
    v_mfma_f32_16x16x32_bf16 a[20:23], a[192:195], v[252:255], a[20:23]
    buffer_load_dwordx4 v8, s[24:27], s49 offen offset:2048 sc1 lds
    s_waitcnt lgkmcnt(2)
    v_mfma_f32_16x16x32_bf16 a[24:27], a[196:199], v[232:235], a[24:27]
    ds_read_b128 a[208:211], v63 offset:4096
    v_mfma_f32_16x16x32_bf16 a[28:31], a[196:199], v[236:239], a[28:31]
    v_mfma_f32_16x16x32_bf16 a[32:35], a[196:199], v[240:243], a[32:35]
    v_add_u32 v62, s52, v62
    v_add_u32 v63, s52, v63
    v_mfma_f32_16x16x32_bf16 a[36:39], a[196:199], v[244:247], a[36:39]
    v_mfma_f32_16x16x32_bf16 a[40:43], a[196:199], v[248:251], a[40:43]
    buffer_load_dwordx4 v[220:223], v11, s[20:23], s50 offen offset:0 sc1
    v_mfma_f32_16x16x32_bf16 a[44:47], a[196:199], v[252:255], a[44:47]
    s_waitcnt lgkmcnt(2)
    v_mfma_f32_16x16x32_bf16 a[48:51], a[200:203], v[232:235], a[48:51]
    ds_read_b128 a[192:195], v62 offset:0
    v_mfma_f32_16x16x32_bf16 a[52:55], a[200:203], v[236:239], a[52:55]
    buffer_load_dwordx4 v[224:227], v11, s[20:23], s50 offen offset:1024 sc1
    v_mfma_f32_16x16x32_bf16 a[56:59], a[200:203], v[240:243], a[56:59]
    v_mfma_f32_16x16x32_bf16 a[60:63], a[200:203], v[244:247], a[60:63]
    v_mfma_f32_16x16x32_bf16 a[64:67], a[200:203], v[248:251], a[64:67]
    buffer_load_dwordx4 v8, s[24:27], s49 offen offset:3072 sc1 lds
    v_mfma_f32_16x16x32_bf16 a[68:71], a[200:203], v[252:255], a[68:71]
    s_waitcnt lgkmcnt(2)
    v_mfma_f32_16x16x32_bf16 a[72:75], a[204:207], v[232:235], a[72:75]
    ds_read_b128 a[196:199], v62 offset:1024
    v_mfma_f32_16x16x32_bf16 a[76:79], a[204:207], v[236:239], a[76:79]
    s_add_u32 s56, s48, 8192
    buffer_store_dwordx4 a[168:171], v60, s[20:23], s56 offen offset:3072 sc1
    v_mfma_f32_16x16x32_bf16 a[80:83], a[204:207], v[240:243], a[80:83]
    v_mfma_f32_16x16x32_bf16 a[84:87], a[204:207], v[244:247], a[84:87]
    buffer_load_dwordx4 v[228:231], v11, s[20:23], s50 offen offset:2048 sc1
    v_mfma_f32_16x16x32_bf16 a[88:91], a[204:207], v[248:251], a[88:91]
    v_mfma_f32_16x16x32_bf16 a[92:95], a[204:207], v[252:255], a[92:95]
    s_waitcnt lgkmcnt(2)
    v_mfma_f32_16x16x32_bf16 a[96:99], a[208:211], v[232:235], a[96:99]
    ds_read_b128 a[200:203], v62 offset:2048
    v_mfma_f32_16x16x32_bf16 a[100:103], a[208:211], v[236:239], a[100:103]
    s_add_u32 m0, m0, 4096
    v_mfma_f32_16x16x32_bf16 a[104:107], a[208:211], v[240:243], a[104:107]
    buffer_load_dwordx4 v8, s[24:27], s54 offen offset:0 sc1 lds
    v_mfma_f32_16x16x32_bf16 a[108:111], a[208:211], v[244:247], a[108:111]
    s_add_u32 s44, s44, 1
    v_mfma_f32_16x16x32_bf16 a[112:115], a[208:211], v[248:251], a[112:115]
    s_waitcnt vmcnt(16)
    v_mfma_f32_16x16x32_bf16 a[116:119], a[208:211], v[252:255], a[116:119]
    s_waitcnt lgkmcnt(2)
    v_mfma_f32_16x16x32_bf16 v[64:67], a[192:195], v[184:187], v[64:67]
    ds_read_b128 a[204:207], v62 offset:3072
    v_mfma_f32_16x16x32_bf16 v[68:71], a[192:195], v[188:191], v[68:71]
    v_mfma_f32_16x16x32_bf16 v[72:75], a[192:195], v[192:195], v[72:75]
    v_mfma_f32_16x16x32_bf16 v[76:79], a[192:195], v[196:199], v[76:79]
    s_cmp_eq_u32 s44, 11
    s_cselect_b32 s55, s76, 10240
    v_mfma_f32_16x16x32_bf16 v[80:83], a[192:195], v[200:203], v[80:83]
    v_mfma_f32_16x16x32_bf16 v[84:87], a[192:195], v[204:207], v[84:87]
    s_waitcnt lgkmcnt(2)
    v_mfma_f32_16x16x32_bf16 v[88:91], a[196:199], v[184:187], v[88:91]
    ds_read_b128 a[208:211], v62 offset:4096
    v_mfma_f32_16x16x32_bf16 v[92:95], a[196:199], v[188:191], v[92:95]
    s_add_u32 s49, s49, s55
    s_add_u32 s56, s48, 16384
    buffer_store_dwordx4 a[176:179], v60, s[20:23], s56 offen offset:1024 sc1
    v_mfma_f32_16x16x32_bf16 v[96:99], a[196:199], v[192:195], v[96:99]
    s_add_u32 s54, s49, 4096
    v_mfma_f32_16x16x32_bf16 v[100:103], a[196:199], v[196:199], v[100:103]
    s_add_u32 s97, s97, 20480
    v_mfma_f32_16x16x32_bf16 v[104:107], a[196:199], v[200:203], v[104:107]
    s_cmp_eq_u32 s97, 163840
    s_cselect_b32 s97, 0, s97
    v_mfma_f32_16x16x32_bf16 v[108:111], a[196:199], v[204:207], v[108:111]
    s_waitcnt lgkmcnt(2)
    v_mfma_f32_16x16x32_bf16 v[112:115], a[200:203], v[184:187], v[112:115]
    ds_read_b128 a[192:195], v63 offset:0
    v_mfma_f32_16x16x32_bf16 v[116:119], a[200:203], v[188:191], v[116:119]
    s_add_u32 m0, s97, s96
    v_mfma_f32_16x16x32_bf16 v[120:123], a[200:203], v[192:195], v[120:123]
    buffer_load_dwordx4 v8, s[24:27], s49 offen offset:0 sc1 lds
    v_mfma_f32_16x16x32_bf16 v[124:127], a[200:203], v[196:199], v[124:127]
    s_cmp_eq_u32 s44, 14
    s_cselect_b32 s55, s78, 6144
    v_mfma_f32_16x16x32_bf16 v[128:131], a[200:203], v[200:203], v[128:131]
    s_add_u32 s50, s50, s55
    v_mfma_f32_16x16x32_bf16 v[132:135], a[200:203], v[204:207], v[132:135]
    s_waitcnt lgkmcnt(2)
    v_mfma_f32_16x16x32_bf16 v[136:139], a[204:207], v[184:187], v[136:139]
    ds_read_b128 a[196:199], v63 offset:1024
    v_mfma_f32_16x16x32_bf16 v[140:143], a[204:207], v[188:191], v[140:143]
    buffer_load_dwordx4 v[232:235], v10, s[20:23], s50 offen offset:0 sc1
    v_mfma_f32_16x16x32_bf16 v[144:147], a[204:207], v[192:195], v[144:147]
    v_mfma_f32_16x16x32_bf16 v[148:151], a[204:207], v[196:199], v[148:151]
    v_mfma_f32_16x16x32_bf16 v[152:155], a[204:207], v[200:203], v[152:155]
    buffer_load_dwordx4 v[236:239], v10, s[20:23], s50 offen offset:1024 sc1
    v_mfma_f32_16x16x32_bf16 v[156:159], a[204:207], v[204:207], v[156:159]
    s_waitcnt lgkmcnt(2)
    v_mfma_f32_16x16x32_bf16 v[160:163], a[208:211], v[184:187], v[160:163]
    ds_read_b128 a[200:203], v63 offset:2048
    v_mfma_f32_16x16x32_bf16 v[164:167], a[208:211], v[188:191], v[164:167]
    buffer_load_dwordx4 v8, s[24:27], s49 offen offset:1024 sc1 lds
    v_mfma_f32_16x16x32_bf16 v[168:171], a[208:211], v[192:195], v[168:171]
    s_add_u32 s56, s48, 20480
    buffer_store_dwordx4 a[184:187], v60, s[20:23], s56 offen offset:3072 sc1
    v_mfma_f32_16x16x32_bf16 v[172:175], a[208:211], v[196:199], v[172:175]
    v_mfma_f32_16x16x32_bf16 v[176:179], a[208:211], v[200:203], v[176:179]
    buffer_load_dwordx4 v[240:243], v10, s[20:23], s50 offen offset:2048 sc1
    v_mfma_f32_16x16x32_bf16 v[180:183], a[208:211], v[204:207], v[180:183]
    s_waitcnt lgkmcnt(2)
    v_mfma_f32_16x16x32_bf16 a[0:3], a[192:195], v[184:187], a[0:3]
    ds_read_b128 a[204:207], v63 offset:3072
    v_mfma_f32_16x16x32_bf16 a[4:7], a[192:195], v[188:191], a[4:7]
    v_mfma_f32_16x16x32_bf16 a[8:11], a[192:195], v[192:195], a[8:11]
    s_add_u32 s99, s99, 20480
    v_mfma_f32_16x16x32_bf16 a[12:15], a[192:195], v[196:199], a[12:15]
    v_mfma_f32_16x16x32_bf16 a[16:19], a[192:195], v[200:203], a[16:19]
    s_cmp_eq_u32 s99, 163840
    s_cselect_b32 s52, s95, 20480
    s_cselect_b32 s99, 0, s99
    v_mfma_f32_16x16x32_bf16 a[20:23], a[192:195], v[204:207], a[20:23]
    buffer_load_dwordx4 v8, s[24:27], s49 offen offset:2048 sc1 lds
    s_waitcnt lgkmcnt(2)
    v_mfma_f32_16x16x32_bf16 a[24:27], a[196:199], v[184:187], a[24:27]
    ds_read_b128 a[208:211], v63 offset:4096
    v_mfma_f32_16x16x32_bf16 a[28:31], a[196:199], v[188:191], a[28:31]
    v_mfma_f32_16x16x32_bf16 a[32:35], a[196:199], v[192:195], a[32:35]
    v_add_u32 v62, s52, v62
    v_add_u32 v63, s52, v63
    v_mfma_f32_16x16x32_bf16 a[36:39], a[196:199], v[196:199], a[36:39]
    v_mfma_f32_16x16x32_bf16 a[40:43], a[196:199], v[200:203], a[40:43]
    buffer_load_dwordx4 v[244:247], v11, s[20:23], s50 offen offset:0 sc1
    v_mfma_f32_16x16x32_bf16 a[44:47], a[196:199], v[204:207], a[44:47]
    s_waitcnt lgkmcnt(2)
    v_mfma_f32_16x16x32_bf16 a[48:51], a[200:203], v[184:187], a[48:51]
    ds_read_b128 a[192:195], v62 offset:0
    v_mfma_f32_16x16x32_bf16 a[52:55], a[200:203], v[188:191], a[52:55]
    buffer_load_dwordx4 v[248:251], v11, s[20:23], s50 offen offset:1024 sc1
    v_mfma_f32_16x16x32_bf16 a[56:59], a[200:203], v[192:195], a[56:59]
    v_mfma_f32_16x16x32_bf16 a[60:63], a[200:203], v[196:199], a[60:63]
    v_mfma_f32_16x16x32_bf16 a[64:67], a[200:203], v[200:203], a[64:67]
    buffer_load_dwordx4 v8, s[24:27], s49 offen offset:3072 sc1 lds
    v_mfma_f32_16x16x32_bf16 a[68:71], a[200:203], v[204:207], a[68:71]
    s_waitcnt lgkmcnt(2)
    v_mfma_f32_16x16x32_bf16 a[72:75], a[204:207], v[184:187], a[72:75]
    ds_read_b128 a[196:199], v62 offset:1024
    v_mfma_f32_16x16x32_bf16 a[76:79], a[204:207], v[188:191], a[76:79]
    v_mfma_f32_16x16x32_bf16 a[80:83], a[204:207], v[192:195], a[80:83]
    v_mfma_f32_16x16x32_bf16 a[84:87], a[204:207], v[196:199], a[84:87]
    buffer_load_dwordx4 v[252:255], v11, s[20:23], s50 offen offset:2048 sc1
    v_mfma_f32_16x16x32_bf16 a[88:91], a[204:207], v[200:203], a[88:91]
    v_mfma_f32_16x16x32_bf16 a[92:95], a[204:207], v[204:207], a[92:95]
    s_waitcnt lgkmcnt(2)
    v_mfma_f32_16x16x32_bf16 a[96:99], a[208:211], v[184:187], a[96:99]
    ds_read_b128 a[200:203], v62 offset:2048
    v_mfma_f32_16x16x32_bf16 a[100:103], a[208:211], v[188:191], a[100:103]
    s_add_u32 m0, m0, 4096
    v_mfma_f32_16x16x32_bf16 a[104:107], a[208:211], v[192:195], a[104:107]
    buffer_load_dwordx4 v8, s[24:27], s54 offen offset:0 sc1 lds
    v_mfma_f32_16x16x32_bf16 a[108:111], a[208:211], v[196:199], a[108:111]
    s_add_u32 s44, s44, 1
    v_mfma_f32_16x16x32_bf16 a[112:115], a[208:211], v[200:203], a[112:115]
    s_waitcnt vmcnt(14)
    v_mfma_f32_16x16x32_bf16 a[116:119], a[208:211], v[204:207], a[116:119]
    s_waitcnt lgkmcnt(2)
    v_mfma_f32_16x16x32_bf16 v[64:67], a[192:195], v[208:211], v[64:67]
    ds_read_b128 a[204:207], v62 offset:3072
    v_mfma_f32_16x16x32_bf16 v[68:71], a[192:195], v[212:215], v[68:71]
    v_mfma_f32_16x16x32_bf16 v[72:75], a[192:195], v[216:219], v[72:75]
    v_mfma_f32_16x16x32_bf16 v[76:79], a[192:195], v[220:223], v[76:79]
    s_cmp_eq_u32 s44, 11
    s_cselect_b32 s55, s76, 10240
    v_mfma_f32_16x16x32_bf16 v[80:83], a[192:195], v[224:227], v[80:83]
    v_mfma_f32_16x16x32_bf16 v[84:87], a[192:195], v[228:231], v[84:87]
    s_waitcnt lgkmcnt(2)
    v_mfma_f32_16x16x32_bf16 v[88:91], a[196:199], v[208:211], v[88:91]
    ds_read_b128 a[208:211], v62 offset:4096
    v_mfma_f32_16x16x32_bf16 v[92:95], a[196:199], v[212:215], v[92:95]
    s_add_u32 s49, s49, s55
    v_mfma_f32_16x16x32_bf16 v[96:99], a[196:199], v[216:219], v[96:99]
    s_add_u32 s54, s49, 4096
    v_mfma_f32_16x16x32_bf16 v[100:103], a[196:199], v[220:223], v[100:103]
    s_add_u32 s97, s97, 20480
    v_mfma_f32_16x16x32_bf16 v[104:107], a[196:199], v[224:227], v[104:107]
    s_cmp_eq_u32 s97, 163840
    s_cselect_b32 s97, 0, s97
    v_mfma_f32_16x16x32_bf16 v[108:111], a[196:199], v[228:231], v[108:111]
    s_waitcnt lgkmcnt(2)
    s_waitcnt vmcnt(7)
    buffer_store_dword v4, v3, s[88:91], s93 offen offset:16 sc1
    v_mfma_f32_16x16x32_bf16 v[112:115], a[200:203], v[208:211], v[112:115]
    ds_read_b128 a[192:195], v63 offset:0
    v_mfma_f32_16x16x32_bf16 v[116:119], a[200:203], v[212:215], v[116:119]
    s_add_u32 m0, s97, s96
    v_mfma_f32_16x16x32_bf16 v[120:123], a[200:203], v[216:219], v[120:123]
    buffer_load_dwordx4 v8, s[24:27], s49 offen offset:0 sc1 lds
    v_mfma_f32_16x16x32_bf16 v[124:127], a[200:203], v[220:223], v[124:127]
    s_cmp_eq_u32 s44, 14
    s_cselect_b32 s55, s78, 6144
    v_mfma_f32_16x16x32_bf16 v[128:131], a[200:203], v[224:227], v[128:131]
    s_add_u32 s50, s50, s55
    v_mfma_f32_16x16x32_bf16 v[132:135], a[200:203], v[228:231], v[132:135]
    s_waitcnt lgkmcnt(2)
    v_mfma_f32_16x16x32_bf16 v[136:139], a[204:207], v[208:211], v[136:139]
    ds_read_b128 a[196:199], v63 offset:1024
    v_mfma_f32_16x16x32_bf16 v[140:143], a[204:207], v[212:215], v[140:143]
    buffer_load_dwordx4 v[184:187], v10, s[20:23], s50 offen offset:0 sc1
    v_mfma_f32_16x16x32_bf16 v[144:147], a[204:207], v[216:219], v[144:147]
    v_mfma_f32_16x16x32_bf16 v[148:151], a[204:207], v[220:223], v[148:151]
    v_mfma_f32_16x16x32_bf16 v[152:155], a[204:207], v[224:227], v[152:155]
    buffer_load_dwordx4 v[188:191], v10, s[20:23], s50 offen offset:1024 sc1
    v_mfma_f32_16x16x32_bf16 v[156:159], a[204:207], v[228:231], v[156:159]
    s_waitcnt lgkmcnt(2)
    v_mfma_f32_16x16x32_bf16 v[160:163], a[208:211], v[208:211], v[160:163]
    ds_read_b128 a[200:203], v63 offset:2048
    v_mfma_f32_16x16x32_bf16 v[164:167], a[208:211], v[212:215], v[164:167]
    buffer_load_dwordx4 v8, s[24:27], s49 offen offset:1024 sc1 lds
    v_mfma_f32_16x16x32_bf16 v[168:171], a[208:211], v[216:219], v[168:171]
    v_mfma_f32_16x16x32_bf16 v[172:175], a[208:211], v[220:223], v[172:175]
    v_mfma_f32_16x16x32_bf16 v[176:179], a[208:211], v[224:227], v[176:179]
    buffer_load_dwordx4 v[192:195], v10, s[20:23], s50 offen offset:2048 sc1
    v_mfma_f32_16x16x32_bf16 v[180:183], a[208:211], v[228:231], v[180:183]
    s_waitcnt lgkmcnt(2)
    v_mfma_f32_16x16x32_bf16 a[0:3], a[192:195], v[208:211], a[0:3]
    ds_read_b128 a[204:207], v63 offset:3072
    v_mfma_f32_16x16x32_bf16 a[4:7], a[192:195], v[212:215], a[4:7]
    v_mfma_f32_16x16x32_bf16 a[8:11], a[192:195], v[216:219], a[8:11]
    s_add_u32 s99, s99, 20480
    v_mfma_f32_16x16x32_bf16 a[12:15], a[192:195], v[220:223], a[12:15]
    v_mfma_f32_16x16x32_bf16 a[16:19], a[192:195], v[224:227], a[16:19]
    s_cmp_eq_u32 s99, 163840
    s_cselect_b32 s52, s95, 20480
    s_cselect_b32 s99, 0, s99
    v_mfma_f32_16x16x32_bf16 a[20:23], a[192:195], v[228:231], a[20:23]
    buffer_load_dwordx4 v8, s[24:27], s49 offen offset:2048 sc1 lds
    s_waitcnt lgkmcnt(2)
    v_mfma_f32_16x16x32_bf16 a[24:27], a[196:199], v[208:211], a[24:27]
    ds_read_b128 a[208:211], v63 offset:4096
    v_mfma_f32_16x16x32_bf16 a[28:31], a[196:199], v[212:215], a[28:31]
    v_mfma_f32_16x16x32_bf16 a[32:35], a[196:199], v[216:219], a[32:35]
    v_add_u32 v62, s52, v62
    v_add_u32 v63, s52, v63
    v_mfma_f32_16x16x32_bf16 a[36:39], a[196:199], v[220:223], a[36:39]
    v_mfma_f32_16x16x32_bf16 a[40:43], a[196:199], v[224:227], a[40:43]
    buffer_load_dwordx4 v[196:199], v11, s[20:23], s50 offen offset:0 sc1
    v_mfma_f32_16x16x32_bf16 a[44:47], a[196:199], v[228:231], a[44:47]
    s_waitcnt lgkmcnt(2)
    v_mfma_f32_16x16x32_bf16 a[48:51], a[200:203], v[208:211], a[48:51]
    ds_read_b128 a[192:195], v62 offset:0
    v_mfma_f32_16x16x32_bf16 a[52:55], a[200:203], v[212:215], a[52:55]
    buffer_load_dwordx4 v[200:203], v11, s[20:23], s50 offen offset:1024 sc1
    v_mfma_f32_16x16x32_bf16 a[56:59], a[200:203], v[216:219], a[56:59]
    v_mfma_f32_16x16x32_bf16 a[60:63], a[200:203], v[220:223], a[60:63]
    v_mfma_f32_16x16x32_bf16 a[64:67], a[200:203], v[224:227], a[64:67]
    buffer_load_dwordx4 v8, s[24:27], s49 offen offset:3072 sc1 lds
    v_mfma_f32_16x16x32_bf16 a[68:71], a[200:203], v[228:231], a[68:71]
    s_waitcnt lgkmcnt(2)
    v_mfma_f32_16x16x32_bf16 a[72:75], a[204:207], v[208:211], a[72:75]
    ds_read_b128 a[196:199], v62 offset:1024
    v_mfma_f32_16x16x32_bf16 a[76:79], a[204:207], v[212:215], a[76:79]
    v_mfma_f32_16x16x32_bf16 a[80:83], a[204:207], v[216:219], a[80:83]
    v_mfma_f32_16x16x32_bf16 a[84:87], a[204:207], v[220:223], a[84:87]
    buffer_load_dwordx4 v[204:207], v11, s[20:23], s50 offen offset:2048 sc1
    v_mfma_f32_16x16x32_bf16 a[88:91], a[204:207], v[224:227], a[88:91]
    v_mfma_f32_16x16x32_bf16 a[92:95], a[204:207], v[228:231], a[92:95]
    s_waitcnt lgkmcnt(2)
    v_mfma_f32_16x16x32_bf16 a[96:99], a[208:211], v[208:211], a[96:99]
    ds_read_b128 a[200:203], v62 offset:2048
    v_mfma_f32_16x16x32_bf16 a[100:103], a[208:211], v[212:215], a[100:103]
    s_add_u32 m0, m0, 4096
    v_mfma_f32_16x16x32_bf16 a[104:107], a[208:211], v[216:219], a[104:107]
    buffer_load_dwordx4 v8, s[24:27], s54 offen offset:0 sc1 lds
    v_mfma_f32_16x16x32_bf16 a[108:111], a[208:211], v[220:223], a[108:111]
    s_add_u32 s44, s44, 1
    v_mfma_f32_16x16x32_bf16 a[112:115], a[208:211], v[224:227], a[112:115]
    s_waitcnt vmcnt(13)
    v_mfma_f32_16x16x32_bf16 a[116:119], a[208:211], v[228:231], a[116:119]
    s_waitcnt lgkmcnt(2)
L_oploop:
    s_cmp_eq_u32 s44, 11
    s_cbranch_scc1 L_oparm
    s_cmp_eq_u32 s44, 14
    s_cbranch_scc1 L_oppoll
L_opbody:
    v_mfma_f32_16x16x32_bf16 v[64:67], a[192:195], v[232:235], v[64:67]
    ds_read_b128 a[204:207], v62 offset:3072
    v_mfma_f32_16x16x32_bf16 v[68:71], a[192:195], v[236:239], v[68:71]
    s_waitcnt vmcnt(11)
    v_mfma_f32_16x16x32_bf16 v[72:75], a[192:195], v[240:243], v[72:75]
    s_barrier
    v_mfma_f32_16x16x32_bf16 v[76:79], a[192:195], v[244:247], v[76:79]
    s_cmp_eq_u32 s44, 11
    s_cselect_b32 s55, s76, 10240
    v_mfma_f32_16x16x32_bf16 v[80:83], a[192:195], v[248:251], v[80:83]
    v_mfma_f32_16x16x32_bf16 v[84:87], a[192:195], v[252:255], v[84:87]
    s_waitcnt lgkmcnt(2)
    v_mfma_f32_16x16x32_bf16 v[88:91], a[196:199], v[232:235], v[88:91]
    ds_read_b128 a[208:211], v62 offset:4096
    v_mfma_f32_16x16x32_bf16 v[92:95], a[196:199], v[236:239], v[92:95]
    s_add_u32 s49, s49, s55
    v_mfma_f32_16x16x32_bf16 v[96:99], a[196:199], v[240:243], v[96:99]
    s_add_u32 s54, s49, 4096
    v_mfma_f32_16x16x32_bf16 v[100:103], a[196:199], v[244:247], v[100:103]
    s_add_u32 s97, s97, 20480
    v_mfma_f32_16x16x32_bf16 v[104:107], a[196:199], v[248:251], v[104:107]
    s_cmp_eq_u32 s97, 163840
    s_cselect_b32 s97, 0, s97
    v_mfma_f32_16x16x32_bf16 v[108:111], a[196:199], v[252:255], v[108:111]
    s_waitcnt lgkmcnt(2)
    v_mfma_f32_16x16x32_bf16 v[112:115], a[200:203], v[232:235], v[112:115]
    ds_read_b128 a[192:195], v63 offset:0
    v_mfma_f32_16x16x32_bf16 v[116:119], a[200:203], v[236:239], v[116:119]
    s_add_u32 m0, s97, s96
    v_mfma_f32_16x16x32_bf16 v[120:123], a[200:203], v[240:243], v[120:123]
    buffer_load_dwordx4 v8, s[24:27], s49 offen offset:0 sc1 lds
    v_mfma_f32_16x16x32_bf16 v[124:127], a[200:203], v[244:247], v[124:127]
    s_cmp_eq_u32 s44, 14
    s_cselect_b32 s55, s78, 6144
    v_mfma_f32_16x16x32_bf16 v[128:131], a[200:203], v[248:251], v[128:131]
    s_add_u32 s50, s50, s55
    v_mfma_f32_16x16x32_bf16 v[132:135], a[200:203], v[252:255], v[132:135]
    s_waitcnt lgkmcnt(2)
    v_mfma_f32_16x16x32_bf16 v[136:139], a[204:207], v[232:235], v[136:139]
    ds_read_b128 a[196:199], v63 offset:1024
    v_mfma_f32_16x16x32_bf16 v[140:143], a[204:207], v[236:239], v[140:143]
    buffer_load_dwordx4 v[208:211], v10, s[20:23], s50 offen offset:0 sc1
    v_mfma_f32_16x16x32_bf16 v[144:147], a[204:207], v[240:243], v[144:147]
    v_mfma_f32_16x16x32_bf16 v[148:151], a[204:207], v[244:247], v[148:151]
    v_mfma_f32_16x16x32_bf16 v[152:155], a[204:207], v[248:251], v[152:155]
    buffer_load_dwordx4 v[212:215], v10, s[20:23], s50 offen offset:1024 sc1
    v_mfma_f32_16x16x32_bf16 v[156:159], a[204:207], v[252:255], v[156:159]
    s_waitcnt lgkmcnt(2)
    v_mfma_f32_16x16x32_bf16 v[160:163], a[208:211], v[232:235], v[160:163]
    ds_read_b128 a[200:203], v63 offset:2048
    v_mfma_f32_16x16x32_bf16 v[164:167], a[208:211], v[236:239], v[164:167]
    buffer_load_dwordx4 v8, s[24:27], s49 offen offset:1024 sc1 lds
    v_mfma_f32_16x16x32_bf16 v[168:171], a[208:211], v[240:243], v[168:171]
    v_mfma_f32_16x16x32_bf16 v[172:175], a[208:211], v[244:247], v[172:175]
    v_mfma_f32_16x16x32_bf16 v[176:179], a[208:211], v[248:251], v[176:179]
    buffer_load_dwordx4 v[216:219], v10, s[20:23], s50 offen offset:2048 sc1
    v_mfma_f32_16x16x32_bf16 v[180:183], a[208:211], v[252:255], v[180:183]
    s_waitcnt lgkmcnt(2)
    v_mfma_f32_16x16x32_bf16 a[0:3], a[192:195], v[232:235], a[0:3]
    ds_read_b128 a[204:207], v63 offset:3072
    v_mfma_f32_16x16x32_bf16 a[4:7], a[192:195], v[236:239], a[4:7]
    v_mfma_f32_16x16x32_bf16 a[8:11], a[192:195], v[240:243], a[8:11]
    s_add_u32 s99, s99, 20480
    v_mfma_f32_16x16x32_bf16 a[12:15], a[192:195], v[244:247], a[12:15]
    v_mfma_f32_16x16x32_bf16 a[16:19], a[192:195], v[248:251], a[16:19]
    s_cmp_eq_u32 s99, 163840
    s_cselect_b32 s52, s95, 20480
    s_cselect_b32 s99, 0, s99
    v_mfma_f32_16x16x32_bf16 a[20:23], a[192:195], v[252:255], a[20:23]
    buffer_load_dwordx4 v8, s[24:27], s49 offen offset:2048 sc1 lds
    s_waitcnt lgkmcnt(2)
    v_mfma_f32_16x16x32_bf16 a[24:27], a[196:199], v[232:235], a[24:27]
    ds_read_b128 a[208:211], v63 offset:4096
    v_mfma_f32_16x16x32_bf16 a[28:31], a[196:199], v[236:239], a[28:31]
    v_mfma_f32_16x16x32_bf16 a[32:35], a[196:199], v[240:243], a[32:35]
    v_add_u32 v62, s52, v62
    v_add_u32 v63, s52, v63
    v_mfma_f32_16x16x32_bf16 a[36:39], a[196:199], v[244:247], a[36:39]
    v_mfma_f32_16x16x32_bf16 a[40:43], a[196:199], v[248:251], a[40:43]
    buffer_load_dwordx4 v[220:223], v11, s[20:23], s50 offen offset:0 sc1
    v_mfma_f32_16x16x32_bf16 a[44:47], a[196:199], v[252:255], a[44:47]
    s_waitcnt lgkmcnt(2)
    v_mfma_f32_16x16x32_bf16 a[48:51], a[200:203], v[232:235], a[48:51]
    ds_read_b128 a[192:195], v62 offset:0
    v_mfma_f32_16x16x32_bf16 a[52:55], a[200:203], v[236:239], a[52:55]
    buffer_load_dwordx4 v[224:227], v11, s[20:23], s50 offen offset:1024 sc1
    v_mfma_f32_16x16x32_bf16 a[56:59], a[200:203], v[240:243], a[56:59]
    v_mfma_f32_16x16x32_bf16 a[60:63], a[200:203], v[244:247], a[60:63]
    v_mfma_f32_16x16x32_bf16 a[64:67], a[200:203], v[248:251], a[64:67]
    buffer_load_dwordx4 v8, s[24:27], s49 offen offset:3072 sc1 lds
    v_mfma_f32_16x16x32_bf16 a[68:71], a[200:203], v[252:255], a[68:71]
    s_waitcnt lgkmcnt(2)
    v_mfma_f32_16x16x32_bf16 a[72:75], a[204:207], v[232:235], a[72:75]
    ds_read_b128 a[196:199], v62 offset:1024
    v_mfma_f32_16x16x32_bf16 a[76:79], a[204:207], v[236:239], a[76:79]
    v_mfma_f32_16x16x32_bf16 a[80:83], a[204:207], v[240:243], a[80:83]
    v_mfma_f32_16x16x32_bf16 a[84:87], a[204:207], v[244:247], a[84:87]
    buffer_load_dwordx4 v[228:231], v11, s[20:23], s50 offen offset:2048 sc1
    v_mfma_f32_16x16x32_bf16 a[88:91], a[204:207], v[248:251], a[88:91]
    v_mfma_f32_16x16x32_bf16 a[92:95], a[204:207], v[252:255], a[92:95]
    s_waitcnt lgkmcnt(2)
    v_mfma_f32_16x16x32_bf16 a[96:99], a[208:211], v[232:235], a[96:99]
    ds_read_b128 a[200:203], v62 offset:2048
    v_mfma_f32_16x16x32_bf16 a[100:103], a[208:211], v[236:239], a[100:103]
    s_add_u32 m0, m0, 4096
    v_mfma_f32_16x16x32_bf16 a[104:107], a[208:211], v[240:243], a[104:107]
    buffer_load_dwordx4 v8, s[24:27], s54 offen offset:0 sc1 lds
    v_mfma_f32_16x16x32_bf16 a[108:111], a[208:211], v[244:247], a[108:111]
    s_add_u32 s44, s44, 1
    v_mfma_f32_16x16x32_bf16 a[112:115], a[208:211], v[248:251], a[112:115]
    s_waitcnt vmcnt(12)
    v_mfma_f32_16x16x32_bf16 a[116:119], a[208:211], v[252:255], a[116:119]
    s_waitcnt lgkmcnt(2)
    v_mfma_f32_16x16x32_bf16 v[64:67], a[192:195], v[184:187], v[64:67]
    ds_read_b128 a[204:207], v62 offset:3072
    v_mfma_f32_16x16x32_bf16 v[68:71], a[192:195], v[188:191], v[68:71]
    v_mfma_f32_16x16x32_bf16 v[72:75], a[192:195], v[192:195], v[72:75]
    v_mfma_f32_16x16x32_bf16 v[76:79], a[192:195], v[196:199], v[76:79]
    s_cmp_eq_u32 s44, 11
    s_cselect_b32 s55, s76, 10240
    v_mfma_f32_16x16x32_bf16 v[80:83], a[192:195], v[200:203], v[80:83]
    v_mfma_f32_16x16x32_bf16 v[84:87], a[192:195], v[204:207], v[84:87]
    s_waitcnt lgkmcnt(2)
    v_mfma_f32_16x16x32_bf16 v[88:91], a[196:199], v[184:187], v[88:91]
    ds_read_b128 a[208:211], v62 offset:4096
    v_mfma_f32_16x16x32_bf16 v[92:95], a[196:199], v[188:191], v[92:95]
    s_add_u32 s49, s49, s55
    v_mfma_f32_16x16x32_bf16 v[96:99], a[196:199], v[192:195], v[96:99]
    s_add_u32 s54, s49, 4096
    v_mfma_f32_16x16x32_bf16 v[100:103], a[196:199], v[196:199], v[100:103]
    s_add_u32 s97, s97, 20480
    v_mfma_f32_16x16x32_bf16 v[104:107], a[196:199], v[200:203], v[104:107]
    s_cmp_eq_u32 s97, 163840
    s_cselect_b32 s97, 0, s97
    v_mfma_f32_16x16x32_bf16 v[108:111], a[196:199], v[204:207], v[108:111]
    s_waitcnt lgkmcnt(2)
    v_mfma_f32_16x16x32_bf16 v[112:115], a[200:203], v[184:187], v[112:115]
    ds_read_b128 a[192:195], v63 offset:0
    v_mfma_f32_16x16x32_bf16 v[116:119], a[200:203], v[188:191], v[116:119]
    s_add_u32 m0, s97, s96
    v_mfma_f32_16x16x32_bf16 v[120:123], a[200:203], v[192:195], v[120:123]
    buffer_load_dwordx4 v8, s[24:27], s49 offen offset:0 sc1 lds
    v_mfma_f32_16x16x32_bf16 v[124:127], a[200:203], v[196:199], v[124:127]
    s_cmp_eq_u32 s44, 14
    s_cselect_b32 s55, s78, 6144
    v_mfma_f32_16x16x32_bf16 v[128:131], a[200:203], v[200:203], v[128:131]
    s_add_u32 s50, s50, s55
    v_mfma_f32_16x16x32_bf16 v[132:135], a[200:203], v[204:207], v[132:135]
    buffer_load_dword v61, v2, s[88:91], s79 offen sc1
    s_waitcnt lgkmcnt(2)
    v_mfma_f32_16x16x32_bf16 v[136:139], a[204:207], v[184:187], v[136:139]
    ds_read_b128 a[196:199], v63 offset:1024
    v_mfma_f32_16x16x32_bf16 v[140:143], a[204:207], v[188:191], v[140:143]
    buffer_load_dwordx4 v[232:235], v10, s[20:23], s50 offen offset:0 sc1
    v_mfma_f32_16x16x32_bf16 v[144:147], a[204:207], v[192:195], v[144:147]
    v_mfma_f32_16x16x32_bf16 v[148:151], a[204:207], v[196:199], v[148:151]
    v_mfma_f32_16x16x32_bf16 v[152:155], a[204:207], v[200:203], v[152:155]
    buffer_load_dwordx4 v[236:239], v10, s[20:23], s50 offen offset:1024 sc1
    v_mfma_f32_16x16x32_bf16 v[156:159], a[204:207], v[204:207], v[156:159]
    s_waitcnt lgkmcnt(2)
    v_mfma_f32_16x16x32_bf16 v[160:163], a[208:211], v[184:187], v[160:163]
    ds_read_b128 a[200:203], v63 offset:2048
    v_mfma_f32_16x16x32_bf16 v[164:167], a[208:211], v[188:191], v[164:167]
    buffer_load_dwordx4 v8, s[24:27], s49 offen offset:1024 sc1 lds
    v_mfma_f32_16x16x32_bf16 v[168:171], a[208:211], v[192:195], v[168:171]
    v_mfma_f32_16x16x32_bf16 v[172:175], a[208:211], v[196:199], v[172:175]
    v_mfma_f32_16x16x32_bf16 v[176:179], a[208:211], v[200:203], v[176:179]
    buffer_load_dwordx4 v[240:243], v10, s[20:23], s50 offen offset:2048 sc1
    v_mfma_f32_16x16x32_bf16 v[180:183], a[208:211], v[204:207], v[180:183]
    s_waitcnt lgkmcnt(2)
    v_mfma_f32_16x16x32_bf16 a[0:3], a[192:195], v[184:187], a[0:3]
    ds_read_b128 a[204:207], v63 offset:3072
    v_mfma_f32_16x16x32_bf16 a[4:7], a[192:195], v[188:191], a[4:7]
    v_mfma_f32_16x16x32_bf16 a[8:11], a[192:195], v[192:195], a[8:11]
    s_add_u32 s99, s99, 20480
    v_mfma_f32_16x16x32_bf16 a[12:15], a[192:195], v[196:199], a[12:15]
    v_mfma_f32_16x16x32_bf16 a[16:19], a[192:195], v[200:203], a[16:19]
    s_cmp_eq_u32 s99, 163840
    s_cselect_b32 s52, s95, 20480
    s_cselect_b32 s99, 0, s99
    v_mfma_f32_16x16x32_bf16 a[20:23], a[192:195], v[204:207], a[20:23]
    buffer_load_dwordx4 v8, s[24:27], s49 offen offset:2048 sc1 lds
    s_waitcnt lgkmcnt(2)
    v_mfma_f32_16x16x32_bf16 a[24:27], a[196:199], v[184:187], a[24:27]
    ds_read_b128 a[208:211], v63 offset:4096
    v_mfma_f32_16x16x32_bf16 a[28:31], a[196:199], v[188:191], a[28:31]
    v_mfma_f32_16x16x32_bf16 a[32:35], a[196:199], v[192:195], a[32:35]
    v_add_u32 v62, s52, v62
    v_add_u32 v63, s52, v63
    v_mfma_f32_16x16x32_bf16 a[36:39], a[196:199], v[196:199], a[36:39]
    v_mfma_f32_16x16x32_bf16 a[40:43], a[196:199], v[200:203], a[40:43]
    buffer_load_dwordx4 v[244:247], v11, s[20:23], s50 offen offset:0 sc1
    v_mfma_f32_16x16x32_bf16 a[44:47], a[196:199], v[204:207], a[44:47]
    s_waitcnt lgkmcnt(2)
    v_mfma_f32_16x16x32_bf16 a[48:51], a[200:203], v[184:187], a[48:51]
    ds_read_b128 a[192:195], v62 offset:0
    v_mfma_f32_16x16x32_bf16 a[52:55], a[200:203], v[188:191], a[52:55]
    buffer_load_dwordx4 v[248:251], v11, s[20:23], s50 offen offset:1024 sc1
    v_mfma_f32_16x16x32_bf16 a[56:59], a[200:203], v[192:195], a[56:59]
    v_mfma_f32_16x16x32_bf16 a[60:63], a[200:203], v[196:199], a[60:63]
    v_mfma_f32_16x16x32_bf16 a[64:67], a[200:203], v[200:203], a[64:67]
    buffer_load_dwordx4 v8, s[24:27], s49 offen offset:3072 sc1 lds
    v_mfma_f32_16x16x32_bf16 a[68:71], a[200:203], v[204:207], a[68:71]
    s_waitcnt lgkmcnt(2)
    v_mfma_f32_16x16x32_bf16 a[72:75], a[204:207], v[184:187], a[72:75]
    ds_read_b128 a[196:199], v62 offset:1024
    v_mfma_f32_16x16x32_bf16 a[76:79], a[204:207], v[188:191], a[76:79]
    v_mfma_f32_16x16x32_bf16 a[80:83], a[204:207], v[192:195], a[80:83]
    v_mfma_f32_16x16x32_bf16 a[84:87], a[204:207], v[196:199], a[84:87]
    buffer_load_dwordx4 v[252:255], v11, s[20:23], s50 offen offset:2048 sc1
    v_mfma_f32_16x16x32_bf16 a[88:91], a[204:207], v[200:203], a[88:91]
    v_mfma_f32_16x16x32_bf16 a[92:95], a[204:207], v[204:207], a[92:95]
    s_waitcnt lgkmcnt(2)
    v_mfma_f32_16x16x32_bf16 a[96:99], a[208:211], v[184:187], a[96:99]
    ds_read_b128 a[200:203], v62 offset:2048
    v_mfma_f32_16x16x32_bf16 a[100:103], a[208:211], v[188:191], a[100:103]
    s_add_u32 m0, m0, 4096
    v_mfma_f32_16x16x32_bf16 a[104:107], a[208:211], v[192:195], a[104:107]
    buffer_load_dwordx4 v8, s[24:27], s54 offen offset:0 sc1 lds
    v_mfma_f32_16x16x32_bf16 a[108:111], a[208:211], v[196:199], a[108:111]
    s_add_u32 s44, s44, 1
    v_mfma_f32_16x16x32_bf16 a[112:115], a[208:211], v[200:203], a[112:115]
    s_waitcnt vmcnt(13)
    v_mfma_f32_16x16x32_bf16 a[116:119], a[208:211], v[204:207], a[116:119]
    s_waitcnt lgkmcnt(2)
    v_mfma_f32_16x16x32_bf16 v[64:67], a[192:195], v[208:211], v[64:67]
    ds_read_b128 a[204:207], v62 offset:3072
    v_mfma_f32_16x16x32_bf16 v[68:71], a[192:195], v[212:215], v[68:71]
    v_mfma_f32_16x16x32_bf16 v[72:75], a[192:195], v[216:219], v[72:75]
    v_mfma_f32_16x16x32_bf16 v[76:79], a[192:195], v[220:223], v[76:79]
    s_cmp_eq_u32 s44, 11
    s_cselect_b32 s55, s76, 10240
    v_mfma_f32_16x16x32_bf16 v[80:83], a[192:195], v[224:227], v[80:83]
    v_mfma_f32_16x16x32_bf16 v[84:87], a[192:195], v[228:231], v[84:87]
    s_waitcnt lgkmcnt(2)
    v_mfma_f32_16x16x32_bf16 v[88:91], a[196:199], v[208:211], v[88:91]
    ds_read_b128 a[208:211], v62 offset:4096
    v_mfma_f32_16x16x32_bf16 v[92:95], a[196:199], v[212:215], v[92:95]
    s_add_u32 s49, s49, s55
    v_mfma_f32_16x16x32_bf16 v[96:99], a[196:199], v[216:219], v[96:99]
    s_add_u32 s54, s49, 4096
    v_mfma_f32_16x16x32_bf16 v[100:103], a[196:199], v[220:223], v[100:103]
    s_add_u32 s97, s97, 20480
    v_mfma_f32_16x16x32_bf16 v[104:107], a[196:199], v[224:227], v[104:107]
    s_cmp_eq_u32 s97, 163840
    s_cselect_b32 s97, 0, s97
    v_mfma_f32_16x16x32_bf16 v[108:111], a[196:199], v[228:231], v[108:111]
    s_waitcnt lgkmcnt(2)
    v_mfma_f32_16x16x32_bf16 v[112:115], a[200:203], v[208:211], v[112:115]
    ds_read_b128 a[192:195], v63 offset:0
    v_mfma_f32_16x16x32_bf16 v[116:119], a[200:203], v[212:215], v[116:119]
    s_add_u32 m0, s97, s96
    v_mfma_f32_16x16x32_bf16 v[120:123], a[200:203], v[216:219], v[120:123]
    buffer_load_dwordx4 v8, s[24:27], s49 offen offset:0 sc1 lds
    v_mfma_f32_16x16x32_bf16 v[124:127], a[200:203], v[220:223], v[124:127]
    s_cmp_eq_u32 s44, 14
    s_cselect_b32 s55, s78, 6144
    v_mfma_f32_16x16x32_bf16 v[128:131], a[200:203], v[224:227], v[128:131]
    s_add_u32 s50, s50, s55
    v_mfma_f32_16x16x32_bf16 v[132:135], a[200:203], v[228:231], v[132:135]
    s_waitcnt lgkmcnt(2)
    v_mfma_f32_16x16x32_bf16 v[136:139], a[204:207], v[208:211], v[136:139]
    ds_read_b128 a[196:199], v63 offset:1024
    v_mfma_f32_16x16x32_bf16 v[140:143], a[204:207], v[212:215], v[140:143]
    buffer_load_dwordx4 v[184:187], v10, s[20:23], s50 offen offset:0 sc1
    v_mfma_f32_16x16x32_bf16 v[144:147], a[204:207], v[216:219], v[144:147]
    v_mfma_f32_16x16x32_bf16 v[148:151], a[204:207], v[220:223], v[148:151]
    v_mfma_f32_16x16x32_bf16 v[152:155], a[204:207], v[224:227], v[152:155]
    buffer_load_dwordx4 v[188:191], v10, s[20:23], s50 offen offset:1024 sc1
    v_mfma_f32_16x16x32_bf16 v[156:159], a[204:207], v[228:231], v[156:159]
    s_waitcnt lgkmcnt(2)
    v_mfma_f32_16x16x32_bf16 v[160:163], a[208:211], v[208:211], v[160:163]
    ds_read_b128 a[200:203], v63 offset:2048
    v_mfma_f32_16x16x32_bf16 v[164:167], a[208:211], v[212:215], v[164:167]
    buffer_load_dwordx4 v8, s[24:27], s49 offen offset:1024 sc1 lds
    v_mfma_f32_16x16x32_bf16 v[168:171], a[208:211], v[216:219], v[168:171]
    v_mfma_f32_16x16x32_bf16 v[172:175], a[208:211], v[220:223], v[172:175]
    v_mfma_f32_16x16x32_bf16 v[176:179], a[208:211], v[224:227], v[176:179]
    buffer_load_dwordx4 v[192:195], v10, s[20:23], s50 offen offset:2048 sc1
    v_mfma_f32_16x16x32_bf16 v[180:183], a[208:211], v[228:231], v[180:183]
    s_waitcnt lgkmcnt(2)
    v_mfma_f32_16x16x32_bf16 a[0:3], a[192:195], v[208:211], a[0:3]
    ds_read_b128 a[204:207], v63 offset:3072
    v_mfma_f32_16x16x32_bf16 a[4:7], a[192:195], v[212:215], a[4:7]
    v_mfma_f32_16x16x32_bf16 a[8:11], a[192:195], v[216:219], a[8:11]
    s_add_u32 s99, s99, 20480
    v_mfma_f32_16x16x32_bf16 a[12:15], a[192:195], v[220:223], a[12:15]
    v_mfma_f32_16x16x32_bf16 a[16:19], a[192:195], v[224:227], a[16:19]
    s_cmp_eq_u32 s99, 163840
    s_cselect_b32 s52, s95, 20480
    s_cselect_b32 s99, 0, s99
    v_mfma_f32_16x16x32_bf16 a[20:23], a[192:195], v[228:231], a[20:23]
    buffer_load_dwordx4 v8, s[24:27], s49 offen offset:2048 sc1 lds
    s_waitcnt lgkmcnt(2)
    v_mfma_f32_16x16x32_bf16 a[24:27], a[196:199], v[208:211], a[24:27]
    ds_read_b128 a[208:211], v63 offset:4096
    v_mfma_f32_16x16x32_bf16 a[28:31], a[196:199], v[212:215], a[28:31]
    v_mfma_f32_16x16x32_bf16 a[32:35], a[196:199], v[216:219], a[32:35]
    v_add_u32 v62, s52, v62
    v_add_u32 v63, s52, v63
    v_mfma_f32_16x16x32_bf16 a[36:39], a[196:199], v[220:223], a[36:39]
    v_mfma_f32_16x16x32_bf16 a[40:43], a[196:199], v[224:227], a[40:43]
    buffer_load_dwordx4 v[196:199], v11, s[20:23], s50 offen offset:0 sc1
    v_mfma_f32_16x16x32_bf16 a[44:47], a[196:199], v[228:231], a[44:47]
    s_waitcnt lgkmcnt(2)
    v_mfma_f32_16x16x32_bf16 a[48:51], a[200:203], v[208:211], a[48:51]
    ds_read_b128 a[192:195], v62 offset:0
    v_mfma_f32_16x16x32_bf16 a[52:55], a[200:203], v[212:215], a[52:55]
    buffer_load_dwordx4 v[200:203], v11, s[20:23], s50 offen offset:1024 sc1
    v_mfma_f32_16x16x32_bf16 a[56:59], a[200:203], v[216:219], a[56:59]
    v_mfma_f32_16x16x32_bf16 a[60:63], a[200:203], v[220:223], a[60:63]
    v_mfma_f32_16x16x32_bf16 a[64:67], a[200:203], v[224:227], a[64:67]
    buffer_load_dwordx4 v8, s[24:27], s49 offen offset:3072 sc1 lds
    v_mfma_f32_16x16x32_bf16 a[68:71], a[200:203], v[228:231], a[68:71]
    s_waitcnt lgkmcnt(2)
    v_mfma_f32_16x16x32_bf16 a[72:75], a[204:207], v[208:211], a[72:75]
    ds_read_b128 a[196:199], v62 offset:1024
    v_mfma_f32_16x16x32_bf16 a[76:79], a[204:207], v[212:215], a[76:79]
    v_mfma_f32_16x16x32_bf16 a[80:83], a[204:207], v[216:219], a[80:83]
    v_mfma_f32_16x16x32_bf16 a[84:87], a[204:207], v[220:223], a[84:87]
    buffer_load_dwordx4 v[204:207], v11, s[20:23], s50 offen offset:2048 sc1
    v_mfma_f32_16x16x32_bf16 a[88:91], a[204:207], v[224:227], a[88:91]
    v_mfma_f32_16x16x32_bf16 a[92:95], a[204:207], v[228:231], a[92:95]
    s_waitcnt lgkmcnt(2)
    v_mfma_f32_16x16x32_bf16 a[96:99], a[208:211], v[208:211], a[96:99]
    ds_read_b128 a[200:203], v62 offset:2048
    v_mfma_f32_16x16x32_bf16 a[100:103], a[208:211], v[212:215], a[100:103]
    s_add_u32 m0, m0, 4096
    v_mfma_f32_16x16x32_bf16 a[104:107], a[208:211], v[216:219], a[104:107]
    buffer_load_dwordx4 v8, s[24:27], s54 offen offset:0 sc1 lds
    v_mfma_f32_16x16x32_bf16 a[108:111], a[208:211], v[220:223], a[108:111]
    s_add_u32 s44, s44, 1
    v_mfma_f32_16x16x32_bf16 a[112:115], a[208:211], v[224:227], a[112:115]
    s_waitcnt vmcnt(12)
    v_mfma_f32_16x16x32_bf16 a[116:119], a[208:211], v[228:231], a[116:119]
    s_waitcnt lgkmcnt(2)
    s_cmp_lg_u32 s44, 26
    s_cbranch_scc1 L_oploop
    v_mfma_f32_16x16x32_bf16 v[64:67], a[192:195], v[232:235], v[64:67]
    ds_read_b128 a[204:207], v62 offset:3072
    v_mfma_f32_16x16x32_bf16 v[68:71], a[192:195], v[236:239], v[68:71]
    s_waitcnt vmcnt(11)
    v_mfma_f32_16x16x32_bf16 v[72:75], a[192:195], v[240:243], v[72:75]
    s_barrier
    v_mfma_f32_16x16x32_bf16 v[76:79], a[192:195], v[244:247], v[76:79]
    s_cmp_eq_u32 s44, 11
    s_cselect_b32 s55, s76, 10240
    v_mfma_f32_16x16x32_bf16 v[80:83], a[192:195], v[248:251], v[80:83]
    v_mfma_f32_16x16x32_bf16 v[84:87], a[192:195], v[252:255], v[84:87]
    s_waitcnt lgkmcnt(2)
    v_mfma_f32_16x16x32_bf16 v[88:91], a[196:199], v[232:235], v[88:91]
    ds_read_b128 a[208:211], v62 offset:4096
    v_mfma_f32_16x16x32_bf16 v[92:95], a[196:199], v[236:239], v[92:95]
    s_add_u32 s49, s49, s55
    v_mfma_f32_16x16x32_bf16 v[96:99], a[196:199], v[240:243], v[96:99]
    s_add_u32 s54, s49, 4096
    v_mfma_f32_16x16x32_bf16 v[100:103], a[196:199], v[244:247], v[100:103]
    s_add_u32 s97, s97, 20480
    v_mfma_f32_16x16x32_bf16 v[104:107], a[196:199], v[248:251], v[104:107]
    s_cmp_eq_u32 s97, 163840
    s_cselect_b32 s97, 0, s97
    v_mfma_f32_16x16x32_bf16 v[108:111], a[196:199], v[252:255], v[108:111]
    s_waitcnt lgkmcnt(2)
    v_mfma_f32_16x16x32_bf16 v[112:115], a[200:203], v[232:235], v[112:115]
    ds_read_b128 a[192:195], v63 offset:0
    v_mfma_f32_16x16x32_bf16 v[116:119], a[200:203], v[236:239], v[116:119]
    s_add_u32 m0, s97, s96
    v_mfma_f32_16x16x32_bf16 v[120:123], a[200:203], v[240:243], v[120:123]
    buffer_load_dwordx4 v8, s[24:27], s49 offen offset:0 sc1 lds
    v_mfma_f32_16x16x32_bf16 v[124:127], a[200:203], v[244:247], v[124:127]
    s_cmp_eq_u32 s44, 14
    s_cselect_b32 s55, s78, 6144
    v_mfma_f32_16x16x32_bf16 v[128:131], a[200:203], v[248:251], v[128:131]
    s_add_u32 s50, s50, s55
    v_mfma_f32_16x16x32_bf16 v[132:135], a[200:203], v[252:255], v[132:135]
    s_waitcnt lgkmcnt(2)
    v_mfma_f32_16x16x32_bf16 v[136:139], a[204:207], v[232:235], v[136:139]
    ds_read_b128 a[196:199], v63 offset:1024
    v_mfma_f32_16x16x32_bf16 v[140:143], a[204:207], v[236:239], v[140:143]
    buffer_load_dwordx4 v[208:211], v10, s[20:23], s50 offen offset:0 sc1
    v_mfma_f32_16x16x32_bf16 v[144:147], a[204:207], v[240:243], v[144:147]
    v_mfma_f32_16x16x32_bf16 v[148:151], a[204:207], v[244:247], v[148:151]
    v_mfma_f32_16x16x32_bf16 v[152:155], a[204:207], v[248:251], v[152:155]
    buffer_load_dwordx4 v[212:215], v10, s[20:23], s50 offen offset:1024 sc1
    v_mfma_f32_16x16x32_bf16 v[156:159], a[204:207], v[252:255], v[156:159]
    s_waitcnt lgkmcnt(2)
    v_mfma_f32_16x16x32_bf16 v[160:163], a[208:211], v[232:235], v[160:163]
    ds_read_b128 a[200:203], v63 offset:2048
    v_mfma_f32_16x16x32_bf16 v[164:167], a[208:211], v[236:239], v[164:167]
    buffer_load_dwordx4 v8, s[24:27], s49 offen offset:1024 sc1 lds
    v_mfma_f32_16x16x32_bf16 v[168:171], a[208:211], v[240:243], v[168:171]
    buffer_load_dwordx4 v[216:219], v10, s[20:23], s50 offen offset:2048 sc1
    v_mfma_f32_16x16x32_bf16 v[172:175], a[208:211], v[244:247], v[172:175]
    v_mfma_f32_16x16x32_bf16 v[176:179], a[208:211], v[248:251], v[176:179]
    buffer_load_dwordx4 v[220:223], v11, s[20:23], s50 offen offset:0 sc1
    v_mfma_f32_16x16x32_bf16 v[180:183], a[208:211], v[252:255], v[180:183]
    s_waitcnt lgkmcnt(2)
    v_mfma_f32_16x16x32_bf16 a[0:3], a[192:195], v[232:235], a[0:3]
    ds_read_b128 a[204:207], v63 offset:3072
    v_mfma_f32_16x16x32_bf16 a[4:7], a[192:195], v[236:239], a[4:7]
    buffer_load_dwordx4 v[224:227], v11, s[20:23], s50 offen offset:1024 sc1
    v_mfma_f32_16x16x32_bf16 a[8:11], a[192:195], v[240:243], a[8:11]
    s_add_u32 s99, s99, 20480
    v_mfma_f32_16x16x32_bf16 a[12:15], a[192:195], v[244:247], a[12:15]
    buffer_load_dwordx4 v[228:231], v11, s[20:23], s50 offen offset:2048 sc1
    v_mfma_f32_16x16x32_bf16 a[16:19], a[192:195], v[248:251], a[16:19]
    s_cmp_eq_u32 s99, 163840
    s_cselect_b32 s52, s95, 20480
    s_cselect_b32 s99, 0, s99
    v_mfma_f32_16x16x32_bf16 a[20:23], a[192:195], v[252:255], a[20:23]
    buffer_load_dwordx4 v8, s[24:27], s49 offen offset:2048 sc1 lds
    s_waitcnt lgkmcnt(2)
    v_mfma_f32_16x16x32_bf16 a[24:27], a[196:199], v[232:235], a[24:27]
    ds_read_b128 a[208:211], v63 offset:4096
    v_mfma_f32_16x16x32_bf16 a[28:31], a[196:199], v[236:239], a[28:31]
    s_add_u32 s50, s50, 6144
    v_mfma_f32_16x16x32_bf16 a[32:35], a[196:199], v[240:243], a[32:35]
    v_add_u32 v62, s52, v62
    v_add_u32 v63, s52, v63
    v_mfma_f32_16x16x32_bf16 a[36:39], a[196:199], v[244:247], a[36:39]
    buffer_load_dwordx4 a[132:135], v11, s[20:23], s50 offen offset:0 sc1
    v_mfma_f32_16x16x32_bf16 a[40:43], a[196:199], v[248:251], a[40:43]
    v_mfma_f32_16x16x32_bf16 a[44:47], a[196:199], v[252:255], a[44:47]
    buffer_load_dwordx4 a[136:139], v11, s[20:23], s50 offen offset:1024 sc1
    s_waitcnt lgkmcnt(2)
    v_mfma_f32_16x16x32_bf16 a[48:51], a[200:203], v[232:235], a[48:51]
    ds_read_b128 a[192:195], v62 offset:0
    v_mfma_f32_16x16x32_bf16 a[52:55], a[200:203], v[236:239], a[52:55]
    v_mfma_f32_16x16x32_bf16 a[56:59], a[200:203], v[240:243], a[56:59]
    buffer_load_dwordx4 a[140:143], v11, s[20:23], s50 offen offset:2048 sc1
    v_mfma_f32_16x16x32_bf16 a[60:63], a[200:203], v[244:247], a[60:63]
    v_mfma_f32_16x16x32_bf16 a[64:67], a[200:203], v[248:251], a[64:67]
    buffer_load_dwordx4 v8, s[24:27], s49 offen offset:3072 sc1 lds
    v_mfma_f32_16x16x32_bf16 a[68:71], a[200:203], v[252:255], a[68:71]
    s_waitcnt lgkmcnt(2)
    v_mfma_f32_16x16x32_bf16 a[72:75], a[204:207], v[232:235], a[72:75]
    ds_read_b128 a[196:199], v62 offset:1024
    v_mfma_f32_16x16x32_bf16 a[76:79], a[204:207], v[236:239], a[76:79]
    buffer_load_dwordx4 a[120:123], v10, s[20:23], s50 offen offset:0 sc1
    v_mfma_f32_16x16x32_bf16 a[80:83], a[204:207], v[240:243], a[80:83]
    v_mfma_f32_16x16x32_bf16 a[84:87], a[204:207], v[244:247], a[84:87]
    buffer_load_dwordx4 a[124:127], v10, s[20:23], s50 offen offset:1024 sc1
    v_mfma_f32_16x16x32_bf16 a[88:91], a[204:207], v[248:251], a[88:91]
    v_mfma_f32_16x16x32_bf16 a[92:95], a[204:207], v[252:255], a[92:95]
    buffer_load_dwordx4 a[128:131], v10, s[20:23], s50 offen offset:2048 sc1
    s_waitcnt lgkmcnt(2)
    v_mfma_f32_16x16x32_bf16 a[96:99], a[208:211], v[232:235], a[96:99]
    ds_read_b128 a[200:203], v62 offset:2048
    v_mfma_f32_16x16x32_bf16 a[100:103], a[208:211], v[236:239], a[100:103]
    s_add_u32 m0, m0, 4096
    v_mfma_f32_16x16x32_bf16 a[104:107], a[208:211], v[240:243], a[104:107]
    buffer_load_dwordx4 v8, s[24:27], s54 offen offset:0 sc1 lds
    v_mfma_f32_16x16x32_bf16 a[108:111], a[208:211], v[244:247], a[108:111]
    s_add_u32 s44, s44, 1
    v_mfma_f32_16x16x32_bf16 a[112:115], a[208:211], v[248:251], a[112:115]
    s_waitcnt vmcnt(18)
    v_mfma_f32_16x16x32_bf16 a[116:119], a[208:211], v[252:255], a[116:119]
    s_waitcnt lgkmcnt(2)
    v_mfma_f32_16x16x32_bf16 v[76:79], a[192:195], v[196:199], v[76:79]
    ds_read_b128 a[204:207], v62 offset:3072
    v_mfma_f32_16x16x32_bf16 v[80:83], a[192:195], v[200:203], v[80:83]
    ds_read_b128 a[208:211], v62 offset:4096
    v_mfma_f32_16x16x32_bf16 v[84:87], a[192:195], v[204:207], v[84:87]
    s_waitcnt lgkmcnt(2)
    v_mfma_f32_16x16x32_bf16 v[100:103], a[196:199], v[196:199], v[100:103]
    ds_read_b128 a[192:195], v63 offset:0
    v_mfma_f32_16x16x32_bf16 v[104:107], a[196:199], v[200:203], v[104:107]
    s_waitcnt vmcnt(17)
    s_barrier
    v_mfma_f32_16x16x32_bf16 v[108:111], a[196:199], v[204:207], v[108:111]
    s_add_u32 s50, s50, 6144
    v_mfma_f32_16x16x32_bf16 v[124:127], a[200:203], v[196:199], v[124:127]
    ds_read_b128 a[196:199], v63 offset:1024
    v_mfma_f32_16x16x32_bf16 v[128:131], a[200:203], v[200:203], v[128:131]
    buffer_load_dwordx4 v[244:247], v11, s[20:23], s50 offen offset:0 sc1
    v_mfma_f32_16x16x32_bf16 v[132:135], a[200:203], v[204:207], v[132:135]
    s_waitcnt lgkmcnt(2)
    v_mfma_f32_16x16x32_bf16 v[148:151], a[204:207], v[196:199], v[148:151]
    ds_read_b128 a[200:203], v63 offset:2048
    v_mfma_f32_16x16x32_bf16 v[152:155], a[204:207], v[200:203], v[152:155]
    buffer_load_dwordx4 v[248:251], v11, s[20:23], s50 offen offset:1024 sc1
    v_mfma_f32_16x16x32_bf16 v[156:159], a[204:207], v[204:207], v[156:159]
    v_mfma_f32_16x16x32_bf16 v[172:175], a[208:211], v[196:199], v[172:175]
    ds_read_b128 a[204:207], v63 offset:3072
    v_mfma_f32_16x16x32_bf16 v[176:179], a[208:211], v[200:203], v[176:179]
    buffer_load_dwordx4 v[252:255], v11, s[20:23], s50 offen offset:2048 sc1
    v_mfma_f32_16x16x32_bf16 v[180:183], a[208:211], v[204:207], v[180:183]
    s_waitcnt lgkmcnt(2)
    v_mfma_f32_16x16x32_bf16 a[12:15], a[192:195], v[196:199], a[12:15]
    ds_read_b128 a[208:211], v63 offset:4096
    v_mfma_f32_16x16x32_bf16 a[16:19], a[192:195], v[200:203], a[16:19]
    buffer_load_dwordx4 v[232:235], v10, s[20:23], s50 offen offset:0 sc1
    v_mfma_f32_16x16x32_bf16 a[20:23], a[192:195], v[204:207], a[20:23]
    v_mfma_f32_16x16x32_bf16 a[36:39], a[196:199], v[196:199], a[36:39]
    ds_read_b128 a[192:195], v62 offset:20480
    v_mfma_f32_16x16x32_bf16 a[40:43], a[196:199], v[200:203], a[40:43]
    buffer_load_dwordx4 v[236:239], v10, s[20:23], s50 offen offset:1024 sc1
    v_mfma_f32_16x16x32_bf16 a[44:47], a[196:199], v[204:207], a[44:47]
    s_waitcnt lgkmcnt(2)
    v_mfma_f32_16x16x32_bf16 a[60:63], a[200:203], v[196:199], a[60:63]
    ds_read_b128 a[196:199], v62 offset:21504
    v_mfma_f32_16x16x32_bf16 a[64:67], a[200:203], v[200:203], a[64:67]
    buffer_load_dwordx4 v[240:243], v10, s[20:23], s50 offen offset:2048 sc1
    v_mfma_f32_16x16x32_bf16 a[68:71], a[200:203], v[204:207], a[68:71]
    s_add_u32 s50, s50, 6144
    v_mfma_f32_16x16x32_bf16 a[84:87], a[204:207], v[196:199], a[84:87]
    ds_read_b128 a[200:203], v62 offset:22528
    v_mfma_f32_16x16x32_bf16 a[88:91], a[204:207], v[200:203], a[88:91]
    buffer_load_dwordx4 a[156:159], v11, s[20:23], s50 offen offset:0 sc1
    v_mfma_f32_16x16x32_bf16 a[92:95], a[204:207], v[204:207], a[92:95]
    s_waitcnt lgkmcnt(2)
    v_mfma_f32_16x16x32_bf16 a[108:111], a[208:211], v[196:199], a[108:111]
    ds_read_b128 a[204:207], v62 offset:23552
    v_mfma_f32_16x16x32_bf16 a[112:115], a[208:211], v[200:203], a[112:115]
    buffer_load_dwordx4 a[160:163], v11, s[20:23], s50 offen offset:1024 sc1
    s_waitcnt vmcnt(17)
    v_mfma_f32_16x16x32_bf16 a[116:119], a[208:211], v[204:207], a[116:119]
    v_mfma_f32_16x16x32_bf16 v[76:79], a[192:195], v[220:223], v[76:79]
    ds_read_b128 a[208:211], v62 offset:24576
    v_mfma_f32_16x16x32_bf16 v[80:83], a[192:195], v[224:227], v[80:83]
    buffer_load_dwordx4 a[164:167], v11, s[20:23], s50 offen offset:2048 sc1
    v_mfma_f32_16x16x32_bf16 v[84:87], a[192:195], v[228:231], v[84:87]
    s_waitcnt lgkmcnt(2)
    v_mfma_f32_16x16x32_bf16 v[100:103], a[196:199], v[220:223], v[100:103]
    ds_read_b128 a[192:195], v63 offset:20480
    v_mfma_f32_16x16x32_bf16 v[104:107], a[196:199], v[224:227], v[104:107]
    buffer_load_dwordx4 a[144:147], v10, s[20:23], s50 offen offset:0 sc1
    v_mfma_f32_16x16x32_bf16 v[108:111], a[196:199], v[228:231], v[108:111]
    v_mfma_f32_16x16x32_bf16 v[124:127], a[200:203], v[220:223], v[124:127]
    ds_read_b128 a[196:199], v63 offset:21504
    v_mfma_f32_16x16x32_bf16 v[128:131], a[200:203], v[224:227], v[128:131]
    buffer_load_dwordx4 a[148:151], v10, s[20:23], s50 offen offset:1024 sc1
    v_mfma_f32_16x16x32_bf16 v[132:135], a[200:203], v[228:231], v[132:135]
    s_waitcnt lgkmcnt(2)
    v_mfma_f32_16x16x32_bf16 v[148:151], a[204:207], v[220:223], v[148:151]
    ds_read_b128 a[200:203], v63 offset:22528
    v_mfma_f32_16x16x32_bf16 v[152:155], a[204:207], v[224:227], v[152:155]
    buffer_load_dwordx4 a[152:155], v10, s[20:23], s50 offen offset:2048 sc1
    v_mfma_f32_16x16x32_bf16 v[156:159], a[204:207], v[228:231], v[156:159]
    v_mfma_f32_16x16x32_bf16 v[172:175], a[208:211], v[220:223], v[172:175]
    ds_read_b128 a[204:207], v63 offset:23552
    v_mfma_f32_16x16x32_bf16 v[176:179], a[208:211], v[224:227], v[176:179]
    s_mul_i32 s52, s4, 15360
    v_mfma_f32_16x16x32_bf16 v[180:183], a[208:211], v[228:231], v[180:183]
    s_waitcnt lgkmcnt(2)
    v_add_u32 v40, 61440, v62
    v_add_u32 v41, 61440, v63
    v_mfma_f32_16x16x32_bf16 a[12:15], a[192:195], v[220:223], a[12:15]
    ds_read_b128 a[208:211], v63 offset:24576
    v_lshlrev_b32 v8, 4, v1
    v_mfma_f32_16x16x32_bf16 a[16:19], a[192:195], v[224:227], a[16:19]
    v_bfrev_b32 v46, 1
    v_writelane_b32 v46, 0, 0
    s_xor_b32 s53, s4, 2
    v_mfma_f32_16x16x32_bf16 a[20:23], a[192:195], v[228:231], a[20:23]
    v_mfma_f32_16x16x32_bf16 a[36:39], a[196:199], v[220:223], a[36:39]
    ds_read_b128 a[192:195], v62 offset:40960
    v_mfma_f32_16x16x32_bf16 a[40:43], a[196:199], v[224:227], a[40:43]
    s_mul_i32 s53, s53, 15360
    v_mfma_f32_16x16x32_bf16 a[44:47], a[196:199], v[228:231], a[44:47]
    s_waitcnt lgkmcnt(2)
    v_mfma_f32_16x16x32_bf16 a[60:63], a[200:203], v[220:223], a[60:63]
    ds_read_b128 a[196:199], v62 offset:41984
    v_mfma_f32_16x16x32_bf16 a[64:67], a[200:203], v[224:227], a[64:67]
    s_and_b32 s54, s37, 1
    v_mfma_f32_16x16x32_bf16 a[68:71], a[200:203], v[228:231], a[68:71]
    v_mfma_f32_16x16x32_bf16 a[84:87], a[204:207], v[220:223], a[84:87]
    ds_read_b128 a[200:203], v62 offset:43008
    v_mfma_f32_16x16x32_bf16 a[88:91], a[204:207], v[224:227], a[88:91]
    s_lshl_b32 s55, s6, 1
    v_mfma_f32_16x16x32_bf16 a[92:95], a[204:207], v[228:231], a[92:95]
    s_waitcnt lgkmcnt(2)
    v_mfma_f32_16x16x32_bf16 a[108:111], a[208:211], v[220:223], a[108:111]
    ds_read_b128 a[204:207], v62 offset:44032
    v_mfma_f32_16x16x32_bf16 a[112:115], a[208:211], v[224:227], a[112:115]
    s_waitcnt vmcnt(17)
    s_add_u32 s54, s54, s55
    v_mfma_f32_16x16x32_bf16 a[116:119], a[208:211], v[228:231], a[116:119]
    v_mfma_f32_16x16x32_bf16 v[76:79], a[192:195], a[132:135], v[76:79]
    ds_read_b128 a[208:211], v62 offset:45056
    v_mfma_f32_16x16x32_bf16 v[80:83], a[192:195], a[136:139], v[80:83]
    s_waitcnt vmcnt(12)
    s_barrier
    v_mfma_f32_16x16x32_bf16 v[84:87], a[192:195], a[140:143], v[84:87]
    s_waitcnt lgkmcnt(2)
    v_mfma_f32_16x16x32_bf16 v[100:103], a[196:199], a[132:135], v[100:103]
    ds_read_b128 a[192:195], v63 offset:40960
    v_mfma_f32_16x16x32_bf16 v[104:107], a[196:199], a[136:139], v[104:107]
    s_mul_i32 s54, s54, 122880
    v_mfma_f32_16x16x32_bf16 v[108:111], a[196:199], a[140:143], v[108:111]
    v_mfma_f32_16x16x32_bf16 v[124:127], a[200:203], a[132:135], v[124:127]
    ds_read_b128 a[196:199], v63 offset:41984
    v_mfma_f32_16x16x32_bf16 v[128:131], a[200:203], a[136:139], v[128:131]
    s_mul_i32 s55, s5, 160
    v_mfma_f32_16x16x32_bf16 v[132:135], a[200:203], a[140:143], v[132:135]
    s_waitcnt lgkmcnt(2)
    v_mfma_f32_16x16x32_bf16 v[148:151], a[204:207], a[132:135], v[148:151]
    ds_read_b128 a[200:203], v63 offset:43008
    v_mfma_f32_16x16x32_bf16 v[152:155], a[204:207], a[136:139], v[152:155]
    s_add_u32 s54, s54, s55
    v_mfma_f32_16x16x32_bf16 v[156:159], a[204:207], a[140:143], v[156:159]
    v_mfma_f32_16x16x32_bf16 v[172:175], a[208:211], a[132:135], v[172:175]
    ds_read_b128 a[204:207], v63 offset:44032
    v_mfma_f32_16x16x32_bf16 v[176:179], a[208:211], a[136:139], v[176:179]
    s_lshl_b32 s55, s2, 2
    v_mfma_f32_16x16x32_bf16 v[180:183], a[208:211], a[140:143], v[180:183]
    s_waitcnt lgkmcnt(2)
    v_mfma_f32_16x16x32_bf16 a[12:15], a[192:195], a[132:135], a[12:15]
    ds_read_b128 a[208:211], v63 offset:45056
    v_mfma_f32_16x16x32_bf16 a[16:19], a[192:195], a[136:139], a[16:19]
    s_add_u32 s55, s55, s4
    v_mfma_f32_16x16x32_bf16 a[20:23], a[192:195], a[140:143], a[20:23]
    v_mfma_f32_16x16x32_bf16 a[36:39], a[196:199], a[132:135], a[36:39]
    ds_read_b128 a[192:195], v40 offset:0
    v_mfma_f32_16x16x32_bf16 a[40:43], a[196:199], a[136:139], a[40:43]
    s_lshl_b32 s56, s55, 13
    v_mfma_f32_16x16x32_bf16 a[44:47], a[196:199], a[140:143], a[44:47]
    s_waitcnt lgkmcnt(2)
    v_mfma_f32_16x16x32_bf16 a[60:63], a[200:203], a[132:135], a[60:63]
    ds_read_b128 a[196:199], v40 offset:1024
    v_mfma_f32_16x16x32_bf16 a[64:67], a[200:203], a[136:139], a[64:67]
    s_xor_b32 s57, s56, 0x40000
    v_mfma_f32_16x16x32_bf16 a[68:71], a[200:203], a[140:143], a[68:71]
    v_mfma_f32_16x16x32_bf16 a[84:87], a[204:207], a[132:135], a[84:87]
    ds_read_b128 a[200:203], v40 offset:2048
    v_mfma_f32_16x16x32_bf16 a[88:91], a[204:207], a[136:139], a[88:91]
    s_xor_b32 s94, s93, 1024
    v_mfma_f32_16x16x32_bf16 a[92:95], a[204:207], a[140:143], a[92:95]
    s_waitcnt lgkmcnt(2)
    v_mfma_f32_16x16x32_bf16 a[108:111], a[208:211], a[132:135], a[108:111]
    ds_read_b128 a[204:207], v40 offset:3072
    v_mfma_f32_16x16x32_bf16 a[112:115], a[208:211], a[136:139], a[112:115]
    s_waitcnt vmcnt(9)
    v_mfma_f32_16x16x32_bf16 a[116:119], a[208:211], a[140:143], a[116:119]
    v_mfma_f32_16x16x32_bf16 v[76:79], a[192:195], v[244:247], v[76:79]
    ds_read_b128 a[208:211], v40 offset:4096
    v_mfma_f32_16x16x32_bf16 v[80:83], a[192:195], v[248:251], v[80:83]
    v_mfma_f32_16x16x32_bf16 v[84:87], a[192:195], v[252:255], v[84:87]
    s_waitcnt lgkmcnt(2)
    v_add_u32 v9, s52, v8
    v_add_u32 v10, s53, v8
    v_mfma_f32_16x16x32_bf16 v[100:103], a[196:199], v[244:247], v[100:103]
    ds_read_b128 a[192:195], v41 offset:0
    v_and_b32 v11, 15, v1
    v_mfma_f32_16x16x32_bf16 v[104:107], a[196:199], v[248:251], v[104:107]
    v_mul_u32_u24 v11, 2560, v11
    v_lshrrev_b32 v12, 4, v1
    v_mfma_f32_16x16x32_bf16 v[108:111], a[196:199], v[252:255], v[108:111]
    v_lshl_add_u32 v11, v12, 3, v11
    v_add_u32 v11, s54, v11
    v_mfma_f32_16x16x32_bf16 v[124:127], a[200:203], v[244:247], v[124:127]
    ds_read_b128 a[196:199], v41 offset:1024
    v_lshlrev_b32 v13, 3, v12
    v_mfma_f32_16x16x32_bf16 v[128:131], a[200:203], v[248:251], v[128:131]
    v_sub_u32 v13, v11, v13
    v_and_b32 v14, 1, v12
    v_mfma_f32_16x16x32_bf16 v[132:135], a[200:203], v[252:255], v[132:135]
    s_waitcnt lgkmcnt(2)
    v_lshl_add_u32 v13, v14, 5, v13
    v_lshrrev_b32 v14, 1, v12
    v_mfma_f32_16x16x32_bf16 v[148:151], a[204:207], v[244:247], v[148:151]
    ds_read_b128 a[200:203], v41 offset:2048
    v_lshl_add_u32 v13, v14, 4, v13
    v_mfma_f32_16x16x32_bf16 v[152:155], a[204:207], v[248:251], v[152:155]
    v_mov_b32 v15, 1
    v_mfma_f32_16x16x32_bf16 v[156:159], a[204:207], v[252:255], v[156:159]
    v_mfma_f32_16x16x32_bf16 v[172:175], a[208:211], v[244:247], v[172:175]
    ds_read_b128 a[204:207], v41 offset:3072
    v_mfma_f32_16x16x32_bf16 v[176:179], a[208:211], v[248:251], v[176:179]
    v_mfma_f32_16x16x32_bf16 v[180:183], a[208:211], v[252:255], v[180:183]
    s_waitcnt lgkmcnt(2)
    v_mfma_f32_16x16x32_bf16 a[12:15], a[192:195], v[244:247], a[12:15]
    ds_read_b128 a[208:211], v41 offset:4096
    v_mfma_f32_16x16x32_bf16 a[16:19], a[192:195], v[248:251], a[16:19]
    v_mfma_f32_16x16x32_bf16 a[20:23], a[192:195], v[252:255], a[20:23]
    v_mfma_f32_16x16x32_bf16 a[36:39], a[196:199], v[244:247], a[36:39]
    ds_read_b128 a[192:195], v41 offset:20480
    v_mfma_f32_16x16x32_bf16 a[40:43], a[196:199], v[248:251], a[40:43]
    v_mfma_f32_16x16x32_bf16 a[44:47], a[196:199], v[252:255], a[44:47]
    s_waitcnt lgkmcnt(2)
    v_mfma_f32_16x16x32_bf16 a[60:63], a[200:203], v[244:247], a[60:63]
    ds_read_b128 a[196:199], v41 offset:21504
    v_mfma_f32_16x16x32_bf16 a[64:67], a[200:203], v[248:251], a[64:67]
    v_mfma_f32_16x16x32_bf16 a[68:71], a[200:203], v[252:255], a[68:71]
    v_mfma_f32_16x16x32_bf16 a[84:87], a[204:207], v[244:247], a[84:87]
    ds_read_b128 a[200:203], v41 offset:22528
    v_mfma_f32_16x16x32_bf16 a[88:91], a[204:207], v[248:251], a[88:91]
    v_mfma_f32_16x16x32_bf16 a[92:95], a[204:207], v[252:255], a[92:95]
    s_waitcnt lgkmcnt(2)
    v_mfma_f32_16x16x32_bf16 a[108:111], a[208:211], v[244:247], a[108:111]
    ds_read_b128 a[204:207], v41 offset:23552
    v_mfma_f32_16x16x32_bf16 a[112:115], a[208:211], v[248:251], a[112:115]
    s_waitcnt vmcnt(3)
    v_mfma_f32_16x16x32_bf16 a[116:119], a[208:211], v[252:255], a[116:119]
    v_mfma_f32_16x16x32_bf16 a[12:15], a[192:195], a[156:159], a[12:15]
    ds_read_b128 a[208:211], v41 offset:24576
    v_mfma_f32_16x16x32_bf16 a[16:19], a[192:195], a[160:163], a[16:19]
    v_mfma_f32_16x16x32_bf16 a[20:23], a[192:195], a[164:167], a[20:23]
    s_waitcnt lgkmcnt(2)
    v_mfma_f32_16x16x32_bf16 a[36:39], a[196:199], a[156:159], a[36:39]
    ds_read_b128 a[192:195], v40 offset:20480
    v_mfma_f32_16x16x32_bf16 a[40:43], a[196:199], a[160:163], a[40:43]
    ds_write_b128 v9, a[12:15] offset:0
    v_mfma_f32_16x16x32_bf16 a[44:47], a[196:199], a[164:167], a[44:47]
    ds_write_b128 v9, a[16:19] offset:5120
    v_mfma_f32_16x16x32_bf16 a[60:63], a[200:203], a[156:159], a[60:63]
    ds_read_b128 a[196:199], v40 offset:21504
    v_mfma_f32_16x16x32_bf16 a[64:67], a[200:203], a[160:163], a[64:67]
    ds_write_b128 v9, a[20:23] offset:10240
    v_mfma_f32_16x16x32_bf16 a[68:71], a[200:203], a[164:167], a[68:71]
    ds_write_b128 v9, a[36:39] offset:1024
    s_waitcnt lgkmcnt(6)
    v_mfma_f32_16x16x32_bf16 a[84:87], a[204:207], a[156:159], a[84:87]
    ds_read_b128 a[200:203], v40 offset:22528
    v_mfma_f32_16x16x32_bf16 a[88:91], a[204:207], a[160:163], a[88:91]
    ds_write_b128 v9, a[40:43] offset:6144
    v_mfma_f32_16x16x32_bf16 a[92:95], a[204:207], a[164:167], a[92:95]
    ds_write_b128 v9, a[44:47] offset:11264
    v_mfma_f32_16x16x32_bf16 a[108:111], a[208:211], a[156:159], a[108:111]
    ds_read_b128 a[204:207], v40 offset:23552
    v_mfma_f32_16x16x32_bf16 a[112:115], a[208:211], a[160:163], a[112:115]
    ds_write_b128 v9, a[60:63] offset:2048
    v_mfma_f32_16x16x32_bf16 a[116:119], a[208:211], a[164:167], a[116:119]
    ds_write_b128 v9, a[64:67] offset:7168
    s_waitcnt lgkmcnt(8)
    v_mfma_f32_16x16x32_bf16 v[76:79], a[192:195], a[156:159], v[76:79]
    ds_read_b128 a[208:211], v40 offset:24576
    v_mfma_f32_16x16x32_bf16 v[80:83], a[192:195], a[160:163], v[80:83]
    ds_write_b128 v9, a[68:71] offset:12288
    v_mfma_f32_16x16x32_bf16 v[84:87], a[192:195], a[164:167], v[84:87]
    ds_write_b128 v9, a[84:87] offset:3072
    v_mfma_f32_16x16x32_bf16 v[100:103], a[196:199], a[156:159], v[100:103]
    ds_read_b128 a[192:195], v62 offset:0
    v_mfma_f32_16x16x32_bf16 v[104:107], a[196:199], a[160:163], v[104:107]
    ds_write_b128 v9, a[88:91] offset:8192
    v_mfma_f32_16x16x32_bf16 v[108:111], a[196:199], a[164:167], v[108:111]
    ds_write_b128 v9, a[92:95] offset:13312
    s_waitcnt lgkmcnt(8)
    v_mfma_f32_16x16x32_bf16 v[124:127], a[200:203], a[156:159], v[124:127]
    ds_read_b128 a[196:199], v62 offset:1024
    v_mfma_f32_16x16x32_bf16 v[128:131], a[200:203], a[160:163], v[128:131]
    ds_write_b128 v9, a[108:111] offset:4096
    v_mfma_f32_16x16x32_bf16 v[132:135], a[200:203], a[164:167], v[132:135]
    ds_write_b128 v9, a[112:115] offset:9216
    v_mfma_f32_16x16x32_bf16 v[148:151], a[204:207], a[156:159], v[148:151]
    ds_read_b128 a[200:203], v62 offset:2048
    v_mfma_f32_16x16x32_bf16 v[152:155], a[204:207], a[160:163], v[152:155]
    ds_write_b128 v9, a[116:119] offset:14336
    v_mfma_f32_16x16x32_bf16 v[156:159], a[204:207], a[164:167], v[156:159]
    s_waitcnt lgkmcnt(7)
    v_mfma_f32_16x16x32_bf16 v[172:175], a[208:211], a[156:159], v[172:175]
    ds_read_b128 a[204:207], v62 offset:3072
    v_mfma_f32_16x16x32_bf16 v[176:179], a[208:211], a[160:163], v[176:179]
    s_waitcnt vmcnt(0)
    v_mfma_f32_16x16x32_bf16 v[180:183], a[208:211], a[164:167], v[180:183]
    s_waitcnt lgkmcnt(1)
    s_barrier
    v_mfma_f32_16x16x32_bf16 v[64:67], a[192:195], v[184:187], v[64:67]
    ds_read_b128 a[208:211], v62 offset:4096
    v_mfma_f32_16x16x32_bf16 v[68:71], a[192:195], v[188:191], v[68:71]
    ds_read_b128 v[16:19], v10 offset:0
    v_mfma_f32_16x16x32_bf16 v[72:75], a[192:195], v[192:195], v[72:75]
    ds_read_b128 v[20:23], v10 offset:1024
    v_mfma_f32_16x16x32_bf16 v[88:91], a[196:199], v[184:187], v[88:91]
    ds_read_b128 a[192:195], v63 offset:0
    v_mfma_f32_16x16x32_bf16 v[92:95], a[196:199], v[188:191], v[92:95]
    ds_read_b128 v[24:27], v10 offset:2048
    v_mfma_f32_16x16x32_bf16 v[96:99], a[196:199], v[192:195], v[96:99]
    ds_read_b128 v[28:31], v10 offset:3072
    v_mfma_f32_16x16x32_bf16 v[112:115], a[200:203], v[184:187], v[112:115]
    ds_read_b128 a[196:199], v63 offset:1024
    v_mfma_f32_16x16x32_bf16 v[116:119], a[200:203], v[188:191], v[116:119]
    ds_read_b128 v[32:35], v10 offset:4096
    s_waitcnt lgkmcnt(6)
    v_mfma_f32_16x16x32_bf16 v[120:123], a[200:203], v[192:195], v[120:123]
    v_add_f32 v76, v76, v16
    v_add_f32 v77, v77, v17
    v_mfma_f32_16x16x32_bf16 v[136:139], a[204:207], v[184:187], v[136:139]
    ds_read_b128 a[200:203], v63 offset:2048
    v_add_f32 v78, v78, v18
    v_mfma_f32_16x16x32_bf16 v[140:143], a[204:207], v[188:191], v[140:143]
    v_add_f32 v79, v79, v19
    v_cvt_pk_bf16_f32 v48, v76, v77
    v_mfma_f32_16x16x32_bf16 v[144:147], a[204:207], v[192:195], v[144:147]
    ds_read_b128 v[16:19], v10 offset:5120
    v_cvt_pk_bf16_f32 v49, v78, v79
    v_mfma_f32_16x16x32_bf16 v[160:163], a[208:211], v[184:187], v[160:163]
    ds_read_b128 a[204:207], v63 offset:3072
    s_waitcnt lgkmcnt(8)
    v_mfma_f32_16x16x32_bf16 v[164:167], a[208:211], v[188:191], v[164:167]
    v_add_f32 v100, v100, v20
    v_add_f32 v101, v101, v21
    v_mfma_f32_16x16x32_bf16 v[168:171], a[208:211], v[192:195], v[168:171]
    s_waitcnt lgkmcnt(4)
    v_add_f32 v102, v102, v22
    v_add_f32 v103, v103, v23
    v_mfma_f32_16x16x32_bf16 a[0:3], a[192:195], v[184:187], a[0:3]
    ds_read_b128 a[208:211], v63 offset:4096
    v_cvt_pk_bf16_f32 v50, v100, v101
    v_mfma_f32_16x16x32_bf16 a[4:7], a[192:195], v[188:191], a[4:7]
    ds_read_b128 v[20:23], v10 offset:6144
    v_cvt_pk_bf16_f32 v51, v102, v103
    v_mfma_f32_16x16x32_bf16 a[8:11], a[192:195], v[192:195], a[8:11]
    buffer_store_dwordx4 v[48:51], v8, s[88:91], s57 offen offset:0 sc1
    v_mfma_f32_16x16x32_bf16 a[24:27], a[196:199], v[184:187], a[24:27]
    ds_read_b128 a[192:195], v62 offset:20480
    v_mfma_f32_16x16x32_bf16 a[28:31], a[196:199], v[188:191], a[28:31]
    v_add_f32 v124, v124, v24
    v_add_f32 v125, v125, v25
    v_mfma_f32_16x16x32_bf16 a[32:35], a[196:199], v[192:195], a[32:35]
    s_waitcnt lgkmcnt(3)
    v_add_f32 v126, v126, v26
    v_add_f32 v127, v127, v27
    v_mfma_f32_16x16x32_bf16 a[48:51], a[200:203], v[184:187], a[48:51]
    ds_read_b128 a[196:199], v62 offset:21504
    v_cvt_pk_bf16_f32 v52, v124, v125
    v_mfma_f32_16x16x32_bf16 a[52:55], a[200:203], v[188:191], a[52:55]
    ds_read_b128 v[24:27], v10 offset:7168
    v_cvt_pk_bf16_f32 v53, v126, v127
    v_mfma_f32_16x16x32_bf16 a[56:59], a[200:203], v[192:195], a[56:59]
    v_add_f32 v148, v148, v28
    v_add_f32 v149, v149, v29
    v_mfma_f32_16x16x32_bf16 a[72:75], a[204:207], v[184:187], a[72:75]
    ds_read_b128 a[200:203], v62 offset:22528
    v_add_f32 v150, v150, v30
    v_mfma_f32_16x16x32_bf16 a[76:79], a[204:207], v[188:191], a[76:79]
    v_add_f32 v151, v151, v31
    v_cvt_pk_bf16_f32 v54, v148, v149
    v_mfma_f32_16x16x32_bf16 a[80:83], a[204:207], v[192:195], a[80:83]
    ds_read_b128 v[28:31], v10 offset:8192
    s_waitcnt lgkmcnt(4)
    v_cvt_pk_bf16_f32 v55, v150, v151
    v_mfma_f32_16x16x32_bf16 a[96:99], a[208:211], v[184:187], a[96:99]
    ds_read_b128 a[204:207], v62 offset:23552
    v_mfma_f32_16x16x32_bf16 a[100:103], a[208:211], v[188:191], a[100:103]
    buffer_store_dwordx4 v[52:55], v8, s[88:91], s57 offen offset:1024 sc1
    v_mfma_f32_16x16x32_bf16 a[104:107], a[208:211], v[192:195], a[104:107]
    v_add_f32 v172, v172, v32
    v_add_f32 v173, v173, v33
    v_mfma_f32_16x16x32_bf16 v[64:67], a[192:195], v[208:211], v[64:67]
    ds_read_b128 a[208:211], v62 offset:24576
    v_add_f32 v174, v174, v34
    v_mfma_f32_16x16x32_bf16 v[68:71], a[192:195], v[212:215], v[68:71]
    v_add_f32 v175, v175, v35
    v_cvt_pk_bf16_f32 v48, v172, v173
    v_mfma_f32_16x16x32_bf16 v[72:75], a[192:195], v[216:219], v[72:75]
    ds_read_b128 v[32:35], v10 offset:9216
    s_waitcnt lgkmcnt(4)
    v_cvt_pk_bf16_f32 v49, v174, v175
    v_mfma_f32_16x16x32_bf16 v[88:91], a[196:199], v[208:211], v[88:91]
    ds_read_b128 a[192:195], v63 offset:20480
    v_mfma_f32_16x16x32_bf16 v[92:95], a[196:199], v[212:215], v[92:95]
    v_add_f32 v80, v80, v16
    v_add_f32 v81, v81, v17
    v_mfma_f32_16x16x32_bf16 v[96:99], a[196:199], v[216:219], v[96:99]
    v_add_f32 v82, v82, v18
    v_add_f32 v83, v83, v19
    v_mfma_f32_16x16x32_bf16 v[112:115], a[200:203], v[208:211], v[112:115]
    ds_read_b128 a[196:199], v63 offset:21504
    v_cvt_pk_bf16_f32 v50, v80, v81
    v_mfma_f32_16x16x32_bf16 v[116:119], a[200:203], v[212:215], v[116:119]
    ds_read_b128 v[16:19], v10 offset:10240
    v_cvt_pk_bf16_f32 v51, v82, v83
    v_mfma_f32_16x16x32_bf16 v[120:123], a[200:203], v[216:219], v[120:123]
    s_waitcnt lgkmcnt(4)
    buffer_store_dwordx4 v[48:51], v8, s[88:91], s57 offen offset:2048 sc1
    v_mfma_f32_16x16x32_bf16 v[136:139], a[204:207], v[208:211], v[136:139]
    ds_read_b128 a[200:203], v63 offset:22528
    v_mfma_f32_16x16x32_bf16 v[140:143], a[204:207], v[212:215], v[140:143]
    v_add_f32 v104, v104, v20
    v_add_f32 v105, v105, v21
    v_mfma_f32_16x16x32_bf16 v[144:147], a[204:207], v[216:219], v[144:147]
    v_add_f32 v106, v106, v22
    v_add_f32 v107, v107, v23
    v_mfma_f32_16x16x32_bf16 v[160:163], a[208:211], v[208:211], v[160:163]
    ds_read_b128 a[204:207], v63 offset:23552
    v_cvt_pk_bf16_f32 v52, v104, v105
    v_mfma_f32_16x16x32_bf16 v[164:167], a[208:211], v[212:215], v[164:167]
    ds_read_b128 v[20:23], v10 offset:11264
    v_cvt_pk_bf16_f32 v53, v106, v107
    v_mfma_f32_16x16x32_bf16 v[168:171], a[208:211], v[216:219], v[168:171]
    s_waitcnt lgkmcnt(4)
    v_mfma_f32_16x16x32_bf16 a[0:3], a[192:195], v[208:211], a[0:3]
    ds_read_b128 a[208:211], v63 offset:24576
    v_mfma_f32_16x16x32_bf16 a[4:7], a[192:195], v[212:215], a[4:7]
    v_add_f32 v128, v128, v24
    v_add_f32 v129, v129, v25
    v_mfma_f32_16x16x32_bf16 a[8:11], a[192:195], v[216:219], a[8:11]
    v_add_f32 v130, v130, v26
    v_add_f32 v131, v131, v27
    v_mfma_f32_16x16x32_bf16 a[24:27], a[196:199], v[208:211], a[24:27]
    ds_read_b128 a[192:195], v62 offset:40960
    v_cvt_pk_bf16_f32 v54, v128, v129
    v_mfma_f32_16x16x32_bf16 a[28:31], a[196:199], v[212:215], a[28:31]
    ds_read_b128 v[24:27], v10 offset:12288
    v_cvt_pk_bf16_f32 v55, v130, v131
    v_mfma_f32_16x16x32_bf16 a[32:35], a[196:199], v[216:219], a[32:35]
    s_waitcnt lgkmcnt(4)
    buffer_store_dwordx4 v[52:55], v8, s[88:91], s57 offen offset:3072 sc1
    v_mfma_f32_16x16x32_bf16 a[48:51], a[200:203], v[208:211], a[48:51]
    ds_read_b128 a[196:199], v62 offset:41984
    v_mfma_f32_16x16x32_bf16 a[52:55], a[200:203], v[212:215], a[52:55]
    v_add_f32 v152, v152, v28
    v_add_f32 v153, v153, v29
    v_mfma_f32_16x16x32_bf16 a[56:59], a[200:203], v[216:219], a[56:59]
    v_add_f32 v154, v154, v30
    v_add_f32 v155, v155, v31
    v_mfma_f32_16x16x32_bf16 a[72:75], a[204:207], v[208:211], a[72:75]
    ds_read_b128 a[200:203], v62 offset:43008
    v_cvt_pk_bf16_f32 v48, v152, v153
    v_mfma_f32_16x16x32_bf16 a[76:79], a[204:207], v[212:215], a[76:79]
    ds_read_b128 v[28:31], v10 offset:13312
    v_cvt_pk_bf16_f32 v49, v154, v155
    v_mfma_f32_16x16x32_bf16 a[80:83], a[204:207], v[216:219], a[80:83]
    s_waitcnt lgkmcnt(4)
    v_mfma_f32_16x16x32_bf16 a[96:99], a[208:211], v[208:211], a[96:99]
    ds_read_b128 a[204:207], v62 offset:44032
    v_mfma_f32_16x16x32_bf16 a[100:103], a[208:211], v[212:215], a[100:103]
    v_add_f32 v176, v176, v32
    v_add_f32 v177, v177, v33
    v_mfma_f32_16x16x32_bf16 a[104:107], a[208:211], v[216:219], a[104:107]
    v_add_f32 v178, v178, v34
    v_add_f32 v179, v179, v35
    v_mfma_f32_16x16x32_bf16 v[64:67], a[192:195], a[120:123], v[64:67]
    ds_read_b128 a[208:211], v62 offset:45056
    v_cvt_pk_bf16_f32 v50, v176, v177
    v_mfma_f32_16x16x32_bf16 v[68:71], a[192:195], a[124:127], v[68:71]
    ds_read_b128 v[32:35], v10 offset:14336
    v_cvt_pk_bf16_f32 v51, v178, v179
    s_add_u32 s57, s57, 4096
    v_mfma_f32_16x16x32_bf16 v[72:75], a[192:195], a[128:131], v[72:75]
    s_waitcnt lgkmcnt(4)
    buffer_store_dwordx4 v[48:51], v8, s[88:91], s57 offen offset:0 sc1
    v_mfma_f32_16x16x32_bf16 v[88:91], a[196:199], a[120:123], v[88:91]
    ds_read_b128 a[192:195], v63 offset:40960
    v_mfma_f32_16x16x32_bf16 v[92:95], a[196:199], a[124:127], v[92:95]
    v_add_f32 v84, v84, v16
    v_add_f32 v85, v85, v17
    v_mfma_f32_16x16x32_bf16 v[96:99], a[196:199], a[128:131], v[96:99]
    v_add_f32 v86, v86, v18
    v_add_f32 v87, v87, v19
    v_mfma_f32_16x16x32_bf16 v[112:115], a[200:203], a[120:123], v[112:115]
    ds_read_b128 a[196:199], v63 offset:41984
    v_cvt_pk_bf16_f32 v52, v84, v85
    v_mfma_f32_16x16x32_bf16 v[116:119], a[200:203], a[124:127], v[116:119]
    v_cvt_pk_bf16_f32 v53, v86, v87
    v_mfma_f32_16x16x32_bf16 v[120:123], a[200:203], a[128:131], v[120:123]
    s_waitcnt lgkmcnt(3)
    v_mfma_f32_16x16x32_bf16 v[136:139], a[204:207], a[120:123], v[136:139]
    ds_read_b128 a[200:203], v63 offset:43008
    v_mfma_f32_16x16x32_bf16 v[140:143], a[204:207], a[124:127], v[140:143]
    v_add_f32 v108, v108, v20
    v_add_f32 v109, v109, v21
    v_mfma_f32_16x16x32_bf16 v[144:147], a[204:207], a[128:131], v[144:147]
    v_add_f32 v110, v110, v22
    v_add_f32 v111, v111, v23
    v_mfma_f32_16x16x32_bf16 v[160:163], a[208:211], a[120:123], v[160:163]
    ds_read_b128 a[204:207], v63 offset:44032
    v_cvt_pk_bf16_f32 v54, v108, v109
    v_mfma_f32_16x16x32_bf16 v[164:167], a[208:211], a[124:127], v[164:167]
    v_cvt_pk_bf16_f32 v55, v110, v111
    v_mfma_f32_16x16x32_bf16 v[168:171], a[208:211], a[128:131], v[168:171]
    s_waitcnt lgkmcnt(2)
    buffer_store_dwordx4 v[52:55], v8, s[88:91], s57 offen offset:1024 sc1
    v_mfma_f32_16x16x32_bf16 a[0:3], a[192:195], a[120:123], a[0:3]
    ds_read_b128 a[208:211], v63 offset:45056
    v_mfma_f32_16x16x32_bf16 a[4:7], a[192:195], a[124:127], a[4:7]
    v_add_f32 v132, v132, v24
    v_add_f32 v133, v133, v25
    v_mfma_f32_16x16x32_bf16 a[8:11], a[192:195], a[128:131], a[8:11]
    v_add_f32 v134, v134, v26
    v_add_f32 v135, v135, v27
    v_mfma_f32_16x16x32_bf16 a[24:27], a[196:199], a[120:123], a[24:27]
    ds_read_b128 a[192:195], v40 offset:0
    v_cvt_pk_bf16_f32 v48, v132, v133
    v_mfma_f32_16x16x32_bf16 a[28:31], a[196:199], a[124:127], a[28:31]
    v_cvt_pk_bf16_f32 v49, v134, v135
    v_mfma_f32_16x16x32_bf16 a[32:35], a[196:199], a[128:131], a[32:35]
    s_waitcnt lgkmcnt(2)
    v_mfma_f32_16x16x32_bf16 a[48:51], a[200:203], a[120:123], a[48:51]
    ds_read_b128 a[196:199], v40 offset:1024
    v_mfma_f32_16x16x32_bf16 a[52:55], a[200:203], a[124:127], a[52:55]
    v_add_f32 v156, v156, v28
    v_add_f32 v157, v157, v29
    v_mfma_f32_16x16x32_bf16 a[56:59], a[200:203], a[128:131], a[56:59]
    v_add_f32 v158, v158, v30
    v_add_f32 v159, v159, v31
    v_mfma_f32_16x16x32_bf16 a[72:75], a[204:207], a[120:123], a[72:75]
    ds_read_b128 a[200:203], v40 offset:2048
    v_cvt_pk_bf16_f32 v50, v156, v157
    v_mfma_f32_16x16x32_bf16 a[76:79], a[204:207], a[124:127], a[76:79]
    v_cvt_pk_bf16_f32 v51, v158, v159
    v_mfma_f32_16x16x32_bf16 a[80:83], a[204:207], a[128:131], a[80:83]
    s_waitcnt lgkmcnt(2)
    buffer_store_dwordx4 v[48:51], v8, s[88:91], s57 offen offset:2048 sc1
    v_mfma_f32_16x16x32_bf16 a[96:99], a[208:211], a[120:123], a[96:99]
    ds_read_b128 a[204:207], v40 offset:3072
    v_mfma_f32_16x16x32_bf16 a[100:103], a[208:211], a[124:127], a[100:103]
    v_add_f32 v180, v180, v32
    v_add_f32 v181, v181, v33
    v_mfma_f32_16x16x32_bf16 a[104:107], a[208:211], a[128:131], a[104:107]
    v_add_f32 v182, v182, v34
    v_add_f32 v183, v183, v35
    v_mfma_f32_16x16x32_bf16 v[64:67], a[192:195], v[232:235], v[64:67]
    ds_read_b128 a[208:211], v40 offset:4096
    v_cvt_pk_bf16_f32 v52, v180, v181
    v_mfma_f32_16x16x32_bf16 v[68:71], a[192:195], v[236:239], v[68:71]
    v_cvt_pk_bf16_f32 v53, v182, v183
    v_mfma_f32_16x16x32_bf16 v[72:75], a[192:195], v[240:243], v[72:75]
    s_waitcnt lgkmcnt(2)
    buffer_store_dwordx4 v[52:55], v8, s[88:91], s57 offen offset:3072 sc1
    v_mfma_f32_16x16x32_bf16 v[88:91], a[196:199], v[232:235], v[88:91]
    ds_read_b128 a[192:195], v41 offset:0
    v_mfma_f32_16x16x32_bf16 v[92:95], a[196:199], v[236:239], v[92:95]
    v_mfma_f32_16x16x32_bf16 v[96:99], a[196:199], v[240:243], v[96:99]
    v_mfma_f32_16x16x32_bf16 v[112:115], a[200:203], v[232:235], v[112:115]
    ds_read_b128 a[196:199], v41 offset:1024
    v_mfma_f32_16x16x32_bf16 v[116:119], a[200:203], v[236:239], v[116:119]
    v_mfma_f32_16x16x32_bf16 v[120:123], a[200:203], v[240:243], v[120:123]
    s_waitcnt lgkmcnt(2)
    v_mfma_f32_16x16x32_bf16 v[136:139], a[204:207], v[232:235], v[136:139]
    ds_read_b128 a[200:203], v41 offset:2048
    v_mfma_f32_16x16x32_bf16 v[140:143], a[204:207], v[236:239], v[140:143]
    v_mfma_f32_16x16x32_bf16 v[144:147], a[204:207], v[240:243], v[144:147]
    v_mfma_f32_16x16x32_bf16 v[160:163], a[208:211], v[232:235], v[160:163]
    ds_read_b128 a[204:207], v41 offset:3072
    v_mfma_f32_16x16x32_bf16 v[164:167], a[208:211], v[236:239], v[164:167]
    v_mfma_f32_16x16x32_bf16 v[168:171], a[208:211], v[240:243], v[168:171]
    s_waitcnt lgkmcnt(2)
    v_mfma_f32_16x16x32_bf16 a[0:3], a[192:195], v[232:235], a[0:3]
    ds_read_b128 a[208:211], v41 offset:4096
    v_mfma_f32_16x16x32_bf16 a[4:7], a[192:195], v[236:239], a[4:7]
    v_mfma_f32_16x16x32_bf16 a[8:11], a[192:195], v[240:243], a[8:11]
    v_mfma_f32_16x16x32_bf16 a[24:27], a[196:199], v[232:235], a[24:27]
    ds_read_b128 a[192:195], v41 offset:20480
    v_mfma_f32_16x16x32_bf16 a[28:31], a[196:199], v[236:239], a[28:31]
    v_mfma_f32_16x16x32_bf16 a[32:35], a[196:199], v[240:243], a[32:35]
    s_waitcnt lgkmcnt(2)
    v_mfma_f32_16x16x32_bf16 a[48:51], a[200:203], v[232:235], a[48:51]
    ds_read_b128 a[196:199], v41 offset:21504
    v_mfma_f32_16x16x32_bf16 a[52:55], a[200:203], v[236:239], a[52:55]
    v_mfma_f32_16x16x32_bf16 a[56:59], a[200:203], v[240:243], a[56:59]
    v_mfma_f32_16x16x32_bf16 a[72:75], a[204:207], v[232:235], a[72:75]
    ds_read_b128 a[200:203], v41 offset:22528
    v_mfma_f32_16x16x32_bf16 a[76:79], a[204:207], v[236:239], a[76:79]
    v_mfma_f32_16x16x32_bf16 a[80:83], a[204:207], v[240:243], a[80:83]
    s_waitcnt lgkmcnt(2)
    v_mfma_f32_16x16x32_bf16 a[96:99], a[208:211], v[232:235], a[96:99]
    ds_read_b128 a[204:207], v41 offset:23552
    v_mfma_f32_16x16x32_bf16 a[100:103], a[208:211], v[236:239], a[100:103]
    v_mfma_f32_16x16x32_bf16 a[104:107], a[208:211], v[240:243], a[104:107]
    v_mfma_f32_16x16x32_bf16 a[0:3], a[192:195], a[144:147], a[0:3]
    ds_read_b128 a[208:211], v41 offset:24576
    v_mfma_f32_16x16x32_bf16 a[4:7], a[192:195], a[148:151], a[4:7]
    s_waitcnt vmcnt(0)
    buffer_store_dword v15, v46, s[88:91], s94 offen sc1
    v_mfma_f32_16x16x32_bf16 a[8:11], a[192:195], a[152:155], a[8:11]
    s_waitcnt lgkmcnt(2)
    v_mfma_f32_16x16x32_bf16 a[24:27], a[196:199], a[144:147], a[24:27]
    ds_read_b128 a[192:195], v40 offset:20480
    v_mfma_f32_16x16x32_bf16 a[28:31], a[196:199], a[148:151], a[28:31]
    ds_write_b128 v10, a[0:3] offset:0
    v_mfma_f32_16x16x32_bf16 a[32:35], a[196:199], a[152:155], a[32:35]
    ds_write_b128 v10, a[4:7] offset:5120
    v_mfma_f32_16x16x32_bf16 a[48:51], a[200:203], a[144:147], a[48:51]
    ds_read_b128 a[196:199], v40 offset:21504
    v_mfma_f32_16x16x32_bf16 a[52:55], a[200:203], a[148:151], a[52:55]
    ds_write_b128 v10, a[8:11] offset:10240
    v_mfma_f32_16x16x32_bf16 a[56:59], a[200:203], a[152:155], a[56:59]
    s_waitcnt lgkmcnt(5)
    ds_write_b128 v10, a[24:27] offset:1024
    v_mfma_f32_16x16x32_bf16 a[72:75], a[204:207], a[144:147], a[72:75]
    ds_read_b128 a[200:203], v40 offset:22528
    v_mfma_f32_16x16x32_bf16 a[76:79], a[204:207], a[148:151], a[76:79]
    ds_write_b128 v10, a[28:31] offset:6144
    v_mfma_f32_16x16x32_bf16 a[80:83], a[204:207], a[152:155], a[80:83]
    ds_write_b128 v10, a[32:35] offset:11264
    v_mfma_f32_16x16x32_bf16 a[96:99], a[208:211], a[144:147], a[96:99]
    ds_read_b128 a[204:207], v40 offset:23552
    v_mfma_f32_16x16x32_bf16 a[100:103], a[208:211], a[148:151], a[100:103]
    ds_write_b128 v10, a[48:51] offset:2048
    v_mfma_f32_16x16x32_bf16 a[104:107], a[208:211], a[152:155], a[104:107]
    s_waitcnt lgkmcnt(7)
    ds_write_b128 v10, a[52:55] offset:7168
    v_mfma_f32_16x16x32_bf16 v[64:67], a[192:195], a[144:147], v[64:67]
    ds_read_b128 a[208:211], v40 offset:24576
    v_mfma_f32_16x16x32_bf16 v[68:71], a[192:195], a[148:151], v[68:71]
    ds_write_b128 v10, a[56:59] offset:12288
    v_mfma_f32_16x16x32_bf16 v[72:75], a[192:195], a[152:155], v[72:75]
    ds_write_b128 v10, a[72:75] offset:3072
    v_mfma_f32_16x16x32_bf16 v[88:91], a[196:199], a[144:147], v[88:91]
    ds_write_b128 v10, a[76:79] offset:8192
    v_mfma_f32_16x16x32_bf16 v[92:95], a[196:199], a[148:151], v[92:95]
    ds_write_b128 v10, a[80:83] offset:13312
    v_mfma_f32_16x16x32_bf16 v[96:99], a[196:199], a[152:155], v[96:99]
    s_waitcnt lgkmcnt(7)
    ds_write_b128 v10, a[96:99] offset:4096
    v_mfma_f32_16x16x32_bf16 v[112:115], a[200:203], a[144:147], v[112:115]
    ds_write_b128 v10, a[100:103] offset:9216
    v_mfma_f32_16x16x32_bf16 v[116:119], a[200:203], a[148:151], v[116:119]
    ds_write_b128 v10, a[104:107] offset:14336
    v_mfma_f32_16x16x32_bf16 v[120:123], a[200:203], a[152:155], v[120:123]
    v_mfma_f32_16x16x32_bf16 v[136:139], a[204:207], a[144:147], v[136:139]
    v_mfma_f32_16x16x32_bf16 v[140:143], a[204:207], a[148:151], v[140:143]
    v_mfma_f32_16x16x32_bf16 v[144:147], a[204:207], a[152:155], v[144:147]
    s_waitcnt lgkmcnt(7)
    v_mfma_f32_16x16x32_bf16 v[160:163], a[208:211], a[144:147], v[160:163]
    v_mfma_f32_16x16x32_bf16 v[164:167], a[208:211], a[148:151], v[164:167]
    v_mfma_f32_16x16x32_bf16 v[168:171], a[208:211], a[152:155], v[168:171]
    buffer_load_dword v60, off, s[88:91], s93 sc1
    s_waitcnt lgkmcnt(0)
    s_barrier
    ds_read_b128 v[184:187], v9 offset:0
    ds_read_b128 v[188:191], v9 offset:1024
    ds_read_b128 v[192:195], v9 offset:2048
    ds_read_b128 v[196:199], v9 offset:3072
    ds_read_b128 v[200:203], v9 offset:4096
    ds_read_b128 v[204:207], v9 offset:5120
    ds_read_b128 v[208:211], v9 offset:6144
    ds_read_b128 v[212:215], v9 offset:7168
    ds_read_b128 v[216:219], v9 offset:8192
    ds_read_b128 v[220:223], v9 offset:9216
    ds_read_b128 v[224:227], v9 offset:10240
    ds_read_b128 v[228:231], v9 offset:11264
    ds_read_b128 v[232:235], v9 offset:12288
    ds_read_b128 v[236:239], v9 offset:13312
    ds_read_b128 v[240:243], v9 offset:14336
    s_mov_b32 s55, 0x100000
    s_branch L_xchk
L_xpoll:
    buffer_load_dword v60, off, s[88:91], s93 sc1
L_xchk:
    s_waitcnt vmcnt(0)
    v_readfirstlane_b32 s52, v60
    s_nop 3
    s_cmp_eq_u32 s52, 1
    s_cbranch_scc1 L_xgo
    s_sub_u32 s55, s55, 1
    s_cmp_lg_u32 s55, 0
    s_cbranch_scc1 L_xpoll
L_xgo:
    buffer_load_dwordx4 v[16:19], v8, s[88:91], s56 offen offset:0 sc1
    buffer_load_dwordx4 v[20:23], v8, s[88:91], s56 offen offset:1024 sc1
    buffer_load_dwordx4 v[24:27], v8, s[88:91], s56 offen offset:2048 sc1
    buffer_load_dwordx4 v[28:31], v8, s[88:91], s56 offen offset:3072 sc1
    s_add_u32 s56, s56, 4096
    buffer_load_dwordx4 v[32:35], v8, s[88:91], s56 offen offset:0 sc1
    buffer_load_dwordx4 v[40:43], v8, s[88:91], s56 offen offset:1024 sc1
    buffer_load_dwordx4 v[44:47], v8, s[88:91], s56 offen offset:2048 sc1
    buffer_load_dwordx4 v[48:51], v8, s[88:91], s56 offen offset:3072 sc1
    s_waitcnt lgkmcnt(14)
    v_pk_add_f32 v[64:65], v[64:65], v[184:185]
    v_pk_add_f32 v[66:67], v[66:67], v[186:187]
    s_waitcnt lgkmcnt(13)
    v_pk_add_f32 v[88:89], v[88:89], v[188:189]
    v_pk_add_f32 v[90:91], v[90:91], v[190:191]
    s_waitcnt lgkmcnt(12)
    v_pk_add_f32 v[112:113], v[112:113], v[192:193]
    v_pk_add_f32 v[114:115], v[114:115], v[194:195]
    s_waitcnt lgkmcnt(11)
    v_pk_add_f32 v[136:137], v[136:137], v[196:197]
    v_pk_add_f32 v[138:139], v[138:139], v[198:199]
    s_waitcnt lgkmcnt(10)
    v_pk_add_f32 v[160:161], v[160:161], v[200:201]
    v_pk_add_f32 v[162:163], v[162:163], v[202:203]
    s_waitcnt lgkmcnt(9)
    v_pk_add_f32 v[68:69], v[68:69], v[204:205]
    v_pk_add_f32 v[70:71], v[70:71], v[206:207]
    s_waitcnt lgkmcnt(8)
    v_pk_add_f32 v[92:93], v[92:93], v[208:209]
    v_pk_add_f32 v[94:95], v[94:95], v[210:211]
    s_waitcnt lgkmcnt(7)
    v_pk_add_f32 v[116:117], v[116:117], v[212:213]
    v_pk_add_f32 v[118:119], v[118:119], v[214:215]
    s_waitcnt lgkmcnt(6)
    v_pk_add_f32 v[140:141], v[140:141], v[216:217]
    v_pk_add_f32 v[142:143], v[142:143], v[218:219]
    s_waitcnt lgkmcnt(5)
    v_pk_add_f32 v[164:165], v[164:165], v[220:221]
    v_pk_add_f32 v[166:167], v[166:167], v[222:223]
    s_waitcnt lgkmcnt(4)
    v_pk_add_f32 v[72:73], v[72:73], v[224:225]
    v_pk_add_f32 v[74:75], v[74:75], v[226:227]
    s_waitcnt lgkmcnt(3)
    v_pk_add_f32 v[96:97], v[96:97], v[228:229]
    v_pk_add_f32 v[98:99], v[98:99], v[230:231]
    s_waitcnt lgkmcnt(2)
    v_pk_add_f32 v[120:121], v[120:121], v[232:233]
    v_pk_add_f32 v[122:123], v[122:123], v[234:235]
    s_waitcnt lgkmcnt(1)
    v_pk_add_f32 v[144:145], v[144:145], v[236:237]
    v_pk_add_f32 v[146:147], v[146:147], v[238:239]
    s_waitcnt lgkmcnt(0)
    v_pk_add_f32 v[168:169], v[168:169], v[240:241]
    v_pk_add_f32 v[170:171], v[170:171], v[242:243]
    s_mov_b32 s53, 0
    s_waitcnt vmcnt(7)
    v_lshlrev_b32 v52, 16, v16
    v_and_b32 v53, 0xffff0000, v16
    v_lshlrev_b32 v54, 16, v17
    v_and_b32 v55, 0xffff0000, v17
    v_pk_add_f32 v[64:65], v[64:65], v[52:53]
    v_pk_add_f32 v[66:67], v[66:67], v[54:55]
    v_cvt_pk_bf16_f32 v184, v64, v65
    v_cvt_pk_bf16_f32 v185, v66, v67
    v_lshlrev_b32 v52, 16, v18
    v_and_b32 v53, 0xffff0000, v18
    v_lshlrev_b32 v54, 16, v19
    v_and_b32 v55, 0xffff0000, v19
    v_pk_add_f32 v[88:89], v[88:89], v[52:53]
    v_pk_add_f32 v[90:91], v[90:91], v[54:55]
    v_cvt_pk_bf16_f32 v186, v88, v89
    v_cvt_pk_bf16_f32 v187, v90, v91
    s_waitcnt vmcnt(6)
    v_lshlrev_b32 v52, 16, v20
    v_and_b32 v53, 0xffff0000, v20
    v_lshlrev_b32 v54, 16, v21
    v_and_b32 v55, 0xffff0000, v21
    v_pk_add_f32 v[112:113], v[112:113], v[52:53]
    v_pk_add_f32 v[114:115], v[114:115], v[54:55]
    v_cvt_pk_bf16_f32 v188, v112, v113
    v_cvt_pk_bf16_f32 v189, v114, v115
    v_permlane16_swap_b32 v184, v186
    v_permlane16_swap_b32 v185, v187
    buffer_store_dwordx4 v[184:187], v13, s[28:31], s53 offen offset:0
    v_lshlrev_b32 v52, 16, v22
    v_and_b32 v53, 0xffff0000, v22
    v_lshlrev_b32 v54, 16, v23
    v_and_b32 v55, 0xffff0000, v23
    v_pk_add_f32 v[136:137], v[136:137], v[52:53]
    v_pk_add_f32 v[138:139], v[138:139], v[54:55]
    v_cvt_pk_bf16_f32 v190, v136, v137
    v_cvt_pk_bf16_f32 v191, v138, v139
    s_waitcnt vmcnt(6)
    v_lshlrev_b32 v52, 16, v24
    v_and_b32 v53, 0xffff0000, v24
    v_lshlrev_b32 v54, 16, v25
    v_and_b32 v55, 0xffff0000, v25
    v_pk_add_f32 v[160:161], v[160:161], v[52:53]
    v_pk_add_f32 v[162:163], v[162:163], v[54:55]
    v_cvt_pk_bf16_f32 v192, v160, v161
    v_cvt_pk_bf16_f32 v193, v162, v163
    buffer_store_dwordx2 v[192:193], v11, s[28:31], s53 offen offset:128
    v_permlane16_swap_b32 v188, v190
    v_permlane16_swap_b32 v189, v191
    buffer_store_dwordx4 v[188:191], v13, s[28:31], s53 offen offset:64
    s_mov_b32 s53, 40960
    v_lshlrev_b32 v52, 16, v26
    v_and_b32 v53, 0xffff0000, v26
    v_lshlrev_b32 v54, 16, v27
    v_and_b32 v55, 0xffff0000, v27
    v_pk_add_f32 v[68:69], v[68:69], v[52:53]
    v_pk_add_f32 v[70:71], v[70:71], v[54:55]
    v_cvt_pk_bf16_f32 v196, v68, v69
    v_cvt_pk_bf16_f32 v197, v70, v71
    s_waitcnt vmcnt(7)
    v_lshlrev_b32 v52, 16, v28
    v_and_b32 v53, 0xffff0000, v28
    v_lshlrev_b32 v54, 16, v29
    v_and_b32 v55, 0xffff0000, v29
    v_pk_add_f32 v[92:93], v[92:93], v[52:53]
    v_pk_add_f32 v[94:95], v[94:95], v[54:55]
    v_cvt_pk_bf16_f32 v198, v92, v93
    v_cvt_pk_bf16_f32 v199, v94, v95
    v_lshlrev_b32 v52, 16, v30
    v_and_b32 v53, 0xffff0000, v30
    v_lshlrev_b32 v54, 16, v31
    v_and_b32 v55, 0xffff0000, v31
    v_pk_add_f32 v[116:117], v[116:117], v[52:53]
    v_pk_add_f32 v[118:119], v[118:119], v[54:55]
    v_cvt_pk_bf16_f32 v200, v116, v117
    v_cvt_pk_bf16_f32 v201, v118, v119
    v_permlane16_swap_b32 v196, v198
    v_permlane16_swap_b32 v197, v199
    buffer_store_dwordx4 v[196:199], v13, s[28:31], s53 offen offset:0
    s_waitcnt vmcnt(7)
    v_lshlrev_b32 v52, 16, v32
    v_and_b32 v53, 0xffff0000, v32
    v_lshlrev_b32 v54, 16, v33
    v_and_b32 v55, 0xffff0000, v33
    v_pk_add_f32 v[140:141], v[140:141], v[52:53]
    v_pk_add_f32 v[142:143], v[142:143], v[54:55]
    v_cvt_pk_bf16_f32 v202, v140, v141
    v_cvt_pk_bf16_f32 v203, v142, v143
    v_lshlrev_b32 v52, 16, v34
    v_and_b32 v53, 0xffff0000, v34
    v_lshlrev_b32 v54, 16, v35
    v_and_b32 v55, 0xffff0000, v35
    v_pk_add_f32 v[164:165], v[164:165], v[52:53]
    v_pk_add_f32 v[166:167], v[166:167], v[54:55]
    v_cvt_pk_bf16_f32 v204, v164, v165
    v_cvt_pk_bf16_f32 v205, v166, v167
    buffer_store_dwordx2 v[204:205], v11, s[28:31], s53 offen offset:128
    v_permlane16_swap_b32 v200, v202
    v_permlane16_swap_b32 v201, v203
    buffer_store_dwordx4 v[200:203], v13, s[28:31], s53 offen offset:64
    s_mov_b32 s53, 81920
    s_waitcnt vmcnt(8)
    v_lshlrev_b32 v52, 16, v40
    v_and_b32 v53, 0xffff0000, v40
    v_lshlrev_b32 v54, 16, v41
    v_and_b32 v55, 0xffff0000, v41
    v_pk_add_f32 v[72:73], v[72:73], v[52:53]
    v_pk_add_f32 v[74:75], v[74:75], v[54:55]
    v_cvt_pk_bf16_f32 v208, v72, v73
    v_cvt_pk_bf16_f32 v209, v74, v75
    v_lshlrev_b32 v52, 16, v42
    v_and_b32 v53, 0xffff0000, v42
    v_lshlrev_b32 v54, 16, v43
    v_and_b32 v55, 0xffff0000, v43
    v_pk_add_f32 v[96:97], v[96:97], v[52:53]
    v_pk_add_f32 v[98:99], v[98:99], v[54:55]
    v_cvt_pk_bf16_f32 v210, v96, v97
    v_cvt_pk_bf16_f32 v211, v98, v99
    s_waitcnt vmcnt(7)
    v_lshlrev_b32 v52, 16, v44
    v_and_b32 v53, 0xffff0000, v44
    v_lshlrev_b32 v54, 16, v45
    v_and_b32 v55, 0xffff0000, v45
    v_pk_add_f32 v[120:121], v[120:121], v[52:53]
    v_pk_add_f32 v[122:123], v[122:123], v[54:55]
    v_cvt_pk_bf16_f32 v212, v120, v121
    v_cvt_pk_bf16_f32 v213, v122, v123
    v_permlane16_swap_b32 v208, v210
    v_permlane16_swap_b32 v209, v211
    buffer_store_dwordx4 v[208:211], v13, s[28:31], s53 offen offset:0
    v_lshlrev_b32 v52, 16, v46
    v_and_b32 v53, 0xffff0000, v46
    v_lshlrev_b32 v54, 16, v47
    v_and_b32 v55, 0xffff0000, v47
    v_pk_add_f32 v[144:145], v[144:145], v[52:53]
    v_pk_add_f32 v[146:147], v[146:147], v[54:55]
    v_cvt_pk_bf16_f32 v214, v144, v145
    v_cvt_pk_bf16_f32 v215, v146, v147
    s_waitcnt vmcnt(7)
    v_lshlrev_b32 v52, 16, v48
    v_and_b32 v53, 0xffff0000, v48
    v_lshlrev_b32 v54, 16, v49
    v_and_b32 v55, 0xffff0000, v49
    v_pk_add_f32 v[168:169], v[168:169], v[52:53]
    v_pk_add_f32 v[170:171], v[170:171], v[54:55]
    v_cvt_pk_bf16_f32 v216, v168, v169
    v_cvt_pk_bf16_f32 v217, v170, v171
    buffer_store_dwordx2 v[216:217], v11, s[28:31], s53 offen offset:128
    v_permlane16_swap_b32 v212, v214
    v_permlane16_swap_b32 v213, v215
    buffer_store_dwordx4 v[212:215], v13, s[28:31], s53 offen offset:64
L_end:
    s_endpgm
L_oparm:
    s_mov_b32 s79, 0
    s_branch L_opbody
L_oppoll:
    s_mov_b32 s79, s77
    s_mov_b32 s55, 0x40000
L_oppoll1:
    v_cmp_eq_u32 vcc, 1, v61
    s_nop 4
    s_and_b32 s52, vcc_lo, 15
    s_cmp_eq_u32 s52, 15
    s_cbranch_scc1 L_opbody
    buffer_load_dword v61, v2, s[88:91], 0 offen sc1
    s_waitcnt vmcnt(0)
    s_sub_u32 s55, s55, 1
    s_cmp_lg_u32 s55, 0
    s_cbranch_scc1 L_oppoll1
    s_branch L_opbody
L_sig0:
    s_cmp_eq_u32 s7, 0
    s_cbranch_scc1 L_nosig0
    s_lshl_b32 s52, s36, 2
    v_mov_b32 v49, 0x1
    v_mov_b32 v48, s52
    s_mov_b64 exec, 1
    buffer_atomic_add v49, v48, s[32:35], 0 offen sc1
    s_mov_b64 exec, -1
    s_branch L_nosig0
L_polla0:
    s_lshr_b32 s53, s36, 4
    s_lshl_b32 s53, s53, 6
    v_and_b32 v187, 15, v1
    v_lshlrev_b32 v187, 2, v187
    s_mov_b32 s55, 0x40000
L_polla:
    buffer_load_dword v188, v187, s[32:35], s53 offen sc1
    s_waitcnt vmcnt(0)
    v_and_b32 v188, 0xff, v188
    v_cmp_gt_u32 vcc, 8, v188
    s_nop 4
    s_cbranch_vccz L_pollret0
    s_sleep 8
    s_sub_u32 s55, s55, 1
    s_cmp_lg_u32 s55, 0
    s_cbranch_scc1 L_polla
    s_branch L_pollret0
L_codeend:
L_slow:
    s_lshl_b32 s52, s7, 21
    s_add_u32 s80, s72, s52
    s_addc_u32 s81, s73, 0
    s_mov_b32 s82, 131072
    s_mov_b32 s83, 0x20000
    s_add_u32 s76, s74, s52
    s_addc_u32 s77, s75, 0
    s_mov_b32 s78, 131072
    s_mov_b32 s79, 0x20000
    v_and_b32 v184, 15, v1
    v_lshrrev_b32 v185, 4, v1
    v_lshlrev_b32 v186, 1, v184
    v_lshlrev_b32 v184, 8, v184
    v_lshl_add_u32 v184, v185, 4, v184
    v_lshl_add_u32 v185, v185, 10, v186
    v_mov_b32 v40, 0xff800000
    v_mov_b32 v44, 0xff800000
    v_mov_b32 v48, 0xff800000
    v_mov_b32 v52, 0xff800000
    v_mov_b32 v56, 0xff800000
    v_mov_b32 v60, 0xff800000
    s_mov_b32 s52, 0
L_slow1:
    s_add_u32 s53, s52, 0
    buffer_load_dwordx4 v[64:67], v184, s[80:83], s53 offen offset:0
    buffer_load_dwordx4 v[68:71], v184, s[80:83], s53 offen offset:64
    buffer_load_dwordx4 v[72:75], v184, s[80:83], s53 offen offset:128
    buffer_load_dwordx4 v[76:79], v184, s[80:83], s53 offen offset:192
    s_add_u32 s53, s52, 4096
    buffer_load_dwordx4 v[80:83], v184, s[80:83], s53 offen offset:0
    buffer_load_dwordx4 v[84:87], v184, s[80:83], s53 offen offset:64
    buffer_load_dwordx4 v[88:91], v184, s[80:83], s53 offen offset:128
    buffer_load_dwordx4 v[92:95], v184, s[80:83], s53 offen offset:192
    s_waitcnt vmcnt(0)
    v_mfma_f32_16x16x32_bf16 v[160:163], v[64:67], a[192:195], 0
    v_mfma_f32_16x16x32_bf16 v[160:163], v[68:71], a[196:199], v[160:163]
    v_mfma_f32_16x16x32_bf16 v[160:163], v[72:75], a[200:203], v[160:163]
    v_mfma_f32_16x16x32_bf16 v[160:163], v[76:79], a[204:207], v[160:163]
    v_mfma_f32_16x16x32_bf16 v[164:167], v[80:83], a[192:195], 0
    v_mfma_f32_16x16x32_bf16 v[164:167], v[84:87], a[196:199], v[164:167]
    v_mfma_f32_16x16x32_bf16 v[164:167], v[88:91], a[200:203], v[164:167]
    v_mfma_f32_16x16x32_bf16 v[164:167], v[92:95], a[204:207], v[164:167]
    s_nop 7
    s_nop 3
    v_max3_f32 v40, v40, v160, v161
    v_max3_f32 v40, v40, v162, v163
    v_max3_f32 v40, v40, v164, v165
    v_max3_f32 v40, v40, v166, v167
    v_mfma_f32_16x16x32_bf16 v[160:163], v[64:67], a[208:211], 0
    v_mfma_f32_16x16x32_bf16 v[160:163], v[68:71], a[212:215], v[160:163]
    v_mfma_f32_16x16x32_bf16 v[160:163], v[72:75], a[216:219], v[160:163]
    v_mfma_f32_16x16x32_bf16 v[160:163], v[76:79], a[220:223], v[160:163]
    v_mfma_f32_16x16x32_bf16 v[164:167], v[80:83], a[208:211], 0
    v_mfma_f32_16x16x32_bf16 v[164:167], v[84:87], a[212:215], v[164:167]
    v_mfma_f32_16x16x32_bf16 v[164:167], v[88:91], a[216:219], v[164:167]
    v_mfma_f32_16x16x32_bf16 v[164:167], v[92:95], a[220:223], v[164:167]
    s_nop 7
    s_nop 3
    v_max3_f32 v44, v44, v160, v161
    v_max3_f32 v44, v44, v162, v163
    v_max3_f32 v44, v44, v164, v165
    v_max3_f32 v44, v44, v166, v167
    v_mfma_f32_16x16x32_bf16 v[160:163], v[64:67], a[224:227], 0
    v_mfma_f32_16x16x32_bf16 v[160:163], v[68:71], a[228:231], v[160:163]
    v_mfma_f32_16x16x32_bf16 v[160:163], v[72:75], a[232:235], v[160:163]
    v_mfma_f32_16x16x32_bf16 v[160:163], v[76:79], a[236:239], v[160:163]
    v_mfma_f32_16x16x32_bf16 v[164:167], v[80:83], a[224:227], 0
    v_mfma_f32_16x16x32_bf16 v[164:167], v[84:87], a[228:231], v[164:167]
    v_mfma_f32_16x16x32_bf16 v[164:167], v[88:91], a[232:235], v[164:167]
    v_mfma_f32_16x16x32_bf16 v[164:167], v[92:95], a[236:239], v[164:167]
    s_nop 7
    s_nop 3
    v_max3_f32 v48, v48, v160, v161
    v_max3_f32 v48, v48, v162, v163
    v_max3_f32 v48, v48, v164, v165
    v_max3_f32 v48, v48, v166, v167
    v_mfma_f32_16x16x32_bf16 v[160:163], v[64:67], a[240:243], 0
    v_mfma_f32_16x16x32_bf16 v[160:163], v[68:71], a[244:247], v[160:163]
    v_mfma_f32_16x16x32_bf16 v[160:163], v[72:75], a[248:251], v[160:163]
    v_mfma_f32_16x16x32_bf16 v[160:163], v[76:79], a[252:255], v[160:163]
    v_mfma_f32_16x16x32_bf16 v[164:167], v[80:83], a[240:243], 0
    v_mfma_f32_16x16x32_bf16 v[164:167], v[84:87], a[244:247], v[164:167]
    v_mfma_f32_16x16x32_bf16 v[164:167], v[88:91], a[248:251], v[164:167]
    v_mfma_f32_16x16x32_bf16 v[164:167], v[92:95], a[252:255], v[164:167]
    s_nop 7
    s_nop 3
    v_max3_f32 v52, v52, v160, v161
    v_max3_f32 v52, v52, v162, v163
    v_max3_f32 v52, v52, v164, v165
    v_max3_f32 v52, v52, v166, v167
    v_mfma_f32_16x16x32_bf16 v[160:163], v[64:67], v[192:195], 0
    v_mfma_f32_16x16x32_bf16 v[160:163], v[68:71], v[196:199], v[160:163]
    v_mfma_f32_16x16x32_bf16 v[160:163], v[72:75], v[200:203], v[160:163]
    v_mfma_f32_16x16x32_bf16 v[160:163], v[76:79], v[204:207], v[160:163]
    v_mfma_f32_16x16x32_bf16 v[164:167], v[80:83], v[192:195], 0
    v_mfma_f32_16x16x32_bf16 v[164:167], v[84:87], v[196:199], v[164:167]
    v_mfma_f32_16x16x32_bf16 v[164:167], v[88:91], v[200:203], v[164:167]
    v_mfma_f32_16x16x32_bf16 v[164:167], v[92:95], v[204:207], v[164:167]
    s_nop 7
    s_nop 3
    v_max3_f32 v56, v56, v160, v161
    v_max3_f32 v56, v56, v162, v163
    v_max3_f32 v56, v56, v164, v165
    v_max3_f32 v56, v56, v166, v167
    v_mfma_f32_16x16x32_bf16 v[160:163], v[64:67], v[224:227], 0
    v_mfma_f32_16x16x32_bf16 v[160:163], v[68:71], v[228:231], v[160:163]
    v_mfma_f32_16x16x32_bf16 v[160:163], v[72:75], v[232:235], v[160:163]
    v_mfma_f32_16x16x32_bf16 v[160:163], v[76:79], v[236:239], v[160:163]
    v_mfma_f32_16x16x32_bf16 v[164:167], v[80:83], v[224:227], 0
    v_mfma_f32_16x16x32_bf16 v[164:167], v[84:87], v[228:231], v[164:167]
    v_mfma_f32_16x16x32_bf16 v[164:167], v[88:91], v[232:235], v[164:167]
    v_mfma_f32_16x16x32_bf16 v[164:167], v[92:95], v[236:239], v[164:167]
    s_nop 7
    s_nop 3
    v_max3_f32 v60, v60, v160, v161
    v_max3_f32 v60, v60, v162, v163
    v_max3_f32 v60, v60, v164, v165
    v_max3_f32 v60, v60, v166, v167
    s_add_u32 s52, s52, 8192
    s_cmp_lg_u32 s52, 131072
    s_cbranch_scc1 L_slow1
    v_mov_b32 v41, v40
    s_nop 1
    v_permlane32_swap_b32 v40, v41
    v_max_f32 v40, v40, v41
    v_mov_b32 v41, v40
    s_nop 1
    v_permlane16_swap_b32 v40, v41
    v_max_f32 v40, v40, v41
    v_mul_f32 v40, -1.0, v40
    v_mov_b32 v41, v40
    v_mov_b32 v42, v40
    v_mov_b32 v43, v40
    v_mov_b32 v45, v44
    s_nop 1
    v_permlane32_swap_b32 v44, v45
    v_max_f32 v44, v44, v45
    v_mov_b32 v45, v44
    s_nop 1
    v_permlane16_swap_b32 v44, v45
    v_max_f32 v44, v44, v45
    v_mul_f32 v44, -1.0, v44
    v_mov_b32 v45, v44
    v_mov_b32 v46, v44
    v_mov_b32 v47, v44
    v_mov_b32 v49, v48
    s_nop 1
    v_permlane32_swap_b32 v48, v49
    v_max_f32 v48, v48, v49
    v_mov_b32 v49, v48
    s_nop 1
    v_permlane16_swap_b32 v48, v49
    v_max_f32 v48, v48, v49
    v_mul_f32 v48, -1.0, v48
    v_mov_b32 v49, v48
    v_mov_b32 v50, v48
    v_mov_b32 v51, v48
    v_mov_b32 v53, v52
    s_nop 1
    v_permlane32_swap_b32 v52, v53
    v_max_f32 v52, v52, v53
    v_mov_b32 v53, v52
    s_nop 1
    v_permlane16_swap_b32 v52, v53
    v_max_f32 v52, v52, v53
    v_mul_f32 v52, -1.0, v52
    v_mov_b32 v53, v52
    v_mov_b32 v54, v52
    v_mov_b32 v55, v52
    v_mov_b32 v57, v56
    s_nop 1
    v_permlane32_swap_b32 v56, v57
    v_max_f32 v56, v56, v57
    v_mov_b32 v57, v56
    s_nop 1
    v_permlane16_swap_b32 v56, v57
    v_max_f32 v56, v56, v57
    v_mul_f32 v56, -1.0, v56
    v_mov_b32 v57, v56
    v_mov_b32 v58, v56
    v_mov_b32 v59, v56
    v_mov_b32 v61, v60
    s_nop 1
    v_permlane32_swap_b32 v60, v61
    v_max_f32 v60, v60, v61
    v_mov_b32 v61, v60
    s_nop 1
    v_permlane16_swap_b32 v60, v61
    v_max_f32 v60, v60, v61
    v_mul_f32 v60, -1.0, v60
    v_mov_b32 v61, v60
    v_mov_b32 v62, v60
    v_mov_b32 v63, v60
    v_accvgpr_write_b32 a0, 0
    v_accvgpr_write_b32 a1, 0
    v_accvgpr_write_b32 a2, 0
    v_accvgpr_write_b32 a3, 0
    v_accvgpr_write_b32 a4, 0
    v_accvgpr_write_b32 a5, 0
    v_accvgpr_write_b32 a6, 0
    v_accvgpr_write_b32 a7, 0
    v_accvgpr_write_b32 a8, 0
    v_accvgpr_write_b32 a9, 0
    v_accvgpr_write_b32 a10, 0
    v_accvgpr_write_b32 a11, 0
    v_accvgpr_write_b32 a12, 0
    v_accvgpr_write_b32 a13, 0
    v_accvgpr_write_b32 a14, 0
    v_accvgpr_write_b32 a15, 0
    v_accvgpr_write_b32 a16, 0
    v_accvgpr_write_b32 a17, 0
    v_accvgpr_write_b32 a18, 0
    v_accvgpr_write_b32 a19, 0
    v_accvgpr_write_b32 a20, 0
    v_accvgpr_write_b32 a21, 0
    v_accvgpr_write_b32 a22, 0
    v_accvgpr_write_b32 a23, 0
    v_accvgpr_write_b32 a24, 0
    v_accvgpr_write_b32 a25, 0
    v_accvgpr_write_b32 a26, 0
    v_accvgpr_write_b32 a27, 0
    v_accvgpr_write_b32 a28, 0
    v_accvgpr_write_b32 a29, 0
    v_accvgpr_write_b32 a30, 0
    v_accvgpr_write_b32 a31, 0
    v_accvgpr_write_b32 a32, 0
    v_accvgpr_write_b32 a33, 0
    v_accvgpr_write_b32 a34, 0
    v_accvgpr_write_b32 a35, 0
    v_accvgpr_write_b32 a36, 0
    v_accvgpr_write_b32 a37, 0
    v_accvgpr_write_b32 a38, 0
    v_accvgpr_write_b32 a39, 0
    v_accvgpr_write_b32 a40, 0
    v_accvgpr_write_b32 a41, 0
    v_accvgpr_write_b32 a42, 0
    v_accvgpr_write_b32 a43, 0
    v_accvgpr_write_b32 a44, 0
    v_accvgpr_write_b32 a45, 0
    v_accvgpr_write_b32 a46, 0
    v_accvgpr_write_b32 a47, 0
    v_accvgpr_write_b32 a48, 0
    v_accvgpr_write_b32 a49, 0
    v_accvgpr_write_b32 a50, 0
    v_accvgpr_write_b32 a51, 0
    v_accvgpr_write_b32 a52, 0
    v_accvgpr_write_b32 a53, 0
    v_accvgpr_write_b32 a54, 0
    v_accvgpr_write_b32 a55, 0
    v_accvgpr_write_b32 a56, 0
    v_accvgpr_write_b32 a57, 0
    v_accvgpr_write_b32 a58, 0
    v_accvgpr_write_b32 a59, 0
    v_accvgpr_write_b32 a60, 0
    v_accvgpr_write_b32 a61, 0
    v_accvgpr_write_b32 a62, 0
    v_accvgpr_write_b32 a63, 0
    v_accvgpr_write_b32 a64, 0
    v_accvgpr_write_b32 a65, 0
    v_accvgpr_write_b32 a66, 0
    v_accvgpr_write_b32 a67, 0
    v_accvgpr_write_b32 a68, 0
    v_accvgpr_write_b32 a69, 0
    v_accvgpr_write_b32 a70, 0
    v_accvgpr_write_b32 a71, 0
    v_accvgpr_write_b32 a72, 0
    v_accvgpr_write_b32 a73, 0
    v_accvgpr_write_b32 a74, 0
    v_accvgpr_write_b32 a75, 0
    v_accvgpr_write_b32 a76, 0
    v_accvgpr_write_b32 a77, 0
    v_accvgpr_write_b32 a78, 0
    v_accvgpr_write_b32 a79, 0
    v_accvgpr_write_b32 a80, 0
    v_accvgpr_write_b32 a81, 0
    v_accvgpr_write_b32 a82, 0
    v_accvgpr_write_b32 a83, 0
    v_accvgpr_write_b32 a84, 0
    v_accvgpr_write_b32 a85, 0
    v_accvgpr_write_b32 a86, 0
    v_accvgpr_write_b32 a87, 0
    v_accvgpr_write_b32 a88, 0
    v_accvgpr_write_b32 a89, 0
    v_accvgpr_write_b32 a90, 0
    v_accvgpr_write_b32 a91, 0
    v_accvgpr_write_b32 a92, 0
    v_accvgpr_write_b32 a93, 0
    v_accvgpr_write_b32 a94, 0
    v_accvgpr_write_b32 a95, 0
    v_accvgpr_write_b32 a96, 0
    v_accvgpr_write_b32 a97, 0
    v_accvgpr_write_b32 a98, 0
    v_accvgpr_write_b32 a99, 0
    v_accvgpr_write_b32 a100, 0
    v_accvgpr_write_b32 a101, 0
    v_accvgpr_write_b32 a102, 0
    v_accvgpr_write_b32 a103, 0
    v_accvgpr_write_b32 a104, 0
    v_accvgpr_write_b32 a105, 0
    v_accvgpr_write_b32 a106, 0
    v_accvgpr_write_b32 a107, 0
    v_accvgpr_write_b32 a108, 0
    v_accvgpr_write_b32 a109, 0
    v_accvgpr_write_b32 a110, 0
    v_accvgpr_write_b32 a111, 0
    v_accvgpr_write_b32 a112, 0
    v_accvgpr_write_b32 a113, 0
    v_accvgpr_write_b32 a114, 0
    v_accvgpr_write_b32 a115, 0
    v_accvgpr_write_b32 a116, 0
    v_accvgpr_write_b32 a117, 0
    v_accvgpr_write_b32 a118, 0
    v_accvgpr_write_b32 a119, 0
    v_accvgpr_write_b32 a120, 0
    v_accvgpr_write_b32 a121, 0
    v_accvgpr_write_b32 a122, 0
    v_accvgpr_write_b32 a123, 0
    v_accvgpr_write_b32 a124, 0
    v_accvgpr_write_b32 a125, 0
    v_accvgpr_write_b32 a126, 0
    v_accvgpr_write_b32 a127, 0
    v_accvgpr_write_b32 a128, 0
    v_accvgpr_write_b32 a129, 0
    v_accvgpr_write_b32 a130, 0
    v_accvgpr_write_b32 a131, 0
    v_accvgpr_write_b32 a132, 0
    v_accvgpr_write_b32 a133, 0
    v_accvgpr_write_b32 a134, 0
    v_accvgpr_write_b32 a135, 0
    v_accvgpr_write_b32 a136, 0
    v_accvgpr_write_b32 a137, 0
    v_accvgpr_write_b32 a138, 0
    v_accvgpr_write_b32 a139, 0
    v_accvgpr_write_b32 a140, 0
    v_accvgpr_write_b32 a141, 0
    v_accvgpr_write_b32 a142, 0
    v_accvgpr_write_b32 a143, 0
    v_accvgpr_write_b32 a144, 0
    v_accvgpr_write_b32 a145, 0
    v_accvgpr_write_b32 a146, 0
    v_accvgpr_write_b32 a147, 0
    v_accvgpr_write_b32 a148, 0
    v_accvgpr_write_b32 a149, 0
    v_accvgpr_write_b32 a150, 0
    v_accvgpr_write_b32 a151, 0
    v_accvgpr_write_b32 a152, 0
    v_accvgpr_write_b32 a153, 0
    v_accvgpr_write_b32 a154, 0
    v_accvgpr_write_b32 a155, 0
    v_accvgpr_write_b32 a156, 0
    v_accvgpr_write_b32 a157, 0
    v_accvgpr_write_b32 a158, 0
    v_accvgpr_write_b32 a159, 0
    v_accvgpr_write_b32 a160, 0
    v_accvgpr_write_b32 a161, 0
    v_accvgpr_write_b32 a162, 0
    v_accvgpr_write_b32 a163, 0
    v_accvgpr_write_b32 a164, 0
    v_accvgpr_write_b32 a165, 0
    v_accvgpr_write_b32 a166, 0
    v_accvgpr_write_b32 a167, 0
    v_accvgpr_write_b32 a168, 0
    v_accvgpr_write_b32 a169, 0
    v_accvgpr_write_b32 a170, 0
    v_accvgpr_write_b32 a171, 0
    v_accvgpr_write_b32 a172, 0
    v_accvgpr_write_b32 a173, 0
    v_accvgpr_write_b32 a174, 0
    v_accvgpr_write_b32 a175, 0
    v_accvgpr_write_b32 a176, 0
    v_accvgpr_write_b32 a177, 0
    v_accvgpr_write_b32 a178, 0
    v_accvgpr_write_b32 a179, 0
    v_accvgpr_write_b32 a180, 0
    v_accvgpr_write_b32 a181, 0
    v_accvgpr_write_b32 a182, 0
    v_accvgpr_write_b32 a183, 0
    v_accvgpr_write_b32 a184, 0
    v_accvgpr_write_b32 a185, 0
    v_accvgpr_write_b32 a186, 0
    v_accvgpr_write_b32 a187, 0
    v_accvgpr_write_b32 a188, 0
    v_accvgpr_write_b32 a189, 0
    v_accvgpr_write_b32 a190, 0
    v_accvgpr_write_b32 a191, 0
    v_mov_b32 v208, 0
    v_mov_b32 v209, 0
    v_mov_b32 v210, 0
    v_mov_b32 v211, 0
    v_mov_b32 v212, 0
    v_mov_b32 v213, 0
    v_mov_b32 v214, 0
    v_mov_b32 v215, 0
    v_mov_b32 v216, 0
    v_mov_b32 v217, 0
    v_mov_b32 v218, 0
    v_mov_b32 v219, 0
    v_mov_b32 v220, 0
    v_mov_b32 v221, 0
    v_mov_b32 v222, 0
    v_mov_b32 v223, 0
    v_mov_b32 v240, 0
    v_mov_b32 v241, 0
    v_mov_b32 v242, 0
    v_mov_b32 v243, 0
    v_mov_b32 v244, 0
    v_mov_b32 v245, 0
    v_mov_b32 v246, 0
    v_mov_b32 v247, 0
    s_mov_b32 s52, 0
L_slow2:
    s_add_u32 s53, s52, 0
    buffer_load_dwordx4 v[64:67], v184, s[80:83], s53 offen offset:0
    buffer_load_dwordx4 v[68:71], v184, s[80:83], s53 offen offset:64
    buffer_load_dwordx4 v[72:75], v184, s[80:83], s53 offen offset:128
    buffer_load_dwordx4 v[76:79], v184, s[80:83], s53 offen offset:192
    s_add_u32 s53, s52, 4096
    buffer_load_dwordx4 v[80:83], v184, s[80:83], s53 offen offset:0
    buffer_load_dwordx4 v[84:87], v184, s[80:83], s53 offen offset:64
    buffer_load_dwordx4 v[88:91], v184, s[80:83], s53 offen offset:128
    buffer_load_dwordx4 v[92:95], v184, s[80:83], s53 offen offset:192
    s_add_u32 s53, s52, 0
    buffer_load_ushort v96, v185, s[76:79], s53 offen offset:0
    buffer_load_ushort v128, v185, s[76:79], s53 offen offset:256
    buffer_load_ushort v97, v185, s[76:79], s53 offen offset:512
    buffer_load_ushort v129, v185, s[76:79], s53 offen offset:768
    buffer_load_ushort v100, v185, s[76:79], s53 offen offset:32
    buffer_load_ushort v132, v185, s[76:79], s53 offen offset:288
    buffer_load_ushort v101, v185, s[76:79], s53 offen offset:544
    buffer_load_ushort v133, v185, s[76:79], s53 offen offset:800
    buffer_load_ushort v104, v185, s[76:79], s53 offen offset:64
    buffer_load_ushort v136, v185, s[76:79], s53 offen offset:320
    buffer_load_ushort v105, v185, s[76:79], s53 offen offset:576
    buffer_load_ushort v137, v185, s[76:79], s53 offen offset:832
    buffer_load_ushort v108, v185, s[76:79], s53 offen offset:96
    buffer_load_ushort v140, v185, s[76:79], s53 offen offset:352
    buffer_load_ushort v109, v185, s[76:79], s53 offen offset:608
    buffer_load_ushort v141, v185, s[76:79], s53 offen offset:864
    buffer_load_ushort v112, v185, s[76:79], s53 offen offset:128
    buffer_load_ushort v144, v185, s[76:79], s53 offen offset:384
    buffer_load_ushort v113, v185, s[76:79], s53 offen offset:640
    buffer_load_ushort v145, v185, s[76:79], s53 offen offset:896
    buffer_load_ushort v116, v185, s[76:79], s53 offen offset:160
    buffer_load_ushort v148, v185, s[76:79], s53 offen offset:416
    buffer_load_ushort v117, v185, s[76:79], s53 offen offset:672
    buffer_load_ushort v149, v185, s[76:79], s53 offen offset:928
    buffer_load_ushort v120, v185, s[76:79], s53 offen offset:192
    buffer_load_ushort v152, v185, s[76:79], s53 offen offset:448
    buffer_load_ushort v121, v185, s[76:79], s53 offen offset:704
    buffer_load_ushort v153, v185, s[76:79], s53 offen offset:960
    buffer_load_ushort v124, v185, s[76:79], s53 offen offset:224
    buffer_load_ushort v156, v185, s[76:79], s53 offen offset:480
    buffer_load_ushort v125, v185, s[76:79], s53 offen offset:736
    buffer_load_ushort v157, v185, s[76:79], s53 offen offset:992
    s_waitcnt vmcnt(0)
    s_add_u32 s53, s52, 4096
    buffer_load_ushort v98, v185, s[76:79], s53 offen offset:0
    buffer_load_ushort v130, v185, s[76:79], s53 offen offset:256
    buffer_load_ushort v99, v185, s[76:79], s53 offen offset:512
    buffer_load_ushort v131, v185, s[76:79], s53 offen offset:768
    buffer_load_ushort v102, v185, s[76:79], s53 offen offset:32
    buffer_load_ushort v134, v185, s[76:79], s53 offen offset:288
    buffer_load_ushort v103, v185, s[76:79], s53 offen offset:544
    buffer_load_ushort v135, v185, s[76:79], s53 offen offset:800
    buffer_load_ushort v106, v185, s[76:79], s53 offen offset:64
    buffer_load_ushort v138, v185, s[76:79], s53 offen offset:320
    buffer_load_ushort v107, v185, s[76:79], s53 offen offset:576
    buffer_load_ushort v139, v185, s[76:79], s53 offen offset:832
    buffer_load_ushort v110, v185, s[76:79], s53 offen offset:96
    buffer_load_ushort v142, v185, s[76:79], s53 offen offset:352
    buffer_load_ushort v111, v185, s[76:79], s53 offen offset:608
    buffer_load_ushort v143, v185, s[76:79], s53 offen offset:864
    buffer_load_ushort v114, v185, s[76:79], s53 offen offset:128
    buffer_load_ushort v146, v185, s[76:79], s53 offen offset:384
    buffer_load_ushort v115, v185, s[76:79], s53 offen offset:640
    buffer_load_ushort v147, v185, s[76:79], s53 offen offset:896
    buffer_load_ushort v118, v185, s[76:79], s53 offen offset:160
    buffer_load_ushort v150, v185, s[76:79], s53 offen offset:416
    buffer_load_ushort v119, v185, s[76:79], s53 offen offset:672
    buffer_load_ushort v151, v185, s[76:79], s53 offen offset:928
    buffer_load_ushort v122, v185, s[76:79], s53 offen offset:192
    buffer_load_ushort v154, v185, s[76:79], s53 offen offset:448
    buffer_load_ushort v123, v185, s[76:79], s53 offen offset:704
    buffer_load_ushort v155, v185, s[76:79], s53 offen offset:960
    buffer_load_ushort v126, v185, s[76:79], s53 offen offset:224
    buffer_load_ushort v158, v185, s[76:79], s53 offen offset:480
    buffer_load_ushort v127, v185, s[76:79], s53 offen offset:736
    buffer_load_ushort v159, v185, s[76:79], s53 offen offset:992
    s_waitcnt vmcnt(0)
    v_lshl_or_b32 v96, v128, 16, v96
    v_lshl_or_b32 v97, v129, 16, v97
    v_lshl_or_b32 v98, v130, 16, v98
    v_lshl_or_b32 v99, v131, 16, v99
    v_lshl_or_b32 v100, v132, 16, v100
    v_lshl_or_b32 v101, v133, 16, v101
    v_lshl_or_b32 v102, v134, 16, v102
    v_lshl_or_b32 v103, v135, 16, v103
    v_lshl_or_b32 v104, v136, 16, v104
    v_lshl_or_b32 v105, v137, 16, v105
    v_lshl_or_b32 v106, v138, 16, v106
    v_lshl_or_b32 v107, v139, 16, v107
    v_lshl_or_b32 v108, v140, 16, v108
    v_lshl_or_b32 v109, v141, 16, v109
    v_lshl_or_b32 v110, v142, 16, v110
    v_lshl_or_b32 v111, v143, 16, v111
    v_lshl_or_b32 v112, v144, 16, v112
    v_lshl_or_b32 v113, v145, 16, v113
    v_lshl_or_b32 v114, v146, 16, v114
    v_lshl_or_b32 v115, v147, 16, v115
    v_lshl_or_b32 v116, v148, 16, v116
    v_lshl_or_b32 v117, v149, 16, v117
    v_lshl_or_b32 v118, v150, 16, v118
    v_lshl_or_b32 v119, v151, 16, v119
    v_lshl_or_b32 v120, v152, 16, v120
    v_lshl_or_b32 v121, v153, 16, v121
    v_lshl_or_b32 v122, v154, 16, v122
    v_lshl_or_b32 v123, v155, 16, v123
    v_lshl_or_b32 v124, v156, 16, v124
    v_lshl_or_b32 v125, v157, 16, v125
    v_lshl_or_b32 v126, v158, 16, v126
    v_lshl_or_b32 v127, v159, 16, v127
    v_mfma_f32_16x16x32_bf16 v[160:163], v[64:67], a[192:195], v[40:43]
    v_mfma_f32_16x16x32_bf16 v[160:163], v[68:71], a[196:199], v[160:163]
    v_mfma_f32_16x16x32_bf16 v[160:163], v[72:75], a[200:203], v[160:163]
    v_mfma_f32_16x16x32_bf16 v[160:163], v[76:79], a[204:207], v[160:163]
    v_mfma_f32_16x16x32_bf16 v[164:167], v[80:83], a[192:195], v[40:43]
    v_mfma_f32_16x16x32_bf16 v[164:167], v[84:87], a[196:199], v[164:167]
    v_mfma_f32_16x16x32_bf16 v[164:167], v[88:91], a[200:203], v[164:167]
    v_mfma_f32_16x16x32_bf16 v[164:167], v[92:95], a[204:207], v[164:167]
    s_nop 7
    s_nop 3
    v_exp_f32 v160, v160
    v_exp_f32 v161, v161
    v_exp_f32 v162, v162
    v_exp_f32 v163, v163
    v_exp_f32 v164, v164
    v_exp_f32 v165, v165
    v_exp_f32 v166, v166
    v_exp_f32 v167, v167
    s_nop 0
    v_cvt_pk_bf16_f32 v176, v160, v161
    v_cvt_pk_bf16_f32 v177, v162, v163
    v_cvt_pk_bf16_f32 v178, v164, v165
    v_cvt_pk_bf16_f32 v179, v166, v167
    s_nop 1
    v_mfma_f32_16x16x32_bf16 a[0:3], v[96:99], v[176:179], a[0:3]
    v_mfma_f32_16x16x32_bf16 a[4:7], v[100:103], v[176:179], a[4:7]
    v_mfma_f32_16x16x32_bf16 a[8:11], v[104:107], v[176:179], a[8:11]
    v_mfma_f32_16x16x32_bf16 a[12:15], v[108:111], v[176:179], a[12:15]
    v_mfma_f32_16x16x32_bf16 a[16:19], v[112:115], v[176:179], a[16:19]
    v_mfma_f32_16x16x32_bf16 a[20:23], v[116:119], v[176:179], a[20:23]
    v_mfma_f32_16x16x32_bf16 a[24:27], v[120:123], v[176:179], a[24:27]
    v_mfma_f32_16x16x32_bf16 a[28:31], v[124:127], v[176:179], a[28:31]
    v_mfma_f32_16x16x32_bf16 v[208:211], v[34:37], v[176:179], v[208:211]
    s_nop 3
    v_mfma_f32_16x16x32_bf16 v[160:163], v[64:67], a[208:211], v[44:47]
    v_mfma_f32_16x16x32_bf16 v[160:163], v[68:71], a[212:215], v[160:163]
    v_mfma_f32_16x16x32_bf16 v[160:163], v[72:75], a[216:219], v[160:163]
    v_mfma_f32_16x16x32_bf16 v[160:163], v[76:79], a[220:223], v[160:163]
    v_mfma_f32_16x16x32_bf16 v[164:167], v[80:83], a[208:211], v[44:47]
    v_mfma_f32_16x16x32_bf16 v[164:167], v[84:87], a[212:215], v[164:167]
    v_mfma_f32_16x16x32_bf16 v[164:167], v[88:91], a[216:219], v[164:167]
    v_mfma_f32_16x16x32_bf16 v[164:167], v[92:95], a[220:223], v[164:167]
    s_nop 7
    s_nop 3
    v_exp_f32 v160, v160
    v_exp_f32 v161, v161
    v_exp_f32 v162, v162
    v_exp_f32 v163, v163
    v_exp_f32 v164, v164
    v_exp_f32 v165, v165
    v_exp_f32 v166, v166
    v_exp_f32 v167, v167
    s_nop 0
    v_cvt_pk_bf16_f32 v176, v160, v161
    v_cvt_pk_bf16_f32 v177, v162, v163
    v_cvt_pk_bf16_f32 v178, v164, v165
    v_cvt_pk_bf16_f32 v179, v166, v167
    s_nop 1
    v_mfma_f32_16x16x32_bf16 a[32:35], v[96:99], v[176:179], a[32:35]
    v_mfma_f32_16x16x32_bf16 a[36:39], v[100:103], v[176:179], a[36:39]
    v_mfma_f32_16x16x32_bf16 a[40:43], v[104:107], v[176:179], a[40:43]
    v_mfma_f32_16x16x32_bf16 a[44:47], v[108:111], v[176:179], a[44:47]
    v_mfma_f32_16x16x32_bf16 a[48:51], v[112:115], v[176:179], a[48:51]
    v_mfma_f32_16x16x32_bf16 a[52:55], v[116:119], v[176:179], a[52:55]
    v_mfma_f32_16x16x32_bf16 a[56:59], v[120:123], v[176:179], a[56:59]
    v_mfma_f32_16x16x32_bf16 a[60:63], v[124:127], v[176:179], a[60:63]
    v_mfma_f32_16x16x32_bf16 v[212:215], v[34:37], v[176:179], v[212:215]
    s_nop 3
    v_mfma_f32_16x16x32_bf16 v[160:163], v[64:67], a[224:227], v[48:51]
    v_mfma_f32_16x16x32_bf16 v[160:163], v[68:71], a[228:231], v[160:163]
    v_mfma_f32_16x16x32_bf16 v[160:163], v[72:75], a[232:235], v[160:163]
    v_mfma_f32_16x16x32_bf16 v[160:163], v[76:79], a[236:239], v[160:163]
    v_mfma_f32_16x16x32_bf16 v[164:167], v[80:83], a[224:227], v[48:51]
    v_mfma_f32_16x16x32_bf16 v[164:167], v[84:87], a[228:231], v[164:167]
    v_mfma_f32_16x16x32_bf16 v[164:167], v[88:91], a[232:235], v[164:167]
    v_mfma_f32_16x16x32_bf16 v[164:167], v[92:95], a[236:239], v[164:167]
    s_nop 7
    s_nop 3
    v_exp_f32 v160, v160
    v_exp_f32 v161, v161
    v_exp_f32 v162, v162
    v_exp_f32 v163, v163
    v_exp_f32 v164, v164
    v_exp_f32 v165, v165
    v_exp_f32 v166, v166
    v_exp_f32 v167, v167
    s_nop 0
    v_cvt_pk_bf16_f32 v176, v160, v161
    v_cvt_pk_bf16_f32 v177, v162, v163
    v_cvt_pk_bf16_f32 v178, v164, v165
    v_cvt_pk_bf16_f32 v179, v166, v167
    s_nop 1
    v_mfma_f32_16x16x32_bf16 a[64:67], v[96:99], v[176:179], a[64:67]
    v_mfma_f32_16x16x32_bf16 a[68:71], v[100:103], v[176:179], a[68:71]
    v_mfma_f32_16x16x32_bf16 a[72:75], v[104:107], v[176:179], a[72:75]
    v_mfma_f32_16x16x32_bf16 a[76:79], v[108:111], v[176:179], a[76:79]
    v_mfma_f32_16x16x32_bf16 a[80:83], v[112:115], v[176:179], a[80:83]
    v_mfma_f32_16x16x32_bf16 a[84:87], v[116:119], v[176:179], a[84:87]
    v_mfma_f32_16x16x32_bf16 a[88:91], v[120:123], v[176:179], a[88:91]
    v_mfma_f32_16x16x32_bf16 a[92:95], v[124:127], v[176:179], a[92:95]
    v_mfma_f32_16x16x32_bf16 v[216:219], v[34:37], v[176:179], v[216:219]
    s_nop 3
    v_mfma_f32_16x16x32_bf16 v[160:163], v[64:67], a[240:243], v[52:55]
    v_mfma_f32_16x16x32_bf16 v[160:163], v[68:71], a[244:247], v[160:163]
    v_mfma_f32_16x16x32_bf16 v[160:163], v[72:75], a[248:251], v[160:163]
    v_mfma_f32_16x16x32_bf16 v[160:163], v[76:79], a[252:255], v[160:163]
    v_mfma_f32_16x16x32_bf16 v[164:167], v[80:83], a[240:243], v[52:55]
    v_mfma_f32_16x16x32_bf16 v[164:167], v[84:87], a[244:247], v[164:167]
    v_mfma_f32_16x16x32_bf16 v[164:167], v[88:91], a[248:251], v[164:167]
    v_mfma_f32_16x16x32_bf16 v[164:167], v[92:95], a[252:255], v[164:167]
    s_nop 7
    s_nop 3
    v_exp_f32 v160, v160
    v_exp_f32 v161, v161
    v_exp_f32 v162, v162
    v_exp_f32 v163, v163
    v_exp_f32 v164, v164
    v_exp_f32 v165, v165
    v_exp_f32 v166, v166
    v_exp_f32 v167, v167
    s_nop 0
    v_cvt_pk_bf16_f32 v176, v160, v161
    v_cvt_pk_bf16_f32 v177, v162, v163
    v_cvt_pk_bf16_f32 v178, v164, v165
    v_cvt_pk_bf16_f32 v179, v166, v167
    s_nop 1
    v_mfma_f32_16x16x32_bf16 a[96:99], v[96:99], v[176:179], a[96:99]
    v_mfma_f32_16x16x32_bf16 a[100:103], v[100:103], v[176:179], a[100:103]
    v_mfma_f32_16x16x32_bf16 a[104:107], v[104:107], v[176:179], a[104:107]
    v_mfma_f32_16x16x32_bf16 a[108:111], v[108:111], v[176:179], a[108:111]
    v_mfma_f32_16x16x32_bf16 a[112:115], v[112:115], v[176:179], a[112:115]
    v_mfma_f32_16x16x32_bf16 a[116:119], v[116:119], v[176:179], a[116:119]
    v_mfma_f32_16x16x32_bf16 a[120:123], v[120:123], v[176:179], a[120:123]
    v_mfma_f32_16x16x32_bf16 a[124:127], v[124:127], v[176:179], a[124:127]
    v_mfma_f32_16x16x32_bf16 v[220:223], v[34:37], v[176:179], v[220:223]
    s_nop 3
    v_mfma_f32_16x16x32_bf16 v[160:163], v[64:67], v[192:195], v[56:59]
    v_mfma_f32_16x16x32_bf16 v[160:163], v[68:71], v[196:199], v[160:163]
    v_mfma_f32_16x16x32_bf16 v[160:163], v[72:75], v[200:203], v[160:163]
    v_mfma_f32_16x16x32_bf16 v[160:163], v[76:79], v[204:207], v[160:163]
    v_mfma_f32_16x16x32_bf16 v[164:167], v[80:83], v[192:195], v[56:59]
    v_mfma_f32_16x16x32_bf16 v[164:167], v[84:87], v[196:199], v[164:167]
    v_mfma_f32_16x16x32_bf16 v[164:167], v[88:91], v[200:203], v[164:167]
    v_mfma_f32_16x16x32_bf16 v[164:167], v[92:95], v[204:207], v[164:167]
    s_nop 7
    s_nop 3
    v_exp_f32 v160, v160
    v_exp_f32 v161, v161
    v_exp_f32 v162, v162
    v_exp_f32 v163, v163
    v_exp_f32 v164, v164
    v_exp_f32 v165, v165
    v_exp_f32 v166, v166
    v_exp_f32 v167, v167
    s_nop 0
    v_cvt_pk_bf16_f32 v176, v160, v161
    v_cvt_pk_bf16_f32 v177, v162, v163
    v_cvt_pk_bf16_f32 v178, v164, v165
    v_cvt_pk_bf16_f32 v179, v166, v167
    s_nop 1
    v_mfma_f32_16x16x32_bf16 a[128:131], v[96:99], v[176:179], a[128:131]
    v_mfma_f32_16x16x32_bf16 a[132:135], v[100:103], v[176:179], a[132:135]
    v_mfma_f32_16x16x32_bf16 a[136:139], v[104:107], v[176:179], a[136:139]
    v_mfma_f32_16x16x32_bf16 a[140:143], v[108:111], v[176:179], a[140:143]
    v_mfma_f32_16x16x32_bf16 a[144:147], v[112:115], v[176:179], a[144:147]
    v_mfma_f32_16x16x32_bf16 a[148:151], v[116:119], v[176:179], a[148:151]
    v_mfma_f32_16x16x32_bf16 a[152:155], v[120:123], v[176:179], a[152:155]
    v_mfma_f32_16x16x32_bf16 a[156:159], v[124:127], v[176:179], a[156:159]
    v_mfma_f32_16x16x32_bf16 v[240:243], v[34:37], v[176:179], v[240:243]
    s_nop 3
    v_mfma_f32_16x16x32_bf16 v[160:163], v[64:67], v[224:227], v[60:63]
    v_mfma_f32_16x16x32_bf16 v[160:163], v[68:71], v[228:231], v[160:163]
    v_mfma_f32_16x16x32_bf16 v[160:163], v[72:75], v[232:235], v[160:163]
    v_mfma_f32_16x16x32_bf16 v[160:163], v[76:79], v[236:239], v[160:163]
    v_mfma_f32_16x16x32_bf16 v[164:167], v[80:83], v[224:227], v[60:63]
    v_mfma_f32_16x16x32_bf16 v[164:167], v[84:87], v[228:231], v[164:167]
    v_mfma_f32_16x16x32_bf16 v[164:167], v[88:91], v[232:235], v[164:167]
    v_mfma_f32_16x16x32_bf16 v[164:167], v[92:95], v[236:239], v[164:167]
    s_nop 7
    s_nop 3
    v_exp_f32 v160, v160
    v_exp_f32 v161, v161
    v_exp_f32 v162, v162
    v_exp_f32 v163, v163
    v_exp_f32 v164, v164
    v_exp_f32 v165, v165
    v_exp_f32 v166, v166
    v_exp_f32 v167, v167
    s_nop 0
    v_cvt_pk_bf16_f32 v176, v160, v161
    v_cvt_pk_bf16_f32 v177, v162, v163
    v_cvt_pk_bf16_f32 v178, v164, v165
    v_cvt_pk_bf16_f32 v179, v166, v167
    s_nop 1
    v_mfma_f32_16x16x32_bf16 a[160:163], v[96:99], v[176:179], a[160:163]
    v_mfma_f32_16x16x32_bf16 a[164:167], v[100:103], v[176:179], a[164:167]
    v_mfma_f32_16x16x32_bf16 a[168:171], v[104:107], v[176:179], a[168:171]
    v_mfma_f32_16x16x32_bf16 a[172:175], v[108:111], v[176:179], a[172:175]
    v_mfma_f32_16x16x32_bf16 a[176:179], v[112:115], v[176:179], a[176:179]
    v_mfma_f32_16x16x32_bf16 a[180:183], v[116:119], v[176:179], a[180:183]
    v_mfma_f32_16x16x32_bf16 a[184:187], v[120:123], v[176:179], a[184:187]
    v_mfma_f32_16x16x32_bf16 a[188:191], v[124:127], v[176:179], a[188:191]
    v_mfma_f32_16x16x32_bf16 v[244:247], v[34:37], v[176:179], v[244:247]
    s_nop 3
    s_add_u32 s52, s52, 8192
    s_cmp_lg_u32 s52, 131072
    s_cbranch_scc1 L_slow2
    s_nop 7
    s_nop 3
    s_cmp_eq_u32 s7, 1
    s_cbranch_scc1 L_slowret1
    s_branch L_slowret
.section .rodata,"a"
.p2align 6
.amdhsa_kernel concat_heads__mha_block_cached__mha_block_cached__near_ridge_kernel
  .amdhsa_next_free_vgpr 512
  .amdhsa_next_free_sgpr 102
  .amdhsa_accum_offset 256
  .amdhsa_group_segment_fixed_size 0
  .amdhsa_float_denorm_mode_32 3
  .amdhsa_kernarg_size 104
  .amdhsa_user_sgpr_count 2
  .amdhsa_user_sgpr_kernarg_segment_ptr 1
  .amdhsa_system_sgpr_workgroup_id_x 1
.end_amdhsa_kernel
```
